```python
import torch

def _softmax(x, axis=-1):
    return torch.softmax(x, dim=axis)
def _gelu(x):
    return torch.nn.functional.gelu(x, approximate="tanh")
def _silu(x):
    return torch.nn.functional.silu(x)
def _sigmoid(x):
    return torch.sigmoid(x)
def _layernorm(x, axis=-1, eps=1e-5):
    m = x.mean(dim=axis, keepdim=True)
    v = x.var(dim=axis, keepdim=True, unbiased=False)
    return (x - m) / torch.sqrt(v + eps)
def _scatter_add(tgt, idx, src, axis=0):
    return tgt.clone().index_add_(axis, idx, src)
def _segment_sum(src, seg, n):
    out = torch.zeros((n,) + src.shape[1:], dtype=src.dtype)
    return out.index_add_(0, seg, src)
def _pad(x, pw):
    flat = tuple(v for pair in reversed(pw) for v in pair)
    return torch.nn.functional.pad(x, flat)

kernel_name = 'concat_heads__gqa_block_cached__mha_block_cached__near_ridge'

def setup_inputs():

    _w = (lambda a: (lambda t: t.to(torch.bfloat16) if t.is_floating_point() else t)(torch.as_tensor(a)))
    def _A_setup():
        B, Sq, D = 8, 144, 576
        Hq, Hkv, Sk, Dh = 32, 16, 1024, 128
        assert Hq % Hkv == 0, (Hq, Hkv)
        return {
            "x": _w((lambda *s: torch.randn(*s, dtype=torch.bfloat16) * 0.8)(B, Sq, D)),
            "k_cache": _w((lambda *s: torch.randn(*s, dtype=torch.bfloat16) * 0.8)(B, Hkv, Sk, Dh)),
            "v_cache": _w((lambda *s: torch.randn(*s, dtype=torch.bfloat16) * 0.05)(B, Hkv, Sk, Dh)),
            "wq": _w((lambda *s: torch.randn(*s, dtype=torch.bfloat16) * 0.8)(D, Hq * Dh) * (D ** -0.5)),
            "wo": _w((lambda *s: torch.randn(*s, dtype=torch.bfloat16) * 0.05)(Hq * Dh, D) * ((Hq * Dh) ** -0.5)),
        }
    _A_in = _A_setup()

    def _B_setup():
        B, Sq, D = 8, 144, 576
        H, Sk, Dh = 32, 1024, 128
        return {
            "x": _w((lambda *s: torch.randn(*s, dtype=torch.bfloat16) * 0.8)(B, Sq, D)),
            "k_cache": _w((lambda *s: torch.randn(*s, dtype=torch.bfloat16) * 0.8)(B, H, Sk, Dh)),
            "v_cache": _w((lambda *s: torch.randn(*s, dtype=torch.bfloat16) * 0.05)(B, H, Sk, Dh)),
            "wq": _w((lambda *s: torch.randn(*s, dtype=torch.bfloat16) * 0.8)(D, H * Dh) * (D ** -0.5)),
            "wo": _w((lambda *s: torch.randn(*s, dtype=torch.bfloat16) * 0.05)(H * Dh, D) * ((H * Dh) ** -0.5)),
        }
    _B_in = _B_setup()

    return {
        "A_x": _A_in["x"],
        "A_k_cache": _A_in["k_cache"],
        "A_v_cache": _A_in["v_cache"],
        "A_wq": _A_in["wq"],
        "A_wo": _A_in["wo"],
        "B_x": _B_in["x"],
        "B_k_cache": _B_in["k_cache"],
        "B_v_cache": _B_in["v_cache"],
        "B_wq": _B_in["wq"],
        "B_wo": _B_in["wo"],
    }

def reference(A_x, A_k_cache, A_v_cache, A_wq, A_wo, B_x, B_k_cache, B_v_cache, B_wq, B_wo):
    def _A_ref(x, k_cache, v_cache, wq, wo):
        B, Sq, D = x.shape
        Hq, Dh = 32, 128
        Hkv = k_cache.shape[1]
        rep = Hq // Hkv
        q = (lambda x, *d: x.permute(*d))((x @ wq).reshape(B, Sq, Hq, Dh), 0, 2, 1, 3)
        k = (lambda x, n, axis: torch.repeat_interleave(x, n, dim=axis))(k_cache, rep, axis=1)
        v = (lambda x, n, axis: torch.repeat_interleave(x, n, dim=axis))(v_cache, rep, axis=1)
        scores = torch.einsum("bhqd,bhkd->bhqk", q, k) * (Dh ** -0.5)
        p = _softmax(scores, axis=-1)
        o = torch.einsum("bhqk,bhkd->bhqd", p, v)
        return (lambda x, *d: x.permute(*d))(o, 0, 2, 1, 3).reshape(B, Sq, Hq * Dh) @ wo

    def _B_ref(x, k_cache, v_cache, wq, wo):
        B, Sq, D = x.shape
        H, Dh = 32, 128
        q = (lambda x, *d: x.permute(*d))((x @ wq).reshape(B, Sq, H, Dh), 0, 2, 1, 3)
        scores = torch.einsum("bhqd,bhkd->bhqk", q, k_cache) * (Dh ** -0.5)
        p = _softmax(scores, axis=-1)
        o = torch.einsum("bhqk,bhkd->bhqd", p, v_cache)
        return (lambda x, *d: x.permute(*d))(o, 0, 2, 1, 3).reshape(B, Sq, H * Dh) @ wo

    a = _A_ref(A_x, A_k_cache, A_v_cache, A_wq, A_wo)
    b = _B_ref(B_x, B_k_cache, B_v_cache, B_wq, B_wo)
    return torch.concatenate([a, b], axis=-1)
```

```asm
; @launch grid=(256,1,1) block=(512,1,1) lds=163840
.amdgcn_target "amdgcn-amd-amdhsa--gfx950"
.text
.globl concat_heads__gqa_block_cached__mha_block_cached__near_ridge_kernel
.p2align 8
.type concat_heads__gqa_block_cached__mha_block_cached__near_ridge_kernel,@function
concat_heads__gqa_block_cached__mha_block_cached__near_ridge_kernel:
    s_cmp_ge_u32 s2, 256
    s_cbranch_scc1 K_END
    s_load_dwordx16 s[80:95], s[0:1], 0x0
    s_load_dwordx4 s[96:99], s[0:1], 0x40
    s_load_dwordx4 s[76:79], s[0:1], 0x50
    s_load_dwordx2 s[74:75], s[0:1], 0x60
    v_and_b32 v254, 63, v0
    v_lshrrev_b32 v1, 6, v0
    s_and_b32 s51, s2, 7
    v_readfirstlane_b32 s36, v1
    s_lshr_b32 s52, s2, 3
    s_bfe_u32 s39, s52, 0x30001
    s_lshr_b32 s53, s52, 4
    s_lshl_b32 s51, s51, 1
    s_add_u32 s40, s53, s51
    s_bcnt1_i32_b32 s41, s52
    s_and_b32 s41, s41, 1
    s_lshr_b32 s37, s36, 2
    s_and_b32 s38, s36, 3
    v_lshrrev_b32 v1, 4, v254
    v_bfe_u32 v2, v254, 2, 2
    v_and_b32 v3, 3, v254
    v_lshrrev_b32 v4, 5, v254
    v_bfe_u32 v5, v254, 4, 1
    v_and_b32 v6, 7, v254
    v_bfe_u32 v7, v254, 3, 2
    v_lshlrev_b32 v8, 2, v5
    v_xor_b32 v8, v8, v6
    v_lshlrev_b32 v8, 4, v8
    v_lshl_add_u32 v11, v4, 7, v8
    v_lshl_add_u32 v8, v7, 13, v11
    s_and_b32 s50, s36, 1
    s_lshl_b32 s51, s50, 15
    s_lshl_b32 s52, s37, 8
    s_add_u32 s51, s51, s52
    v_add_u32 v206, s51, v8
    s_sub_u32 s61, s36, 2
    v_lshrrev_b32 v10, 3, v254
    v_mul_u32_u24 v10, 0x480, v10
    v_xor_b32 v9, v6, v1
    v_lshl_add_u32 v8, v9, 4, v10
    s_and_b32 s51, s36, 1
    s_lshl_b32 s51, s51, 2
    v_xor_b32 v8, s51, v9
    v_lshl_add_u32 v8, v8, 4, v10
    s_mul_i32 s51, s61, 9216
    v_add_u32 v207, s51, v8
    s_lshl_b32 s51, s37, 2
    v_xor_b32 v8, s51, v9
    v_lshl_add_u32 v8, v8, 4, v10
    s_mul_i32 s51, s37, 9216
    s_add_u32 s51, s51, 147456
    v_add_u32 v208, s51, v8
    s_lshl_b32 s60, s37, 13
    s_lshl_b32 s51, s50, 10
    s_add_u32 s60, s60, s51
    s_lshl_b32 s61, s61, 10
    s_lshl_b32 s43, s37, 10
    s_add_u32 s43, s43, 0x4000
    s_lshl_b32 s51, s50, 5
    s_mov_b32 s54, -1
    s_mov_b32 s55, 0
    s_lshl_b64 s[54:55], s[54:55], s51
    s_mul_i32 s63, s2, 5
    s_lshr_b32 s51, s2, 5
    s_add_u32 s63, s63, s51
    s_lshl_b32 s51, s37, 4
    s_mul_i32 s51, s51, s41
    s_add_u32 s63, s63, s51
    s_and_b32 s63, s63, 31
    s_lshl_b32 s63, s63, 13
    s_waitcnt lgkmcnt(0)
    s_cmp_eq_u32 s41, 0
    s_cselect_b64 s[4:5], s[80:81], s[90:91]
    s_cselect_b64 s[12:13], s[82:83], s[92:93]
    s_cselect_b64 s[16:17], s[84:85], s[94:95]
    s_cselect_b64 s[8:9], s[86:87], s[96:97]
    s_cselect_b64 s[20:21], s[88:89], s[98:99]
    s_lshl_b32 s51, s40, 9
    s_add_u32 s8, s8, s51
    s_addc_u32 s9, s9, 0
    s_sub_u32 s10, 4718592, s51
    s_mov_b32 s11, 0x20000
    s_mul_i32 s51, s39, 165888
    s_add_u32 s4, s4, s51
    s_addc_u32 s5, s5, 0
    s_mov_b32 s6, 165888
    s_mov_b32 s7, 0x20000
    s_add_u32 s57, s36, 2
    s_and_b32 s57, s57, 7
    s_cmp_lt_u32 s57, 4
    s_cbranch_scc1 INIT_H
    s_mov_b32 s52, 0x0
    s_add_u32 m0, s60, 0x0
    s_nop 0
    buffer_load_dwordx4 v206, s[8:11], s52 offen nt lds
    s_add_u32 m0, m0, 0x800
    s_add_u32 s51, s52, 0x10000
    buffer_load_dwordx4 v206, s[8:11], s51 offen nt lds
    s_add_u32 m0, m0, 0x800
    s_add_u32 s51, s52, 0x20000
    buffer_load_dwordx4 v206, s[8:11], s51 offen nt lds
    s_add_u32 m0, m0, 0x800
    s_add_u32 s51, s52, 0x30000
    buffer_load_dwordx4 v206, s[8:11], s51 offen nt lds
    s_mov_b32 s52, 0x40000
    s_add_u32 m0, s60, 0x4000
    s_nop 0
    buffer_load_dwordx4 v206, s[8:11], s52 offen nt lds
    s_add_u32 m0, m0, 0x800
    s_add_u32 s51, s52, 0x10000
    buffer_load_dwordx4 v206, s[8:11], s51 offen nt lds
    s_add_u32 m0, m0, 0x800
    s_add_u32 s51, s52, 0x20000
    buffer_load_dwordx4 v206, s[8:11], s51 offen nt lds
    s_add_u32 m0, m0, 0x800
    s_add_u32 s51, s52, 0x30000
    buffer_load_dwordx4 v206, s[8:11], s51 offen nt lds
    s_mov_b32 s52, 0x0
    s_add_u32 m0, s61, 0x8000
    s_nop 0
    buffer_load_dwordx4 v207, s[4:7], s52 offen nt lds
    s_add_u32 m0, m0, 0x1000
    s_add_u32 s51, s52, 0x9000
    buffer_load_dwordx4 v207, s[4:7], s51 offen nt lds
    s_add_u32 m0, m0, 0x1000
    s_add_u32 s51, s52, 0x12000
    buffer_load_dwordx4 v207, s[4:7], s51 offen nt lds
    s_add_u32 m0, m0, 0x1000
    s_add_u32 s51, s52, 0x1b000
    buffer_load_dwordx4 v207, s[4:7], s51 offen nt lds
    s_add_u32 m0, s43, 0x8000
    s_mov_b64 exec, s[54:55]
    buffer_load_dwordx4 v208, s[4:7], s52 offen nt lds
    s_mov_b64 exec, -1
    s_mov_b32 s52, 0x80000
    s_add_u32 m0, s60, 0xc800
    s_nop 0
    buffer_load_dwordx4 v206, s[8:11], s52 offen nt lds
    s_add_u32 m0, m0, 0x800
    s_add_u32 s51, s52, 0x10000
    buffer_load_dwordx4 v206, s[8:11], s51 offen nt lds
    s_add_u32 m0, m0, 0x800
    s_add_u32 s51, s52, 0x20000
    buffer_load_dwordx4 v206, s[8:11], s51 offen nt lds
    s_add_u32 m0, m0, 0x800
    s_add_u32 s51, s52, 0x30000
    buffer_load_dwordx4 v206, s[8:11], s51 offen nt lds
    s_mov_b32 s52, 0xc0000
    s_add_u32 m0, s60, 0x10800
    s_nop 0
    buffer_load_dwordx4 v206, s[8:11], s52 offen nt lds
    s_add_u32 m0, m0, 0x800
    s_add_u32 s51, s52, 0x10000
    buffer_load_dwordx4 v206, s[8:11], s51 offen nt lds
    s_add_u32 m0, m0, 0x800
    s_add_u32 s51, s52, 0x20000
    buffer_load_dwordx4 v206, s[8:11], s51 offen nt lds
    s_add_u32 m0, m0, 0x800
    s_add_u32 s51, s52, 0x30000
    buffer_load_dwordx4 v206, s[8:11], s51 offen nt lds
    s_mov_b32 s52, 0x80
    s_add_u32 m0, s61, 0x14800
    s_nop 0
    buffer_load_dwordx4 v207, s[4:7], s52 offen nt lds
    s_add_u32 m0, m0, 0x1000
    s_add_u32 s51, s52, 0x9000
    buffer_load_dwordx4 v207, s[4:7], s51 offen nt lds
    s_add_u32 m0, m0, 0x1000
    s_add_u32 s51, s52, 0x12000
    buffer_load_dwordx4 v207, s[4:7], s51 offen nt lds
    s_add_u32 m0, m0, 0x1000
    s_add_u32 s51, s52, 0x1b000
    buffer_load_dwordx4 v207, s[4:7], s51 offen nt lds
    s_add_u32 m0, s43, 0x14800
    s_mov_b64 exec, s[54:55]
    buffer_load_dwordx4 v208, s[4:7], s52 offen nt lds
    s_mov_b64 exec, -1
    s_mov_b32 s52, 0x100000
    s_add_u32 m0, s60, 0x19000
    s_nop 0
    buffer_load_dwordx4 v206, s[8:11], s52 offen nt lds
    s_add_u32 m0, m0, 0x800
    s_add_u32 s51, s52, 0x10000
    buffer_load_dwordx4 v206, s[8:11], s51 offen nt lds
    s_add_u32 m0, m0, 0x800
    s_add_u32 s51, s52, 0x20000
    buffer_load_dwordx4 v206, s[8:11], s51 offen nt lds
    s_add_u32 m0, m0, 0x800
    s_add_u32 s51, s52, 0x30000
    buffer_load_dwordx4 v206, s[8:11], s51 offen nt lds
INIT_H:
    s_lshl_b32 s51, s39, 4
    s_add_u32 s51, s51, s40
    s_lshl_b32 s52, s51, 1
    s_add_u32 s52, s52, s37
    s_cmp_eq_u32 s41, 0
    s_cselect_b32 s51, s51, s52
    s_lshl_b32 s51, s51, 18
    s_add_u32 s12, s12, s51
    s_addc_u32 s13, s13, 0
    s_mov_b32 s14, 0x40000
    s_mov_b32 s15, 0x20000
    s_add_u32 s16, s16, s51
    s_addc_u32 s17, s17, 0
    s_mov_b32 s18, 0x40000
    s_mov_b32 s19, 0x20000
    s_lshl_b32 s51, s39, 4
    s_add_u32 s51, s51, s40
    s_lshl_b32 s51, s51, 1
    s_add_u32 s51, s51, s37
    s_lshl_b32 s51, s51, 18
    s_cmp_eq_u32 s50, 0
    s_cselect_b64 s[28:29], s[92:93], s[94:95]
    s_cselect_b32 s73, 0x3, 0x2
    s_add_u32 s28, s28, s51
    s_addc_u32 s29, s29, 0
    s_cmp_eq_u32 s41, 0
    s_cselect_b32 s30, 0x40000, 0
    s_mov_b32 s31, 0x20000
    s_xor_b32 s51, s2, 8
    s_mul_i32 s52, s51, 5
    s_lshr_b32 s51, s51, 5
    s_add_u32 s52, s52, s51
    s_lshl_b32 s51, s37, 4
    s_add_u32 s52, s52, s51
    s_add_u32 s73, s73, s52
    s_and_b32 s73, s73, 31
    s_lshl_b32 s73, s73, 13
    s_mov_b32 s49, 0x800
    v_lshlrev_b32 v209, 5, v254
    v_mov_b32 v72, 0
    s_cmp_lt_u32 s57, 4
    s_cbranch_scc0 INIT_J
INIT_J:
    s_sub_u32 s59, s36, 2
    s_and_b32 s59, s59, 3
    s_cmp_eq_u32 s41, 0
    s_cselect_b32 s59, s59, s50
    s_lshl_b32 s59, s59, 10
    v_lshl_add_u32 v8, v7, 8, v11
    v_add_u32 v249, s59, v8
    s_lshr_b32 s51, s59, 9
    v_xor_b32 v8, v6, v5
    v_xor_b32 v8, s51, v8
    v_lshlrev_b32 v8, 4, v8
    v_lshl_add_u32 v8, v4, 7, v8
    v_lshl_add_u32 v8, v7, 8, v8
    v_add_u32 v248, s59, v8
    s_lshl_b32 s42, s37, 13
    s_mul_i32 s42, s42, s41
    s_mul_i32 s45, s41, 0x12000
    s_add_u32 s45, s45, s42
    s_mul_i32 s44, s41, 0xc000
    v_bfe_u32 v10, v254, 1, 1
    v_lshl_add_u32 v11, v2, 1, v10
    v_bfe_u32 v8, v254, 2, 3
    v_lshlrev_b32 v8, 10, v8
    v_lshl_add_u32 v8, v3, 7, v8
    v_xor_b32 v9, v4, v11
    v_lshl_add_u32 v8, v9, 4, v8
    v_add_u32 v238, s42, v8
    v_xor_b32 v239, 0x20, v238
    v_xor_b32 v240, 0x40, v238
    v_xor_b32 v241, 0x60, v238
    v_xor_b32 v9, v1, v11
    v_lshlrev_b32 v9, 4, v9
    v_lshl_add_u32 v9, v3, 7, v9
    v_lshl_add_u32 v244, v2, 10, v9
    v_add_u32 v244, s42, v244
    v_lshrrev_b32 v9, 1, v2
    v_lshlrev_b32 v9, 6, v9
    v_lshl_add_u32 v6, v2, 7, v9
    v_and_b32 v7, 1, v254
    v_lshl_add_u32 v8, v10, 4, v6
    v_lshl_add_u32 v8, v7, 3, v8
    v_add_u32 v8, 0x2000, v8
    v_add_u32 v8, s45, v8
    v_lshl_add_u32 v245, v1, 10, v8
    v_lshl_add_u32 v8, v5, 5, v8
    v_lshl_add_u32 v8, v4, 10, v8
    v_add_u32 v242, s44, v8
    s_add_u32 s59, s59, s42
    s_mov_b32 s42, 0
    v_xor_b32 v243, 64, v242
    v_lshl_add_u32 v8, v7, 4, v6
    v_lshl_add_u32 v8, v10, 3, v8
    v_lshl_add_u32 v8, v5, 5, v8
    v_lshl_add_u32 v8, v4, 11, v8
    s_lshl_b32 s51, s37, 13
    v_add_u32 v196, s51, v8
    v_lshl_add_u32 v8, v3, 4, v6
    s_and_b32 s52, s38, 1
    s_lshl_b32 s52, s52, 6
    v_xor_b32 v8, s52, v8
    v_lshl_add_u32 v8, v1, 11, v8
    s_lshr_b32 s52, s38, 1
    s_lshl_b32 s52, s52, 9
    s_add_u32 s52, s52, s51
    v_add_u32 v197, s52, v8
    v_bfe_u32 v10, v254, 1, 3
    v_and_b32 v8, 31, v254
    v_lshlrev_b32 v8, 7, v8
    v_xor_b32 v9, v4, v10
    v_lshl_add_u32 v8, v9, 4, v8
    s_lshl_b32 s52, s38, 12
    s_add_u32 s52, s52, 0x8000
    v_add_u32 v198, s52, v8
    v_and_b32 v8, 15, v254
    v_lshlrev_b32 v8, 7, v8
    v_xor_b32 v9, v1, v10
    v_lshl_add_u32 v8, v9, 4, v8
    v_add_u32 v199, 0xc000, v8
    s_mov_b32 s56, 0x3e0293ee
    s_mov_b32 s58, 0x41000000
    s_lshr_b32 s51, s40, 2
    s_mul_i32 s51, s51, 1179648
    s_and_b32 s52, s40, 3
    s_lshr_b32 s53, s52, 1
    s_lshl_b32 s52, s52, 2
    s_add_u32 s52, s52, s53
    s_lshl_b32 s52, s52, 6
    s_add_u32 s51, s51, s52
    s_add_u32 s20, s20, s51
    s_addc_u32 s21, s21, 0
    s_sub_u32 s22, 1179648, s52
    s_mov_b32 s23, 0x20000
    s_lshl_b32 s51, s41, 3
    s_add_u32 s51, s51, s39
    s_lshl_b32 s51, s51, 12
    s_add_u32 s51, s51, 0x3000000
    s_add_u32 s96, s74, s51
    s_addc_u32 s97, s75, 0
    s_mov_b32 s98, 4096
    s_mov_b32 s99, 0x20000
    s_cmp_lg_u32 s36, 0
    s_cbranch_scc1 NOCLR
    s_lshl_b32 s51, s40, 8
    v_mov_b32 v8, 0
    v_lshlrev_b32 v9, 2, v254
    buffer_store_dword v8, v9, s[96:99], s51 offen sc1
NOCLR:
    s_cmp_eq_u32 s41, 0
    s_mov_b32 s51, 0x9800
    s_cselect_b32 s64, s51, 0x9800
    s_mov_b32 s51, 0x13000
    s_cselect_b32 s65, s51, 0x0
    s_mov_b32 s51, 0x1c800
    s_cselect_b32 s66, s51, 0x13000
    s_mov_b32 s51, 0x0
    s_cselect_b32 s67, s51, 0x1c800
    v_mov_b32 v64, 0
    v_mov_b32 v65, 0
    v_mov_b32 v66, 0
    v_mov_b32 v67, 0
    v_mov_b32 v68, 0
    v_mov_b32 v69, 0
    v_mov_b32 v70, 0
    v_mov_b32 v71, 0
    s_mov_b32 s69, 0
    s_mov_b32 s70, 0x1d000
    s_mov_b32 s71, 0x140000
    s_mov_b32 s47, 0x21000
    s_mov_b32 s72, 0x100
    s_mov_b32 s50, 6
    s_cmp_lt_u32 s57, 4
    s_cbranch_scc1 QH
    s_setprio 1
    v_add_u32 v200, s69, v196
    v_add_u32 v202, s69, v197
    v_add_u32 v203, s69, v198
    v_add_u32 v205, s69, v199
    v_xor_b32 v201, 64, v200
    v_xor_b32 v204, 32, v203
    s_waitcnt vmcnt(17) lgkmcnt(0)
    s_barrier
    ds_read_b64_tr_b16 v[144:145], v200 offset:0
    ds_read_b64_tr_b16 v[146:147], v200 offset:1024
    ds_read_b64_tr_b16 v[148:149], v201 offset:0
    ds_read_b64_tr_b16 v[150:151], v201 offset:1024
    ds_read_b64_tr_b16 v[152:153], v200 offset:512
    ds_read_b64_tr_b16 v[154:155], v200 offset:1536
    ds_read_b64_tr_b16 v[156:157], v201 offset:512
    ds_read_b64_tr_b16 v[158:159], v201 offset:1536
    ds_read_b128 v[160:163], v203
    s_add_u32 m0, s60, s70
    s_nop 0
    buffer_load_dwordx4 v206, s[8:11], s71 offen nt lds
    s_add_u32 m0, m0, 0x800
    s_add_u32 s51, s71, 0x10000
    buffer_load_dwordx4 v206, s[8:11], s51 offen nt lds
    s_add_u32 m0, m0, 0x800
    s_add_u32 s51, s71, 0x20000
    buffer_load_dwordx4 v206, s[8:11], s51 offen nt lds
    s_add_u32 m0, m0, 0x800
    s_add_u32 s51, s71, 0x30000
    buffer_load_dwordx4 v206, s[8:11], s51 offen nt lds
    s_add_u32 m0, s61, s47
    s_nop 0
    buffer_load_dwordx4 v207, s[4:7], s72 offen nt lds
    ds_read_b64_tr_b16 v[164:165], v200 offset:4096
    ds_read_b64_tr_b16 v[166:167], v200 offset:5120
    ds_read_b64_tr_b16 v[168:169], v201 offset:4096
    ds_read_b64_tr_b16 v[170:171], v201 offset:5120
    ds_read_b64_tr_b16 v[172:173], v200 offset:4608
    ds_read_b64_tr_b16 v[174:175], v200 offset:5632
    s_waitcnt lgkmcnt(6)
    v_mfma_f32_32x32x16_bf16 v[0:15], v[144:147], v[160:163], 0
    ds_read_b64_tr_b16 v[176:177], v201 offset:4608
    ds_read_b64_tr_b16 v[178:179], v201 offset:5632
    ds_read_b128 v[180:183], v204
    s_add_u32 m0, m0, 0x1000
    s_add_u32 s51, s72, 0x9000
    buffer_load_dwordx4 v207, s[4:7], s51 offen nt lds
    v_mfma_f32_32x32x16_bf16 v[16:31], v[148:151], v[160:163], 0
    ds_read_b64_tr_b16 v[184:185], v202 offset:0
    ds_read_b64_tr_b16 v[186:187], v202 offset:1024
    ds_read_b64_tr_b16 v[188:189], v202 offset:8
    s_add_u32 m0, m0, 0x1000
    s_add_u32 s51, s72, 0x12000
    buffer_load_dwordx4 v207, s[4:7], s51 offen nt lds
    v_mfma_f32_32x32x16_bf16 v[32:47], v[152:155], v[160:163], 0
    ds_read_b64_tr_b16 v[190:191], v202 offset:1032
    ds_read_b128 v[192:195], v205
    s_add_u32 m0, m0, 0x1000
    s_add_u32 s51, s72, 0x1b000
    buffer_load_dwordx4 v207, s[4:7], s51 offen nt lds
    v_mfma_f32_32x32x16_bf16 v[48:63], v[156:159], v[160:163], 0
    s_add_u32 m0, s43, s47
    s_mov_b64 exec, s[54:55]
    buffer_load_dwordx4 v208, s[4:7], s72 offen nt lds
    s_mov_b64 exec, -1
    s_add_u32 s70, s69, 0x0
    s_add_u32 s71, s71, 0x40000
    s_cmp_ge_u32 s71, 0x480000
    s_cselect_b32 s70, 0x30000, s70
    v_add_u32 v200, 0x4000, v200
    v_add_u32 v202, 0x4000, v202
    v_xor_b32 v203, 64, v203
    v_xor_b32 v205, 64, v205
    v_xor_b32 v201, 64, v200
    v_xor_b32 v204, 32, v203
    s_waitcnt lgkmcnt(0)
    s_barrier
    ds_read_b64_tr_b16 v[144:145], v200 offset:0
    ds_read_b64_tr_b16 v[146:147], v200 offset:1024
    ds_read_b64_tr_b16 v[148:149], v201 offset:0
    ds_read_b64_tr_b16 v[150:151], v201 offset:1024
    ds_read_b64_tr_b16 v[152:153], v200 offset:512
    ds_read_b64_tr_b16 v[154:155], v200 offset:1536
    ds_read_b64_tr_b16 v[156:157], v201 offset:512
    ds_read_b64_tr_b16 v[158:159], v201 offset:1536
    ds_read_b128 v[160:163], v203
    v_mfma_f32_32x32x16_bf16 v[0:15], v[164:167], v[180:183], v[0:15]
    s_add_u32 m0, s60, s70
    s_nop 0
    buffer_load_dwordx4 v206, s[8:11], s71 offen nt lds
    v_mfma_f32_32x32x16_bf16 v[16:31], v[168:171], v[180:183], v[16:31]
    s_add_u32 m0, m0, 0x800
    s_add_u32 s51, s71, 0x10000
    buffer_load_dwordx4 v206, s[8:11], s51 offen nt lds
    v_mfma_f32_32x32x16_bf16 v[32:47], v[172:175], v[180:183], v[32:47]
    s_add_u32 m0, m0, 0x800
    s_add_u32 s51, s71, 0x20000
    buffer_load_dwordx4 v206, s[8:11], s51 offen nt lds
    v_mfma_f32_32x32x16_bf16 v[48:63], v[176:179], v[180:183], v[48:63]
    s_add_u32 m0, m0, 0x800
    s_add_u32 s51, s71, 0x30000
    buffer_load_dwordx4 v206, s[8:11], s51 offen nt lds
    v_mfma_f32_16x16x32_bf16 v[64:67], v[184:187], v[192:195], v[64:67]
    v_mfma_f32_16x16x32_bf16 v[68:71], v[188:191], v[192:195], v[68:71]
    ds_read_b64_tr_b16 v[164:165], v200 offset:4096
    ds_read_b64_tr_b16 v[166:167], v200 offset:5120
    ds_read_b64_tr_b16 v[168:169], v201 offset:4096
    ds_read_b64_tr_b16 v[170:171], v201 offset:5120
    ds_read_b64_tr_b16 v[172:173], v200 offset:4608
    ds_read_b64_tr_b16 v[174:175], v200 offset:5632
    s_waitcnt lgkmcnt(6)
    v_mfma_f32_32x32x16_bf16 v[0:15], v[144:147], v[160:163], v[0:15]
    ds_read_b64_tr_b16 v[176:177], v201 offset:4608
    ds_read_b64_tr_b16 v[178:179], v201 offset:5632
    ds_read_b128 v[180:183], v204
    v_mfma_f32_32x32x16_bf16 v[16:31], v[148:151], v[160:163], v[16:31]
    ds_read_b64_tr_b16 v[184:185], v202 offset:0
    ds_read_b64_tr_b16 v[186:187], v202 offset:1024
    ds_read_b64_tr_b16 v[188:189], v202 offset:8
    v_mfma_f32_32x32x16_bf16 v[32:47], v[152:155], v[160:163], v[32:47]
    ds_read_b64_tr_b16 v[190:191], v202 offset:1032
    ds_read_b128 v[192:195], v205
    v_mfma_f32_32x32x16_bf16 v[48:63], v[156:159], v[160:163], v[48:63]
    s_add_u32 s70, s69, 0x4000
    s_add_u32 s71, s71, 0x40000
    s_cmp_ge_u32 s71, 0x480000
    s_cselect_b32 s70, 0x30000, s70
    s_add_u32 s47, s69, 0x8000
    s_add_u32 s72, s72, 128
    s_add_u32 s69, s69, 0xc800
    s_cmp_ge_u32 s69, 0x25800
    s_cselect_b32 s69, 0, s69
QLOOP1:
    v_add_u32 v200, s69, v196
    v_add_u32 v202, s69, v197
    v_add_u32 v203, s69, v198
    v_add_u32 v205, s69, v199
    v_xor_b32 v201, 64, v200
    v_xor_b32 v204, 32, v203
    s_waitcnt vmcnt(17) lgkmcnt(0)
    s_barrier
    ds_read_b64_tr_b16 v[144:145], v200 offset:0
    ds_read_b64_tr_b16 v[146:147], v200 offset:1024
    ds_read_b64_tr_b16 v[148:149], v201 offset:0
    ds_read_b64_tr_b16 v[150:151], v201 offset:1024
    ds_read_b64_tr_b16 v[152:153], v200 offset:512
    ds_read_b64_tr_b16 v[154:155], v200 offset:1536
    ds_read_b64_tr_b16 v[156:157], v201 offset:512
    ds_read_b64_tr_b16 v[158:159], v201 offset:1536
    ds_read_b128 v[160:163], v203
    v_mfma_f32_32x32x16_bf16 v[0:15], v[164:167], v[180:183], v[0:15]
    s_add_u32 m0, s60, s70
    s_nop 0
    buffer_load_dwordx4 v206, s[8:11], s71 offen nt lds
    v_mfma_f32_32x32x16_bf16 v[16:31], v[168:171], v[180:183], v[16:31]
    s_add_u32 m0, m0, 0x800
    s_add_u32 s51, s71, 0x10000
    buffer_load_dwordx4 v206, s[8:11], s51 offen nt lds
    v_mfma_f32_32x32x16_bf16 v[32:47], v[172:175], v[180:183], v[32:47]
    s_add_u32 m0, m0, 0x800
    s_add_u32 s51, s71, 0x20000
    buffer_load_dwordx4 v206, s[8:11], s51 offen nt lds
    v_mfma_f32_32x32x16_bf16 v[48:63], v[176:179], v[180:183], v[48:63]
    s_add_u32 m0, m0, 0x800
    s_add_u32 s51, s71, 0x30000
    buffer_load_dwordx4 v206, s[8:11], s51 offen nt lds
    v_mfma_f32_16x16x32_bf16 v[64:67], v[184:187], v[192:195], v[64:67]
    s_add_u32 m0, s61, s47
    s_nop 0
    buffer_load_dwordx4 v207, s[4:7], s72 offen nt lds
    v_mfma_f32_16x16x32_bf16 v[68:71], v[188:191], v[192:195], v[68:71]
    s_add_u32 m0, m0, 0x1000
    s_add_u32 s51, s72, 0x9000
    buffer_load_dwordx4 v207, s[4:7], s51 offen nt lds
    ds_read_b64_tr_b16 v[164:165], v200 offset:4096
    ds_read_b64_tr_b16 v[166:167], v200 offset:5120
    ds_read_b64_tr_b16 v[168:169], v201 offset:4096
    ds_read_b64_tr_b16 v[170:171], v201 offset:5120
    ds_read_b64_tr_b16 v[172:173], v200 offset:4608
    ds_read_b64_tr_b16 v[174:175], v200 offset:5632
    s_waitcnt lgkmcnt(6)
    v_mfma_f32_32x32x16_bf16 v[0:15], v[144:147], v[160:163], v[0:15]
    ds_read_b64_tr_b16 v[176:177], v201 offset:4608
    ds_read_b64_tr_b16 v[178:179], v201 offset:5632
    ds_read_b128 v[180:183], v204
    s_add_u32 m0, m0, 0x1000
    s_add_u32 s51, s72, 0x12000
    buffer_load_dwordx4 v207, s[4:7], s51 offen nt lds
    v_mfma_f32_32x32x16_bf16 v[16:31], v[148:151], v[160:163], v[16:31]
    ds_read_b64_tr_b16 v[184:185], v202 offset:0
    ds_read_b64_tr_b16 v[186:187], v202 offset:1024
    ds_read_b64_tr_b16 v[188:189], v202 offset:8
    s_add_u32 m0, m0, 0x1000
    s_add_u32 s51, s72, 0x1b000
    buffer_load_dwordx4 v207, s[4:7], s51 offen nt lds
    v_mfma_f32_32x32x16_bf16 v[32:47], v[152:155], v[160:163], v[32:47]
    ds_read_b64_tr_b16 v[190:191], v202 offset:1032
    ds_read_b128 v[192:195], v205
    s_add_u32 m0, s43, s47
    s_mov_b64 exec, s[54:55]
    buffer_load_dwordx4 v208, s[4:7], s72 offen nt lds
    s_mov_b64 exec, -1
    v_mfma_f32_32x32x16_bf16 v[48:63], v[156:159], v[160:163], v[48:63]
    s_add_u32 s70, s69, 0x0
    s_add_u32 s71, s71, 0x40000
    s_cmp_ge_u32 s71, 0x480000
    s_cselect_b32 s70, 0x30000, s70
    v_add_u32 v200, 0x4000, v200
    v_add_u32 v202, 0x4000, v202
    v_xor_b32 v203, 64, v203
    v_xor_b32 v205, 64, v205
    v_xor_b32 v201, 64, v200
    v_xor_b32 v204, 32, v203
    s_waitcnt lgkmcnt(0)
    s_barrier
    ds_read_b64_tr_b16 v[144:145], v200 offset:0
    ds_read_b64_tr_b16 v[146:147], v200 offset:1024
    ds_read_b64_tr_b16 v[148:149], v201 offset:0
    ds_read_b64_tr_b16 v[150:151], v201 offset:1024
    ds_read_b64_tr_b16 v[152:153], v200 offset:512
    ds_read_b64_tr_b16 v[154:155], v200 offset:1536
    ds_read_b64_tr_b16 v[156:157], v201 offset:512
    ds_read_b64_tr_b16 v[158:159], v201 offset:1536
    ds_read_b128 v[160:163], v203
    v_mfma_f32_32x32x16_bf16 v[0:15], v[164:167], v[180:183], v[0:15]
    s_add_u32 m0, s60, s70
    s_nop 0
    buffer_load_dwordx4 v206, s[8:11], s71 offen nt lds
    v_mfma_f32_32x32x16_bf16 v[16:31], v[168:171], v[180:183], v[16:31]
    s_add_u32 m0, m0, 0x800
    s_add_u32 s51, s71, 0x10000
    buffer_load_dwordx4 v206, s[8:11], s51 offen nt lds
    v_mfma_f32_32x32x16_bf16 v[32:47], v[172:175], v[180:183], v[32:47]
    s_add_u32 m0, m0, 0x800
    s_add_u32 s51, s71, 0x20000
    buffer_load_dwordx4 v206, s[8:11], s51 offen nt lds
    v_mfma_f32_32x32x16_bf16 v[48:63], v[176:179], v[180:183], v[48:63]
    s_add_u32 m0, m0, 0x800
    s_add_u32 s51, s71, 0x30000
    buffer_load_dwordx4 v206, s[8:11], s51 offen nt lds
    v_mfma_f32_16x16x32_bf16 v[64:67], v[184:187], v[192:195], v[64:67]
    v_mfma_f32_16x16x32_bf16 v[68:71], v[188:191], v[192:195], v[68:71]
    ds_read_b64_tr_b16 v[164:165], v200 offset:4096
    ds_read_b64_tr_b16 v[166:167], v200 offset:5120
    ds_read_b64_tr_b16 v[168:169], v201 offset:4096
    ds_read_b64_tr_b16 v[170:171], v201 offset:5120
    ds_read_b64_tr_b16 v[172:173], v200 offset:4608
    ds_read_b64_tr_b16 v[174:175], v200 offset:5632
    s_waitcnt lgkmcnt(6)
    v_mfma_f32_32x32x16_bf16 v[0:15], v[144:147], v[160:163], v[0:15]
    ds_read_b64_tr_b16 v[176:177], v201 offset:4608
    ds_read_b64_tr_b16 v[178:179], v201 offset:5632
    ds_read_b128 v[180:183], v204
    v_mfma_f32_32x32x16_bf16 v[16:31], v[148:151], v[160:163], v[16:31]
    ds_read_b64_tr_b16 v[184:185], v202 offset:0
    ds_read_b64_tr_b16 v[186:187], v202 offset:1024
    ds_read_b64_tr_b16 v[188:189], v202 offset:8
    v_mfma_f32_32x32x16_bf16 v[32:47], v[152:155], v[160:163], v[32:47]
    ds_read_b64_tr_b16 v[190:191], v202 offset:1032
    ds_read_b128 v[192:195], v205
    v_mfma_f32_32x32x16_bf16 v[48:63], v[156:159], v[160:163], v[48:63]
    s_add_u32 s70, s69, 0x4000
    s_add_u32 s71, s71, 0x40000
    s_cmp_ge_u32 s71, 0x480000
    s_cselect_b32 s70, 0x30000, s70
    s_add_u32 s47, s69, 0x8000
    s_add_u32 s72, s72, 128
    s_add_u32 s69, s69, 0xc800
    s_cmp_ge_u32 s69, 0x25800
    s_cselect_b32 s69, 0, s69
    s_sub_u32 s50, s50, 1
    s_cmp_lg_u32 s50, 0
    s_cbranch_scc1 QLOOP1
    s_cmp_eq_u32 s41, 0
    s_cbranch_scc0 QTB
    v_add_u32 v200, s69, v196
    v_add_u32 v202, s69, v197
    v_add_u32 v203, s69, v198
    v_add_u32 v205, s69, v199
    v_xor_b32 v201, 64, v200
    v_xor_b32 v204, 32, v203
    s_waitcnt vmcnt(17) lgkmcnt(0)
    s_barrier
    ds_read_b64_tr_b16 v[144:145], v200 offset:0
    ds_read_b64_tr_b16 v[146:147], v200 offset:1024
    ds_read_b64_tr_b16 v[148:149], v201 offset:0
    ds_read_b64_tr_b16 v[150:151], v201 offset:1024
    ds_read_b64_tr_b16 v[152:153], v200 offset:512
    ds_read_b64_tr_b16 v[154:155], v200 offset:1536
    ds_read_b64_tr_b16 v[156:157], v201 offset:512
    ds_read_b64_tr_b16 v[158:159], v201 offset:1536
    ds_read_b128 v[160:163], v203
    v_mfma_f32_32x32x16_bf16 v[0:15], v[164:167], v[180:183], v[0:15]
    v_xor_b32 v72, 64, v248
    s_mov_b32 s48, s63
    s_mov_b32 s44, s42
    s_mov_b32 s62, -1
    s_add_u32 m0, s44, s59
    s_add_u32 s52, s48, 0x1000
    buffer_load_dwordx4 v248, s[12:15], s48 offen nt lds
    v_mfma_f32_32x32x16_bf16 v[16:31], v[168:171], v[180:183], v[16:31]
    s_add_u32 m0, m0, 0x1000
    s_add_u32 s53, s46, 0x1000
    buffer_load_dwordx4 v248, s[12:15], s52 offen nt lds
    v_mfma_f32_32x32x16_bf16 v[32:47], v[172:175], v[180:183], v[32:47]
    s_mov_b32 s46, s48
    s_add_u32 s48, s48, 0x2000
    s_and_b32 s48, s48, 0x3ffff
    s_add_u32 s62, s62, 1
    s_add_u32 s44, s42, 0x4000
    s_add_u32 m0, s44, s59
    s_add_u32 s52, s48, 0x1000
    buffer_load_dwordx4 v248, s[12:15], s48 offen nt lds
    v_mfma_f32_32x32x16_bf16 v[48:63], v[176:179], v[180:183], v[48:63]
    s_add_u32 m0, m0, 0x1000
    s_add_u32 s53, s46, 0x1000
    buffer_load_dwordx4 v248, s[12:15], s52 offen nt lds
    v_mfma_f32_16x16x32_bf16 v[64:67], v[184:187], v[192:195], v[64:67]
    s_add_u32 m0, m0, 0x1000
    s_nop 0
    buffer_load_dwordx4 v249, s[16:19], s46 offen nt lds
    v_mfma_f32_16x16x32_bf16 v[68:71], v[188:191], v[192:195], v[68:71]
    s_add_u32 m0, m0, 0x1000
    s_nop 0
    buffer_load_dwordx4 v249, s[16:19], s53 offen nt lds
    ds_read_b64_tr_b16 v[164:165], v200 offset:4096
    ds_read_b64_tr_b16 v[166:167], v200 offset:5120
    ds_read_b64_tr_b16 v[168:169], v201 offset:4096
    ds_read_b64_tr_b16 v[170:171], v201 offset:5120
    ds_read_b64_tr_b16 v[172:173], v200 offset:4608
    ds_read_b64_tr_b16 v[174:175], v200 offset:5632
    s_waitcnt lgkmcnt(6)
    v_mfma_f32_32x32x16_bf16 v[0:15], v[144:147], v[160:163], v[0:15]
    ds_read_b64_tr_b16 v[176:177], v201 offset:4608
    ds_read_b64_tr_b16 v[178:179], v201 offset:5632
    ds_read_b128 v[180:183], v204
    s_mov_b32 s46, s48
    s_add_u32 s48, s48, 0x2000
    s_and_b32 s48, s48, 0x3ffff
    s_add_u32 s62, s62, 1
    s_add_u32 s44, s42, 0x8000
    s_add_u32 m0, s44, s59
    s_add_u32 s52, s48, 0x1000
    buffer_load_dwordx4 v248, s[12:15], s48 offen nt lds
    v_mfma_f32_32x32x16_bf16 v[16:31], v[148:151], v[160:163], v[16:31]
    ds_read_b64_tr_b16 v[184:185], v202 offset:0
    ds_read_b64_tr_b16 v[186:187], v202 offset:1024
    ds_read_b64_tr_b16 v[188:189], v202 offset:8
    s_add_u32 m0, m0, 0x1000
    s_add_u32 s53, s46, 0x1000
    buffer_load_dwordx4 v248, s[12:15], s52 offen nt lds
    v_mfma_f32_32x32x16_bf16 v[32:47], v[152:155], v[160:163], v[32:47]
    ds_read_b64_tr_b16 v[190:191], v202 offset:1032
    ds_read_b128 v[192:195], v205
    s_add_u32 m0, m0, 0x1000
    s_nop 0
    buffer_load_dwordx4 v249, s[16:19], s46 offen nt lds
    v_mfma_f32_32x32x16_bf16 v[48:63], v[156:159], v[160:163], v[48:63]
    s_add_u32 m0, m0, 0x1000
    s_nop 0
    buffer_load_dwordx4 v249, s[16:19], s53 offen nt lds
    v_add_u32 v200, 0x4000, v200
    v_add_u32 v202, 0x4000, v202
    v_xor_b32 v203, 64, v203
    v_xor_b32 v205, 64, v205
    v_xor_b32 v201, 64, v200
    v_xor_b32 v204, 32, v203
    s_waitcnt lgkmcnt(0)
    s_barrier
    ds_read_b64_tr_b16 v[144:145], v200 offset:0
    ds_read_b64_tr_b16 v[146:147], v200 offset:1024
    ds_read_b64_tr_b16 v[148:149], v201 offset:0
    ds_read_b64_tr_b16 v[150:151], v201 offset:1024
    ds_read_b64_tr_b16 v[152:153], v200 offset:512
    ds_read_b64_tr_b16 v[154:155], v200 offset:1536
    ds_read_b64_tr_b16 v[156:157], v201 offset:512
    ds_read_b64_tr_b16 v[158:159], v201 offset:1536
    ds_read_b128 v[160:163], v203
    v_mfma_f32_32x32x16_bf16 v[0:15], v[164:167], v[180:183], v[0:15]
    s_mov_b32 s46, s48
    s_add_u32 s48, s48, 0x2000
    s_and_b32 s48, s48, 0x3ffff
    s_add_u32 s62, s62, 1
    s_add_u32 s44, s42, 0xc000
    s_add_u32 m0, s44, s59
    s_add_u32 s52, s48, 0x1000
    buffer_load_dwordx4 v248, s[12:15], s48 offen nt lds
    v_mfma_f32_32x32x16_bf16 v[16:31], v[168:171], v[180:183], v[16:31]
    s_add_u32 m0, m0, 0x1000
    s_add_u32 s53, s46, 0x1000
    buffer_load_dwordx4 v248, s[12:15], s52 offen nt lds
    v_mfma_f32_32x32x16_bf16 v[32:47], v[172:175], v[180:183], v[32:47]
    s_add_u32 m0, m0, 0x1000
    s_nop 0
    buffer_load_dwordx4 v249, s[16:19], s46 offen nt lds
    v_mfma_f32_32x32x16_bf16 v[48:63], v[176:179], v[180:183], v[48:63]
    s_add_u32 m0, m0, 0x1000
    s_nop 0
    buffer_load_dwordx4 v249, s[16:19], s53 offen nt lds
    v_mfma_f32_16x16x32_bf16 v[64:67], v[184:187], v[192:195], v[64:67]
    v_mfma_f32_16x16x32_bf16 v[68:71], v[188:191], v[192:195], v[68:71]
    ds_read_b64_tr_b16 v[164:165], v200 offset:4096
    ds_read_b64_tr_b16 v[166:167], v200 offset:5120
    ds_read_b64_tr_b16 v[168:169], v201 offset:4096
    ds_read_b64_tr_b16 v[170:171], v201 offset:5120
    ds_read_b64_tr_b16 v[172:173], v200 offset:4608
    ds_read_b64_tr_b16 v[174:175], v200 offset:5632
    s_waitcnt lgkmcnt(6)
    v_mfma_f32_32x32x16_bf16 v[0:15], v[144:147], v[160:163], v[0:15]
    ds_read_b64_tr_b16 v[176:177], v201 offset:4608
    ds_read_b64_tr_b16 v[178:179], v201 offset:5632
    ds_read_b128 v[180:183], v204
    v_mfma_f32_32x32x16_bf16 v[16:31], v[148:151], v[160:163], v[16:31]
    ds_read_b64_tr_b16 v[184:185], v202 offset:0
    ds_read_b64_tr_b16 v[186:187], v202 offset:1024
    ds_read_b64_tr_b16 v[188:189], v202 offset:8
    v_mfma_f32_32x32x16_bf16 v[32:47], v[152:155], v[160:163], v[32:47]
    ds_read_b64_tr_b16 v[190:191], v202 offset:1032
    ds_read_b128 v[192:195], v205
    v_mfma_f32_32x32x16_bf16 v[48:63], v[156:159], v[160:163], v[48:63]
    s_add_u32 s69, s69, 0xc800
    s_cmp_ge_u32 s69, 0x25800
    s_cselect_b32 s69, 0, s69
    v_add_u32 v200, s69, v196
    v_add_u32 v202, s69, v197
    v_add_u32 v203, s69, v198
    v_add_u32 v205, s69, v199
    v_xor_b32 v201, 64, v200
    v_xor_b32 v204, 32, v203
    s_waitcnt vmcnt(18) lgkmcnt(0)
    s_barrier
    ds_read_b64_tr_b16 v[144:145], v200 offset:0
    ds_read_b64_tr_b16 v[146:147], v200 offset:1024
    ds_read_b64_tr_b16 v[148:149], v201 offset:0
    ds_read_b64_tr_b16 v[150:151], v201 offset:1024
    ds_read_b64_tr_b16 v[152:153], v200 offset:512
    ds_read_b64_tr_b16 v[154:155], v200 offset:1536
    ds_read_b64_tr_b16 v[156:157], v201 offset:512
    ds_read_b64_tr_b16 v[158:159], v201 offset:1536
    ds_read_b128 v[160:163], v203
    v_mfma_f32_32x32x16_bf16 v[0:15], v[164:167], v[180:183], v[0:15]
    v_mfma_f32_32x32x16_bf16 v[16:31], v[168:171], v[180:183], v[16:31]
    v_mfma_f32_32x32x16_bf16 v[32:47], v[172:175], v[180:183], v[32:47]
    v_mfma_f32_32x32x16_bf16 v[48:63], v[176:179], v[180:183], v[48:63]
    v_mfma_f32_16x16x32_bf16 v[64:67], v[184:187], v[192:195], v[64:67]
    v_mfma_f32_16x16x32_bf16 v[68:71], v[188:191], v[192:195], v[68:71]
    ds_read_b64_tr_b16 v[164:165], v200 offset:4096
    ds_read_b64_tr_b16 v[166:167], v200 offset:5120
    ds_read_b64_tr_b16 v[168:169], v201 offset:4096
    ds_read_b64_tr_b16 v[170:171], v201 offset:5120
    ds_read_b64_tr_b16 v[172:173], v200 offset:4608
    ds_read_b64_tr_b16 v[174:175], v200 offset:5632
    s_waitcnt lgkmcnt(6)
    v_mfma_f32_32x32x16_bf16 v[0:15], v[144:147], v[160:163], v[0:15]
    ds_read_b64_tr_b16 v[176:177], v201 offset:4608
    ds_read_b64_tr_b16 v[178:179], v201 offset:5632
    ds_read_b128 v[180:183], v204
    v_mfma_f32_32x32x16_bf16 v[16:31], v[148:151], v[160:163], v[16:31]
    ds_read_b64_tr_b16 v[184:185], v202 offset:0
    ds_read_b64_tr_b16 v[186:187], v202 offset:1024
    ds_read_b64_tr_b16 v[188:189], v202 offset:8
    v_mfma_f32_32x32x16_bf16 v[32:47], v[152:155], v[160:163], v[32:47]
    ds_read_b64_tr_b16 v[190:191], v202 offset:1032
    ds_read_b128 v[192:195], v205
    v_mfma_f32_32x32x16_bf16 v[48:63], v[156:159], v[160:163], v[48:63]
    v_add_u32 v200, 0x4000, v200
    v_add_u32 v202, 0x4000, v202
    v_xor_b32 v203, 64, v203
    v_xor_b32 v205, 64, v205
    v_xor_b32 v201, 64, v200
    v_xor_b32 v204, 32, v203
    s_waitcnt lgkmcnt(0)
    s_barrier
    ds_read_b64_tr_b16 v[144:145], v200 offset:0
    ds_read_b64_tr_b16 v[146:147], v200 offset:1024
    ds_read_b64_tr_b16 v[148:149], v201 offset:0
    ds_read_b64_tr_b16 v[150:151], v201 offset:1024
    ds_read_b64_tr_b16 v[152:153], v200 offset:512
    ds_read_b64_tr_b16 v[154:155], v200 offset:1536
    ds_read_b64_tr_b16 v[156:157], v201 offset:512
    ds_read_b64_tr_b16 v[158:159], v201 offset:1536
    ds_read_b128 v[160:163], v203
    v_mfma_f32_32x32x16_bf16 v[0:15], v[164:167], v[180:183], v[0:15]
    v_mfma_f32_32x32x16_bf16 v[16:31], v[168:171], v[180:183], v[16:31]
    v_mfma_f32_32x32x16_bf16 v[32:47], v[172:175], v[180:183], v[32:47]
    v_mfma_f32_32x32x16_bf16 v[48:63], v[176:179], v[180:183], v[48:63]
    v_mfma_f32_16x16x32_bf16 v[64:67], v[184:187], v[192:195], v[64:67]
    v_mfma_f32_16x16x32_bf16 v[68:71], v[188:191], v[192:195], v[68:71]
    ds_read_b64_tr_b16 v[164:165], v200 offset:4096
    ds_read_b64_tr_b16 v[166:167], v200 offset:5120
    ds_read_b64_tr_b16 v[168:169], v201 offset:4096
    ds_read_b64_tr_b16 v[170:171], v201 offset:5120
    ds_read_b64_tr_b16 v[172:173], v200 offset:4608
    ds_read_b64_tr_b16 v[174:175], v200 offset:5632
    s_waitcnt lgkmcnt(6)
    v_mfma_f32_32x32x16_bf16 v[0:15], v[144:147], v[160:163], v[0:15]
    ds_read_b64_tr_b16 v[176:177], v201 offset:4608
    ds_read_b64_tr_b16 v[178:179], v201 offset:5632
    ds_read_b128 v[180:183], v204
    v_mfma_f32_32x32x16_bf16 v[16:31], v[148:151], v[160:163], v[16:31]
    ds_read_b64_tr_b16 v[184:185], v202 offset:0
    ds_read_b64_tr_b16 v[186:187], v202 offset:1024
    ds_read_b64_tr_b16 v[188:189], v202 offset:8
    v_mfma_f32_32x32x16_bf16 v[32:47], v[152:155], v[160:163], v[32:47]
    ds_read_b64_tr_b16 v[190:191], v202 offset:1032
    ds_read_b128 v[192:195], v205
    v_mfma_f32_32x32x16_bf16 v[48:63], v[156:159], v[160:163], v[48:63]
    s_add_u32 s69, s69, 0xc800
    s_cmp_ge_u32 s69, 0x25800
    s_cselect_b32 s69, 0, s69
    s_branch QX
QTB:
    v_add_u32 v200, s69, v196
    v_add_u32 v202, s69, v197
    v_add_u32 v203, s69, v198
    v_add_u32 v205, s69, v199
    v_xor_b32 v201, 64, v200
    v_xor_b32 v204, 32, v203
    s_waitcnt vmcnt(17) lgkmcnt(0)
    s_barrier
    ds_read_b64_tr_b16 v[144:145], v200 offset:0
    ds_read_b64_tr_b16 v[146:147], v200 offset:1024
    ds_read_b64_tr_b16 v[148:149], v201 offset:0
    ds_read_b64_tr_b16 v[150:151], v201 offset:1024
    ds_read_b64_tr_b16 v[152:153], v200 offset:512
    ds_read_b64_tr_b16 v[154:155], v200 offset:1536
    ds_read_b64_tr_b16 v[156:157], v201 offset:512
    ds_read_b64_tr_b16 v[158:159], v201 offset:1536
    ds_read_b128 v[160:163], v203
    v_mfma_f32_32x32x16_bf16 v[0:15], v[164:167], v[180:183], v[0:15]
    v_xor_b32 v72, 64, v248
    s_add_u32 s48, s63, 0x0
    s_and_b32 s48, s48, 0x3ffff
    s_mov_b32 s44, 0x0
    s_add_u32 m0, s44, s59
    s_add_u32 s52, s48, 0x1000
    buffer_load_dwordx4 v248, s[12:15], s48 offen nt lds
    v_mfma_f32_32x32x16_bf16 v[16:31], v[168:171], v[180:183], v[16:31]
    buffer_load_dwordx4 v72, s[12:15], s48 offen offset:2048 nt lds
    v_mfma_f32_32x32x16_bf16 v[32:47], v[172:175], v[180:183], v[32:47]
    s_add_u32 m0, m0, 0x1000
    s_nop 0
    buffer_load_dwordx4 v248, s[12:15], s52 offen nt lds
    v_mfma_f32_32x32x16_bf16 v[48:63], v[176:179], v[180:183], v[48:63]
    buffer_load_dwordx4 v72, s[12:15], s52 offen offset:2048 nt lds
    v_mfma_f32_16x16x32_bf16 v[64:67], v[184:187], v[192:195], v[64:67]
    s_add_u32 s48, s63, 0x2000
    s_and_b32 s48, s48, 0x3ffff
    s_mov_b32 s44, 0x4000
    s_add_u32 m0, s44, s59
    s_add_u32 s52, s48, 0x1000
    buffer_load_dwordx4 v248, s[12:15], s48 offen nt lds
    v_mfma_f32_16x16x32_bf16 v[68:71], v[188:191], v[192:195], v[68:71]
    buffer_load_dwordx4 v72, s[12:15], s48 offen offset:2048 nt lds
    ds_read_b64_tr_b16 v[164:165], v200 offset:4096
    ds_read_b64_tr_b16 v[166:167], v200 offset:5120
    ds_read_b64_tr_b16 v[168:169], v201 offset:4096
    ds_read_b64_tr_b16 v[170:171], v201 offset:5120
    ds_read_b64_tr_b16 v[172:173], v200 offset:4608
    ds_read_b64_tr_b16 v[174:175], v200 offset:5632
    s_waitcnt lgkmcnt(6)
    v_mfma_f32_32x32x16_bf16 v[0:15], v[144:147], v[160:163], v[0:15]
    ds_read_b64_tr_b16 v[176:177], v201 offset:4608
    ds_read_b64_tr_b16 v[178:179], v201 offset:5632
    ds_read_b128 v[180:183], v204
    s_add_u32 m0, m0, 0x1000
    s_nop 0
    buffer_load_dwordx4 v248, s[12:15], s52 offen nt lds
    v_mfma_f32_32x32x16_bf16 v[16:31], v[148:151], v[160:163], v[16:31]
    ds_read_b64_tr_b16 v[184:185], v202 offset:0
    ds_read_b64_tr_b16 v[186:187], v202 offset:1024
    ds_read_b64_tr_b16 v[188:189], v202 offset:8
    buffer_load_dwordx4 v72, s[12:15], s52 offen offset:2048 nt lds
    v_mfma_f32_32x32x16_bf16 v[32:47], v[152:155], v[160:163], v[32:47]
    ds_read_b64_tr_b16 v[190:191], v202 offset:1032
    ds_read_b128 v[192:195], v205
    s_add_u32 s48, s63, 0x4000
    s_and_b32 s48, s48, 0x3ffff
    s_mov_b32 s44, 0x8000
    s_add_u32 m0, s44, s59
    s_add_u32 s52, s48, 0x1000
    buffer_load_dwordx4 v248, s[12:15], s48 offen nt lds
    v_mfma_f32_32x32x16_bf16 v[48:63], v[156:159], v[160:163], v[48:63]
    buffer_load_dwordx4 v72, s[12:15], s48 offen offset:2048 nt lds
    s_add_u32 m0, m0, 0x1000
    s_nop 0
    buffer_load_dwordx4 v248, s[12:15], s52 offen nt lds
    buffer_load_dwordx4 v72, s[12:15], s52 offen offset:2048 nt lds
    v_add_u32 v200, 0x4000, v200
    v_add_u32 v202, 0x4000, v202
    v_xor_b32 v203, 64, v203
    v_xor_b32 v205, 64, v205
    v_xor_b32 v201, 64, v200
    v_xor_b32 v204, 32, v203
    s_waitcnt lgkmcnt(0)
    s_barrier
    ds_read_b64_tr_b16 v[144:145], v200 offset:0
    ds_read_b64_tr_b16 v[146:147], v200 offset:1024
    ds_read_b64_tr_b16 v[148:149], v201 offset:0
    ds_read_b64_tr_b16 v[150:151], v201 offset:1024
    ds_read_b64_tr_b16 v[152:153], v200 offset:512
    ds_read_b64_tr_b16 v[154:155], v200 offset:1536
    ds_read_b64_tr_b16 v[156:157], v201 offset:512
    ds_read_b64_tr_b16 v[158:159], v201 offset:1536
    ds_read_b128 v[160:163], v203
    v_mfma_f32_32x32x16_bf16 v[0:15], v[164:167], v[180:183], v[0:15]
    s_add_u32 s48, s63, 0x6000
    s_and_b32 s48, s48, 0x3ffff
    s_mov_b32 s44, 0xc000
    s_add_u32 m0, s44, s59
    s_add_u32 s52, s48, 0x1000
    buffer_load_dwordx4 v248, s[12:15], s48 offen nt lds
    v_mfma_f32_32x32x16_bf16 v[16:31], v[168:171], v[180:183], v[16:31]
    buffer_load_dwordx4 v72, s[12:15], s48 offen offset:2048 nt lds
    v_mfma_f32_32x32x16_bf16 v[32:47], v[172:175], v[180:183], v[32:47]
    s_add_u32 m0, m0, 0x1000
    s_nop 0
    buffer_load_dwordx4 v248, s[12:15], s52 offen nt lds
    v_mfma_f32_32x32x16_bf16 v[48:63], v[176:179], v[180:183], v[48:63]
    buffer_load_dwordx4 v72, s[12:15], s52 offen offset:2048 nt lds
    v_mfma_f32_16x16x32_bf16 v[64:67], v[184:187], v[192:195], v[64:67]
    v_mfma_f32_16x16x32_bf16 v[68:71], v[188:191], v[192:195], v[68:71]
    ds_read_b64_tr_b16 v[164:165], v200 offset:4096
    ds_read_b64_tr_b16 v[166:167], v200 offset:5120
    ds_read_b64_tr_b16 v[168:169], v201 offset:4096
    ds_read_b64_tr_b16 v[170:171], v201 offset:5120
    ds_read_b64_tr_b16 v[172:173], v200 offset:4608
    ds_read_b64_tr_b16 v[174:175], v200 offset:5632
    s_waitcnt lgkmcnt(6)
    v_mfma_f32_32x32x16_bf16 v[0:15], v[144:147], v[160:163], v[0:15]
    ds_read_b64_tr_b16 v[176:177], v201 offset:4608
    ds_read_b64_tr_b16 v[178:179], v201 offset:5632
    ds_read_b128 v[180:183], v204
    v_mfma_f32_32x32x16_bf16 v[16:31], v[148:151], v[160:163], v[16:31]
    ds_read_b64_tr_b16 v[184:185], v202 offset:0
    ds_read_b64_tr_b16 v[186:187], v202 offset:1024
    ds_read_b64_tr_b16 v[188:189], v202 offset:8
    v_mfma_f32_32x32x16_bf16 v[32:47], v[152:155], v[160:163], v[32:47]
    ds_read_b64_tr_b16 v[190:191], v202 offset:1032
    ds_read_b128 v[192:195], v205
    v_mfma_f32_32x32x16_bf16 v[48:63], v[156:159], v[160:163], v[48:63]
    s_add_u32 s69, s69, 0xc800
    s_cmp_ge_u32 s69, 0x25800
    s_cselect_b32 s69, 0, s69
    v_add_u32 v200, s69, v196
    v_add_u32 v202, s69, v197
    v_add_u32 v203, s69, v198
    v_add_u32 v205, s69, v199
    v_xor_b32 v201, 64, v200
    v_xor_b32 v204, 32, v203
    s_waitcnt vmcnt(20) lgkmcnt(0)
    s_barrier
    ds_read_b64_tr_b16 v[144:145], v200 offset:0
    ds_read_b64_tr_b16 v[146:147], v200 offset:1024
    ds_read_b64_tr_b16 v[148:149], v201 offset:0
    ds_read_b64_tr_b16 v[150:151], v201 offset:1024
    ds_read_b64_tr_b16 v[152:153], v200 offset:512
    ds_read_b64_tr_b16 v[154:155], v200 offset:1536
    ds_read_b64_tr_b16 v[156:157], v201 offset:512
    ds_read_b64_tr_b16 v[158:159], v201 offset:1536
    ds_read_b128 v[160:163], v203
    v_mfma_f32_32x32x16_bf16 v[0:15], v[164:167], v[180:183], v[0:15]
    s_add_u32 s46, s63, 0x0
    s_and_b32 s46, s46, 0x3ffff
    s_mov_b32 s44, 0x0
    s_add_u32 s53, s44, 0x14000
    s_add_u32 m0, s53, s59
    s_add_u32 s53, s46, 0x1000
    buffer_load_dwordx4 v249, s[16:19], s46 offen nt lds
    v_mfma_f32_32x32x16_bf16 v[16:31], v[168:171], v[180:183], v[16:31]
    buffer_load_dwordx4 v249, s[16:19], s46 offen offset:2048 nt lds
    v_mfma_f32_32x32x16_bf16 v[32:47], v[172:175], v[180:183], v[32:47]
    s_add_u32 m0, m0, 0x1000
    s_nop 0
    buffer_load_dwordx4 v249, s[16:19], s53 offen nt lds
    v_mfma_f32_32x32x16_bf16 v[48:63], v[176:179], v[180:183], v[48:63]
    buffer_load_dwordx4 v249, s[16:19], s53 offen offset:2048 nt lds
    v_mfma_f32_16x16x32_bf16 v[64:67], v[184:187], v[192:195], v[64:67]
    v_mfma_f32_16x16x32_bf16 v[68:71], v[188:191], v[192:195], v[68:71]
    ds_read_b64_tr_b16 v[164:165], v200 offset:4096
    ds_read_b64_tr_b16 v[166:167], v200 offset:5120
    ds_read_b64_tr_b16 v[168:169], v201 offset:4096
    ds_read_b64_tr_b16 v[170:171], v201 offset:5120
    ds_read_b64_tr_b16 v[172:173], v200 offset:4608
    ds_read_b64_tr_b16 v[174:175], v200 offset:5632
    s_waitcnt lgkmcnt(6)
    v_mfma_f32_32x32x16_bf16 v[0:15], v[144:147], v[160:163], v[0:15]
    ds_read_b64_tr_b16 v[176:177], v201 offset:4608
    ds_read_b64_tr_b16 v[178:179], v201 offset:5632
    ds_read_b128 v[180:183], v204
    v_mfma_f32_32x32x16_bf16 v[16:31], v[148:151], v[160:163], v[16:31]
    ds_read_b64_tr_b16 v[184:185], v202 offset:0
    ds_read_b64_tr_b16 v[186:187], v202 offset:1024
    ds_read_b64_tr_b16 v[188:189], v202 offset:8
    v_mfma_f32_32x32x16_bf16 v[32:47], v[152:155], v[160:163], v[32:47]
    ds_read_b64_tr_b16 v[190:191], v202 offset:1032
    ds_read_b128 v[192:195], v205
    v_mfma_f32_32x32x16_bf16 v[48:63], v[156:159], v[160:163], v[48:63]
    v_add_u32 v200, 0x4000, v200
    v_add_u32 v202, 0x4000, v202
    v_xor_b32 v203, 64, v203
    v_xor_b32 v205, 64, v205
    v_xor_b32 v201, 64, v200
    v_xor_b32 v204, 32, v203
    s_waitcnt lgkmcnt(0)
    s_barrier
    ds_read_b64_tr_b16 v[144:145], v200 offset:0
    ds_read_b64_tr_b16 v[146:147], v200 offset:1024
    ds_read_b64_tr_b16 v[148:149], v201 offset:0
    ds_read_b64_tr_b16 v[150:151], v201 offset:1024
    ds_read_b64_tr_b16 v[152:153], v200 offset:512
    ds_read_b64_tr_b16 v[154:155], v200 offset:1536
    ds_read_b64_tr_b16 v[156:157], v201 offset:512
    ds_read_b64_tr_b16 v[158:159], v201 offset:1536
    ds_read_b128 v[160:163], v203
    v_mfma_f32_32x32x16_bf16 v[0:15], v[164:167], v[180:183], v[0:15]
    s_add_u32 s46, s63, 0x2000
    s_and_b32 s46, s46, 0x3ffff
    s_mov_b32 s44, 0x4000
    s_add_u32 s53, s44, 0x14000
    s_add_u32 m0, s53, s59
    s_add_u32 s53, s46, 0x1000
    buffer_load_dwordx4 v249, s[16:19], s46 offen nt lds
    v_mfma_f32_32x32x16_bf16 v[16:31], v[168:171], v[180:183], v[16:31]
    buffer_load_dwordx4 v249, s[16:19], s46 offen offset:2048 nt lds
    v_mfma_f32_32x32x16_bf16 v[32:47], v[172:175], v[180:183], v[32:47]
    s_add_u32 m0, m0, 0x1000
    s_nop 0
    buffer_load_dwordx4 v249, s[16:19], s53 offen nt lds
    v_mfma_f32_32x32x16_bf16 v[48:63], v[176:179], v[180:183], v[48:63]
    buffer_load_dwordx4 v249, s[16:19], s53 offen offset:2048 nt lds
    v_mfma_f32_16x16x32_bf16 v[64:67], v[184:187], v[192:195], v[64:67]
    v_mfma_f32_16x16x32_bf16 v[68:71], v[188:191], v[192:195], v[68:71]
    ds_read_b64_tr_b16 v[164:165], v200 offset:4096
    ds_read_b64_tr_b16 v[166:167], v200 offset:5120
    ds_read_b64_tr_b16 v[168:169], v201 offset:4096
    ds_read_b64_tr_b16 v[170:171], v201 offset:5120
    ds_read_b64_tr_b16 v[172:173], v200 offset:4608
    ds_read_b64_tr_b16 v[174:175], v200 offset:5632
    s_waitcnt lgkmcnt(6)
    v_mfma_f32_32x32x16_bf16 v[0:15], v[144:147], v[160:163], v[0:15]
    ds_read_b64_tr_b16 v[176:177], v201 offset:4608
    ds_read_b64_tr_b16 v[178:179], v201 offset:5632
    ds_read_b128 v[180:183], v204
    v_mfma_f32_32x32x16_bf16 v[16:31], v[148:151], v[160:163], v[16:31]
    ds_read_b64_tr_b16 v[184:185], v202 offset:0
    ds_read_b64_tr_b16 v[186:187], v202 offset:1024
    ds_read_b64_tr_b16 v[188:189], v202 offset:8
    v_mfma_f32_32x32x16_bf16 v[32:47], v[152:155], v[160:163], v[32:47]
    ds_read_b64_tr_b16 v[190:191], v202 offset:1032
    ds_read_b128 v[192:195], v205
    v_mfma_f32_32x32x16_bf16 v[48:63], v[156:159], v[160:163], v[48:63]
    s_add_u32 s69, s69, 0xc800
    s_cmp_ge_u32 s69, 0x25800
    s_cselect_b32 s69, 0, s69
    s_branch QX
QH:
    v_add_u32 v200, s69, v196
    v_add_u32 v202, s69, v197
    v_add_u32 v203, s69, v198
    v_add_u32 v205, s69, v199
    v_xor_b32 v201, 64, v200
    v_xor_b32 v204, 32, v203
    s_waitcnt lgkmcnt(0)
    s_barrier
    ds_read_b64_tr_b16 v[144:145], v200 offset:0
    ds_read_b64_tr_b16 v[146:147], v200 offset:1024
    ds_read_b64_tr_b16 v[148:149], v201 offset:0
    ds_read_b64_tr_b16 v[150:151], v201 offset:1024
    ds_read_b64_tr_b16 v[152:153], v200 offset:512
    ds_read_b64_tr_b16 v[154:155], v200 offset:1536
    ds_read_b64_tr_b16 v[156:157], v201 offset:512
    ds_read_b64_tr_b16 v[158:159], v201 offset:1536
    ds_read_b128 v[160:163], v203
    ds_read_b64_tr_b16 v[164:165], v200 offset:4096
    ds_read_b64_tr_b16 v[166:167], v200 offset:5120
    ds_read_b64_tr_b16 v[168:169], v201 offset:4096
    ds_read_b64_tr_b16 v[170:171], v201 offset:5120
    ds_read_b64_tr_b16 v[172:173], v200 offset:4608
    ds_read_b64_tr_b16 v[174:175], v200 offset:5632
    s_waitcnt lgkmcnt(6)
    v_mfma_f32_32x32x16_bf16 v[0:15], v[144:147], v[160:163], 0
    ds_read_b64_tr_b16 v[176:177], v201 offset:4608
    ds_read_b64_tr_b16 v[178:179], v201 offset:5632
    ds_read_b128 v[180:183], v204
    v_mfma_f32_32x32x16_bf16 v[16:31], v[148:151], v[160:163], 0
    ds_read_b64_tr_b16 v[184:185], v202 offset:0
    ds_read_b64_tr_b16 v[186:187], v202 offset:1024
    ds_read_b64_tr_b16 v[188:189], v202 offset:8
    v_mfma_f32_32x32x16_bf16 v[32:47], v[152:155], v[160:163], 0
    ds_read_b64_tr_b16 v[190:191], v202 offset:1032
    ds_read_b128 v[192:195], v205
    v_mfma_f32_32x32x16_bf16 v[48:63], v[156:159], v[160:163], 0
    v_add_u32 v200, 0x4000, v200
    v_add_u32 v202, 0x4000, v202
    v_xor_b32 v203, 64, v203
    v_xor_b32 v205, 64, v205
    v_xor_b32 v201, 64, v200
    v_xor_b32 v204, 32, v203
    s_waitcnt lgkmcnt(0)
    s_barrier
    ds_read_b64_tr_b16 v[144:145], v200 offset:0
    ds_read_b64_tr_b16 v[146:147], v200 offset:1024
    ds_read_b64_tr_b16 v[148:149], v201 offset:0
    ds_read_b64_tr_b16 v[150:151], v201 offset:1024
    ds_read_b64_tr_b16 v[152:153], v200 offset:512
    ds_read_b64_tr_b16 v[154:155], v200 offset:1536
    ds_read_b64_tr_b16 v[156:157], v201 offset:512
    ds_read_b64_tr_b16 v[158:159], v201 offset:1536
    ds_read_b128 v[160:163], v203
    v_mfma_f32_32x32x16_bf16 v[0:15], v[164:167], v[180:183], v[0:15]
    v_mfma_f32_32x32x16_bf16 v[16:31], v[168:171], v[180:183], v[16:31]
    v_mfma_f32_32x32x16_bf16 v[32:47], v[172:175], v[180:183], v[32:47]
    v_mfma_f32_32x32x16_bf16 v[48:63], v[176:179], v[180:183], v[48:63]
    v_mfma_f32_16x16x32_bf16 v[64:67], v[184:187], v[192:195], v[64:67]
    v_mfma_f32_16x16x32_bf16 v[68:71], v[188:191], v[192:195], v[68:71]
    ds_read_b64_tr_b16 v[164:165], v200 offset:4096
    ds_read_b64_tr_b16 v[166:167], v200 offset:5120
    ds_read_b64_tr_b16 v[168:169], v201 offset:4096
    ds_read_b64_tr_b16 v[170:171], v201 offset:5120
    ds_read_b64_tr_b16 v[172:173], v200 offset:4608
    ds_read_b64_tr_b16 v[174:175], v200 offset:5632
    s_waitcnt lgkmcnt(6)
    v_mfma_f32_32x32x16_bf16 v[0:15], v[144:147], v[160:163], v[0:15]
    ds_read_b64_tr_b16 v[176:177], v201 offset:4608
    ds_read_b64_tr_b16 v[178:179], v201 offset:5632
    ds_read_b128 v[180:183], v204
    v_mfma_f32_32x32x16_bf16 v[16:31], v[148:151], v[160:163], v[16:31]
    ds_read_b64_tr_b16 v[184:185], v202 offset:0
    ds_read_b64_tr_b16 v[186:187], v202 offset:1024
    ds_read_b64_tr_b16 v[188:189], v202 offset:8
    v_mfma_f32_32x32x16_bf16 v[32:47], v[152:155], v[160:163], v[32:47]
    ds_read_b64_tr_b16 v[190:191], v202 offset:1032
    ds_read_b128 v[192:195], v205
    v_mfma_f32_32x32x16_bf16 v[48:63], v[156:159], v[160:163], v[48:63]
    s_add_u32 s69, s69, 0xc800
    s_cmp_ge_u32 s69, 0x25800
    s_cselect_b32 s69, 0, s69
QLOOP0:
    v_add_u32 v200, s69, v196
    v_add_u32 v202, s69, v197
    v_add_u32 v203, s69, v198
    v_add_u32 v205, s69, v199
    v_xor_b32 v201, 64, v200
    v_xor_b32 v204, 32, v203
    s_waitcnt lgkmcnt(0)
    s_barrier
    ds_read_b64_tr_b16 v[144:145], v200 offset:0
    ds_read_b64_tr_b16 v[146:147], v200 offset:1024
    ds_read_b64_tr_b16 v[148:149], v201 offset:0
    ds_read_b64_tr_b16 v[150:151], v201 offset:1024
    ds_read_b64_tr_b16 v[152:153], v200 offset:512
    ds_read_b64_tr_b16 v[154:155], v200 offset:1536
    ds_read_b64_tr_b16 v[156:157], v201 offset:512
    ds_read_b64_tr_b16 v[158:159], v201 offset:1536
    ds_read_b128 v[160:163], v203
    v_mfma_f32_32x32x16_bf16 v[0:15], v[164:167], v[180:183], v[0:15]
    v_mfma_f32_32x32x16_bf16 v[16:31], v[168:171], v[180:183], v[16:31]
    v_mfma_f32_32x32x16_bf16 v[32:47], v[172:175], v[180:183], v[32:47]
    v_mfma_f32_32x32x16_bf16 v[48:63], v[176:179], v[180:183], v[48:63]
    v_mfma_f32_16x16x32_bf16 v[64:67], v[184:187], v[192:195], v[64:67]
    v_mfma_f32_16x16x32_bf16 v[68:71], v[188:191], v[192:195], v[68:71]
    ds_read_b64_tr_b16 v[164:165], v200 offset:4096
    ds_read_b64_tr_b16 v[166:167], v200 offset:5120
    ds_read_b64_tr_b16 v[168:169], v201 offset:4096
    ds_read_b64_tr_b16 v[170:171], v201 offset:5120
    ds_read_b64_tr_b16 v[172:173], v200 offset:4608
    ds_read_b64_tr_b16 v[174:175], v200 offset:5632
    s_waitcnt lgkmcnt(6)
    v_mfma_f32_32x32x16_bf16 v[0:15], v[144:147], v[160:163], v[0:15]
    ds_read_b64_tr_b16 v[176:177], v201 offset:4608
    ds_read_b64_tr_b16 v[178:179], v201 offset:5632
    ds_read_b128 v[180:183], v204
    v_mfma_f32_32x32x16_bf16 v[16:31], v[148:151], v[160:163], v[16:31]
    ds_read_b64_tr_b16 v[184:185], v202 offset:0
    ds_read_b64_tr_b16 v[186:187], v202 offset:1024
    ds_read_b64_tr_b16 v[188:189], v202 offset:8
    v_mfma_f32_32x32x16_bf16 v[32:47], v[152:155], v[160:163], v[32:47]
    ds_read_b64_tr_b16 v[190:191], v202 offset:1032
    ds_read_b128 v[192:195], v205
    v_mfma_f32_32x32x16_bf16 v[48:63], v[156:159], v[160:163], v[48:63]
    v_add_u32 v200, 0x4000, v200
    v_add_u32 v202, 0x4000, v202
    v_xor_b32 v203, 64, v203
    v_xor_b32 v205, 64, v205
    v_xor_b32 v201, 64, v200
    v_xor_b32 v204, 32, v203
    s_waitcnt lgkmcnt(0)
    s_barrier
    ds_read_b64_tr_b16 v[144:145], v200 offset:0
    ds_read_b64_tr_b16 v[146:147], v200 offset:1024
    ds_read_b64_tr_b16 v[148:149], v201 offset:0
    ds_read_b64_tr_b16 v[150:151], v201 offset:1024
    ds_read_b64_tr_b16 v[152:153], v200 offset:512
    ds_read_b64_tr_b16 v[154:155], v200 offset:1536
    ds_read_b64_tr_b16 v[156:157], v201 offset:512
    ds_read_b64_tr_b16 v[158:159], v201 offset:1536
    ds_read_b128 v[160:163], v203
    v_mfma_f32_32x32x16_bf16 v[0:15], v[164:167], v[180:183], v[0:15]
    v_mfma_f32_32x32x16_bf16 v[16:31], v[168:171], v[180:183], v[16:31]
    v_mfma_f32_32x32x16_bf16 v[32:47], v[172:175], v[180:183], v[32:47]
    v_mfma_f32_32x32x16_bf16 v[48:63], v[176:179], v[180:183], v[48:63]
    v_mfma_f32_16x16x32_bf16 v[64:67], v[184:187], v[192:195], v[64:67]
    v_mfma_f32_16x16x32_bf16 v[68:71], v[188:191], v[192:195], v[68:71]
    ds_read_b64_tr_b16 v[164:165], v200 offset:4096
    ds_read_b64_tr_b16 v[166:167], v200 offset:5120
    ds_read_b64_tr_b16 v[168:169], v201 offset:4096
    ds_read_b64_tr_b16 v[170:171], v201 offset:5120
    ds_read_b64_tr_b16 v[172:173], v200 offset:4608
    ds_read_b64_tr_b16 v[174:175], v200 offset:5632
    s_waitcnt lgkmcnt(6)
    v_mfma_f32_32x32x16_bf16 v[0:15], v[144:147], v[160:163], v[0:15]
    ds_read_b64_tr_b16 v[176:177], v201 offset:4608
    ds_read_b64_tr_b16 v[178:179], v201 offset:5632
    ds_read_b128 v[180:183], v204
    v_mfma_f32_32x32x16_bf16 v[16:31], v[148:151], v[160:163], v[16:31]
    ds_read_b64_tr_b16 v[184:185], v202 offset:0
    ds_read_b64_tr_b16 v[186:187], v202 offset:1024
    ds_read_b64_tr_b16 v[188:189], v202 offset:8
    v_mfma_f32_32x32x16_bf16 v[32:47], v[152:155], v[160:163], v[32:47]
    ds_read_b64_tr_b16 v[190:191], v202 offset:1032
    ds_read_b128 v[192:195], v205
    v_mfma_f32_32x32x16_bf16 v[48:63], v[156:159], v[160:163], v[48:63]
    s_add_u32 s69, s69, 0xc800
    s_cmp_ge_u32 s69, 0x25800
    s_cselect_b32 s69, 0, s69
    s_sub_u32 s50, s50, 1
    s_cmp_lg_u32 s50, 0
    s_cbranch_scc1 QLOOP0
    v_add_u32 v200, s69, v196
    v_add_u32 v202, s69, v197
    v_add_u32 v203, s69, v198
    v_add_u32 v205, s69, v199
    v_xor_b32 v201, 64, v200
    v_xor_b32 v204, 32, v203
    s_waitcnt lgkmcnt(0)
    s_barrier
    ds_read_b64_tr_b16 v[144:145], v200 offset:0
    ds_read_b64_tr_b16 v[146:147], v200 offset:1024
    ds_read_b64_tr_b16 v[148:149], v201 offset:0
    ds_read_b64_tr_b16 v[150:151], v201 offset:1024
    ds_read_b64_tr_b16 v[152:153], v200 offset:512
    ds_read_b64_tr_b16 v[154:155], v200 offset:1536
    ds_read_b64_tr_b16 v[156:157], v201 offset:512
    ds_read_b64_tr_b16 v[158:159], v201 offset:1536
    ds_read_b128 v[160:163], v203
    v_mfma_f32_32x32x16_bf16 v[0:15], v[164:167], v[180:183], v[0:15]
    v_mfma_f32_32x32x16_bf16 v[16:31], v[168:171], v[180:183], v[16:31]
    v_mfma_f32_32x32x16_bf16 v[32:47], v[172:175], v[180:183], v[32:47]
    v_mfma_f32_32x32x16_bf16 v[48:63], v[176:179], v[180:183], v[48:63]
    v_mfma_f32_16x16x32_bf16 v[64:67], v[184:187], v[192:195], v[64:67]
    v_mfma_f32_16x16x32_bf16 v[68:71], v[188:191], v[192:195], v[68:71]
    ds_read_b64_tr_b16 v[164:165], v200 offset:4096
    ds_read_b64_tr_b16 v[166:167], v200 offset:5120
    ds_read_b64_tr_b16 v[168:169], v201 offset:4096
    ds_read_b64_tr_b16 v[170:171], v201 offset:5120
    ds_read_b64_tr_b16 v[172:173], v200 offset:4608
    ds_read_b64_tr_b16 v[174:175], v200 offset:5632
    s_waitcnt lgkmcnt(6)
    v_mfma_f32_32x32x16_bf16 v[0:15], v[144:147], v[160:163], v[0:15]
    ds_read_b64_tr_b16 v[176:177], v201 offset:4608
    ds_read_b64_tr_b16 v[178:179], v201 offset:5632
    ds_read_b128 v[180:183], v204
    v_mfma_f32_32x32x16_bf16 v[16:31], v[148:151], v[160:163], v[16:31]
    ds_read_b64_tr_b16 v[184:185], v202 offset:0
    ds_read_b64_tr_b16 v[186:187], v202 offset:1024
    ds_read_b64_tr_b16 v[188:189], v202 offset:8
    v_mfma_f32_32x32x16_bf16 v[32:47], v[152:155], v[160:163], v[32:47]
    ds_read_b64_tr_b16 v[190:191], v202 offset:1032
    ds_read_b128 v[192:195], v205
    v_mfma_f32_32x32x16_bf16 v[48:63], v[156:159], v[160:163], v[48:63]
    v_add_u32 v200, 0x4000, v200
    v_add_u32 v202, 0x4000, v202
    v_xor_b32 v203, 64, v203
    v_xor_b32 v205, 64, v205
    v_xor_b32 v201, 64, v200
    v_xor_b32 v204, 32, v203
    s_waitcnt lgkmcnt(0)
    s_barrier
    ds_read_b64_tr_b16 v[144:145], v200 offset:0
    ds_read_b64_tr_b16 v[146:147], v200 offset:1024
    ds_read_b64_tr_b16 v[148:149], v201 offset:0
    ds_read_b64_tr_b16 v[150:151], v201 offset:1024
    ds_read_b64_tr_b16 v[152:153], v200 offset:512
    ds_read_b64_tr_b16 v[154:155], v200 offset:1536
    ds_read_b64_tr_b16 v[156:157], v201 offset:512
    ds_read_b64_tr_b16 v[158:159], v201 offset:1536
    ds_read_b128 v[160:163], v203
    v_mfma_f32_32x32x16_bf16 v[0:15], v[164:167], v[180:183], v[0:15]
    v_mfma_f32_32x32x16_bf16 v[16:31], v[168:171], v[180:183], v[16:31]
    v_mfma_f32_32x32x16_bf16 v[32:47], v[172:175], v[180:183], v[32:47]
    v_mfma_f32_32x32x16_bf16 v[48:63], v[176:179], v[180:183], v[48:63]
    v_mfma_f32_16x16x32_bf16 v[64:67], v[184:187], v[192:195], v[64:67]
    v_mfma_f32_16x16x32_bf16 v[68:71], v[188:191], v[192:195], v[68:71]
    ds_read_b64_tr_b16 v[164:165], v200 offset:4096
    ds_read_b64_tr_b16 v[166:167], v200 offset:5120
    ds_read_b64_tr_b16 v[168:169], v201 offset:4096
    ds_read_b64_tr_b16 v[170:171], v201 offset:5120
    ds_read_b64_tr_b16 v[172:173], v200 offset:4608
    ds_read_b64_tr_b16 v[174:175], v200 offset:5632
    s_waitcnt lgkmcnt(6)
    v_mfma_f32_32x32x16_bf16 v[0:15], v[144:147], v[160:163], v[0:15]
    ds_read_b64_tr_b16 v[176:177], v201 offset:4608
    ds_read_b64_tr_b16 v[178:179], v201 offset:5632
    ds_read_b128 v[180:183], v204
    v_mfma_f32_32x32x16_bf16 v[16:31], v[148:151], v[160:163], v[16:31]
    ds_read_b64_tr_b16 v[184:185], v202 offset:0
    ds_read_b64_tr_b16 v[186:187], v202 offset:1024
    ds_read_b64_tr_b16 v[188:189], v202 offset:8
    v_mfma_f32_32x32x16_bf16 v[32:47], v[152:155], v[160:163], v[32:47]
    ds_read_b64_tr_b16 v[190:191], v202 offset:1032
    ds_read_b128 v[192:195], v205
    v_mfma_f32_32x32x16_bf16 v[48:63], v[156:159], v[160:163], v[48:63]
    s_add_u32 s69, s69, 0xc800
    s_cmp_ge_u32 s69, 0x25800
    s_cselect_b32 s69, 0, s69
    v_add_u32 v200, s69, v196
    v_add_u32 v202, s69, v197
    v_add_u32 v203, s69, v198
    v_add_u32 v205, s69, v199
    v_xor_b32 v201, 64, v200
    v_xor_b32 v204, 32, v203
    s_waitcnt lgkmcnt(0)
    s_barrier
    ds_read_b64_tr_b16 v[144:145], v200 offset:0
    ds_read_b64_tr_b16 v[146:147], v200 offset:1024
    ds_read_b64_tr_b16 v[148:149], v201 offset:0
    ds_read_b64_tr_b16 v[150:151], v201 offset:1024
    ds_read_b64_tr_b16 v[152:153], v200 offset:512
    ds_read_b64_tr_b16 v[154:155], v200 offset:1536
    ds_read_b64_tr_b16 v[156:157], v201 offset:512
    ds_read_b64_tr_b16 v[158:159], v201 offset:1536
    ds_read_b128 v[160:163], v203
    v_mfma_f32_32x32x16_bf16 v[0:15], v[164:167], v[180:183], v[0:15]
    v_mfma_f32_32x32x16_bf16 v[16:31], v[168:171], v[180:183], v[16:31]
    v_mfma_f32_32x32x16_bf16 v[32:47], v[172:175], v[180:183], v[32:47]
    v_mfma_f32_32x32x16_bf16 v[48:63], v[176:179], v[180:183], v[48:63]
    v_mfma_f32_16x16x32_bf16 v[64:67], v[184:187], v[192:195], v[64:67]
    v_mfma_f32_16x16x32_bf16 v[68:71], v[188:191], v[192:195], v[68:71]
    ds_read_b64_tr_b16 v[164:165], v200 offset:4096
    ds_read_b64_tr_b16 v[166:167], v200 offset:5120
    ds_read_b64_tr_b16 v[168:169], v201 offset:4096
    ds_read_b64_tr_b16 v[170:171], v201 offset:5120
    ds_read_b64_tr_b16 v[172:173], v200 offset:4608
    ds_read_b64_tr_b16 v[174:175], v200 offset:5632
    s_waitcnt lgkmcnt(6)
    v_mfma_f32_32x32x16_bf16 v[0:15], v[144:147], v[160:163], v[0:15]
    ds_read_b64_tr_b16 v[176:177], v201 offset:4608
    ds_read_b64_tr_b16 v[178:179], v201 offset:5632
    ds_read_b128 v[180:183], v204
    v_mfma_f32_32x32x16_bf16 v[16:31], v[148:151], v[160:163], v[16:31]
    ds_read_b64_tr_b16 v[184:185], v202 offset:0
    ds_read_b64_tr_b16 v[186:187], v202 offset:1024
    ds_read_b64_tr_b16 v[188:189], v202 offset:8
    v_mfma_f32_32x32x16_bf16 v[32:47], v[152:155], v[160:163], v[32:47]
    ds_read_b64_tr_b16 v[190:191], v202 offset:1032
    ds_read_b128 v[192:195], v205
    v_mfma_f32_32x32x16_bf16 v[48:63], v[156:159], v[160:163], v[48:63]
    v_add_u32 v200, 0x4000, v200
    v_add_u32 v202, 0x4000, v202
    v_xor_b32 v203, 64, v203
    v_xor_b32 v205, 64, v205
    v_xor_b32 v201, 64, v200
    v_xor_b32 v204, 32, v203
    s_waitcnt lgkmcnt(0)
    s_barrier
    ds_read_b64_tr_b16 v[144:145], v200 offset:0
    ds_read_b64_tr_b16 v[146:147], v200 offset:1024
    ds_read_b64_tr_b16 v[148:149], v201 offset:0
    ds_read_b64_tr_b16 v[150:151], v201 offset:1024
    ds_read_b64_tr_b16 v[152:153], v200 offset:512
    ds_read_b64_tr_b16 v[154:155], v200 offset:1536
    ds_read_b64_tr_b16 v[156:157], v201 offset:512
    ds_read_b64_tr_b16 v[158:159], v201 offset:1536
    ds_read_b128 v[160:163], v203
    v_mfma_f32_32x32x16_bf16 v[0:15], v[164:167], v[180:183], v[0:15]
    v_mfma_f32_32x32x16_bf16 v[16:31], v[168:171], v[180:183], v[16:31]
    v_mfma_f32_32x32x16_bf16 v[32:47], v[172:175], v[180:183], v[32:47]
    v_mfma_f32_32x32x16_bf16 v[48:63], v[176:179], v[180:183], v[48:63]
    v_mfma_f32_16x16x32_bf16 v[64:67], v[184:187], v[192:195], v[64:67]
    v_mfma_f32_16x16x32_bf16 v[68:71], v[188:191], v[192:195], v[68:71]
    ds_read_b64_tr_b16 v[164:165], v200 offset:4096
    ds_read_b64_tr_b16 v[166:167], v200 offset:5120
    ds_read_b64_tr_b16 v[168:169], v201 offset:4096
    ds_read_b64_tr_b16 v[170:171], v201 offset:5120
    ds_read_b64_tr_b16 v[172:173], v200 offset:4608
    ds_read_b64_tr_b16 v[174:175], v200 offset:5632
    s_waitcnt lgkmcnt(6)
    v_mfma_f32_32x32x16_bf16 v[0:15], v[144:147], v[160:163], v[0:15]
    ds_read_b64_tr_b16 v[176:177], v201 offset:4608
    ds_read_b64_tr_b16 v[178:179], v201 offset:5632
    ds_read_b128 v[180:183], v204
    v_mfma_f32_32x32x16_bf16 v[16:31], v[148:151], v[160:163], v[16:31]
    ds_read_b64_tr_b16 v[184:185], v202 offset:0
    ds_read_b64_tr_b16 v[186:187], v202 offset:1024
    ds_read_b64_tr_b16 v[188:189], v202 offset:8
    v_mfma_f32_32x32x16_bf16 v[32:47], v[152:155], v[160:163], v[32:47]
    ds_read_b64_tr_b16 v[190:191], v202 offset:1032
    ds_read_b128 v[192:195], v205
    v_mfma_f32_32x32x16_bf16 v[48:63], v[156:159], v[160:163], v[48:63]
    s_add_u32 s69, s69, 0xc800
    s_cmp_ge_u32 s69, 0x25800
    s_cselect_b32 s69, 0, s69
QX:
    s_waitcnt lgkmcnt(0)
    s_barrier
    s_add_u32 s52, s42, s59
    s_lshl_b32 s51, s37, 12
    s_mov_b32 s53, 0x2000
    s_cmp_eq_u32 s41, 0
    s_cselect_b32 s53, s53, 0x24400
    s_add_u32 s43, s51, s53
    s_cmp_eq_u32 s41, 0
    s_cbranch_scc1 NOFLAGCLR
    v_lshlrev_b32 v251, 2, v254
    v_and_b32 v251, 0x7c, v251
    v_add_u32 v251, 0x24000, v251
    v_mov_b32 v252, 0
    ds_write_b32 v251, v252
NOFLAGCLR:
    v_mfma_f32_32x32x16_bf16 v[0:15], v[164:167], v[180:183], v[0:15]
    v_mfma_f32_32x32x16_bf16 v[16:31], v[168:171], v[180:183], v[16:31]
    v_mfma_f32_32x32x16_bf16 v[32:47], v[172:175], v[180:183], v[32:47]
    v_mfma_f32_32x32x16_bf16 v[48:63], v[176:179], v[180:183], v[48:63]
    v_mfma_f32_16x16x32_bf16 v[64:67], v[184:187], v[192:195], v[64:67]
    v_mfma_f32_16x16x32_bf16 v[68:71], v[188:191], v[192:195], v[68:71]
    s_mov_b32 s50, s57
    s_mov_b32 s57, s56
    s_cmp_eq_u32 s41, 0
    s_cbranch_scc0 FILL_B
    s_cmp_lt_u32 s50, 4
    s_cbranch_scc1 NOFILL_A
NOFILL_A:
    s_nop 0
    v_pk_mul_f32 v[0:1], v[0:1], s[56:57]
    v_pk_mul_f32 v[2:3], v[2:3], s[56:57]
    v_pk_mul_f32 v[4:5], v[4:5], s[56:57]
    v_pk_mul_f32 v[6:7], v[6:7], s[56:57]
    v_pk_mul_f32 v[8:9], v[8:9], s[56:57]
    v_pk_mul_f32 v[10:11], v[10:11], s[56:57]
    v_pk_mul_f32 v[12:13], v[12:13], s[56:57]
    v_pk_mul_f32 v[14:15], v[14:15], s[56:57]
    v_pk_mul_f32 v[16:17], v[16:17], s[56:57]
    v_pk_mul_f32 v[18:19], v[18:19], s[56:57]
    v_pk_mul_f32 v[20:21], v[20:21], s[56:57]
    v_pk_mul_f32 v[22:23], v[22:23], s[56:57]
    v_pk_mul_f32 v[24:25], v[24:25], s[56:57]
    v_pk_mul_f32 v[26:27], v[26:27], s[56:57]
    v_pk_mul_f32 v[28:29], v[28:29], s[56:57]
    v_pk_mul_f32 v[30:31], v[30:31], s[56:57]
    v_pk_mul_f32 v[32:33], v[32:33], s[56:57]
    v_pk_mul_f32 v[34:35], v[34:35], s[56:57]
    v_pk_mul_f32 v[36:37], v[36:37], s[56:57]
    v_pk_mul_f32 v[38:39], v[38:39], s[56:57]
    v_pk_mul_f32 v[40:41], v[40:41], s[56:57]
    v_pk_mul_f32 v[42:43], v[42:43], s[56:57]
    v_pk_mul_f32 v[44:45], v[44:45], s[56:57]
    v_pk_mul_f32 v[46:47], v[46:47], s[56:57]
    v_pk_mul_f32 v[48:49], v[48:49], s[56:57]
    v_pk_mul_f32 v[50:51], v[50:51], s[56:57]
    v_pk_mul_f32 v[52:53], v[52:53], s[56:57]
    v_pk_mul_f32 v[54:55], v[54:55], s[56:57]
    v_pk_mul_f32 v[56:57], v[56:57], s[56:57]
    v_pk_mul_f32 v[58:59], v[58:59], s[56:57]
    v_pk_mul_f32 v[60:61], v[60:61], s[56:57]
    v_pk_mul_f32 v[62:63], v[62:63], s[56:57]
    v_pk_mul_f32 v[64:65], v[64:65], s[56:57]
    v_pk_mul_f32 v[66:67], v[66:67], s[56:57]
    v_pk_mul_f32 v[68:69], v[68:69], s[56:57]
    v_pk_mul_f32 v[70:71], v[70:71], s[56:57]
    v_cvt_pk_bf16_f32 v96, v0, v1
    v_cvt_pk_bf16_f32 v97, v2, v3
    v_cvt_pk_bf16_f32 v98, v4, v5
    v_cvt_pk_bf16_f32 v99, v6, v7
    v_cvt_pk_bf16_f32 v100, v8, v9
    v_cvt_pk_bf16_f32 v101, v10, v11
    v_cvt_pk_bf16_f32 v102, v12, v13
    v_cvt_pk_bf16_f32 v103, v14, v15
    v_cvt_pk_bf16_f32 v104, v16, v17
    v_cvt_pk_bf16_f32 v105, v18, v19
    v_cvt_pk_bf16_f32 v106, v20, v21
    v_cvt_pk_bf16_f32 v107, v22, v23
    v_cvt_pk_bf16_f32 v108, v24, v25
    v_cvt_pk_bf16_f32 v109, v26, v27
    v_cvt_pk_bf16_f32 v110, v28, v29
    v_cvt_pk_bf16_f32 v111, v30, v31
    v_cvt_pk_bf16_f32 v112, v32, v33
    v_cvt_pk_bf16_f32 v113, v34, v35
    v_cvt_pk_bf16_f32 v114, v36, v37
    v_cvt_pk_bf16_f32 v115, v38, v39
    v_cvt_pk_bf16_f32 v116, v40, v41
    v_cvt_pk_bf16_f32 v117, v42, v43
    v_cvt_pk_bf16_f32 v118, v44, v45
    v_cvt_pk_bf16_f32 v119, v46, v47
    v_cvt_pk_bf16_f32 v120, v48, v49
    v_cvt_pk_bf16_f32 v121, v50, v51
    v_cvt_pk_bf16_f32 v122, v52, v53
    v_cvt_pk_bf16_f32 v123, v54, v55
    v_cvt_pk_bf16_f32 v124, v56, v57
    v_cvt_pk_bf16_f32 v125, v58, v59
    v_cvt_pk_bf16_f32 v126, v60, v61
    v_cvt_pk_bf16_f32 v127, v62, v63
    v_cvt_pk_bf16_f32 v128, v64, v65
    v_cvt_pk_bf16_f32 v129, v66, v67
    v_cvt_pk_bf16_f32 v130, v68, v69
    v_cvt_pk_bf16_f32 v131, v70, v71
    v_lshlrev_b32 v251, 4, v254
    s_lshl_b32 s51, s38, 10
    s_add_u32 s51, s51, s43
    v_add_u32 v251, s51, v251
    ds_write_b128 v251, v[128:131]
    s_waitcnt vmcnt(12) lgkmcnt(0)
    s_barrier
    s_add_u32 s51, s36, 2
    s_and_b32 s51, s51, 7
    s_cmp_ge_u32 s51, 4
    s_cbranch_scc1 ATT_AL
    s_bitcmp1_b32 s36, 0
    s_cbranch_scc1 ATT_AY
ATT_AX:
    s_setprio 1
    v_lshlrev_b32 v251, 4, v254
    v_add_u32 v251, s43, v251
    ds_read_b128 v[128:131], v251 offset:0
    ds_read_b128 v[132:135], v251 offset:1024
    ds_read_b128 v[136:139], v251 offset:2048
    ds_read_b128 v[140:143], v251 offset:3072
    ds_read_b128 v[204:207], v238 offset:0
    ds_read_b128 v[208:211], v239 offset:0
    ds_read_b128 v[212:215], v240 offset:0
    ds_read_b128 v[216:219], v241 offset:0
    ds_read_b128 v[220:223], v238 offset:512
    ds_read_b128 v[224:227], v239 offset:512
    ds_read_b128 v[228:231], v240 offset:512
    ds_read_b128 v[232:235], v241 offset:512
    s_waitcnt lgkmcnt(7)
    v_mfma_f32_32x32x16_bf16 v[144:159], v[204:207], v[96:99], 0
    s_waitcnt lgkmcnt(6)
    v_mfma_f32_32x32x16_bf16 v[144:159], v[208:211], v[100:103], v[144:159]
    s_waitcnt lgkmcnt(5)
    v_mfma_f32_32x32x16_bf16 v[144:159], v[212:215], v[104:107], v[144:159]
    s_waitcnt lgkmcnt(4)
    v_mfma_f32_32x32x16_bf16 v[144:159], v[216:219], v[108:111], v[144:159]
    s_waitcnt lgkmcnt(3)
    v_mfma_f32_32x32x16_bf16 v[144:159], v[220:223], v[112:115], v[144:159]
    s_waitcnt lgkmcnt(2)
    v_mfma_f32_32x32x16_bf16 v[144:159], v[224:227], v[116:119], v[144:159]
    s_waitcnt lgkmcnt(1)
    v_mfma_f32_32x32x16_bf16 v[144:159], v[228:231], v[120:123], v[144:159]
    s_waitcnt lgkmcnt(0)
    v_mfma_f32_32x32x16_bf16 v[144:159], v[232:235], v[124:127], v[144:159]
    v_mov_b32 v236, 0
    v_mov_b32 v249, 0
    v_mov_b32 v237, 0
    v_mov_b32 v64, 0
    v_mov_b32 v65, 0
    v_mov_b32 v66, 0
    v_mov_b32 v67, 0
    v_mov_b32 v68, 0
    v_mov_b32 v69, 0
    v_mov_b32 v70, 0
    v_mov_b32 v71, 0
    v_mov_b32 v72, 0
    v_mov_b32 v73, 0
    v_mov_b32 v74, 0
    v_mov_b32 v75, 0
    v_mov_b32 v76, 0
    v_mov_b32 v77, 0
    v_mov_b32 v78, 0
    v_mov_b32 v79, 0
    v_mov_b32 v80, 0
    v_mov_b32 v81, 0
    v_mov_b32 v82, 0
    v_mov_b32 v83, 0
    v_mov_b32 v84, 0
    v_mov_b32 v85, 0
    v_mov_b32 v86, 0
    v_mov_b32 v87, 0
    v_mov_b32 v88, 0
    v_mov_b32 v89, 0
    v_mov_b32 v90, 0
    v_mov_b32 v91, 0
    v_mov_b32 v92, 0
    v_mov_b32 v93, 0
    v_mov_b32 v94, 0
    v_mov_b32 v95, 0
    v_add_u32 v246, s42, v244
    v_xor_b32 v247, 64, v246
    v_max3_f32 v250, v144, v145, v146
    v_max3_f32 v250, v250, v147, v148
    v_max3_f32 v250, v250, v149, v150
    v_max3_f32 v250, v250, v151, v152
    v_max3_f32 v250, v250, v153, v154
    v_max3_f32 v250, v250, v155, v156
    v_max3_f32 v250, v250, v157, v158
    v_max_f32 v250, v250, v159
    v_mov_b32 v251, v250
    v_mov_b32 v252, v250
    s_nop 1
    v_permlane32_swap_b32 v251, v252
    v_max_f32 v250, v251, v252
    v_sub_f32 v176, 0, v250
    v_sub_f32 v177, 0, v250
    v_sub_f32 v178, 0, v250
    v_sub_f32 v179, 0, v250
    v_sub_f32 v180, 0, v250
    v_sub_f32 v181, 0, v250
    v_sub_f32 v182, 0, v250
    v_sub_f32 v183, 0, v250
    v_sub_f32 v184, 0, v250
    v_sub_f32 v185, 0, v250
    v_sub_f32 v186, 0, v250
    v_sub_f32 v187, 0, v250
    v_sub_f32 v188, 0, v250
    v_sub_f32 v189, 0, v250
    v_sub_f32 v190, 0, v250
    v_sub_f32 v191, 0, v250
    v_sub_f32 v144, v144, v250
    v_sub_f32 v145, v145, v250
    v_sub_f32 v146, v146, v250
    v_sub_f32 v147, v147, v250
    v_sub_f32 v148, v148, v250
    v_sub_f32 v149, v149, v250
    v_sub_f32 v150, v150, v250
    v_sub_f32 v151, v151, v250
    v_sub_f32 v152, v152, v250
    v_sub_f32 v153, v153, v250
    v_sub_f32 v154, v154, v250
    v_sub_f32 v155, v155, v250
    v_sub_f32 v156, v156, v250
    v_sub_f32 v157, v157, v250
    v_sub_f32 v158, v158, v250
    v_sub_f32 v159, v159, v250
    s_mov_b32 s50, 14
    ds_read_b128 v[204:207], v246 offset:0
    ds_read_b128 v[208:211], v246 offset:4096
    ds_read_b128 v[212:215], v247 offset:0
    ds_read_b128 v[216:219], v247 offset:4096
    ds_read_b128 v[220:223], v246 offset:512
    ds_read_b128 v[224:227], v246 offset:4608
    s_waitcnt lgkmcnt(4)
    v_mfma_f32_16x16x32_bf16 v[192:195], v[204:207], v[128:131], 0
    ds_read_b128 v[228:231], v247 offset:512
    s_mov_b32 s44, s42
    s_add_u32 s42, s42, 0x4000
    s_cmp_ge_u32 s42, 0x28000
    s_cselect_b32 s51, 0x28000, 0
    s_sub_u32 s42, s42, s51
    s_sub_u32 s45, s42, s44
    v_exp_f32 v144, v144
    v_exp_f32 v145, v145
    v_mfma_f32_16x16x32_bf16 v[196:199], v[208:211], v[128:131], 0
    ds_read_b128 v[232:235], v247 offset:4608
    v_exp_f32 v146, v146
    v_add_f32 v236, v236, v144
    v_add_f32 v249, v249, v145
    s_waitcnt lgkmcnt(4)
    v_mfma_f32_16x16x32_bf16 v[192:195], v[212:215], v[132:135], v[192:195]
    v_cvt_pk_bf16_f32 v144, v144, v145
    v_exp_f32 v147, v147
    v_exp_f32 v148, v148
    v_mfma_f32_16x16x32_bf16 v[196:199], v[216:219], v[132:135], v[196:199]
    v_add_f32 v236, v236, v146
    v_add_f32 v249, v249, v147
    v_cvt_pk_bf16_f32 v145, v146, v147
    v_exp_f32 v149, v149
    s_waitcnt lgkmcnt(2)
    v_mfma_f32_16x16x32_bf16 v[192:195], v[220:223], v[136:139], v[192:195]
    v_exp_f32 v150, v150
    v_add_f32 v236, v236, v148
    v_add_f32 v249, v249, v149
    v_mfma_f32_16x16x32_bf16 v[196:199], v[224:227], v[136:139], v[196:199]
    v_cvt_pk_bf16_f32 v146, v148, v149
    v_exp_f32 v151, v151
    v_exp_f32 v152, v152
    s_waitcnt lgkmcnt(0)
    v_mfma_f32_16x16x32_bf16 v[192:195], v[228:231], v[140:143], v[192:195]
    v_add_f32 v236, v236, v150
    v_add_f32 v249, v249, v151
    v_cvt_pk_bf16_f32 v147, v150, v151
    v_exp_f32 v153, v153
    v_mfma_f32_16x16x32_bf16 v[196:199], v[232:235], v[140:143], v[196:199]
    v_exp_f32 v154, v154
    v_add_f32 v236, v236, v152
    v_add_u32 v238, s45, v238
    v_add_u32 v239, s45, v239
    v_add_u32 v240, s45, v240
    v_add_u32 v241, s45, v241
    v_add_u32 v242, s45, v242
    v_add_u32 v243, s45, v243
    v_add_u32 v246, s42, v245
    v_xor_b32 v247, 64, v246
    s_waitcnt lgkmcnt(0)
    s_barrier
    ds_read_b128 v[204:207], v238 offset:0
    ds_read_b128 v[208:211], v239 offset:0
    ds_read_b128 v[212:215], v240 offset:0
    ds_read_b128 v[216:219], v241 offset:0
    ds_read_b128 v[220:223], v238 offset:512
    ds_read_b128 v[224:227], v239 offset:512
    s_waitcnt lgkmcnt(4)
    v_mfma_f32_32x32x16_bf16 v[160:175], v[204:207], v[96:99], v[176:191]
    ds_read_b128 v[228:231], v240 offset:512
    v_max3_f32 v253, v192, v193, v194
    v_max3_f32 v253, v253, v195, v196
    v_max3_f32 v253, v253, v197, v198
    v_max_f32 v253, v253, v199
    ds_swizzle_b32 v251, v253 offset:0x401F
    s_waitcnt lgkmcnt(0)
    v_max_f32 v253, v253, v251
    v_mov_b32 v251, v253
    v_mov_b32 v252, v253
    v_mfma_f32_32x32x16_bf16 v[160:175], v[208:211], v[100:103], v[160:175]
    ds_read_b128 v[232:235], v241 offset:512
    v_permlane32_swap_b32 v251, v252
    v_max_f32 v253, v251, v252
    v_sub_f32 v200, 0, v253
    v_sub_f32 v201, 0, v253
    v_sub_f32 v202, 0, v253
    v_sub_f32 v203, 0, v253
    v_sub_f32 v192, v192, v253
    v_sub_f32 v193, v193, v253
    v_sub_f32 v194, v194, v253
    v_mfma_f32_32x32x16_bf16 v[160:175], v[212:215], v[104:107], v[160:175]
    ds_read_b64_tr_b16 v[204:205], v246 offset:0
    ds_read_b64_tr_b16 v[206:207], v246 offset:4096
    v_sub_f32 v195, v195, v253
    v_sub_f32 v196, v196, v253
    v_sub_f32 v197, v197, v253
    v_sub_f32 v198, v198, v253
    v_sub_f32 v199, v199, v253
    v_exp_f32 v192, v192
    v_exp_f32 v193, v193
    v_mfma_f32_32x32x16_bf16 v[160:175], v[216:219], v[108:111], v[160:175]
    ds_read_b64_tr_b16 v[208:209], v246 offset:32
    ds_read_b64_tr_b16 v[210:211], v246 offset:4128
    v_exp_f32 v194, v194
    v_add_f32 v237, v237, v192
    v_add_f32 v237, v237, v193
    v_cvt_pk_bf16_f32 v192, v192, v193
    v_exp_f32 v195, v195
    v_exp_f32 v196, v196
    v_mfma_f32_32x32x16_bf16 v[160:175], v[220:223], v[112:115], v[160:175]
    ds_read_b64_tr_b16 v[212:213], v247 offset:0
    ds_read_b64_tr_b16 v[214:215], v247 offset:4096
    v_add_f32 v237, v237, v194
    v_add_f32 v237, v237, v195
    v_cvt_pk_bf16_f32 v193, v194, v195
    v_exp_f32 v197, v197
    v_add_f32 v249, v249, v153
    v_exp_f32 v198, v198
    v_cvt_pk_bf16_f32 v152, v152, v153
    v_mfma_f32_32x32x16_bf16 v[160:175], v[224:227], v[116:119], v[160:175]
    ds_read_b64_tr_b16 v[216:217], v247 offset:32
    ds_read_b64_tr_b16 v[218:219], v247 offset:4128
    v_add_f32 v237, v237, v196
    v_add_f32 v237, v237, v197
    v_cvt_pk_bf16_f32 v194, v196, v197
    v_exp_f32 v199, v199
    v_add_f32 v237, v237, v198
    v_add_f32 v237, v237, v199
    v_cvt_pk_bf16_f32 v195, v198, v199
    v_exp_f32 v155, v155
    s_waitcnt lgkmcnt(8)
    v_mfma_f32_32x32x16_bf16 v[160:175], v[228:231], v[120:123], v[160:175]
    ds_read_b64_tr_b16 v[220:221], v246 offset:512
    ds_read_b64_tr_b16 v[222:223], v246 offset:4608
    v_exp_f32 v156, v156
    v_add_f32 v236, v236, v154
    v_add_f32 v249, v249, v155
    v_cvt_pk_bf16_f32 v153, v154, v155
    v_exp_f32 v157, v157
    v_exp_f32 v158, v158
    v_mfma_f32_32x32x16_bf16 v[160:175], v[232:235], v[124:127], v[160:175]
    ds_read_b64_tr_b16 v[224:225], v246 offset:544
    ds_read_b64_tr_b16 v[226:227], v246 offset:4640
    v_add_f32 v236, v236, v156
    v_add_f32 v249, v249, v157
    v_cvt_pk_bf16_f32 v154, v156, v157
    v_exp_f32 v159, v159
    v_add_f32 v236, v236, v158
    v_add_f32 v249, v249, v159
    v_cvt_pk_bf16_f32 v155, v158, v159
    s_waitcnt lgkmcnt(8)
    v_mfma_f32_16x16x32_bf16 v[64:67], v[204:207], v[192:195], v[64:67]
    ds_read_b64_tr_b16 v[228:229], v247 offset:512
    ds_read_b64_tr_b16 v[230:231], v247 offset:4608
    s_mov_b32 s44, s42
    s_add_u32 s42, s42, 0x4000
    s_cmp_ge_u32 s42, 0x28000
    s_cselect_b32 s51, 0x28000, 0
    s_sub_u32 s42, s42, s51
    s_sub_u32 s45, s42, s44
    v_mfma_f32_16x16x32_bf16 v[68:71], v[208:211], v[192:195], v[68:71]
    ds_read_b64_tr_b16 v[232:233], v247 offset:544
    ds_read_b64_tr_b16 v[234:235], v247 offset:4640
    v_max3_f32 v250, v160, v161, v162
    v_max3_f32 v250, v250, v163, v164
    s_waitcnt lgkmcnt(8)
    v_mfma_f32_16x16x32_bf16 v[72:75], v[212:215], v[192:195], v[72:75]
    ds_read_b64_tr_b16 v[204:205], v242 offset:0
    ds_read_b64_tr_b16 v[206:207], v242 offset:2048
    v_max3_f32 v250, v250, v165, v166
    v_max3_f32 v250, v250, v167, v168
    v_mfma_f32_16x16x32_bf16 v[76:79], v[216:219], v[192:195], v[76:79]
    ds_read_b64_tr_b16 v[208:209], v243 offset:0
    ds_read_b64_tr_b16 v[210:211], v243 offset:2048
    v_max3_f32 v250, v250, v169, v170
    v_max3_f32 v250, v250, v171, v172
    s_waitcnt lgkmcnt(8)
    v_mfma_f32_16x16x32_bf16 v[80:83], v[220:223], v[192:195], v[80:83]
    ds_read_b64_tr_b16 v[212:213], v242 offset:512
    ds_read_b64_tr_b16 v[214:215], v242 offset:2560
    v_max3_f32 v250, v250, v173, v174
    v_max_f32 v250, v250, v175
    v_mfma_f32_16x16x32_bf16 v[84:87], v[224:227], v[192:195], v[84:87]
    ds_read_b64_tr_b16 v[216:217], v243 offset:512
    ds_read_b64_tr_b16 v[218:219], v243 offset:2560
    v_cmp_lt_f32 vcc, s58, v250
    s_cbranch_vccnz RARE_AX_first1
    v_exp_f32 v160, v160
    s_waitcnt lgkmcnt(8)
    v_mfma_f32_16x16x32_bf16 v[88:91], v[228:231], v[192:195], v[88:91]
    ds_read_b64_tr_b16 v[220:221], v242 offset:4096
    ds_read_b64_tr_b16 v[222:223], v242 offset:6144
    v_exp_f32 v161, v161
    v_mfma_f32_16x16x32_bf16 v[92:95], v[232:235], v[192:195], v[92:95]
    ds_read_b64_tr_b16 v[224:225], v243 offset:4096
    ds_read_b64_tr_b16 v[226:227], v243 offset:6144
    v_exp_f32 v162, v162
    s_waitcnt lgkmcnt(8)
    v_mfma_f32_32x32x16_bf16 v[0:15], v[204:207], v[144:147], 0
    ds_read_b64_tr_b16 v[228:229], v242 offset:4608
    ds_read_b64_tr_b16 v[230:231], v242 offset:6656
    v_add_f32 v236, v236, v160
    v_add_f32 v249, v249, v161
    v_cvt_pk_bf16_f32 v160, v160, v161
    v_exp_f32 v163, v163
    v_mfma_f32_32x32x16_bf16 v[16:31], v[208:211], v[144:147], 0
    ds_read_b64_tr_b16 v[232:233], v243 offset:4608
    ds_read_b64_tr_b16 v[234:235], v243 offset:6656
    v_exp_f32 v164, v164
    v_add_f32 v236, v236, v162
    s_waitcnt lgkmcnt(8)
    v_mfma_f32_32x32x16_bf16 v[32:47], v[212:215], v[144:147], 0
    v_add_u32 v238, s45, v238
    v_add_u32 v239, s45, v239
    v_add_u32 v240, s45, v240
    v_add_u32 v241, s45, v241
    v_add_u32 v242, s45, v242
    v_add_u32 v243, s45, v243
    v_add_u32 v246, s42, v244
    v_xor_b32 v247, 64, v246
    s_waitcnt lgkmcnt(0)
    s_barrier
    ds_read_b128 v[204:207], v238 offset:0
    v_add_f32 v249, v249, v163
    v_cvt_pk_bf16_f32 v161, v162, v163
    v_exp_f32 v165, v165
    v_mfma_f32_32x32x16_bf16 v[48:63], v[216:219], v[144:147], 0
    ds_read_b128 v[208:211], v239 offset:0
    v_exp_f32 v166, v166
    v_add_f32 v236, v236, v164
    v_mfma_f32_32x32x16_bf16 v[0:15], v[220:223], v[152:155], v[0:15]
    ds_read_b128 v[212:215], v240 offset:0
    v_add_f32 v249, v249, v165
    v_cvt_pk_bf16_f32 v162, v164, v165
    v_exp_f32 v167, v167
    v_mfma_f32_32x32x16_bf16 v[16:31], v[224:227], v[152:155], v[16:31]
    ds_read_b128 v[216:219], v241 offset:0
    v_exp_f32 v168, v168
    v_add_f32 v236, v236, v166
    v_mfma_f32_32x32x16_bf16 v[32:47], v[228:231], v[152:155], v[32:47]
    ds_read_b128 v[220:223], v238 offset:512
    v_add_f32 v249, v249, v167
    v_cvt_pk_bf16_f32 v163, v166, v167
    v_exp_f32 v169, v169
    v_mfma_f32_32x32x16_bf16 v[48:63], v[232:235], v[152:155], v[48:63]
REJ_AX_first1:
    ds_read_b128 v[224:227], v239 offset:512
    v_exp_f32 v170, v170
    v_add_f32 v236, v236, v168
    s_waitcnt lgkmcnt(4)
    v_mfma_f32_32x32x16_bf16 v[144:159], v[204:207], v[96:99], v[176:191]
    ds_read_b128 v[228:231], v240 offset:512
    v_add_f32 v249, v249, v169
    v_cvt_pk_bf16_f32 v168, v168, v169
    v_exp_f32 v171, v171
    v_mfma_f32_32x32x16_bf16 v[144:159], v[208:211], v[100:103], v[144:159]
    ds_read_b128 v[232:235], v241 offset:512
    v_exp_f32 v172, v172
    v_add_f32 v236, v236, v170
    s_waitcnt lgkmcnt(4)
    v_mfma_f32_32x32x16_bf16 v[144:159], v[212:215], v[104:107], v[144:159]
    ds_read_b128 v[204:207], v246 offset:0
    v_add_f32 v249, v249, v171
    v_cvt_pk_bf16_f32 v169, v170, v171
    v_exp_f32 v173, v173
    v_mfma_f32_32x32x16_bf16 v[144:159], v[216:219], v[108:111], v[144:159]
    ds_read_b128 v[208:211], v246 offset:4096
    v_exp_f32 v174, v174
    s_waitcnt lgkmcnt(4)
    v_mfma_f32_32x32x16_bf16 v[144:159], v[220:223], v[112:115], v[144:159]
    ds_read_b128 v[212:215], v247 offset:0
    v_add_f32 v236, v236, v172
    v_add_f32 v249, v249, v173
    v_mfma_f32_32x32x16_bf16 v[144:159], v[224:227], v[116:119], v[144:159]
    ds_read_b128 v[216:219], v247 offset:4096
    v_cvt_pk_bf16_f32 v170, v172, v173
    v_exp_f32 v175, v175
    s_waitcnt lgkmcnt(4)
    v_mfma_f32_32x32x16_bf16 v[144:159], v[228:231], v[120:123], v[144:159]
    ds_read_b128 v[220:223], v246 offset:512
    v_add_f32 v236, v236, v174
    v_add_f32 v249, v249, v175
    v_mfma_f32_32x32x16_bf16 v[144:159], v[232:235], v[124:127], v[144:159]
    ds_read_b128 v[224:227], v246 offset:4608
    v_cvt_pk_bf16_f32 v171, v174, v175
LOOP_AX:
    s_waitcnt lgkmcnt(4)
    v_mfma_f32_16x16x32_bf16 v[192:195], v[204:207], v[128:131], v[200:203]
    ds_read_b128 v[228:231], v247 offset:512
    s_mov_b32 s44, s42
    s_add_u32 s42, s42, 0x4000
    s_cmp_ge_u32 s42, 0x28000
    s_cselect_b32 s51, 0x28000, 0
    s_sub_u32 s42, s42, s51
    s_sub_u32 s45, s42, s44
    v_mfma_f32_16x16x32_bf16 v[196:199], v[208:211], v[128:131], v[200:203]
    ds_read_b128 v[232:235], v247 offset:4608
    v_max3_f32 v250, v144, v145, v146
    v_max3_f32 v250, v250, v147, v148
    s_waitcnt lgkmcnt(4)
    v_mfma_f32_16x16x32_bf16 v[192:195], v[212:215], v[132:135], v[192:195]
    ds_read_b64_tr_b16 v[204:205], v242 offset:0
    ds_read_b64_tr_b16 v[206:207], v242 offset:2048
    v_max3_f32 v250, v250, v149, v150
    v_max3_f32 v250, v250, v151, v152
    v_mfma_f32_16x16x32_bf16 v[196:199], v[216:219], v[132:135], v[196:199]
    ds_read_b64_tr_b16 v[208:209], v243 offset:0
    ds_read_b64_tr_b16 v[210:211], v243 offset:2048
    v_max3_f32 v250, v250, v153, v154
    v_max3_f32 v250, v250, v155, v156
    s_waitcnt lgkmcnt(6)
    v_mfma_f32_16x16x32_bf16 v[192:195], v[220:223], v[136:139], v[192:195]
    ds_read_b64_tr_b16 v[212:213], v242 offset:512
    ds_read_b64_tr_b16 v[214:215], v242 offset:2560
    v_max3_f32 v250, v250, v157, v158
    v_max_f32 v250, v250, v159
    v_mfma_f32_16x16x32_bf16 v[196:199], v[224:227], v[136:139], v[196:199]
    ds_read_b64_tr_b16 v[216:217], v243 offset:512
    ds_read_b64_tr_b16 v[218:219], v243 offset:2560
    v_cmp_lt_f32 vcc, s58, v250
    s_cbranch_vccnz RARE_AX_loop0
    v_exp_f32 v144, v144
    s_waitcnt lgkmcnt(8)
    v_mfma_f32_16x16x32_bf16 v[192:195], v[228:231], v[140:143], v[192:195]
    ds_read_b64_tr_b16 v[220:221], v242 offset:4096
    ds_read_b64_tr_b16 v[222:223], v242 offset:6144
    v_exp_f32 v145, v145
    v_mfma_f32_16x16x32_bf16 v[196:199], v[232:235], v[140:143], v[196:199]
    ds_read_b64_tr_b16 v[224:225], v243 offset:4096
    ds_read_b64_tr_b16 v[226:227], v243 offset:6144
    v_exp_f32 v146, v146
    s_waitcnt lgkmcnt(8)
    v_mfma_f32_32x32x16_bf16 v[0:15], v[204:207], v[160:163], v[0:15]
    ds_read_b64_tr_b16 v[228:229], v242 offset:4608
    ds_read_b64_tr_b16 v[230:231], v242 offset:6656
    v_add_f32 v236, v236, v144
    v_add_f32 v249, v249, v145
    v_cvt_pk_bf16_f32 v144, v144, v145
    v_exp_f32 v147, v147
    v_exp_f32 v148, v148
    v_mfma_f32_32x32x16_bf16 v[16:31], v[208:211], v[160:163], v[16:31]
    ds_read_b64_tr_b16 v[232:233], v243 offset:4608
    ds_read_b64_tr_b16 v[234:235], v243 offset:6656
    v_add_f32 v236, v236, v146
    v_add_f32 v249, v249, v147
    v_cvt_pk_bf16_f32 v145, v146, v147
    v_exp_f32 v149, v149
    v_exp_f32 v150, v150
    s_waitcnt lgkmcnt(8)
    v_mfma_f32_32x32x16_bf16 v[32:47], v[212:215], v[160:163], v[32:47]
    v_add_u32 v238, s45, v238
    v_add_u32 v239, s45, v239
    v_add_u32 v240, s45, v240
    v_add_u32 v241, s45, v241
    v_add_u32 v242, s45, v242
    v_add_u32 v243, s45, v243
    v_add_u32 v246, s42, v245
    v_xor_b32 v247, 64, v246
    s_waitcnt lgkmcnt(0)
    s_barrier
    ds_read_b128 v[204:207], v238 offset:0
    v_add_f32 v236, v236, v148
    v_add_f32 v249, v249, v149
    v_cvt_pk_bf16_f32 v146, v148, v149
    v_exp_f32 v151, v151
    v_mfma_f32_32x32x16_bf16 v[48:63], v[216:219], v[160:163], v[48:63]
    ds_read_b128 v[208:211], v239 offset:0
    v_exp_f32 v152, v152
    v_add_f32 v236, v236, v150
    v_add_f32 v249, v249, v151
    v_cvt_pk_bf16_f32 v147, v150, v151
    v_mfma_f32_32x32x16_bf16 v[0:15], v[220:223], v[168:171], v[0:15]
    ds_read_b128 v[212:215], v240 offset:0
    v_exp_f32 v153, v153
    v_exp_f32 v154, v154
    v_add_f32 v236, v236, v152
    v_mfma_f32_32x32x16_bf16 v[16:31], v[224:227], v[168:171], v[16:31]
    ds_read_b128 v[216:219], v241 offset:0
    v_add_f32 v249, v249, v153
    v_cvt_pk_bf16_f32 v152, v152, v153
    v_exp_f32 v155, v155
    v_exp_f32 v156, v156
    v_mfma_f32_32x32x16_bf16 v[32:47], v[228:231], v[168:171], v[32:47]
    ds_read_b128 v[220:223], v238 offset:512
    v_add_f32 v236, v236, v154
    v_add_f32 v249, v249, v155
    v_cvt_pk_bf16_f32 v153, v154, v155
    v_exp_f32 v157, v157
    v_mfma_f32_32x32x16_bf16 v[48:63], v[232:235], v[168:171], v[48:63]
REJ_AX_loop0:
    ds_read_b128 v[224:227], v239 offset:512
    v_max3_f32 v253, v192, v193, v194
    v_max3_f32 v253, v253, v195, v196
    v_max3_f32 v253, v253, v197, v198
    v_max_f32 v253, v253, v199
    v_cmp_lt_f32 vcc, s58, v253
    s_cbranch_vccnz RRARE_AX_loop
RREJ_AX_loop:
    s_waitcnt lgkmcnt(4)
    v_mfma_f32_32x32x16_bf16 v[160:175], v[204:207], v[96:99], v[176:191]
    ds_read_b128 v[228:231], v240 offset:512
    v_exp_f32 v192, v192
    v_exp_f32 v193, v193
    v_exp_f32 v194, v194
    v_mfma_f32_32x32x16_bf16 v[160:175], v[208:211], v[100:103], v[160:175]
    ds_read_b128 v[232:235], v241 offset:512
    v_add_f32 v237, v237, v192
    v_add_f32 v237, v237, v193
    v_cvt_pk_bf16_f32 v192, v192, v193
    v_exp_f32 v195, v195
    s_waitcnt lgkmcnt(4)
    v_mfma_f32_32x32x16_bf16 v[160:175], v[212:215], v[104:107], v[160:175]
    ds_read_b64_tr_b16 v[204:205], v246 offset:0
    ds_read_b64_tr_b16 v[206:207], v246 offset:4096
    v_exp_f32 v196, v196
    v_add_f32 v237, v237, v194
    v_add_f32 v237, v237, v195
    v_cvt_pk_bf16_f32 v193, v194, v195
    v_mfma_f32_32x32x16_bf16 v[160:175], v[216:219], v[108:111], v[160:175]
    ds_read_b64_tr_b16 v[208:209], v246 offset:32
    ds_read_b64_tr_b16 v[210:211], v246 offset:4128
    v_exp_f32 v197, v197
    v_exp_f32 v198, v198
    v_add_f32 v237, v237, v196
    s_waitcnt lgkmcnt(6)
    v_mfma_f32_32x32x16_bf16 v[160:175], v[220:223], v[112:115], v[160:175]
    ds_read_b64_tr_b16 v[212:213], v247 offset:0
    ds_read_b64_tr_b16 v[214:215], v247 offset:4096
    v_add_f32 v237, v237, v197
    v_cvt_pk_bf16_f32 v194, v196, v197
    v_exp_f32 v199, v199
    v_exp_f32 v158, v158
    v_mfma_f32_32x32x16_bf16 v[160:175], v[224:227], v[116:119], v[160:175]
    ds_read_b64_tr_b16 v[216:217], v247 offset:32
    ds_read_b64_tr_b16 v[218:219], v247 offset:4128
    v_add_f32 v237, v237, v198
    v_add_f32 v237, v237, v199
    v_cvt_pk_bf16_f32 v195, v198, v199
    v_add_f32 v236, v236, v156
    s_waitcnt lgkmcnt(8)
    v_mfma_f32_32x32x16_bf16 v[160:175], v[228:231], v[120:123], v[160:175]
    ds_read_b64_tr_b16 v[220:221], v246 offset:512
    ds_read_b64_tr_b16 v[222:223], v246 offset:4608
    v_add_f32 v249, v249, v157
    v_cvt_pk_bf16_f32 v154, v156, v157
    v_exp_f32 v159, v159
    v_mfma_f32_32x32x16_bf16 v[160:175], v[232:235], v[124:127], v[160:175]
    ds_read_b64_tr_b16 v[224:225], v246 offset:544
    ds_read_b64_tr_b16 v[226:227], v246 offset:4640
    v_add_f32 v236, v236, v158
    v_add_f32 v249, v249, v159
    v_cvt_pk_bf16_f32 v155, v158, v159
    s_waitcnt lgkmcnt(8)
    v_mfma_f32_16x16x32_bf16 v[64:67], v[204:207], v[192:195], v[64:67]
    ds_read_b64_tr_b16 v[228:229], v247 offset:512
    ds_read_b64_tr_b16 v[230:231], v247 offset:4608
    s_mov_b32 s44, s42
    s_add_u32 s42, s42, 0x4000
    s_cmp_ge_u32 s42, 0x28000
    s_cselect_b32 s51, 0x28000, 0
    s_sub_u32 s42, s42, s51
    s_sub_u32 s45, s42, s44
    v_mfma_f32_16x16x32_bf16 v[68:71], v[208:211], v[192:195], v[68:71]
    ds_read_b64_tr_b16 v[232:233], v247 offset:544
    ds_read_b64_tr_b16 v[234:235], v247 offset:4640
    v_max3_f32 v250, v160, v161, v162
    v_max3_f32 v250, v250, v163, v164
    s_waitcnt lgkmcnt(8)
    v_mfma_f32_16x16x32_bf16 v[72:75], v[212:215], v[192:195], v[72:75]
    ds_read_b64_tr_b16 v[204:205], v242 offset:0
    ds_read_b64_tr_b16 v[206:207], v242 offset:2048
    v_max3_f32 v250, v250, v165, v166
    v_max3_f32 v250, v250, v167, v168
    v_mfma_f32_16x16x32_bf16 v[76:79], v[216:219], v[192:195], v[76:79]
    ds_read_b64_tr_b16 v[208:209], v243 offset:0
    ds_read_b64_tr_b16 v[210:211], v243 offset:2048
    v_max3_f32 v250, v250, v169, v170
    v_max3_f32 v250, v250, v171, v172
    s_waitcnt lgkmcnt(8)
    v_mfma_f32_16x16x32_bf16 v[80:83], v[220:223], v[192:195], v[80:83]
    ds_read_b64_tr_b16 v[212:213], v242 offset:512
    ds_read_b64_tr_b16 v[214:215], v242 offset:2560
    v_max3_f32 v250, v250, v173, v174
    v_max_f32 v250, v250, v175
    v_mfma_f32_16x16x32_bf16 v[84:87], v[224:227], v[192:195], v[84:87]
    ds_read_b64_tr_b16 v[216:217], v243 offset:512
    ds_read_b64_tr_b16 v[218:219], v243 offset:2560
    v_cmp_lt_f32 vcc, s58, v250
    s_cbranch_vccnz RARE_AX_loop1
    v_exp_f32 v160, v160
    s_waitcnt lgkmcnt(8)
    v_mfma_f32_16x16x32_bf16 v[88:91], v[228:231], v[192:195], v[88:91]
    ds_read_b64_tr_b16 v[220:221], v242 offset:4096
    ds_read_b64_tr_b16 v[222:223], v242 offset:6144
    v_exp_f32 v161, v161
    v_mfma_f32_16x16x32_bf16 v[92:95], v[232:235], v[192:195], v[92:95]
    ds_read_b64_tr_b16 v[224:225], v243 offset:4096
    ds_read_b64_tr_b16 v[226:227], v243 offset:6144
    v_exp_f32 v162, v162
    s_waitcnt lgkmcnt(8)
    v_mfma_f32_32x32x16_bf16 v[0:15], v[204:207], v[144:147], v[0:15]
    ds_read_b64_tr_b16 v[228:229], v242 offset:4608
    ds_read_b64_tr_b16 v[230:231], v242 offset:6656
    v_add_f32 v236, v236, v160
    v_add_f32 v249, v249, v161
    v_cvt_pk_bf16_f32 v160, v160, v161
    v_exp_f32 v163, v163
    v_mfma_f32_32x32x16_bf16 v[16:31], v[208:211], v[144:147], v[16:31]
    ds_read_b64_tr_b16 v[232:233], v243 offset:4608
    ds_read_b64_tr_b16 v[234:235], v243 offset:6656
    v_exp_f32 v164, v164
    v_add_f32 v236, v236, v162
    s_waitcnt lgkmcnt(8)
    v_mfma_f32_32x32x16_bf16 v[32:47], v[212:215], v[144:147], v[32:47]
    v_add_u32 v238, s45, v238
    v_add_u32 v239, s45, v239
    v_add_u32 v240, s45, v240
    v_add_u32 v241, s45, v241
    v_add_u32 v242, s45, v242
    v_add_u32 v243, s45, v243
    v_add_u32 v246, s42, v244
    v_xor_b32 v247, 64, v246
    s_waitcnt lgkmcnt(0)
    s_barrier
    ds_read_b128 v[204:207], v238 offset:0
    v_add_f32 v249, v249, v163
    v_cvt_pk_bf16_f32 v161, v162, v163
    v_exp_f32 v165, v165
    v_mfma_f32_32x32x16_bf16 v[48:63], v[216:219], v[144:147], v[48:63]
    ds_read_b128 v[208:211], v239 offset:0
    v_exp_f32 v166, v166
    v_add_f32 v236, v236, v164
    v_mfma_f32_32x32x16_bf16 v[0:15], v[220:223], v[152:155], v[0:15]
    ds_read_b128 v[212:215], v240 offset:0
    v_add_f32 v249, v249, v165
    v_cvt_pk_bf16_f32 v162, v164, v165
    v_exp_f32 v167, v167
    v_mfma_f32_32x32x16_bf16 v[16:31], v[224:227], v[152:155], v[16:31]
    ds_read_b128 v[216:219], v241 offset:0
    v_exp_f32 v168, v168
    v_add_f32 v236, v236, v166
    v_mfma_f32_32x32x16_bf16 v[32:47], v[228:231], v[152:155], v[32:47]
    ds_read_b128 v[220:223], v238 offset:512
    v_add_f32 v249, v249, v167
    v_cvt_pk_bf16_f32 v163, v166, v167
    v_exp_f32 v169, v169
    v_mfma_f32_32x32x16_bf16 v[48:63], v[232:235], v[152:155], v[48:63]
REJ_AX_loop1:
    ds_read_b128 v[224:227], v239 offset:512
    v_exp_f32 v170, v170
    v_add_f32 v236, v236, v168
    s_waitcnt lgkmcnt(4)
    v_mfma_f32_32x32x16_bf16 v[144:159], v[204:207], v[96:99], v[176:191]
    ds_read_b128 v[228:231], v240 offset:512
    v_add_f32 v249, v249, v169
    v_cvt_pk_bf16_f32 v168, v168, v169
    v_exp_f32 v171, v171
    v_mfma_f32_32x32x16_bf16 v[144:159], v[208:211], v[100:103], v[144:159]
    ds_read_b128 v[232:235], v241 offset:512
    v_exp_f32 v172, v172
    v_add_f32 v236, v236, v170
    s_waitcnt lgkmcnt(4)
    v_mfma_f32_32x32x16_bf16 v[144:159], v[212:215], v[104:107], v[144:159]
    ds_read_b128 v[204:207], v246 offset:0
    v_add_f32 v249, v249, v171
    v_cvt_pk_bf16_f32 v169, v170, v171
    v_exp_f32 v173, v173
    v_mfma_f32_32x32x16_bf16 v[144:159], v[216:219], v[108:111], v[144:159]
    ds_read_b128 v[208:211], v246 offset:4096
    v_exp_f32 v174, v174
    s_waitcnt lgkmcnt(4)
    v_mfma_f32_32x32x16_bf16 v[144:159], v[220:223], v[112:115], v[144:159]
    ds_read_b128 v[212:215], v247 offset:0
    v_add_f32 v236, v236, v172
    v_add_f32 v249, v249, v173
    v_mfma_f32_32x32x16_bf16 v[144:159], v[224:227], v[116:119], v[144:159]
    ds_read_b128 v[216:219], v247 offset:4096
    v_cvt_pk_bf16_f32 v170, v172, v173
    v_exp_f32 v175, v175
    s_waitcnt lgkmcnt(4)
    v_mfma_f32_32x32x16_bf16 v[144:159], v[228:231], v[120:123], v[144:159]
    ds_read_b128 v[220:223], v246 offset:512
    v_add_f32 v236, v236, v174
    v_add_f32 v249, v249, v175
    v_mfma_f32_32x32x16_bf16 v[144:159], v[232:235], v[124:127], v[144:159]
    ds_read_b128 v[224:227], v246 offset:4608
    v_cvt_pk_bf16_f32 v171, v174, v175
    s_cmp_lg_u32 s50, 3
    s_cbranch_scc1 NOT_AX
    v_and_b32 v251, 3, v254
    v_lshlrev_b32 v251, 7, v251
    v_min_u32 v251, 0x13c, v251
    v_lshrrev_b32 v252, 2, v254
    v_mul_u32_u24 v252, 0x480, v252
    v_add_u32 v251, v251, v252
    s_add_u32 s51, s36, 2
    s_and_b32 s51, s51, 3
    s_mul_i32 s51, s51, 36864
    s_mul_i32 s52, s39, 147456
    s_add_u32 s51, s51, s52
    buffer_load_dword v255, v251, s[20:23], s51 offen
    s_add_u32 s51, s51, 18432
    buffer_load_dword v255, v251, s[20:23], s51 offen
NOT_AX:
    s_sub_u32 s50, s50, 1
    s_cmp_lg_u32 s50, 0
    s_cbranch_scc1 LOOP_AX
    s_waitcnt lgkmcnt(4)
    v_mfma_f32_16x16x32_bf16 v[192:195], v[204:207], v[128:131], v[200:203]
    ds_read_b128 v[228:231], v247 offset:512
    s_mov_b32 s44, s42
    s_add_u32 s42, s42, 0x4000
    s_cmp_ge_u32 s42, 0x28000
    s_cselect_b32 s51, 0x28000, 0
    s_sub_u32 s42, s42, s51
    s_sub_u32 s45, s42, s44
    v_mfma_f32_16x16x32_bf16 v[196:199], v[208:211], v[128:131], v[200:203]
    ds_read_b128 v[232:235], v247 offset:4608
    v_max3_f32 v250, v144, v145, v146
    v_max3_f32 v250, v250, v147, v148
    s_waitcnt lgkmcnt(4)
    v_mfma_f32_16x16x32_bf16 v[192:195], v[212:215], v[132:135], v[192:195]
    ds_read_b64_tr_b16 v[204:205], v242 offset:0
    ds_read_b64_tr_b16 v[206:207], v242 offset:2048
    v_max3_f32 v250, v250, v149, v150
    v_max3_f32 v250, v250, v151, v152
    v_mfma_f32_16x16x32_bf16 v[196:199], v[216:219], v[132:135], v[196:199]
    ds_read_b64_tr_b16 v[208:209], v243 offset:0
    ds_read_b64_tr_b16 v[210:211], v243 offset:2048
    v_max3_f32 v250, v250, v153, v154
    v_max3_f32 v250, v250, v155, v156
    s_waitcnt lgkmcnt(6)
    v_mfma_f32_16x16x32_bf16 v[192:195], v[220:223], v[136:139], v[192:195]
    ds_read_b64_tr_b16 v[212:213], v242 offset:512
    ds_read_b64_tr_b16 v[214:215], v242 offset:2560
    v_max3_f32 v250, v250, v157, v158
    v_max_f32 v250, v250, v159
    v_mfma_f32_16x16x32_bf16 v[196:199], v[224:227], v[136:139], v[196:199]
    ds_read_b64_tr_b16 v[216:217], v243 offset:512
    ds_read_b64_tr_b16 v[218:219], v243 offset:2560
    v_cmp_lt_f32 vcc, s58, v250
    s_cbranch_vccnz RARE_AX_last0
    v_exp_f32 v144, v144
    s_waitcnt lgkmcnt(8)
    v_mfma_f32_16x16x32_bf16 v[192:195], v[228:231], v[140:143], v[192:195]
    ds_read_b64_tr_b16 v[220:221], v242 offset:4096
    ds_read_b64_tr_b16 v[222:223], v242 offset:6144
    v_exp_f32 v145, v145
    v_mfma_f32_16x16x32_bf16 v[196:199], v[232:235], v[140:143], v[196:199]
    ds_read_b64_tr_b16 v[224:225], v243 offset:4096
    ds_read_b64_tr_b16 v[226:227], v243 offset:6144
    v_exp_f32 v146, v146
    s_waitcnt lgkmcnt(8)
    v_mfma_f32_32x32x16_bf16 v[0:15], v[204:207], v[160:163], v[0:15]
    ds_read_b64_tr_b16 v[228:229], v242 offset:4608
    ds_read_b64_tr_b16 v[230:231], v242 offset:6656
    v_add_f32 v236, v236, v144
    v_add_f32 v249, v249, v145
    v_cvt_pk_bf16_f32 v144, v144, v145
    v_exp_f32 v147, v147
    v_exp_f32 v148, v148
    v_mfma_f32_32x32x16_bf16 v[16:31], v[208:211], v[160:163], v[16:31]
    ds_read_b64_tr_b16 v[232:233], v243 offset:4608
    ds_read_b64_tr_b16 v[234:235], v243 offset:6656
    v_add_f32 v236, v236, v146
    v_add_f32 v249, v249, v147
    v_cvt_pk_bf16_f32 v145, v146, v147
    v_exp_f32 v149, v149
    v_exp_f32 v150, v150
    s_waitcnt lgkmcnt(8)
    v_mfma_f32_32x32x16_bf16 v[32:47], v[212:215], v[160:163], v[32:47]
    v_add_u32 v238, s45, v238
    v_add_u32 v239, s45, v239
    v_add_u32 v240, s45, v240
    v_add_u32 v241, s45, v241
    v_add_u32 v242, s45, v242
    v_add_u32 v243, s45, v243
    v_add_u32 v246, s42, v245
    v_xor_b32 v247, 64, v246
    s_waitcnt lgkmcnt(0)
    s_barrier
    ds_read_b128 v[204:207], v238 offset:0
    v_add_f32 v236, v236, v148
    v_add_f32 v249, v249, v149
    v_cvt_pk_bf16_f32 v146, v148, v149
    v_exp_f32 v151, v151
    v_mfma_f32_32x32x16_bf16 v[48:63], v[216:219], v[160:163], v[48:63]
    ds_read_b128 v[208:211], v239 offset:0
    v_exp_f32 v152, v152
    v_add_f32 v236, v236, v150
    v_add_f32 v249, v249, v151
    v_cvt_pk_bf16_f32 v147, v150, v151
    v_mfma_f32_32x32x16_bf16 v[0:15], v[220:223], v[168:171], v[0:15]
    ds_read_b128 v[212:215], v240 offset:0
    v_exp_f32 v153, v153
    v_exp_f32 v154, v154
    v_add_f32 v236, v236, v152
    v_mfma_f32_32x32x16_bf16 v[16:31], v[224:227], v[168:171], v[16:31]
    ds_read_b128 v[216:219], v241 offset:0
    v_add_f32 v249, v249, v153
    v_cvt_pk_bf16_f32 v152, v152, v153
    v_exp_f32 v155, v155
    v_exp_f32 v156, v156
    v_mfma_f32_32x32x16_bf16 v[32:47], v[228:231], v[168:171], v[32:47]
    ds_read_b128 v[220:223], v238 offset:512
    v_add_f32 v236, v236, v154
    v_add_f32 v249, v249, v155
    v_cvt_pk_bf16_f32 v153, v154, v155
    v_exp_f32 v157, v157
    v_mfma_f32_32x32x16_bf16 v[48:63], v[232:235], v[168:171], v[48:63]
REJ_AX_last0:
    ds_read_b128 v[224:227], v239 offset:512
    v_max3_f32 v253, v192, v193, v194
    v_max3_f32 v253, v253, v195, v196
    v_max3_f32 v253, v253, v197, v198
    v_max_f32 v253, v253, v199
    v_cmp_lt_f32 vcc, s58, v253
    s_cbranch_vccnz RRARE_AX_last
RREJ_AX_last:
    s_waitcnt lgkmcnt(4)
    v_mfma_f32_32x32x16_bf16 v[160:175], v[204:207], v[96:99], v[176:191]
    ds_read_b128 v[228:231], v240 offset:512
    v_exp_f32 v192, v192
    v_exp_f32 v193, v193
    v_exp_f32 v194, v194
    v_mfma_f32_32x32x16_bf16 v[160:175], v[208:211], v[100:103], v[160:175]
    ds_read_b128 v[232:235], v241 offset:512
    v_add_f32 v237, v237, v192
    v_add_f32 v237, v237, v193
    v_cvt_pk_bf16_f32 v192, v192, v193
    v_exp_f32 v195, v195
    s_waitcnt lgkmcnt(4)
    v_mfma_f32_32x32x16_bf16 v[160:175], v[212:215], v[104:107], v[160:175]
    ds_read_b64_tr_b16 v[204:205], v246 offset:0
    ds_read_b64_tr_b16 v[206:207], v246 offset:4096
    v_exp_f32 v196, v196
    v_add_f32 v237, v237, v194
    v_add_f32 v237, v237, v195
    v_cvt_pk_bf16_f32 v193, v194, v195
    v_mfma_f32_32x32x16_bf16 v[160:175], v[216:219], v[108:111], v[160:175]
    ds_read_b64_tr_b16 v[208:209], v246 offset:32
    ds_read_b64_tr_b16 v[210:211], v246 offset:4128
    v_exp_f32 v197, v197
    v_exp_f32 v198, v198
    v_add_f32 v237, v237, v196
    s_waitcnt lgkmcnt(6)
    v_mfma_f32_32x32x16_bf16 v[160:175], v[220:223], v[112:115], v[160:175]
    ds_read_b64_tr_b16 v[212:213], v247 offset:0
    ds_read_b64_tr_b16 v[214:215], v247 offset:4096
    v_add_f32 v237, v237, v197
    v_cvt_pk_bf16_f32 v194, v196, v197
    v_exp_f32 v199, v199
    v_exp_f32 v158, v158
    v_mfma_f32_32x32x16_bf16 v[160:175], v[224:227], v[116:119], v[160:175]
    ds_read_b64_tr_b16 v[216:217], v247 offset:32
    ds_read_b64_tr_b16 v[218:219], v247 offset:4128
    v_add_f32 v237, v237, v198
    v_add_f32 v237, v237, v199
    v_cvt_pk_bf16_f32 v195, v198, v199
    v_add_f32 v236, v236, v156
    s_waitcnt lgkmcnt(8)
    v_mfma_f32_32x32x16_bf16 v[160:175], v[228:231], v[120:123], v[160:175]
    ds_read_b64_tr_b16 v[220:221], v246 offset:512
    ds_read_b64_tr_b16 v[222:223], v246 offset:4608
    v_add_f32 v249, v249, v157
    v_cvt_pk_bf16_f32 v154, v156, v157
    v_exp_f32 v159, v159
    v_mfma_f32_32x32x16_bf16 v[160:175], v[232:235], v[124:127], v[160:175]
    ds_read_b64_tr_b16 v[224:225], v246 offset:544
    ds_read_b64_tr_b16 v[226:227], v246 offset:4640
    v_add_f32 v236, v236, v158
    v_add_f32 v249, v249, v159
    v_cvt_pk_bf16_f32 v155, v158, v159
    s_waitcnt lgkmcnt(8)
    v_mfma_f32_16x16x32_bf16 v[64:67], v[204:207], v[192:195], v[64:67]
    ds_read_b64_tr_b16 v[228:229], v247 offset:512
    ds_read_b64_tr_b16 v[230:231], v247 offset:4608
    s_mov_b32 s44, s42
    s_add_u32 s42, s42, 0x4000
    s_cmp_ge_u32 s42, 0x28000
    s_cselect_b32 s51, 0x28000, 0
    s_sub_u32 s42, s42, s51
    s_sub_u32 s45, s42, s44
    v_mfma_f32_16x16x32_bf16 v[68:71], v[208:211], v[192:195], v[68:71]
    ds_read_b64_tr_b16 v[232:233], v247 offset:544
    ds_read_b64_tr_b16 v[234:235], v247 offset:4640
    v_max3_f32 v250, v160, v161, v162
    v_max3_f32 v250, v250, v163, v164
    v_max3_f32 v250, v250, v165, v166
    s_waitcnt lgkmcnt(8)
    v_mfma_f32_16x16x32_bf16 v[72:75], v[212:215], v[192:195], v[72:75]
    ds_read_b64_tr_b16 v[204:205], v242 offset:0
    ds_read_b64_tr_b16 v[206:207], v242 offset:2048
    v_max3_f32 v250, v250, v167, v168
    v_max3_f32 v250, v250, v169, v170
    v_max3_f32 v250, v250, v171, v172
    v_mfma_f32_16x16x32_bf16 v[76:79], v[216:219], v[192:195], v[76:79]
    ds_read_b64_tr_b16 v[208:209], v243 offset:0
    ds_read_b64_tr_b16 v[210:211], v243 offset:2048
    v_max3_f32 v250, v250, v173, v174
    v_max_f32 v250, v250, v175
    v_cmp_lt_f32 vcc, s58, v250
    s_cbranch_vccnz RARE_AX_last1
    s_waitcnt lgkmcnt(8)
    v_mfma_f32_16x16x32_bf16 v[80:83], v[220:223], v[192:195], v[80:83]
    ds_read_b64_tr_b16 v[212:213], v242 offset:512
    ds_read_b64_tr_b16 v[214:215], v242 offset:2560
    v_exp_f32 v160, v160
    v_mfma_f32_16x16x32_bf16 v[84:87], v[224:227], v[192:195], v[84:87]
    ds_read_b64_tr_b16 v[216:217], v243 offset:512
    ds_read_b64_tr_b16 v[218:219], v243 offset:2560
    v_exp_f32 v161, v161
    s_waitcnt lgkmcnt(8)
    v_mfma_f32_16x16x32_bf16 v[88:91], v[228:231], v[192:195], v[88:91]
    ds_read_b64_tr_b16 v[220:221], v242 offset:4096
    ds_read_b64_tr_b16 v[222:223], v242 offset:6144
    v_exp_f32 v162, v162
    v_mfma_f32_16x16x32_bf16 v[92:95], v[232:235], v[192:195], v[92:95]
    ds_read_b64_tr_b16 v[224:225], v243 offset:4096
    ds_read_b64_tr_b16 v[226:227], v243 offset:6144
    v_add_f32 v236, v236, v160
    v_add_f32 v249, v249, v161
    s_waitcnt lgkmcnt(8)
    v_mfma_f32_32x32x16_bf16 v[0:15], v[204:207], v[144:147], v[0:15]
    ds_read_b64_tr_b16 v[228:229], v242 offset:4608
    ds_read_b64_tr_b16 v[230:231], v242 offset:6656
    v_cvt_pk_bf16_f32 v160, v160, v161
    v_exp_f32 v163, v163
    v_exp_f32 v164, v164
    v_add_f32 v236, v236, v162
    v_mfma_f32_32x32x16_bf16 v[16:31], v[208:211], v[144:147], v[16:31]
    ds_read_b64_tr_b16 v[232:233], v243 offset:4608
    ds_read_b64_tr_b16 v[234:235], v243 offset:6656
    v_add_f32 v249, v249, v163
    v_cvt_pk_bf16_f32 v161, v162, v163
    v_exp_f32 v165, v165
    v_exp_f32 v166, v166
    s_waitcnt lgkmcnt(8)
    v_mfma_f32_32x32x16_bf16 v[32:47], v[212:215], v[144:147], v[32:47]
    v_add_u32 v238, s45, v238
    v_add_u32 v239, s45, v239
    v_add_u32 v240, s45, v240
    v_add_u32 v241, s45, v241
    v_add_u32 v242, s45, v242
    v_add_u32 v243, s45, v243
    v_add_u32 v246, s42, v244
    v_xor_b32 v247, 64, v246
    s_waitcnt lgkmcnt(0)
    s_barrier
    v_add_f32 v236, v236, v164
    v_add_f32 v249, v249, v165
    v_cvt_pk_bf16_f32 v162, v164, v165
    v_exp_f32 v167, v167
    v_exp_f32 v168, v168
    v_mfma_f32_32x32x16_bf16 v[48:63], v[216:219], v[144:147], v[48:63]
    v_add_f32 v236, v236, v166
    v_add_f32 v249, v249, v167
    v_cvt_pk_bf16_f32 v163, v166, v167
    v_exp_f32 v169, v169
    v_exp_f32 v170, v170
    v_mfma_f32_32x32x16_bf16 v[0:15], v[220:223], v[152:155], v[0:15]
    v_add_f32 v236, v236, v168
    v_add_f32 v249, v249, v169
    v_cvt_pk_bf16_f32 v168, v168, v169
    v_exp_f32 v171, v171
    v_exp_f32 v172, v172
    v_mfma_f32_32x32x16_bf16 v[16:31], v[224:227], v[152:155], v[16:31]
    v_add_f32 v236, v236, v170
    v_add_f32 v249, v249, v171
    v_cvt_pk_bf16_f32 v169, v170, v171
    v_exp_f32 v173, v173
    v_mfma_f32_32x32x16_bf16 v[32:47], v[228:231], v[152:155], v[32:47]
    v_exp_f32 v174, v174
    v_add_f32 v236, v236, v172
    v_add_f32 v249, v249, v173
    v_cvt_pk_bf16_f32 v170, v172, v173
    v_mfma_f32_32x32x16_bf16 v[48:63], v[232:235], v[152:155], v[48:63]
REJ_AX_last1:
    v_exp_f32 v175, v175
    v_add_f32 v236, v236, v174
    v_add_f32 v249, v249, v175
    v_cvt_pk_bf16_f32 v171, v174, v175
    ds_read_b64_tr_b16 v[204:205], v242 offset:0
    ds_read_b64_tr_b16 v[206:207], v242 offset:2048
    ds_read_b64_tr_b16 v[208:209], v243 offset:0
    ds_read_b64_tr_b16 v[210:211], v243 offset:2048
    ds_read_b64_tr_b16 v[212:213], v242 offset:512
    ds_read_b64_tr_b16 v[214:215], v242 offset:2560
    ds_read_b64_tr_b16 v[216:217], v243 offset:512
    ds_read_b64_tr_b16 v[218:219], v243 offset:2560
    ds_read_b64_tr_b16 v[220:221], v242 offset:4096
    ds_read_b64_tr_b16 v[222:223], v242 offset:6144
    ds_read_b64_tr_b16 v[224:225], v243 offset:4096
    ds_read_b64_tr_b16 v[226:227], v243 offset:6144
    s_waitcnt lgkmcnt(10)
    v_mfma_f32_32x32x16_bf16 v[0:15], v[204:207], v[160:163], v[0:15]
    ds_read_b64_tr_b16 v[228:229], v242 offset:4608
    ds_read_b64_tr_b16 v[230:231], v242 offset:6656
    s_waitcnt lgkmcnt(10)
    v_mfma_f32_32x32x16_bf16 v[16:31], v[208:211], v[160:163], v[16:31]
    ds_read_b64_tr_b16 v[232:233], v243 offset:4608
    ds_read_b64_tr_b16 v[234:235], v243 offset:6656
    s_waitcnt lgkmcnt(10)
    v_mfma_f32_32x32x16_bf16 v[32:47], v[212:215], v[160:163], v[32:47]
    s_waitcnt lgkmcnt(8)
    v_mfma_f32_32x32x16_bf16 v[48:63], v[216:219], v[160:163], v[48:63]
    s_waitcnt lgkmcnt(6)
    v_mfma_f32_32x32x16_bf16 v[0:15], v[220:223], v[168:171], v[0:15]
    s_waitcnt lgkmcnt(4)
    v_mfma_f32_32x32x16_bf16 v[16:31], v[224:227], v[168:171], v[16:31]
    s_waitcnt lgkmcnt(2)
    v_mfma_f32_32x32x16_bf16 v[32:47], v[228:231], v[168:171], v[32:47]
    s_waitcnt lgkmcnt(0)
    v_mfma_f32_32x32x16_bf16 v[48:63], v[232:235], v[168:171], v[48:63]
    v_add_f32 v236, v236, v249
    s_branch TAIL_X
RARE_AX_first1:
    s_waitcnt lgkmcnt(8)
    v_mfma_f32_16x16x32_bf16 v[88:91], v[228:231], v[192:195], v[88:91]
    ds_read_b64_tr_b16 v[220:221], v242 offset:4096
    ds_read_b64_tr_b16 v[222:223], v242 offset:6144
    v_mfma_f32_16x16x32_bf16 v[92:95], v[232:235], v[192:195], v[92:95]
    ds_read_b64_tr_b16 v[224:225], v243 offset:4096
    ds_read_b64_tr_b16 v[226:227], v243 offset:6144
    s_waitcnt lgkmcnt(8)
    v_mfma_f32_32x32x16_bf16 v[0:15], v[204:207], v[144:147], 0
    ds_read_b64_tr_b16 v[228:229], v242 offset:4608
    ds_read_b64_tr_b16 v[230:231], v242 offset:6656
    v_mfma_f32_32x32x16_bf16 v[16:31], v[208:211], v[144:147], 0
    ds_read_b64_tr_b16 v[232:233], v243 offset:4608
    ds_read_b64_tr_b16 v[234:235], v243 offset:6656
    s_waitcnt lgkmcnt(8)
    v_mfma_f32_32x32x16_bf16 v[32:47], v[212:215], v[144:147], 0
    v_add_u32 v238, s45, v238
    v_add_u32 v239, s45, v239
    v_add_u32 v240, s45, v240
    v_add_u32 v241, s45, v241
    v_add_u32 v242, s45, v242
    v_add_u32 v243, s45, v243
    v_add_u32 v246, s42, v244
    v_xor_b32 v247, 64, v246
    s_waitcnt lgkmcnt(0)
    s_barrier
    ds_read_b128 v[204:207], v238 offset:0
    v_mfma_f32_32x32x16_bf16 v[48:63], v[216:219], v[144:147], 0
    ds_read_b128 v[208:211], v239 offset:0
    v_mfma_f32_32x32x16_bf16 v[0:15], v[220:223], v[152:155], v[0:15]
    ds_read_b128 v[212:215], v240 offset:0
    v_mfma_f32_32x32x16_bf16 v[16:31], v[224:227], v[152:155], v[16:31]
    ds_read_b128 v[216:219], v241 offset:0
    v_mfma_f32_32x32x16_bf16 v[32:47], v[228:231], v[152:155], v[32:47]
    ds_read_b128 v[220:223], v238 offset:512
    v_mfma_f32_32x32x16_bf16 v[48:63], v[232:235], v[152:155], v[48:63]
    v_mov_b32 v251, v250
    v_mov_b32 v252, v250
    s_nop 1
    v_permlane32_swap_b32 v251, v252
    v_max_f32 v250, v251, v252
    v_max_f32 v250, 0, v250
    v_exp_f32 v251, -v250
    v_sub_f32 v160, v160, v250
    v_sub_f32 v161, v161, v250
    v_sub_f32 v162, v162, v250
    v_sub_f32 v163, v163, v250
    v_sub_f32 v164, v164, v250
    v_sub_f32 v165, v165, v250
    v_sub_f32 v166, v166, v250
    v_sub_f32 v167, v167, v250
    v_sub_f32 v168, v168, v250
    v_sub_f32 v169, v169, v250
    v_sub_f32 v170, v170, v250
    v_sub_f32 v171, v171, v250
    v_sub_f32 v172, v172, v250
    v_sub_f32 v173, v173, v250
    v_sub_f32 v174, v174, v250
    v_sub_f32 v175, v175, v250
    v_sub_f32 v176, v176, v250
    v_sub_f32 v177, v177, v250
    v_sub_f32 v178, v178, v250
    v_sub_f32 v179, v179, v250
    v_sub_f32 v180, v180, v250
    v_sub_f32 v181, v181, v250
    v_sub_f32 v182, v182, v250
    v_sub_f32 v183, v183, v250
    v_sub_f32 v184, v184, v250
    v_sub_f32 v185, v185, v250
    v_sub_f32 v186, v186, v250
    v_sub_f32 v187, v187, v250
    v_sub_f32 v188, v188, v250
    v_sub_f32 v189, v189, v250
    v_sub_f32 v190, v190, v250
    v_sub_f32 v191, v191, v250
    v_mul_f32 v236, v236, v251
    v_mul_f32 v249, v249, v251
    v_mul_f32 v0, v0, v251
    v_mul_f32 v1, v1, v251
    v_mul_f32 v2, v2, v251
    v_mul_f32 v3, v3, v251
    v_mul_f32 v4, v4, v251
    v_mul_f32 v5, v5, v251
    v_mul_f32 v6, v6, v251
    v_mul_f32 v7, v7, v251
    v_mul_f32 v8, v8, v251
    v_mul_f32 v9, v9, v251
    v_mul_f32 v10, v10, v251
    v_mul_f32 v11, v11, v251
    v_mul_f32 v12, v12, v251
    v_mul_f32 v13, v13, v251
    v_mul_f32 v14, v14, v251
    v_mul_f32 v15, v15, v251
    v_mul_f32 v16, v16, v251
    v_mul_f32 v17, v17, v251
    v_mul_f32 v18, v18, v251
    v_mul_f32 v19, v19, v251
    v_mul_f32 v20, v20, v251
    v_mul_f32 v21, v21, v251
    v_mul_f32 v22, v22, v251
    v_mul_f32 v23, v23, v251
    v_mul_f32 v24, v24, v251
    v_mul_f32 v25, v25, v251
    v_mul_f32 v26, v26, v251
    v_mul_f32 v27, v27, v251
    v_mul_f32 v28, v28, v251
    v_mul_f32 v29, v29, v251
    v_mul_f32 v30, v30, v251
    v_mul_f32 v31, v31, v251
    v_mul_f32 v32, v32, v251
    v_mul_f32 v33, v33, v251
    v_mul_f32 v34, v34, v251
    v_mul_f32 v35, v35, v251
    v_mul_f32 v36, v36, v251
    v_mul_f32 v37, v37, v251
    v_mul_f32 v38, v38, v251
    v_mul_f32 v39, v39, v251
    v_mul_f32 v40, v40, v251
    v_mul_f32 v41, v41, v251
    v_mul_f32 v42, v42, v251
    v_mul_f32 v43, v43, v251
    v_mul_f32 v44, v44, v251
    v_mul_f32 v45, v45, v251
    v_mul_f32 v46, v46, v251
    v_mul_f32 v47, v47, v251
    v_mul_f32 v48, v48, v251
    v_mul_f32 v49, v49, v251
    v_mul_f32 v50, v50, v251
    v_mul_f32 v51, v51, v251
    v_mul_f32 v52, v52, v251
    v_mul_f32 v53, v53, v251
    v_mul_f32 v54, v54, v251
    v_mul_f32 v55, v55, v251
    v_mul_f32 v56, v56, v251
    v_mul_f32 v57, v57, v251
    v_mul_f32 v58, v58, v251
    v_mul_f32 v59, v59, v251
    v_mul_f32 v60, v60, v251
    v_mul_f32 v61, v61, v251
    v_mul_f32 v62, v62, v251
    v_mul_f32 v63, v63, v251
    v_exp_f32 v160, v160
    v_exp_f32 v161, v161
    v_exp_f32 v162, v162
    v_add_f32 v236, v236, v160
    v_add_f32 v249, v249, v161
    v_cvt_pk_bf16_f32 v160, v160, v161
    v_exp_f32 v163, v163
    v_exp_f32 v164, v164
    v_add_f32 v236, v236, v162
    v_add_f32 v249, v249, v163
    v_cvt_pk_bf16_f32 v161, v162, v163
    v_exp_f32 v165, v165
    v_exp_f32 v166, v166
    v_add_f32 v236, v236, v164
    v_add_f32 v249, v249, v165
    v_cvt_pk_bf16_f32 v162, v164, v165
    v_exp_f32 v167, v167
    v_exp_f32 v168, v168
    v_add_f32 v236, v236, v166
    v_add_f32 v249, v249, v167
    v_cvt_pk_bf16_f32 v163, v166, v167
    v_exp_f32 v169, v169
    s_branch REJ_AX_first1
RARE_AX_loop0:
    s_waitcnt lgkmcnt(8)
    v_mfma_f32_16x16x32_bf16 v[192:195], v[228:231], v[140:143], v[192:195]
    ds_read_b64_tr_b16 v[220:221], v242 offset:4096
    ds_read_b64_tr_b16 v[222:223], v242 offset:6144
    v_mfma_f32_16x16x32_bf16 v[196:199], v[232:235], v[140:143], v[196:199]
    ds_read_b64_tr_b16 v[224:225], v243 offset:4096
    ds_read_b64_tr_b16 v[226:227], v243 offset:6144
    s_waitcnt lgkmcnt(8)
    v_mfma_f32_32x32x16_bf16 v[0:15], v[204:207], v[160:163], v[0:15]
    ds_read_b64_tr_b16 v[228:229], v242 offset:4608
    ds_read_b64_tr_b16 v[230:231], v242 offset:6656
    v_mfma_f32_32x32x16_bf16 v[16:31], v[208:211], v[160:163], v[16:31]
    ds_read_b64_tr_b16 v[232:233], v243 offset:4608
    ds_read_b64_tr_b16 v[234:235], v243 offset:6656
    s_waitcnt lgkmcnt(8)
    v_mfma_f32_32x32x16_bf16 v[32:47], v[212:215], v[160:163], v[32:47]
    v_add_u32 v238, s45, v238
    v_add_u32 v239, s45, v239
    v_add_u32 v240, s45, v240
    v_add_u32 v241, s45, v241
    v_add_u32 v242, s45, v242
    v_add_u32 v243, s45, v243
    v_add_u32 v246, s42, v245
    v_xor_b32 v247, 64, v246
    s_waitcnt lgkmcnt(0)
    s_barrier
    ds_read_b128 v[204:207], v238 offset:0
    v_mfma_f32_32x32x16_bf16 v[48:63], v[216:219], v[160:163], v[48:63]
    ds_read_b128 v[208:211], v239 offset:0
    v_mfma_f32_32x32x16_bf16 v[0:15], v[220:223], v[168:171], v[0:15]
    ds_read_b128 v[212:215], v240 offset:0
    v_mfma_f32_32x32x16_bf16 v[16:31], v[224:227], v[168:171], v[16:31]
    ds_read_b128 v[216:219], v241 offset:0
    v_mfma_f32_32x32x16_bf16 v[32:47], v[228:231], v[168:171], v[32:47]
    ds_read_b128 v[220:223], v238 offset:512
    v_mfma_f32_32x32x16_bf16 v[48:63], v[232:235], v[168:171], v[48:63]
    v_mov_b32 v251, v250
    v_mov_b32 v252, v250
    s_nop 1
    v_permlane32_swap_b32 v251, v252
    v_max_f32 v250, v251, v252
    v_max_f32 v250, 0, v250
    v_exp_f32 v251, -v250
    v_sub_f32 v144, v144, v250
    v_sub_f32 v145, v145, v250
    v_sub_f32 v146, v146, v250
    v_sub_f32 v147, v147, v250
    v_sub_f32 v148, v148, v250
    v_sub_f32 v149, v149, v250
    v_sub_f32 v150, v150, v250
    v_sub_f32 v151, v151, v250
    v_sub_f32 v152, v152, v250
    v_sub_f32 v153, v153, v250
    v_sub_f32 v154, v154, v250
    v_sub_f32 v155, v155, v250
    v_sub_f32 v156, v156, v250
    v_sub_f32 v157, v157, v250
    v_sub_f32 v158, v158, v250
    v_sub_f32 v159, v159, v250
    v_sub_f32 v176, v176, v250
    v_sub_f32 v177, v177, v250
    v_sub_f32 v178, v178, v250
    v_sub_f32 v179, v179, v250
    v_sub_f32 v180, v180, v250
    v_sub_f32 v181, v181, v250
    v_sub_f32 v182, v182, v250
    v_sub_f32 v183, v183, v250
    v_sub_f32 v184, v184, v250
    v_sub_f32 v185, v185, v250
    v_sub_f32 v186, v186, v250
    v_sub_f32 v187, v187, v250
    v_sub_f32 v188, v188, v250
    v_sub_f32 v189, v189, v250
    v_sub_f32 v190, v190, v250
    v_sub_f32 v191, v191, v250
    v_mul_f32 v236, v236, v251
    v_mul_f32 v249, v249, v251
    v_mul_f32 v0, v0, v251
    v_mul_f32 v1, v1, v251
    v_mul_f32 v2, v2, v251
    v_mul_f32 v3, v3, v251
    v_mul_f32 v4, v4, v251
    v_mul_f32 v5, v5, v251
    v_mul_f32 v6, v6, v251
    v_mul_f32 v7, v7, v251
    v_mul_f32 v8, v8, v251
    v_mul_f32 v9, v9, v251
    v_mul_f32 v10, v10, v251
    v_mul_f32 v11, v11, v251
    v_mul_f32 v12, v12, v251
    v_mul_f32 v13, v13, v251
    v_mul_f32 v14, v14, v251
    v_mul_f32 v15, v15, v251
    v_mul_f32 v16, v16, v251
    v_mul_f32 v17, v17, v251
    v_mul_f32 v18, v18, v251
    v_mul_f32 v19, v19, v251
    v_mul_f32 v20, v20, v251
    v_mul_f32 v21, v21, v251
    v_mul_f32 v22, v22, v251
    v_mul_f32 v23, v23, v251
    v_mul_f32 v24, v24, v251
    v_mul_f32 v25, v25, v251
    v_mul_f32 v26, v26, v251
    v_mul_f32 v27, v27, v251
    v_mul_f32 v28, v28, v251
    v_mul_f32 v29, v29, v251
    v_mul_f32 v30, v30, v251
    v_mul_f32 v31, v31, v251
    v_mul_f32 v32, v32, v251
    v_mul_f32 v33, v33, v251
    v_mul_f32 v34, v34, v251
    v_mul_f32 v35, v35, v251
    v_mul_f32 v36, v36, v251
    v_mul_f32 v37, v37, v251
    v_mul_f32 v38, v38, v251
    v_mul_f32 v39, v39, v251
    v_mul_f32 v40, v40, v251
    v_mul_f32 v41, v41, v251
    v_mul_f32 v42, v42, v251
    v_mul_f32 v43, v43, v251
    v_mul_f32 v44, v44, v251
    v_mul_f32 v45, v45, v251
    v_mul_f32 v46, v46, v251
    v_mul_f32 v47, v47, v251
    v_mul_f32 v48, v48, v251
    v_mul_f32 v49, v49, v251
    v_mul_f32 v50, v50, v251
    v_mul_f32 v51, v51, v251
    v_mul_f32 v52, v52, v251
    v_mul_f32 v53, v53, v251
    v_mul_f32 v54, v54, v251
    v_mul_f32 v55, v55, v251
    v_mul_f32 v56, v56, v251
    v_mul_f32 v57, v57, v251
    v_mul_f32 v58, v58, v251
    v_mul_f32 v59, v59, v251
    v_mul_f32 v60, v60, v251
    v_mul_f32 v61, v61, v251
    v_mul_f32 v62, v62, v251
    v_mul_f32 v63, v63, v251
    v_exp_f32 v144, v144
    v_exp_f32 v145, v145
    v_exp_f32 v146, v146
    v_add_f32 v236, v236, v144
    v_add_f32 v249, v249, v145
    v_cvt_pk_bf16_f32 v144, v144, v145
    v_exp_f32 v147, v147
    v_exp_f32 v148, v148
    v_add_f32 v236, v236, v146
    v_add_f32 v249, v249, v147
    v_cvt_pk_bf16_f32 v145, v146, v147
    v_exp_f32 v149, v149
    v_exp_f32 v150, v150
    v_add_f32 v236, v236, v148
    v_add_f32 v249, v249, v149
    v_cvt_pk_bf16_f32 v146, v148, v149
    v_exp_f32 v151, v151
    v_exp_f32 v152, v152
    v_add_f32 v236, v236, v150
    v_add_f32 v249, v249, v151
    v_cvt_pk_bf16_f32 v147, v150, v151
    v_exp_f32 v153, v153
    v_exp_f32 v154, v154
    v_add_f32 v236, v236, v152
    v_add_f32 v249, v249, v153
    v_cvt_pk_bf16_f32 v152, v152, v153
    v_exp_f32 v155, v155
    v_exp_f32 v156, v156
    v_add_f32 v236, v236, v154
    v_add_f32 v249, v249, v155
    v_cvt_pk_bf16_f32 v153, v154, v155
    v_exp_f32 v157, v157
    s_branch REJ_AX_loop0
RRARE_AX_loop:
    ds_swizzle_b32 v251, v253 offset:0x401F
    s_waitcnt lgkmcnt(0)
    v_max_f32 v253, v253, v251
    v_mov_b32 v251, v253
    v_mov_b32 v252, v253
    s_nop 1
    v_permlane32_swap_b32 v251, v252
    v_max_f32 v253, v251, v252
    v_max_f32 v253, 0, v253
    v_exp_f32 v251, -v253
    v_sub_f32 v192, v192, v253
    v_sub_f32 v193, v193, v253
    v_sub_f32 v194, v194, v253
    v_sub_f32 v195, v195, v253
    v_sub_f32 v196, v196, v253
    v_sub_f32 v197, v197, v253
    v_sub_f32 v198, v198, v253
    v_sub_f32 v199, v199, v253
    v_sub_f32 v200, v200, v253
    v_sub_f32 v201, v201, v253
    v_sub_f32 v202, v202, v253
    v_sub_f32 v203, v203, v253
    v_mul_f32 v237, v237, v251
    v_mul_f32 v64, v64, v251
    v_mul_f32 v65, v65, v251
    v_mul_f32 v66, v66, v251
    v_mul_f32 v67, v67, v251
    v_mul_f32 v68, v68, v251
    v_mul_f32 v69, v69, v251
    v_mul_f32 v70, v70, v251
    v_mul_f32 v71, v71, v251
    v_mul_f32 v72, v72, v251
    v_mul_f32 v73, v73, v251
    v_mul_f32 v74, v74, v251
    v_mul_f32 v75, v75, v251
    v_mul_f32 v76, v76, v251
    v_mul_f32 v77, v77, v251
    v_mul_f32 v78, v78, v251
    v_mul_f32 v79, v79, v251
    v_mul_f32 v80, v80, v251
    v_mul_f32 v81, v81, v251
    v_mul_f32 v82, v82, v251
    v_mul_f32 v83, v83, v251
    v_mul_f32 v84, v84, v251
    v_mul_f32 v85, v85, v251
    v_mul_f32 v86, v86, v251
    v_mul_f32 v87, v87, v251
    v_mul_f32 v88, v88, v251
    v_mul_f32 v89, v89, v251
    v_mul_f32 v90, v90, v251
    v_mul_f32 v91, v91, v251
    v_mul_f32 v92, v92, v251
    v_mul_f32 v93, v93, v251
    v_mul_f32 v94, v94, v251
    v_mul_f32 v95, v95, v251
    s_branch RREJ_AX_loop
RARE_AX_loop1:
    s_waitcnt lgkmcnt(8)
    v_mfma_f32_16x16x32_bf16 v[88:91], v[228:231], v[192:195], v[88:91]
    ds_read_b64_tr_b16 v[220:221], v242 offset:4096
    ds_read_b64_tr_b16 v[222:223], v242 offset:6144
    v_mfma_f32_16x16x32_bf16 v[92:95], v[232:235], v[192:195], v[92:95]
    ds_read_b64_tr_b16 v[224:225], v243 offset:4096
    ds_read_b64_tr_b16 v[226:227], v243 offset:6144
    s_waitcnt lgkmcnt(8)
    v_mfma_f32_32x32x16_bf16 v[0:15], v[204:207], v[144:147], v[0:15]
    ds_read_b64_tr_b16 v[228:229], v242 offset:4608
    ds_read_b64_tr_b16 v[230:231], v242 offset:6656
    v_mfma_f32_32x32x16_bf16 v[16:31], v[208:211], v[144:147], v[16:31]
    ds_read_b64_tr_b16 v[232:233], v243 offset:4608
    ds_read_b64_tr_b16 v[234:235], v243 offset:6656
    s_waitcnt lgkmcnt(8)
    v_mfma_f32_32x32x16_bf16 v[32:47], v[212:215], v[144:147], v[32:47]
    v_add_u32 v238, s45, v238
    v_add_u32 v239, s45, v239
    v_add_u32 v240, s45, v240
    v_add_u32 v241, s45, v241
    v_add_u32 v242, s45, v242
    v_add_u32 v243, s45, v243
    v_add_u32 v246, s42, v244
    v_xor_b32 v247, 64, v246
    s_waitcnt lgkmcnt(0)
    s_barrier
    ds_read_b128 v[204:207], v238 offset:0
    v_mfma_f32_32x32x16_bf16 v[48:63], v[216:219], v[144:147], v[48:63]
    ds_read_b128 v[208:211], v239 offset:0
    v_mfma_f32_32x32x16_bf16 v[0:15], v[220:223], v[152:155], v[0:15]
    ds_read_b128 v[212:215], v240 offset:0
    v_mfma_f32_32x32x16_bf16 v[16:31], v[224:227], v[152:155], v[16:31]
    ds_read_b128 v[216:219], v241 offset:0
    v_mfma_f32_32x32x16_bf16 v[32:47], v[228:231], v[152:155], v[32:47]
    ds_read_b128 v[220:223], v238 offset:512
    v_mfma_f32_32x32x16_bf16 v[48:63], v[232:235], v[152:155], v[48:63]
    v_mov_b32 v251, v250
    v_mov_b32 v252, v250
    s_nop 1
    v_permlane32_swap_b32 v251, v252
    v_max_f32 v250, v251, v252
    v_max_f32 v250, 0, v250
    v_exp_f32 v251, -v250
    v_sub_f32 v160, v160, v250
    v_sub_f32 v161, v161, v250
    v_sub_f32 v162, v162, v250
    v_sub_f32 v163, v163, v250
    v_sub_f32 v164, v164, v250
    v_sub_f32 v165, v165, v250
    v_sub_f32 v166, v166, v250
    v_sub_f32 v167, v167, v250
    v_sub_f32 v168, v168, v250
    v_sub_f32 v169, v169, v250
    v_sub_f32 v170, v170, v250
    v_sub_f32 v171, v171, v250
    v_sub_f32 v172, v172, v250
    v_sub_f32 v173, v173, v250
    v_sub_f32 v174, v174, v250
    v_sub_f32 v175, v175, v250
    v_sub_f32 v176, v176, v250
    v_sub_f32 v177, v177, v250
    v_sub_f32 v178, v178, v250
    v_sub_f32 v179, v179, v250
    v_sub_f32 v180, v180, v250
    v_sub_f32 v181, v181, v250
    v_sub_f32 v182, v182, v250
    v_sub_f32 v183, v183, v250
    v_sub_f32 v184, v184, v250
    v_sub_f32 v185, v185, v250
    v_sub_f32 v186, v186, v250
    v_sub_f32 v187, v187, v250
    v_sub_f32 v188, v188, v250
    v_sub_f32 v189, v189, v250
    v_sub_f32 v190, v190, v250
    v_sub_f32 v191, v191, v250
    v_mul_f32 v236, v236, v251
    v_mul_f32 v249, v249, v251
    v_mul_f32 v0, v0, v251
    v_mul_f32 v1, v1, v251
    v_mul_f32 v2, v2, v251
    v_mul_f32 v3, v3, v251
    v_mul_f32 v4, v4, v251
    v_mul_f32 v5, v5, v251
    v_mul_f32 v6, v6, v251
    v_mul_f32 v7, v7, v251
    v_mul_f32 v8, v8, v251
    v_mul_f32 v9, v9, v251
    v_mul_f32 v10, v10, v251
    v_mul_f32 v11, v11, v251
    v_mul_f32 v12, v12, v251
    v_mul_f32 v13, v13, v251
    v_mul_f32 v14, v14, v251
    v_mul_f32 v15, v15, v251
    v_mul_f32 v16, v16, v251
    v_mul_f32 v17, v17, v251
    v_mul_f32 v18, v18, v251
    v_mul_f32 v19, v19, v251
    v_mul_f32 v20, v20, v251
    v_mul_f32 v21, v21, v251
    v_mul_f32 v22, v22, v251
    v_mul_f32 v23, v23, v251
    v_mul_f32 v24, v24, v251
    v_mul_f32 v25, v25, v251
    v_mul_f32 v26, v26, v251
    v_mul_f32 v27, v27, v251
    v_mul_f32 v28, v28, v251
    v_mul_f32 v29, v29, v251
    v_mul_f32 v30, v30, v251
    v_mul_f32 v31, v31, v251
    v_mul_f32 v32, v32, v251
    v_mul_f32 v33, v33, v251
    v_mul_f32 v34, v34, v251
    v_mul_f32 v35, v35, v251
    v_mul_f32 v36, v36, v251
    v_mul_f32 v37, v37, v251
    v_mul_f32 v38, v38, v251
    v_mul_f32 v39, v39, v251
    v_mul_f32 v40, v40, v251
    v_mul_f32 v41, v41, v251
    v_mul_f32 v42, v42, v251
    v_mul_f32 v43, v43, v251
    v_mul_f32 v44, v44, v251
    v_mul_f32 v45, v45, v251
    v_mul_f32 v46, v46, v251
    v_mul_f32 v47, v47, v251
    v_mul_f32 v48, v48, v251
    v_mul_f32 v49, v49, v251
    v_mul_f32 v50, v50, v251
    v_mul_f32 v51, v51, v251
    v_mul_f32 v52, v52, v251
    v_mul_f32 v53, v53, v251
    v_mul_f32 v54, v54, v251
    v_mul_f32 v55, v55, v251
    v_mul_f32 v56, v56, v251
    v_mul_f32 v57, v57, v251
    v_mul_f32 v58, v58, v251
    v_mul_f32 v59, v59, v251
    v_mul_f32 v60, v60, v251
    v_mul_f32 v61, v61, v251
    v_mul_f32 v62, v62, v251
    v_mul_f32 v63, v63, v251
    v_exp_f32 v160, v160
    v_exp_f32 v161, v161
    v_exp_f32 v162, v162
    v_add_f32 v236, v236, v160
    v_add_f32 v249, v249, v161
    v_cvt_pk_bf16_f32 v160, v160, v161
    v_exp_f32 v163, v163
    v_exp_f32 v164, v164
    v_add_f32 v236, v236, v162
    v_add_f32 v249, v249, v163
    v_cvt_pk_bf16_f32 v161, v162, v163
    v_exp_f32 v165, v165
    v_exp_f32 v166, v166
    v_add_f32 v236, v236, v164
    v_add_f32 v249, v249, v165
    v_cvt_pk_bf16_f32 v162, v164, v165
    v_exp_f32 v167, v167
    v_exp_f32 v168, v168
    v_add_f32 v236, v236, v166
    v_add_f32 v249, v249, v167
    v_cvt_pk_bf16_f32 v163, v166, v167
    v_exp_f32 v169, v169
    s_branch REJ_AX_loop1
RARE_AX_last0:
    s_waitcnt lgkmcnt(8)
    v_mfma_f32_16x16x32_bf16 v[192:195], v[228:231], v[140:143], v[192:195]
    ds_read_b64_tr_b16 v[220:221], v242 offset:4096
    ds_read_b64_tr_b16 v[222:223], v242 offset:6144
    v_mfma_f32_16x16x32_bf16 v[196:199], v[232:235], v[140:143], v[196:199]
    ds_read_b64_tr_b16 v[224:225], v243 offset:4096
    ds_read_b64_tr_b16 v[226:227], v243 offset:6144
    s_waitcnt lgkmcnt(8)
    v_mfma_f32_32x32x16_bf16 v[0:15], v[204:207], v[160:163], v[0:15]
    ds_read_b64_tr_b16 v[228:229], v242 offset:4608
    ds_read_b64_tr_b16 v[230:231], v242 offset:6656
    v_mfma_f32_32x32x16_bf16 v[16:31], v[208:211], v[160:163], v[16:31]
    ds_read_b64_tr_b16 v[232:233], v243 offset:4608
    ds_read_b64_tr_b16 v[234:235], v243 offset:6656
    s_waitcnt lgkmcnt(8)
    v_mfma_f32_32x32x16_bf16 v[32:47], v[212:215], v[160:163], v[32:47]
    v_add_u32 v238, s45, v238
    v_add_u32 v239, s45, v239
    v_add_u32 v240, s45, v240
    v_add_u32 v241, s45, v241
    v_add_u32 v242, s45, v242
    v_add_u32 v243, s45, v243
    v_add_u32 v246, s42, v245
    v_xor_b32 v247, 64, v246
    s_waitcnt lgkmcnt(0)
    s_barrier
    ds_read_b128 v[204:207], v238 offset:0
    v_mfma_f32_32x32x16_bf16 v[48:63], v[216:219], v[160:163], v[48:63]
    ds_read_b128 v[208:211], v239 offset:0
    v_mfma_f32_32x32x16_bf16 v[0:15], v[220:223], v[168:171], v[0:15]
    ds_read_b128 v[212:215], v240 offset:0
    v_mfma_f32_32x32x16_bf16 v[16:31], v[224:227], v[168:171], v[16:31]
    ds_read_b128 v[216:219], v241 offset:0
    v_mfma_f32_32x32x16_bf16 v[32:47], v[228:231], v[168:171], v[32:47]
    ds_read_b128 v[220:223], v238 offset:512
    v_mfma_f32_32x32x16_bf16 v[48:63], v[232:235], v[168:171], v[48:63]
    v_mov_b32 v251, v250
    v_mov_b32 v252, v250
    s_nop 1
    v_permlane32_swap_b32 v251, v252
    v_max_f32 v250, v251, v252
    v_max_f32 v250, 0, v250
    v_exp_f32 v251, -v250
    v_sub_f32 v144, v144, v250
    v_sub_f32 v145, v145, v250
    v_sub_f32 v146, v146, v250
    v_sub_f32 v147, v147, v250
    v_sub_f32 v148, v148, v250
    v_sub_f32 v149, v149, v250
    v_sub_f32 v150, v150, v250
    v_sub_f32 v151, v151, v250
    v_sub_f32 v152, v152, v250
    v_sub_f32 v153, v153, v250
    v_sub_f32 v154, v154, v250
    v_sub_f32 v155, v155, v250
    v_sub_f32 v156, v156, v250
    v_sub_f32 v157, v157, v250
    v_sub_f32 v158, v158, v250
    v_sub_f32 v159, v159, v250
    v_sub_f32 v176, v176, v250
    v_sub_f32 v177, v177, v250
    v_sub_f32 v178, v178, v250
    v_sub_f32 v179, v179, v250
    v_sub_f32 v180, v180, v250
    v_sub_f32 v181, v181, v250
    v_sub_f32 v182, v182, v250
    v_sub_f32 v183, v183, v250
    v_sub_f32 v184, v184, v250
    v_sub_f32 v185, v185, v250
    v_sub_f32 v186, v186, v250
    v_sub_f32 v187, v187, v250
    v_sub_f32 v188, v188, v250
    v_sub_f32 v189, v189, v250
    v_sub_f32 v190, v190, v250
    v_sub_f32 v191, v191, v250
    v_mul_f32 v236, v236, v251
    v_mul_f32 v249, v249, v251
    v_mul_f32 v0, v0, v251
    v_mul_f32 v1, v1, v251
    v_mul_f32 v2, v2, v251
    v_mul_f32 v3, v3, v251
    v_mul_f32 v4, v4, v251
    v_mul_f32 v5, v5, v251
    v_mul_f32 v6, v6, v251
    v_mul_f32 v7, v7, v251
    v_mul_f32 v8, v8, v251
    v_mul_f32 v9, v9, v251
    v_mul_f32 v10, v10, v251
    v_mul_f32 v11, v11, v251
    v_mul_f32 v12, v12, v251
    v_mul_f32 v13, v13, v251
    v_mul_f32 v14, v14, v251
    v_mul_f32 v15, v15, v251
    v_mul_f32 v16, v16, v251
    v_mul_f32 v17, v17, v251
    v_mul_f32 v18, v18, v251
    v_mul_f32 v19, v19, v251
    v_mul_f32 v20, v20, v251
    v_mul_f32 v21, v21, v251
    v_mul_f32 v22, v22, v251
    v_mul_f32 v23, v23, v251
    v_mul_f32 v24, v24, v251
    v_mul_f32 v25, v25, v251
    v_mul_f32 v26, v26, v251
    v_mul_f32 v27, v27, v251
    v_mul_f32 v28, v28, v251
    v_mul_f32 v29, v29, v251
    v_mul_f32 v30, v30, v251
    v_mul_f32 v31, v31, v251
    v_mul_f32 v32, v32, v251
    v_mul_f32 v33, v33, v251
    v_mul_f32 v34, v34, v251
    v_mul_f32 v35, v35, v251
    v_mul_f32 v36, v36, v251
    v_mul_f32 v37, v37, v251
    v_mul_f32 v38, v38, v251
    v_mul_f32 v39, v39, v251
    v_mul_f32 v40, v40, v251
    v_mul_f32 v41, v41, v251
    v_mul_f32 v42, v42, v251
    v_mul_f32 v43, v43, v251
    v_mul_f32 v44, v44, v251
    v_mul_f32 v45, v45, v251
    v_mul_f32 v46, v46, v251
    v_mul_f32 v47, v47, v251
    v_mul_f32 v48, v48, v251
    v_mul_f32 v49, v49, v251
    v_mul_f32 v50, v50, v251
    v_mul_f32 v51, v51, v251
    v_mul_f32 v52, v52, v251
    v_mul_f32 v53, v53, v251
    v_mul_f32 v54, v54, v251
    v_mul_f32 v55, v55, v251
    v_mul_f32 v56, v56, v251
    v_mul_f32 v57, v57, v251
    v_mul_f32 v58, v58, v251
    v_mul_f32 v59, v59, v251
    v_mul_f32 v60, v60, v251
    v_mul_f32 v61, v61, v251
    v_mul_f32 v62, v62, v251
    v_mul_f32 v63, v63, v251
    v_exp_f32 v144, v144
    v_exp_f32 v145, v145
    v_exp_f32 v146, v146
    v_add_f32 v236, v236, v144
    v_add_f32 v249, v249, v145
    v_cvt_pk_bf16_f32 v144, v144, v145
    v_exp_f32 v147, v147
    v_exp_f32 v148, v148
    v_add_f32 v236, v236, v146
    v_add_f32 v249, v249, v147
    v_cvt_pk_bf16_f32 v145, v146, v147
    v_exp_f32 v149, v149
    v_exp_f32 v150, v150
    v_add_f32 v236, v236, v148
    v_add_f32 v249, v249, v149
    v_cvt_pk_bf16_f32 v146, v148, v149
    v_exp_f32 v151, v151
    v_exp_f32 v152, v152
    v_add_f32 v236, v236, v150
    v_add_f32 v249, v249, v151
    v_cvt_pk_bf16_f32 v147, v150, v151
    v_exp_f32 v153, v153
    v_exp_f32 v154, v154
    v_add_f32 v236, v236, v152
    v_add_f32 v249, v249, v153
    v_cvt_pk_bf16_f32 v152, v152, v153
    v_exp_f32 v155, v155
    v_exp_f32 v156, v156
    v_add_f32 v236, v236, v154
    v_add_f32 v249, v249, v155
    v_cvt_pk_bf16_f32 v153, v154, v155
    v_exp_f32 v157, v157
    s_branch REJ_AX_last0
RRARE_AX_last:
    ds_swizzle_b32 v251, v253 offset:0x401F
    s_waitcnt lgkmcnt(0)
    v_max_f32 v253, v253, v251
    v_mov_b32 v251, v253
    v_mov_b32 v252, v253
    s_nop 1
    v_permlane32_swap_b32 v251, v252
    v_max_f32 v253, v251, v252
    v_max_f32 v253, 0, v253
    v_exp_f32 v251, -v253
    v_sub_f32 v192, v192, v253
    v_sub_f32 v193, v193, v253
    v_sub_f32 v194, v194, v253
    v_sub_f32 v195, v195, v253
    v_sub_f32 v196, v196, v253
    v_sub_f32 v197, v197, v253
    v_sub_f32 v198, v198, v253
    v_sub_f32 v199, v199, v253
    v_sub_f32 v200, v200, v253
    v_sub_f32 v201, v201, v253
    v_sub_f32 v202, v202, v253
    v_sub_f32 v203, v203, v253
    v_mul_f32 v237, v237, v251
    v_mul_f32 v64, v64, v251
    v_mul_f32 v65, v65, v251
    v_mul_f32 v66, v66, v251
    v_mul_f32 v67, v67, v251
    v_mul_f32 v68, v68, v251
    v_mul_f32 v69, v69, v251
    v_mul_f32 v70, v70, v251
    v_mul_f32 v71, v71, v251
    v_mul_f32 v72, v72, v251
    v_mul_f32 v73, v73, v251
    v_mul_f32 v74, v74, v251
    v_mul_f32 v75, v75, v251
    v_mul_f32 v76, v76, v251
    v_mul_f32 v77, v77, v251
    v_mul_f32 v78, v78, v251
    v_mul_f32 v79, v79, v251
    v_mul_f32 v80, v80, v251
    v_mul_f32 v81, v81, v251
    v_mul_f32 v82, v82, v251
    v_mul_f32 v83, v83, v251
    v_mul_f32 v84, v84, v251
    v_mul_f32 v85, v85, v251
    v_mul_f32 v86, v86, v251
    v_mul_f32 v87, v87, v251
    v_mul_f32 v88, v88, v251
    v_mul_f32 v89, v89, v251
    v_mul_f32 v90, v90, v251
    v_mul_f32 v91, v91, v251
    v_mul_f32 v92, v92, v251
    v_mul_f32 v93, v93, v251
    v_mul_f32 v94, v94, v251
    v_mul_f32 v95, v95, v251
    s_branch RREJ_AX_last
RARE_AX_last1:
    s_waitcnt lgkmcnt(8)
    v_mfma_f32_16x16x32_bf16 v[80:83], v[220:223], v[192:195], v[80:83]
    ds_read_b64_tr_b16 v[212:213], v242 offset:512
    ds_read_b64_tr_b16 v[214:215], v242 offset:2560
    v_mfma_f32_16x16x32_bf16 v[84:87], v[224:227], v[192:195], v[84:87]
    ds_read_b64_tr_b16 v[216:217], v243 offset:512
    ds_read_b64_tr_b16 v[218:219], v243 offset:2560
    s_waitcnt lgkmcnt(8)
    v_mfma_f32_16x16x32_bf16 v[88:91], v[228:231], v[192:195], v[88:91]
    ds_read_b64_tr_b16 v[220:221], v242 offset:4096
    ds_read_b64_tr_b16 v[222:223], v242 offset:6144
    v_mfma_f32_16x16x32_bf16 v[92:95], v[232:235], v[192:195], v[92:95]
    ds_read_b64_tr_b16 v[224:225], v243 offset:4096
    ds_read_b64_tr_b16 v[226:227], v243 offset:6144
    s_waitcnt lgkmcnt(8)
    v_mfma_f32_32x32x16_bf16 v[0:15], v[204:207], v[144:147], v[0:15]
    ds_read_b64_tr_b16 v[228:229], v242 offset:4608
    ds_read_b64_tr_b16 v[230:231], v242 offset:6656
    v_mfma_f32_32x32x16_bf16 v[16:31], v[208:211], v[144:147], v[16:31]
    ds_read_b64_tr_b16 v[232:233], v243 offset:4608
    ds_read_b64_tr_b16 v[234:235], v243 offset:6656
    s_waitcnt lgkmcnt(8)
    v_mfma_f32_32x32x16_bf16 v[32:47], v[212:215], v[144:147], v[32:47]
    v_add_u32 v238, s45, v238
    v_add_u32 v239, s45, v239
    v_add_u32 v240, s45, v240
    v_add_u32 v241, s45, v241
    v_add_u32 v242, s45, v242
    v_add_u32 v243, s45, v243
    v_add_u32 v246, s42, v244
    v_xor_b32 v247, 64, v246
    s_waitcnt lgkmcnt(0)
    s_barrier
    v_mfma_f32_32x32x16_bf16 v[48:63], v[216:219], v[144:147], v[48:63]
    v_mfma_f32_32x32x16_bf16 v[0:15], v[220:223], v[152:155], v[0:15]
    v_mfma_f32_32x32x16_bf16 v[16:31], v[224:227], v[152:155], v[16:31]
    v_mfma_f32_32x32x16_bf16 v[32:47], v[228:231], v[152:155], v[32:47]
    v_mfma_f32_32x32x16_bf16 v[48:63], v[232:235], v[152:155], v[48:63]
    v_mov_b32 v251, v250
    v_mov_b32 v252, v250
    s_nop 1
    v_permlane32_swap_b32 v251, v252
    v_max_f32 v250, v251, v252
    v_max_f32 v250, 0, v250
    v_exp_f32 v251, -v250
    v_sub_f32 v160, v160, v250
    v_sub_f32 v161, v161, v250
    v_sub_f32 v162, v162, v250
    v_sub_f32 v163, v163, v250
    v_sub_f32 v164, v164, v250
    v_sub_f32 v165, v165, v250
    v_sub_f32 v166, v166, v250
    v_sub_f32 v167, v167, v250
    v_sub_f32 v168, v168, v250
    v_sub_f32 v169, v169, v250
    v_sub_f32 v170, v170, v250
    v_sub_f32 v171, v171, v250
    v_sub_f32 v172, v172, v250
    v_sub_f32 v173, v173, v250
    v_sub_f32 v174, v174, v250
    v_sub_f32 v175, v175, v250
    v_sub_f32 v176, v176, v250
    v_sub_f32 v177, v177, v250
    v_sub_f32 v178, v178, v250
    v_sub_f32 v179, v179, v250
    v_sub_f32 v180, v180, v250
    v_sub_f32 v181, v181, v250
    v_sub_f32 v182, v182, v250
    v_sub_f32 v183, v183, v250
    v_sub_f32 v184, v184, v250
    v_sub_f32 v185, v185, v250
    v_sub_f32 v186, v186, v250
    v_sub_f32 v187, v187, v250
    v_sub_f32 v188, v188, v250
    v_sub_f32 v189, v189, v250
    v_sub_f32 v190, v190, v250
    v_sub_f32 v191, v191, v250
    v_mul_f32 v236, v236, v251
    v_mul_f32 v249, v249, v251
    v_mul_f32 v0, v0, v251
    v_mul_f32 v1, v1, v251
    v_mul_f32 v2, v2, v251
    v_mul_f32 v3, v3, v251
    v_mul_f32 v4, v4, v251
    v_mul_f32 v5, v5, v251
    v_mul_f32 v6, v6, v251
    v_mul_f32 v7, v7, v251
    v_mul_f32 v8, v8, v251
    v_mul_f32 v9, v9, v251
    v_mul_f32 v10, v10, v251
    v_mul_f32 v11, v11, v251
    v_mul_f32 v12, v12, v251
    v_mul_f32 v13, v13, v251
    v_mul_f32 v14, v14, v251
    v_mul_f32 v15, v15, v251
    v_mul_f32 v16, v16, v251
    v_mul_f32 v17, v17, v251
    v_mul_f32 v18, v18, v251
    v_mul_f32 v19, v19, v251
    v_mul_f32 v20, v20, v251
    v_mul_f32 v21, v21, v251
    v_mul_f32 v22, v22, v251
    v_mul_f32 v23, v23, v251
    v_mul_f32 v24, v24, v251
    v_mul_f32 v25, v25, v251
    v_mul_f32 v26, v26, v251
    v_mul_f32 v27, v27, v251
    v_mul_f32 v28, v28, v251
    v_mul_f32 v29, v29, v251
    v_mul_f32 v30, v30, v251
    v_mul_f32 v31, v31, v251
    v_mul_f32 v32, v32, v251
    v_mul_f32 v33, v33, v251
    v_mul_f32 v34, v34, v251
    v_mul_f32 v35, v35, v251
    v_mul_f32 v36, v36, v251
    v_mul_f32 v37, v37, v251
    v_mul_f32 v38, v38, v251
    v_mul_f32 v39, v39, v251
    v_mul_f32 v40, v40, v251
    v_mul_f32 v41, v41, v251
    v_mul_f32 v42, v42, v251
    v_mul_f32 v43, v43, v251
    v_mul_f32 v44, v44, v251
    v_mul_f32 v45, v45, v251
    v_mul_f32 v46, v46, v251
    v_mul_f32 v47, v47, v251
    v_mul_f32 v48, v48, v251
    v_mul_f32 v49, v49, v251
    v_mul_f32 v50, v50, v251
    v_mul_f32 v51, v51, v251
    v_mul_f32 v52, v52, v251
    v_mul_f32 v53, v53, v251
    v_mul_f32 v54, v54, v251
    v_mul_f32 v55, v55, v251
    v_mul_f32 v56, v56, v251
    v_mul_f32 v57, v57, v251
    v_mul_f32 v58, v58, v251
    v_mul_f32 v59, v59, v251
    v_mul_f32 v60, v60, v251
    v_mul_f32 v61, v61, v251
    v_mul_f32 v62, v62, v251
    v_mul_f32 v63, v63, v251
    v_exp_f32 v160, v160
    v_exp_f32 v161, v161
    v_exp_f32 v162, v162
    v_add_f32 v236, v236, v160
    v_add_f32 v249, v249, v161
    v_cvt_pk_bf16_f32 v160, v160, v161
    v_exp_f32 v163, v163
    v_exp_f32 v164, v164
    v_add_f32 v236, v236, v162
    v_add_f32 v249, v249, v163
    v_cvt_pk_bf16_f32 v161, v162, v163
    v_exp_f32 v165, v165
    v_exp_f32 v166, v166
    v_add_f32 v236, v236, v164
    v_add_f32 v249, v249, v165
    v_cvt_pk_bf16_f32 v162, v164, v165
    v_exp_f32 v167, v167
    v_exp_f32 v168, v168
    v_add_f32 v236, v236, v166
    v_add_f32 v249, v249, v167
    v_cvt_pk_bf16_f32 v163, v166, v167
    v_exp_f32 v169, v169
    v_exp_f32 v170, v170
    v_add_f32 v236, v236, v168
    v_add_f32 v249, v249, v169
    v_cvt_pk_bf16_f32 v168, v168, v169
    v_exp_f32 v171, v171
    v_exp_f32 v172, v172
    v_add_f32 v236, v236, v170
    v_add_f32 v249, v249, v171
    v_cvt_pk_bf16_f32 v169, v170, v171
    v_exp_f32 v173, v173
    v_exp_f32 v174, v174
    v_add_f32 v236, v236, v172
    v_add_f32 v249, v249, v173
    v_cvt_pk_bf16_f32 v170, v172, v173
    s_branch REJ_AX_last1
ATT_AL:
    s_setprio 0
    ds_read_b128 v[204:207], v238 offset:0
    ds_read_b128 v[208:211], v239 offset:0
    ds_read_b128 v[212:215], v240 offset:0
    ds_read_b128 v[216:219], v241 offset:0
    ds_read_b128 v[220:223], v238 offset:512
    ds_read_b128 v[224:227], v239 offset:512
    ds_read_b128 v[228:231], v240 offset:512
    ds_read_b128 v[232:235], v241 offset:512
    s_waitcnt lgkmcnt(7)
    v_mfma_f32_32x32x16_bf16 v[144:159], v[204:207], v[96:99], 0
    s_waitcnt lgkmcnt(6)
    v_mfma_f32_32x32x16_bf16 v[144:159], v[208:211], v[100:103], v[144:159]
    s_waitcnt lgkmcnt(5)
    v_mfma_f32_32x32x16_bf16 v[144:159], v[212:215], v[104:107], v[144:159]
    s_waitcnt lgkmcnt(4)
    v_mfma_f32_32x32x16_bf16 v[144:159], v[216:219], v[108:111], v[144:159]
    s_waitcnt lgkmcnt(3)
    v_mfma_f32_32x32x16_bf16 v[144:159], v[220:223], v[112:115], v[144:159]
    s_waitcnt lgkmcnt(2)
    v_mfma_f32_32x32x16_bf16 v[144:159], v[224:227], v[116:119], v[144:159]
    s_waitcnt lgkmcnt(1)
    v_mfma_f32_32x32x16_bf16 v[144:159], v[228:231], v[120:123], v[144:159]
    s_waitcnt lgkmcnt(0)
    v_mfma_f32_32x32x16_bf16 v[144:159], v[232:235], v[124:127], v[144:159]
    v_mov_b32 v236, 0
    v_mov_b32 v65, 0
    v_mov_b32 v237, 0
    v_xor_b32 v64, 64, v248
    s_nop 7
    v_max3_f32 v250, v144, v145, v146
    v_max3_f32 v250, v250, v147, v148
    v_max3_f32 v250, v250, v149, v150
    v_max3_f32 v250, v250, v151, v152
    v_max3_f32 v250, v250, v153, v154
    v_max3_f32 v250, v250, v155, v156
    v_max3_f32 v250, v250, v157, v158
    v_max_f32 v250, v250, v159
    v_mov_b32 v251, v250
    v_mov_b32 v252, v250
    s_nop 1
    v_permlane32_swap_b32 v251, v252
    v_max_f32 v250, v251, v252
    v_sub_f32 v176, 0, v250
    v_sub_f32 v177, 0, v250
    v_sub_f32 v178, 0, v250
    v_sub_f32 v179, 0, v250
    v_sub_f32 v180, 0, v250
    v_sub_f32 v181, 0, v250
    v_sub_f32 v182, 0, v250
    v_sub_f32 v183, 0, v250
    v_sub_f32 v184, 0, v250
    v_sub_f32 v185, 0, v250
    v_sub_f32 v186, 0, v250
    v_sub_f32 v187, 0, v250
    v_sub_f32 v188, 0, v250
    v_sub_f32 v189, 0, v250
    v_sub_f32 v190, 0, v250
    v_sub_f32 v191, 0, v250
    v_sub_f32 v144, v144, v250
    v_sub_f32 v145, v145, v250
    v_sub_f32 v146, v146, v250
    v_sub_f32 v147, v147, v250
    v_sub_f32 v148, v148, v250
    v_sub_f32 v149, v149, v250
    v_sub_f32 v150, v150, v250
    v_sub_f32 v151, v151, v250
    v_sub_f32 v152, v152, v250
    v_sub_f32 v153, v153, v250
    v_sub_f32 v154, v154, v250
    v_sub_f32 v155, v155, v250
    v_sub_f32 v156, v156, v250
    v_sub_f32 v157, v157, v250
    v_sub_f32 v158, v158, v250
    v_sub_f32 v159, v159, v250
    s_mov_b32 s50, 14
    s_mov_b32 s44, s42
    s_add_u32 s42, s42, 0x4000
    s_cmp_ge_u32 s42, 0x28000
    s_cselect_b32 s51, 0x28000, 0
    s_sub_u32 s42, s42, s51
    s_sub_u32 s45, s42, s44
    s_add_u32 s44, s42, 0xc000
    s_cmp_ge_u32 s44, 0x28000
    s_cselect_b32 s51, 0x28000, 0
    s_sub_u32 s44, s44, s51
    s_mov_b32 s46, s48
    s_add_u32 s48, s48, 0x2000
    s_and_b32 s48, s48, 0x3ffff
    s_add_u32 s62, s62, 1
    s_cmp_lt_u32 s62, 31
    s_cselect_b32 s14, 0x40000, 0
    s_cmp_lt_u32 s62, 32
    s_cselect_b32 s18, 0x40000, 0
    s_cselect_b32 s44, s44, 0x30000
    v_add_u32 v238, s45, v238
    v_add_u32 v239, s45, v239
    v_add_u32 v240, s45, v240
    v_add_u32 v241, s45, v241
    v_add_u32 v242, s45, v242
    v_add_u32 v243, s45, v243
    s_waitcnt vmcnt(8) lgkmcnt(0)
    s_barrier
    ds_read_b128 v[204:207], v238 offset:0
    ds_read_b128 v[208:211], v239 offset:0
    ds_read_b128 v[212:215], v240 offset:0
    ds_read_b128 v[216:219], v241 offset:0
    ds_read_b128 v[220:223], v238 offset:512
    ds_read_b128 v[224:227], v239 offset:512
    s_waitcnt lgkmcnt(4)
    v_mfma_f32_32x32x16_bf16 v[160:175], v[204:207], v[96:99], v[176:191]
    ds_read_b128 v[228:231], v240 offset:512
    s_add_u32 m0, s44, s59
    s_add_u32 s52, s48, 0x1000
    buffer_load_dwordx4 v248, s[12:15], s48 offen nt lds
    v_exp_f32 v144, v144
    v_exp_f32 v145, v145
    v_exp_f32 v146, v146
    v_add_f32 v236, v236, v144
    v_mfma_f32_32x32x16_bf16 v[160:175], v[208:211], v[100:103], v[160:175]
    ds_read_b128 v[232:235], v241 offset:512
    s_add_u32 m0, m0, 0x1000
    s_add_u32 s53, s46, 0x1000
    buffer_load_dwordx4 v248, s[12:15], s52 offen nt lds
    v_add_f32 v65, v65, v145
    v_cvt_pk_bf16_f32 v144, v144, v145
    v_exp_f32 v147, v147
    v_exp_f32 v148, v148
    v_add_f32 v236, v236, v146
    s_waitcnt lgkmcnt(4)
    v_mfma_f32_32x32x16_bf16 v[160:175], v[212:215], v[104:107], v[160:175]
    ds_read_b64_tr_b16 v[204:205], v242 offset:0
    ds_read_b64_tr_b16 v[206:207], v242 offset:2048
    s_add_u32 m0, m0, 0x1000
    s_nop 0
    buffer_load_dwordx4 v249, s[16:19], s46 offen nt lds
    v_add_f32 v65, v65, v147
    v_cvt_pk_bf16_f32 v145, v146, v147
    v_exp_f32 v149, v149
    v_exp_f32 v150, v150
    v_add_f32 v236, v236, v148
    v_mfma_f32_32x32x16_bf16 v[160:175], v[216:219], v[108:111], v[160:175]
    ds_read_b64_tr_b16 v[208:209], v243 offset:0
    ds_read_b64_tr_b16 v[210:211], v243 offset:2048
    s_add_u32 m0, m0, 0x1000
    s_nop 0
    buffer_load_dwordx4 v249, s[16:19], s53 offen nt lds
    v_add_f32 v65, v65, v149
    v_cvt_pk_bf16_f32 v146, v148, v149
    v_exp_f32 v151, v151
    v_exp_f32 v152, v152
    v_add_f32 v236, v236, v150
    s_waitcnt lgkmcnt(6)
    v_mfma_f32_32x32x16_bf16 v[160:175], v[220:223], v[112:115], v[160:175]
    ds_read_b64_tr_b16 v[212:213], v242 offset:512
    ds_read_b64_tr_b16 v[214:215], v242 offset:2560
    v_add_f32 v65, v65, v151
    v_cvt_pk_bf16_f32 v147, v150, v151
    v_exp_f32 v153, v153
    v_exp_f32 v154, v154
    v_add_f32 v236, v236, v152
    v_mfma_f32_32x32x16_bf16 v[160:175], v[224:227], v[116:119], v[160:175]
    ds_read_b64_tr_b16 v[216:217], v243 offset:512
    ds_read_b64_tr_b16 v[218:219], v243 offset:2560
    v_add_f32 v65, v65, v153
    v_cvt_pk_bf16_f32 v152, v152, v153
    v_exp_f32 v155, v155
    v_exp_f32 v156, v156
    v_add_f32 v236, v236, v154
    s_waitcnt lgkmcnt(8)
    v_mfma_f32_32x32x16_bf16 v[160:175], v[228:231], v[120:123], v[160:175]
    ds_read_b64_tr_b16 v[220:221], v242 offset:4096
    ds_read_b64_tr_b16 v[222:223], v242 offset:6144
    v_add_f32 v65, v65, v155
    v_cvt_pk_bf16_f32 v153, v154, v155
    v_exp_f32 v157, v157
    v_exp_f32 v158, v158
    v_add_f32 v236, v236, v156
    v_mfma_f32_32x32x16_bf16 v[160:175], v[232:235], v[124:127], v[160:175]
    ds_read_b64_tr_b16 v[224:225], v243 offset:4096
    ds_read_b64_tr_b16 v[226:227], v243 offset:6144
    v_add_f32 v65, v65, v157
    v_cvt_pk_bf16_f32 v154, v156, v157
    v_exp_f32 v159, v159
    v_add_f32 v236, v236, v158
    v_add_f32 v65, v65, v159
    v_cvt_pk_bf16_f32 v155, v158, v159
    s_waitcnt lgkmcnt(8)
    v_mfma_f32_32x32x16_bf16 v[0:15], v[204:207], v[144:147], 0
    ds_read_b64_tr_b16 v[228:229], v242 offset:4608
    ds_read_b64_tr_b16 v[230:231], v242 offset:6656
    s_mov_b32 s44, s42
    s_add_u32 s42, s42, 0x4000
    s_cmp_ge_u32 s42, 0x28000
    s_cselect_b32 s51, 0x28000, 0
    s_sub_u32 s42, s42, s51
    s_sub_u32 s45, s42, s44
    v_mfma_f32_32x32x16_bf16 v[16:31], v[208:211], v[144:147], 0
    ds_read_b64_tr_b16 v[232:233], v243 offset:4608
    ds_read_b64_tr_b16 v[234:235], v243 offset:6656
    s_add_u32 s44, s42, 0xc000
    s_cmp_ge_u32 s44, 0x28000
    s_cselect_b32 s51, 0x28000, 0
    s_sub_u32 s44, s44, s51
    s_mov_b32 s46, s48
    s_add_u32 s48, s48, 0x2000
    v_max3_f32 v250, v160, v161, v162
    v_max3_f32 v250, v250, v163, v164
    v_max3_f32 v250, v250, v165, v166
    v_max3_f32 v250, v250, v167, v168
    v_max3_f32 v250, v250, v169, v170
    s_waitcnt lgkmcnt(8)
    v_mfma_f32_32x32x16_bf16 v[32:47], v[212:215], v[144:147], 0
    s_and_b32 s48, s48, 0x3ffff
    s_add_u32 s62, s62, 1
    s_cmp_lt_u32 s62, 31
    s_cselect_b32 s14, 0x40000, 0
    s_cmp_lt_u32 s62, 32
    s_cselect_b32 s18, 0x40000, 0
    s_cselect_b32 s44, s44, 0x30000
    v_add_u32 v238, s45, v238
    v_add_u32 v239, s45, v239
    v_add_u32 v240, s45, v240
    v_add_u32 v241, s45, v241
    v_add_u32 v242, s45, v242
    v_add_u32 v243, s45, v243
    s_waitcnt vmcnt(8) lgkmcnt(0)
    s_barrier
    ds_read_b128 v[204:207], v238 offset:0
    s_add_u32 m0, s44, s59
    s_add_u32 s52, s48, 0x1000
    buffer_load_dwordx4 v248, s[12:15], s48 offen nt lds
    v_max3_f32 v250, v250, v171, v172
    v_max3_f32 v250, v250, v173, v174
    v_max_f32 v250, v250, v175
    v_cmp_lt_f32 vcc, s58, v250
    s_cbranch_vccnz RARE_AL_first1
    v_exp_f32 v160, v160
    v_mfma_f32_32x32x16_bf16 v[48:63], v[216:219], v[144:147], 0
    ds_read_b128 v[208:211], v239 offset:0
    s_add_u32 m0, m0, 0x1000
    s_add_u32 s53, s46, 0x1000
    buffer_load_dwordx4 v248, s[12:15], s52 offen nt lds
    v_exp_f32 v161, v161
    v_exp_f32 v162, v162
    v_add_f32 v236, v236, v160
    v_mfma_f32_32x32x16_bf16 v[0:15], v[220:223], v[152:155], v[0:15]
    ds_read_b128 v[212:215], v240 offset:0
    s_add_u32 m0, m0, 0x1000
    s_nop 0
    buffer_load_dwordx4 v249, s[16:19], s46 offen nt lds
    v_add_f32 v65, v65, v161
    v_cvt_pk_bf16_f32 v160, v160, v161
    v_exp_f32 v163, v163
    v_exp_f32 v164, v164
    v_mfma_f32_32x32x16_bf16 v[16:31], v[224:227], v[152:155], v[16:31]
    ds_read_b128 v[216:219], v241 offset:0
    s_add_u32 m0, m0, 0x1000
    s_nop 0
    buffer_load_dwordx4 v249, s[16:19], s53 offen nt lds
    v_add_f32 v236, v236, v162
    v_add_f32 v65, v65, v163
    v_cvt_pk_bf16_f32 v161, v162, v163
    v_exp_f32 v165, v165
    v_mfma_f32_32x32x16_bf16 v[32:47], v[228:231], v[152:155], v[32:47]
    ds_read_b128 v[220:223], v238 offset:512
    v_exp_f32 v166, v166
    v_add_f32 v236, v236, v164
    v_add_f32 v65, v65, v165
    v_mfma_f32_32x32x16_bf16 v[48:63], v[232:235], v[152:155], v[48:63]
REJ_AL_first1:
    ds_read_b128 v[224:227], v239 offset:512
    v_cvt_pk_bf16_f32 v162, v164, v165
    v_exp_f32 v167, v167
    v_exp_f32 v168, v168
    s_waitcnt lgkmcnt(4)
    v_mfma_f32_32x32x16_bf16 v[144:159], v[204:207], v[96:99], v[176:191]
    ds_read_b128 v[228:231], v240 offset:512
    v_add_f32 v236, v236, v166
    v_add_f32 v65, v65, v167
    v_cvt_pk_bf16_f32 v163, v166, v167
    v_exp_f32 v169, v169
    v_mfma_f32_32x32x16_bf16 v[144:159], v[208:211], v[100:103], v[144:159]
    ds_read_b128 v[232:235], v241 offset:512
    v_exp_f32 v170, v170
    v_add_f32 v236, v236, v168
    v_add_f32 v65, v65, v169
    s_waitcnt lgkmcnt(4)
    v_mfma_f32_32x32x16_bf16 v[144:159], v[212:215], v[104:107], v[144:159]
    ds_read_b64_tr_b16 v[204:205], v242 offset:0
    ds_read_b64_tr_b16 v[206:207], v242 offset:2048
    v_cvt_pk_bf16_f32 v168, v168, v169
    v_exp_f32 v171, v171
    v_exp_f32 v172, v172
    v_mfma_f32_32x32x16_bf16 v[144:159], v[216:219], v[108:111], v[144:159]
    ds_read_b64_tr_b16 v[208:209], v243 offset:0
    ds_read_b64_tr_b16 v[210:211], v243 offset:2048
    v_add_f32 v236, v236, v170
    v_add_f32 v65, v65, v171
    v_cvt_pk_bf16_f32 v169, v170, v171
    s_waitcnt lgkmcnt(6)
    v_mfma_f32_32x32x16_bf16 v[144:159], v[220:223], v[112:115], v[144:159]
    ds_read_b64_tr_b16 v[212:213], v242 offset:512
    ds_read_b64_tr_b16 v[214:215], v242 offset:2560
    v_exp_f32 v173, v173
    v_exp_f32 v174, v174
    v_mfma_f32_32x32x16_bf16 v[144:159], v[224:227], v[116:119], v[144:159]
    ds_read_b64_tr_b16 v[216:217], v243 offset:512
    ds_read_b64_tr_b16 v[218:219], v243 offset:2560
    v_add_f32 v236, v236, v172
    v_add_f32 v65, v65, v173
    v_cvt_pk_bf16_f32 v170, v172, v173
    s_waitcnt lgkmcnt(8)
    v_mfma_f32_32x32x16_bf16 v[144:159], v[228:231], v[120:123], v[144:159]
    ds_read_b64_tr_b16 v[220:221], v242 offset:4096
    ds_read_b64_tr_b16 v[222:223], v242 offset:6144
    v_exp_f32 v175, v175
    v_add_f32 v236, v236, v174
    v_mfma_f32_32x32x16_bf16 v[144:159], v[232:235], v[124:127], v[144:159]
    ds_read_b64_tr_b16 v[224:225], v243 offset:4096
    ds_read_b64_tr_b16 v[226:227], v243 offset:6144
    v_add_f32 v65, v65, v175
    v_cvt_pk_bf16_f32 v171, v174, v175
LOOP_AL:
    s_waitcnt lgkmcnt(8)
    v_mfma_f32_32x32x16_bf16 v[0:15], v[204:207], v[160:163], v[0:15]
    ds_read_b64_tr_b16 v[228:229], v242 offset:4608
    ds_read_b64_tr_b16 v[230:231], v242 offset:6656
    s_mov_b32 s44, s42
    s_add_u32 s42, s42, 0x4000
    s_cmp_ge_u32 s42, 0x28000
    s_cselect_b32 s51, 0x28000, 0
    s_sub_u32 s42, s42, s51
    s_sub_u32 s45, s42, s44
    v_mfma_f32_32x32x16_bf16 v[16:31], v[208:211], v[160:163], v[16:31]
    ds_read_b64_tr_b16 v[232:233], v243 offset:4608
    ds_read_b64_tr_b16 v[234:235], v243 offset:6656
    s_add_u32 s44, s42, 0xc000
    s_cmp_ge_u32 s44, 0x28000
    s_cselect_b32 s51, 0x28000, 0
    s_sub_u32 s44, s44, s51
    s_mov_b32 s46, s48
    s_add_u32 s48, s48, 0x2000
    v_max3_f32 v250, v144, v145, v146
    v_max3_f32 v250, v250, v147, v148
    v_max3_f32 v250, v250, v149, v150
    v_max3_f32 v250, v250, v151, v152
    v_max3_f32 v250, v250, v153, v154
    s_waitcnt lgkmcnt(8)
    v_mfma_f32_32x32x16_bf16 v[32:47], v[212:215], v[160:163], v[32:47]
    s_and_b32 s48, s48, 0x3ffff
    s_add_u32 s62, s62, 1
    s_cmp_lt_u32 s62, 31
    s_cselect_b32 s14, 0x40000, 0
    s_cmp_lt_u32 s62, 32
    s_cselect_b32 s18, 0x40000, 0
    s_cselect_b32 s44, s44, 0x30000
    v_add_u32 v238, s45, v238
    v_add_u32 v239, s45, v239
    v_add_u32 v240, s45, v240
    v_add_u32 v241, s45, v241
    v_add_u32 v242, s45, v242
    v_add_u32 v243, s45, v243
    s_waitcnt vmcnt(8) lgkmcnt(0)
    s_barrier
    ds_read_b128 v[204:207], v238 offset:0
    s_add_u32 m0, s44, s59
    s_add_u32 s52, s48, 0x1000
    buffer_load_dwordx4 v248, s[12:15], s48 offen nt lds
    v_max3_f32 v250, v250, v155, v156
    v_max3_f32 v250, v250, v157, v158
    v_max_f32 v250, v250, v159
    v_cmp_lt_f32 vcc, s58, v250
    s_cbranch_vccnz RARE_AL_loop0
    v_exp_f32 v144, v144
    v_mfma_f32_32x32x16_bf16 v[48:63], v[216:219], v[160:163], v[48:63]
    ds_read_b128 v[208:211], v239 offset:0
    s_add_u32 m0, m0, 0x1000
    s_add_u32 s53, s46, 0x1000
    buffer_load_dwordx4 v248, s[12:15], s52 offen nt lds
    v_exp_f32 v145, v145
    v_exp_f32 v146, v146
    v_add_f32 v236, v236, v144
    v_mfma_f32_32x32x16_bf16 v[0:15], v[220:223], v[168:171], v[0:15]
    ds_read_b128 v[212:215], v240 offset:0
    s_add_u32 m0, m0, 0x1000
    s_nop 0
    buffer_load_dwordx4 v249, s[16:19], s46 offen nt lds
    v_add_f32 v65, v65, v145
    v_cvt_pk_bf16_f32 v144, v144, v145
    v_exp_f32 v147, v147
    v_exp_f32 v148, v148
    v_mfma_f32_32x32x16_bf16 v[16:31], v[224:227], v[168:171], v[16:31]
    ds_read_b128 v[216:219], v241 offset:0
    s_add_u32 m0, m0, 0x1000
    s_nop 0
    buffer_load_dwordx4 v249, s[16:19], s53 offen nt lds
    v_add_f32 v236, v236, v146
    v_add_f32 v65, v65, v147
    v_cvt_pk_bf16_f32 v145, v146, v147
    v_exp_f32 v149, v149
    v_mfma_f32_32x32x16_bf16 v[32:47], v[228:231], v[168:171], v[32:47]
    ds_read_b128 v[220:223], v238 offset:512
    v_exp_f32 v150, v150
    v_add_f32 v236, v236, v148
    v_add_f32 v65, v65, v149
    v_mfma_f32_32x32x16_bf16 v[48:63], v[232:235], v[168:171], v[48:63]
REJ_AL_loop0:
    ds_read_b128 v[224:227], v239 offset:512
    v_cvt_pk_bf16_f32 v146, v148, v149
    v_exp_f32 v151, v151
    v_exp_f32 v152, v152
    s_waitcnt lgkmcnt(4)
    v_mfma_f32_32x32x16_bf16 v[160:175], v[204:207], v[96:99], v[176:191]
    ds_read_b128 v[228:231], v240 offset:512
    v_add_f32 v236, v236, v150
    v_add_f32 v65, v65, v151
    v_cvt_pk_bf16_f32 v147, v150, v151
    v_exp_f32 v153, v153
    v_mfma_f32_32x32x16_bf16 v[160:175], v[208:211], v[100:103], v[160:175]
    ds_read_b128 v[232:235], v241 offset:512
    v_exp_f32 v154, v154
    v_add_f32 v236, v236, v152
    v_add_f32 v65, v65, v153
    s_waitcnt lgkmcnt(4)
    v_mfma_f32_32x32x16_bf16 v[160:175], v[212:215], v[104:107], v[160:175]
    ds_read_b64_tr_b16 v[204:205], v242 offset:0
    ds_read_b64_tr_b16 v[206:207], v242 offset:2048
    v_cvt_pk_bf16_f32 v152, v152, v153
    v_exp_f32 v155, v155
    v_exp_f32 v156, v156
    v_mfma_f32_32x32x16_bf16 v[160:175], v[216:219], v[108:111], v[160:175]
    ds_read_b64_tr_b16 v[208:209], v243 offset:0
    ds_read_b64_tr_b16 v[210:211], v243 offset:2048
    v_add_f32 v236, v236, v154
    v_add_f32 v65, v65, v155
    v_cvt_pk_bf16_f32 v153, v154, v155
    s_waitcnt lgkmcnt(6)
    v_mfma_f32_32x32x16_bf16 v[160:175], v[220:223], v[112:115], v[160:175]
    ds_read_b64_tr_b16 v[212:213], v242 offset:512
    ds_read_b64_tr_b16 v[214:215], v242 offset:2560
    v_exp_f32 v157, v157
    v_exp_f32 v158, v158
    v_mfma_f32_32x32x16_bf16 v[160:175], v[224:227], v[116:119], v[160:175]
    ds_read_b64_tr_b16 v[216:217], v243 offset:512
    ds_read_b64_tr_b16 v[218:219], v243 offset:2560
    v_add_f32 v236, v236, v156
    v_add_f32 v65, v65, v157
    v_cvt_pk_bf16_f32 v154, v156, v157
    s_waitcnt lgkmcnt(8)
    v_mfma_f32_32x32x16_bf16 v[160:175], v[228:231], v[120:123], v[160:175]
    ds_read_b64_tr_b16 v[220:221], v242 offset:4096
    ds_read_b64_tr_b16 v[222:223], v242 offset:6144
    v_exp_f32 v159, v159
    v_add_f32 v236, v236, v158
    v_mfma_f32_32x32x16_bf16 v[160:175], v[232:235], v[124:127], v[160:175]
    ds_read_b64_tr_b16 v[224:225], v243 offset:4096
    ds_read_b64_tr_b16 v[226:227], v243 offset:6144
    v_add_f32 v65, v65, v159
    v_cvt_pk_bf16_f32 v155, v158, v159
    s_waitcnt lgkmcnt(8)
    v_mfma_f32_32x32x16_bf16 v[0:15], v[204:207], v[144:147], v[0:15]
    ds_read_b64_tr_b16 v[228:229], v242 offset:4608
    ds_read_b64_tr_b16 v[230:231], v242 offset:6656
    s_mov_b32 s44, s42
    s_add_u32 s42, s42, 0x4000
    s_cmp_ge_u32 s42, 0x28000
    s_cselect_b32 s51, 0x28000, 0
    s_sub_u32 s42, s42, s51
    s_sub_u32 s45, s42, s44
    v_mfma_f32_32x32x16_bf16 v[16:31], v[208:211], v[144:147], v[16:31]
    ds_read_b64_tr_b16 v[232:233], v243 offset:4608
    ds_read_b64_tr_b16 v[234:235], v243 offset:6656
    s_add_u32 s44, s42, 0xc000
    s_cmp_ge_u32 s44, 0x28000
    s_cselect_b32 s51, 0x28000, 0
    s_sub_u32 s44, s44, s51
    s_mov_b32 s46, s48
    s_add_u32 s48, s48, 0x2000
    v_max3_f32 v250, v160, v161, v162
    v_max3_f32 v250, v250, v163, v164
    v_max3_f32 v250, v250, v165, v166
    v_max3_f32 v250, v250, v167, v168
    v_max3_f32 v250, v250, v169, v170
    s_waitcnt lgkmcnt(8)
    v_mfma_f32_32x32x16_bf16 v[32:47], v[212:215], v[144:147], v[32:47]
    s_and_b32 s48, s48, 0x3ffff
    s_add_u32 s62, s62, 1
    s_cmp_lt_u32 s62, 31
    s_cselect_b32 s14, 0x40000, 0
    s_cmp_lt_u32 s62, 32
    s_cselect_b32 s18, 0x40000, 0
    s_cselect_b32 s44, s44, 0x30000
    v_add_u32 v238, s45, v238
    v_add_u32 v239, s45, v239
    v_add_u32 v240, s45, v240
    v_add_u32 v241, s45, v241
    v_add_u32 v242, s45, v242
    v_add_u32 v243, s45, v243
    s_waitcnt vmcnt(8) lgkmcnt(0)
    s_barrier
    ds_read_b128 v[204:207], v238 offset:0
    s_add_u32 m0, s44, s59
    s_add_u32 s52, s48, 0x1000
    buffer_load_dwordx4 v248, s[12:15], s48 offen nt lds
    v_max3_f32 v250, v250, v171, v172
    v_max3_f32 v250, v250, v173, v174
    v_max_f32 v250, v250, v175
    v_cmp_lt_f32 vcc, s58, v250
    s_cbranch_vccnz RARE_AL_loop1
    v_exp_f32 v160, v160
    v_mfma_f32_32x32x16_bf16 v[48:63], v[216:219], v[144:147], v[48:63]
    ds_read_b128 v[208:211], v239 offset:0
    s_add_u32 m0, m0, 0x1000
    s_add_u32 s53, s46, 0x1000
    buffer_load_dwordx4 v248, s[12:15], s52 offen nt lds
    v_exp_f32 v161, v161
    v_exp_f32 v162, v162
    v_add_f32 v236, v236, v160
    v_mfma_f32_32x32x16_bf16 v[0:15], v[220:223], v[152:155], v[0:15]
    ds_read_b128 v[212:215], v240 offset:0
    s_add_u32 m0, m0, 0x1000
    s_nop 0
    buffer_load_dwordx4 v249, s[16:19], s46 offen nt lds
    v_add_f32 v65, v65, v161
    v_cvt_pk_bf16_f32 v160, v160, v161
    v_exp_f32 v163, v163
    v_exp_f32 v164, v164
    v_mfma_f32_32x32x16_bf16 v[16:31], v[224:227], v[152:155], v[16:31]
    ds_read_b128 v[216:219], v241 offset:0
    s_add_u32 m0, m0, 0x1000
    s_nop 0
    buffer_load_dwordx4 v249, s[16:19], s53 offen nt lds
    v_add_f32 v236, v236, v162
    v_add_f32 v65, v65, v163
    v_cvt_pk_bf16_f32 v161, v162, v163
    v_exp_f32 v165, v165
    v_mfma_f32_32x32x16_bf16 v[32:47], v[228:231], v[152:155], v[32:47]
    ds_read_b128 v[220:223], v238 offset:512
    v_exp_f32 v166, v166
    v_add_f32 v236, v236, v164
    v_add_f32 v65, v65, v165
    v_mfma_f32_32x32x16_bf16 v[48:63], v[232:235], v[152:155], v[48:63]
REJ_AL_loop1:
    ds_read_b128 v[224:227], v239 offset:512
    v_cvt_pk_bf16_f32 v162, v164, v165
    v_exp_f32 v167, v167
    v_exp_f32 v168, v168
    s_waitcnt lgkmcnt(4)
    v_mfma_f32_32x32x16_bf16 v[144:159], v[204:207], v[96:99], v[176:191]
    ds_read_b128 v[228:231], v240 offset:512
    v_add_f32 v236, v236, v166
    v_add_f32 v65, v65, v167
    v_cvt_pk_bf16_f32 v163, v166, v167
    v_exp_f32 v169, v169
    v_mfma_f32_32x32x16_bf16 v[144:159], v[208:211], v[100:103], v[144:159]
    ds_read_b128 v[232:235], v241 offset:512
    v_exp_f32 v170, v170
    v_add_f32 v236, v236, v168
    v_add_f32 v65, v65, v169
    s_waitcnt lgkmcnt(4)
    v_mfma_f32_32x32x16_bf16 v[144:159], v[212:215], v[104:107], v[144:159]
    ds_read_b64_tr_b16 v[204:205], v242 offset:0
    ds_read_b64_tr_b16 v[206:207], v242 offset:2048
    v_cvt_pk_bf16_f32 v168, v168, v169
    v_exp_f32 v171, v171
    v_exp_f32 v172, v172
    v_mfma_f32_32x32x16_bf16 v[144:159], v[216:219], v[108:111], v[144:159]
    ds_read_b64_tr_b16 v[208:209], v243 offset:0
    ds_read_b64_tr_b16 v[210:211], v243 offset:2048
    v_add_f32 v236, v236, v170
    v_add_f32 v65, v65, v171
    v_cvt_pk_bf16_f32 v169, v170, v171
    s_waitcnt lgkmcnt(6)
    v_mfma_f32_32x32x16_bf16 v[144:159], v[220:223], v[112:115], v[144:159]
    ds_read_b64_tr_b16 v[212:213], v242 offset:512
    ds_read_b64_tr_b16 v[214:215], v242 offset:2560
    v_exp_f32 v173, v173
    v_exp_f32 v174, v174
    v_mfma_f32_32x32x16_bf16 v[144:159], v[224:227], v[116:119], v[144:159]
    ds_read_b64_tr_b16 v[216:217], v243 offset:512
    ds_read_b64_tr_b16 v[218:219], v243 offset:2560
    v_add_f32 v236, v236, v172
    v_add_f32 v65, v65, v173
    v_cvt_pk_bf16_f32 v170, v172, v173
    s_waitcnt lgkmcnt(8)
    v_mfma_f32_32x32x16_bf16 v[144:159], v[228:231], v[120:123], v[144:159]
    ds_read_b64_tr_b16 v[220:221], v242 offset:4096
    ds_read_b64_tr_b16 v[222:223], v242 offset:6144
    v_exp_f32 v175, v175
    v_add_f32 v236, v236, v174
    v_mfma_f32_32x32x16_bf16 v[144:159], v[232:235], v[124:127], v[144:159]
    ds_read_b64_tr_b16 v[224:225], v243 offset:4096
    ds_read_b64_tr_b16 v[226:227], v243 offset:6144
    v_add_f32 v65, v65, v175
    v_cvt_pk_bf16_f32 v171, v174, v175
    s_sub_u32 s50, s50, 1
    s_cmp_lg_u32 s50, 0
    s_cbranch_scc1 LOOP_AL
    s_sub_u32 s51, s36, 2
    s_mul_i32 s61, s51, 5120
    s_add_u32 s61, s61, 18432
    s_mul_i32 s51, s51, 18432
    v_add_u32 v251, 0, v254
    v_mul_u32_u24 v252, 0xccd, v251
    v_lshrrev_b32 v252, 16, v252
    v_mul_u32_u24 v73, 20, v252
    v_sub_u32 v251, v251, v73
    v_mul_u32_u24 v252, 0x480, v252
    v_lshl_add_u32 v251, v251, 4, v252
    v_add_u32 v73, s51, v251
    v_add_u32 v251, 64, v254
    v_mul_u32_u24 v252, 0xccd, v251
    v_lshrrev_b32 v252, 16, v252
    v_mul_u32_u24 v74, 20, v252
    v_sub_u32 v251, v251, v74
    v_mul_u32_u24 v252, 0x480, v252
    v_lshl_add_u32 v251, v251, 4, v252
    v_add_u32 v74, s51, v251
    v_add_u32 v251, 128, v254
    v_mul_u32_u24 v252, 0xccd, v251
    v_lshrrev_b32 v252, 16, v252
    v_mul_u32_u24 v75, 20, v252
    v_sub_u32 v251, v251, v75
    v_mul_u32_u24 v252, 0x480, v252
    v_lshl_add_u32 v251, v251, 4, v252
    v_add_u32 v75, s51, v251
    v_add_u32 v251, 192, v254
    v_mul_u32_u24 v252, 0xccd, v251
    v_lshrrev_b32 v252, 16, v252
    v_mul_u32_u24 v76, 20, v252
    v_sub_u32 v251, v251, v76
    v_mul_u32_u24 v252, 0x480, v252
    v_lshl_add_u32 v251, v251, 4, v252
    v_add_u32 v76, s51, v251
    v_add_u32 v251, 256, v254
    v_mul_u32_u24 v252, 0xccd, v251
    v_lshrrev_b32 v252, 16, v252
    v_mul_u32_u24 v77, 20, v252
    v_sub_u32 v251, v251, v77
    v_mul_u32_u24 v252, 0x480, v252
    v_lshl_add_u32 v251, v251, 4, v252
    v_add_u32 v77, s51, v251
    s_waitcnt lgkmcnt(8)
    v_mfma_f32_32x32x16_bf16 v[0:15], v[204:207], v[160:163], v[0:15]
    ds_read_b64_tr_b16 v[228:229], v242 offset:4608
    ds_read_b64_tr_b16 v[230:231], v242 offset:6656
    s_mov_b32 s44, s42
    s_add_u32 s42, s42, 0x4000
    s_cmp_ge_u32 s42, 0x28000
    s_cselect_b32 s51, 0x28000, 0
    s_sub_u32 s42, s42, s51
    s_sub_u32 s45, s42, s44
    v_mfma_f32_32x32x16_bf16 v[16:31], v[208:211], v[160:163], v[16:31]
    ds_read_b64_tr_b16 v[232:233], v243 offset:4608
    ds_read_b64_tr_b16 v[234:235], v243 offset:6656
    v_max3_f32 v250, v144, v145, v146
    v_max3_f32 v250, v250, v147, v148
    v_max3_f32 v250, v250, v149, v150
    v_max3_f32 v250, v250, v151, v152
    v_max3_f32 v250, v250, v153, v154
    s_waitcnt lgkmcnt(8)
    v_mfma_f32_32x32x16_bf16 v[32:47], v[212:215], v[160:163], v[32:47]
    v_add_u32 v238, s45, v238
    v_add_u32 v239, s45, v239
    v_add_u32 v240, s45, v240
    v_add_u32 v241, s45, v241
    v_add_u32 v242, s45, v242
    v_add_u32 v243, s45, v243
    s_waitcnt vmcnt(8) lgkmcnt(0)
    s_barrier
    ds_read_b128 v[204:207], v238 offset:0
    s_add_u32 s53, s40, 0
    s_and_b32 s53, s53, 3
    s_mul_i32 s53, s53, 294912
    s_add_u32 s53, s53, 0
    s_add_u32 m0, s64, s61
    s_nop 0
    buffer_load_dwordx4 v73, s[20:23], s53 offen lds
    v_max3_f32 v250, v250, v155, v156
    v_max3_f32 v250, v250, v157, v158
    v_max_f32 v250, v250, v159
    v_cmp_lt_f32 vcc, s58, v250
    s_cbranch_vccnz RARE_AL_last0
    v_exp_f32 v144, v144
    v_mfma_f32_32x32x16_bf16 v[48:63], v[216:219], v[160:163], v[48:63]
    ds_read_b128 v[208:211], v239 offset:0
    s_add_u32 m0, m0, 0x400
    s_nop 0
    buffer_load_dwordx4 v74, s[20:23], s53 offen lds
    v_exp_f32 v145, v145
    v_exp_f32 v146, v146
    v_add_f32 v236, v236, v144
    v_mfma_f32_32x32x16_bf16 v[0:15], v[220:223], v[168:171], v[0:15]
    ds_read_b128 v[212:215], v240 offset:0
    s_add_u32 m0, m0, 0x400
    s_nop 0
    buffer_load_dwordx4 v75, s[20:23], s53 offen lds
    v_add_f32 v65, v65, v145
    v_cvt_pk_bf16_f32 v144, v144, v145
    v_exp_f32 v147, v147
    v_exp_f32 v148, v148
    v_mfma_f32_32x32x16_bf16 v[16:31], v[224:227], v[168:171], v[16:31]
    ds_read_b128 v[216:219], v241 offset:0
    s_add_u32 m0, m0, 0x400
    s_nop 0
    buffer_load_dwordx4 v76, s[20:23], s53 offen lds
    v_add_f32 v236, v236, v146
    v_add_f32 v65, v65, v147
    v_cvt_pk_bf16_f32 v145, v146, v147
    v_exp_f32 v149, v149
    v_mfma_f32_32x32x16_bf16 v[32:47], v[228:231], v[168:171], v[32:47]
    ds_read_b128 v[220:223], v238 offset:512
    s_add_u32 m0, m0, 0x400
    s_nop 0
    buffer_load_dwordx4 v77, s[20:23], s53 offen lds
    v_exp_f32 v150, v150
    v_add_f32 v236, v236, v148
    v_add_f32 v65, v65, v149
    v_mfma_f32_32x32x16_bf16 v[48:63], v[232:235], v[168:171], v[48:63]
REJ_AL_last0:
    ds_read_b128 v[224:227], v239 offset:512
    v_cvt_pk_bf16_f32 v146, v148, v149
    v_exp_f32 v151, v151
    v_exp_f32 v152, v152
    s_waitcnt lgkmcnt(4)
    v_mfma_f32_32x32x16_bf16 v[160:175], v[204:207], v[96:99], v[176:191]
    ds_read_b128 v[228:231], v240 offset:512
    v_add_f32 v236, v236, v150
    v_add_f32 v65, v65, v151
    v_cvt_pk_bf16_f32 v147, v150, v151
    v_exp_f32 v153, v153
    v_mfma_f32_32x32x16_bf16 v[160:175], v[208:211], v[100:103], v[160:175]
    ds_read_b128 v[232:235], v241 offset:512
    v_exp_f32 v154, v154
    v_add_f32 v236, v236, v152
    v_add_f32 v65, v65, v153
    s_waitcnt lgkmcnt(4)
    v_mfma_f32_32x32x16_bf16 v[160:175], v[212:215], v[104:107], v[160:175]
    ds_read_b64_tr_b16 v[204:205], v242 offset:0
    ds_read_b64_tr_b16 v[206:207], v242 offset:2048
    v_cvt_pk_bf16_f32 v152, v152, v153
    v_exp_f32 v155, v155
    v_exp_f32 v156, v156
    v_mfma_f32_32x32x16_bf16 v[160:175], v[216:219], v[108:111], v[160:175]
    ds_read_b64_tr_b16 v[208:209], v243 offset:0
    ds_read_b64_tr_b16 v[210:211], v243 offset:2048
    v_add_f32 v236, v236, v154
    v_add_f32 v65, v65, v155
    v_cvt_pk_bf16_f32 v153, v154, v155
    s_waitcnt lgkmcnt(6)
    v_mfma_f32_32x32x16_bf16 v[160:175], v[220:223], v[112:115], v[160:175]
    ds_read_b64_tr_b16 v[212:213], v242 offset:512
    ds_read_b64_tr_b16 v[214:215], v242 offset:2560
    v_exp_f32 v157, v157
    v_exp_f32 v158, v158
    v_mfma_f32_32x32x16_bf16 v[160:175], v[224:227], v[116:119], v[160:175]
    ds_read_b64_tr_b16 v[216:217], v243 offset:512
    ds_read_b64_tr_b16 v[218:219], v243 offset:2560
    v_add_f32 v236, v236, v156
    v_add_f32 v65, v65, v157
    v_cvt_pk_bf16_f32 v154, v156, v157
    s_waitcnt lgkmcnt(8)
    v_mfma_f32_32x32x16_bf16 v[160:175], v[228:231], v[120:123], v[160:175]
    ds_read_b64_tr_b16 v[220:221], v242 offset:4096
    ds_read_b64_tr_b16 v[222:223], v242 offset:6144
    v_exp_f32 v159, v159
    v_add_f32 v236, v236, v158
    v_mfma_f32_32x32x16_bf16 v[160:175], v[232:235], v[124:127], v[160:175]
    ds_read_b64_tr_b16 v[224:225], v243 offset:4096
    ds_read_b64_tr_b16 v[226:227], v243 offset:6144
    v_add_f32 v65, v65, v159
    v_cvt_pk_bf16_f32 v155, v158, v159
    s_waitcnt lgkmcnt(8)
    v_mfma_f32_32x32x16_bf16 v[0:15], v[204:207], v[144:147], v[0:15]
    ds_read_b64_tr_b16 v[228:229], v242 offset:4608
    ds_read_b64_tr_b16 v[230:231], v242 offset:6656
    s_mov_b32 s44, s42
    s_add_u32 s42, s42, 0x4000
    s_cmp_ge_u32 s42, 0x28000
    s_cselect_b32 s51, 0x28000, 0
    s_sub_u32 s42, s42, s51
    s_sub_u32 s45, s42, s44
    v_mfma_f32_32x32x16_bf16 v[16:31], v[208:211], v[144:147], v[16:31]
    ds_read_b64_tr_b16 v[232:233], v243 offset:4608
    ds_read_b64_tr_b16 v[234:235], v243 offset:6656
    v_max3_f32 v250, v160, v161, v162
    v_max3_f32 v250, v250, v163, v164
    v_max3_f32 v250, v250, v165, v166
    v_max3_f32 v250, v250, v167, v168
    v_max3_f32 v250, v250, v169, v170
    v_max3_f32 v250, v250, v171, v172
    v_max3_f32 v250, v250, v173, v174
    v_max_f32 v250, v250, v175
    v_cmp_lt_f32 vcc, s58, v250
    s_cbranch_vccnz RARE_AL_last1
    v_exp_f32 v160, v160
    s_waitcnt lgkmcnt(8)
    v_mfma_f32_32x32x16_bf16 v[32:47], v[212:215], v[144:147], v[32:47]
    v_add_u32 v238, s45, v238
    v_add_u32 v239, s45, v239
    v_add_u32 v240, s45, v240
    v_add_u32 v241, s45, v241
    v_add_u32 v242, s45, v242
    v_add_u32 v243, s45, v243
    s_waitcnt vmcnt(9) lgkmcnt(0)
    s_barrier
    s_add_u32 s53, s40, 0
    s_and_b32 s53, s53, 3
    s_mul_i32 s53, s53, 294912
    s_add_u32 s53, s53, 73728
    s_add_u32 m0, s65, s61
    s_nop 0
    buffer_load_dwordx4 v73, s[20:23], s53 offen lds
    v_exp_f32 v161, v161
    v_exp_f32 v162, v162
    v_add_f32 v236, v236, v160
    v_add_f32 v65, v65, v161
    v_cvt_pk_bf16_f32 v160, v160, v161
    v_exp_f32 v163, v163
    v_mfma_f32_32x32x16_bf16 v[48:63], v[216:219], v[144:147], v[48:63]
    s_add_u32 m0, m0, 0x400
    s_nop 0
    buffer_load_dwordx4 v74, s[20:23], s53 offen lds
    v_exp_f32 v164, v164
    v_add_f32 v236, v236, v162
    v_add_f32 v65, v65, v163
    v_cvt_pk_bf16_f32 v161, v162, v163
    v_exp_f32 v165, v165
    v_exp_f32 v166, v166
    v_mfma_f32_32x32x16_bf16 v[0:15], v[220:223], v[152:155], v[0:15]
    s_add_u32 m0, m0, 0x400
    s_nop 0
    buffer_load_dwordx4 v75, s[20:23], s53 offen lds
    v_add_f32 v236, v236, v164
    v_add_f32 v65, v65, v165
    v_cvt_pk_bf16_f32 v162, v164, v165
    v_exp_f32 v167, v167
    v_exp_f32 v168, v168
    v_add_f32 v236, v236, v166
    v_add_f32 v65, v65, v167
    v_mfma_f32_32x32x16_bf16 v[16:31], v[224:227], v[152:155], v[16:31]
    s_add_u32 m0, m0, 0x400
    s_nop 0
    buffer_load_dwordx4 v76, s[20:23], s53 offen lds
    v_cvt_pk_bf16_f32 v163, v166, v167
    v_exp_f32 v169, v169
    v_exp_f32 v170, v170
    v_add_f32 v236, v236, v168
    v_add_f32 v65, v65, v169
    v_cvt_pk_bf16_f32 v168, v168, v169
    v_exp_f32 v171, v171
    v_mfma_f32_32x32x16_bf16 v[32:47], v[228:231], v[152:155], v[32:47]
    s_add_u32 m0, m0, 0x400
    s_nop 0
    buffer_load_dwordx4 v77, s[20:23], s53 offen lds
    v_exp_f32 v172, v172
    v_add_f32 v236, v236, v170
    v_add_f32 v65, v65, v171
    v_cvt_pk_bf16_f32 v169, v170, v171
    v_exp_f32 v173, v173
    v_exp_f32 v174, v174
    v_mfma_f32_32x32x16_bf16 v[48:63], v[232:235], v[152:155], v[48:63]
REJ_AL_last1:
    v_add_f32 v236, v236, v172
    v_add_f32 v65, v65, v173
    v_cvt_pk_bf16_f32 v170, v172, v173
    v_exp_f32 v175, v175
    v_add_f32 v236, v236, v174
    v_add_f32 v65, v65, v175
    v_cvt_pk_bf16_f32 v171, v174, v175
    ds_read_b64_tr_b16 v[204:205], v242 offset:0
    ds_read_b64_tr_b16 v[206:207], v242 offset:2048
    ds_read_b64_tr_b16 v[208:209], v243 offset:0
    ds_read_b64_tr_b16 v[210:211], v243 offset:2048
    ds_read_b64_tr_b16 v[212:213], v242 offset:512
    ds_read_b64_tr_b16 v[214:215], v242 offset:2560
    ds_read_b64_tr_b16 v[216:217], v243 offset:512
    ds_read_b64_tr_b16 v[218:219], v243 offset:2560
    ds_read_b64_tr_b16 v[220:221], v242 offset:4096
    ds_read_b64_tr_b16 v[222:223], v242 offset:6144
    ds_read_b64_tr_b16 v[224:225], v243 offset:4096
    ds_read_b64_tr_b16 v[226:227], v243 offset:6144
    s_waitcnt lgkmcnt(10)
    v_mfma_f32_32x32x16_bf16 v[0:15], v[204:207], v[160:163], v[0:15]
    ds_read_b64_tr_b16 v[228:229], v242 offset:4608
    ds_read_b64_tr_b16 v[230:231], v242 offset:6656
    s_waitcnt lgkmcnt(10)
    v_mfma_f32_32x32x16_bf16 v[16:31], v[208:211], v[160:163], v[16:31]
    ds_read_b64_tr_b16 v[232:233], v243 offset:4608
    ds_read_b64_tr_b16 v[234:235], v243 offset:6656
    s_waitcnt lgkmcnt(10)
    v_mfma_f32_32x32x16_bf16 v[32:47], v[212:215], v[160:163], v[32:47]
    s_waitcnt lgkmcnt(8)
    v_mfma_f32_32x32x16_bf16 v[48:63], v[216:219], v[160:163], v[48:63]
    s_waitcnt lgkmcnt(6)
    v_mfma_f32_32x32x16_bf16 v[0:15], v[220:223], v[168:171], v[0:15]
    s_waitcnt lgkmcnt(4)
    v_mfma_f32_32x32x16_bf16 v[16:31], v[224:227], v[168:171], v[16:31]
    s_waitcnt lgkmcnt(2)
    v_mfma_f32_32x32x16_bf16 v[32:47], v[228:231], v[168:171], v[32:47]
    s_waitcnt lgkmcnt(0)
    v_mfma_f32_32x32x16_bf16 v[48:63], v[232:235], v[168:171], v[48:63]
    v_add_f32 v236, v236, v65
    s_branch TAIL_L
RARE_AL_first1:
    v_mfma_f32_32x32x16_bf16 v[48:63], v[216:219], v[144:147], 0
    ds_read_b128 v[208:211], v239 offset:0
    s_add_u32 m0, m0, 0x1000
    s_add_u32 s53, s46, 0x1000
    buffer_load_dwordx4 v248, s[12:15], s52 offen nt lds
    v_mfma_f32_32x32x16_bf16 v[0:15], v[220:223], v[152:155], v[0:15]
    ds_read_b128 v[212:215], v240 offset:0
    s_add_u32 m0, m0, 0x1000
    s_nop 0
    buffer_load_dwordx4 v249, s[16:19], s46 offen nt lds
    v_mfma_f32_32x32x16_bf16 v[16:31], v[224:227], v[152:155], v[16:31]
    ds_read_b128 v[216:219], v241 offset:0
    s_add_u32 m0, m0, 0x1000
    s_nop 0
    buffer_load_dwordx4 v249, s[16:19], s53 offen nt lds
    v_mfma_f32_32x32x16_bf16 v[32:47], v[228:231], v[152:155], v[32:47]
    ds_read_b128 v[220:223], v238 offset:512
    v_mfma_f32_32x32x16_bf16 v[48:63], v[232:235], v[152:155], v[48:63]
    v_mov_b32 v251, v250
    v_mov_b32 v252, v250
    s_nop 1
    v_permlane32_swap_b32 v251, v252
    v_max_f32 v250, v251, v252
    v_max_f32 v250, 0, v250
    v_exp_f32 v251, -v250
    v_sub_f32 v160, v160, v250
    v_sub_f32 v161, v161, v250
    v_sub_f32 v162, v162, v250
    v_sub_f32 v163, v163, v250
    v_sub_f32 v164, v164, v250
    v_sub_f32 v165, v165, v250
    v_sub_f32 v166, v166, v250
    v_sub_f32 v167, v167, v250
    v_sub_f32 v168, v168, v250
    v_sub_f32 v169, v169, v250
    v_sub_f32 v170, v170, v250
    v_sub_f32 v171, v171, v250
    v_sub_f32 v172, v172, v250
    v_sub_f32 v173, v173, v250
    v_sub_f32 v174, v174, v250
    v_sub_f32 v175, v175, v250
    v_sub_f32 v176, v176, v250
    v_sub_f32 v177, v177, v250
    v_sub_f32 v178, v178, v250
    v_sub_f32 v179, v179, v250
    v_sub_f32 v180, v180, v250
    v_sub_f32 v181, v181, v250
    v_sub_f32 v182, v182, v250
    v_sub_f32 v183, v183, v250
    v_sub_f32 v184, v184, v250
    v_sub_f32 v185, v185, v250
    v_sub_f32 v186, v186, v250
    v_sub_f32 v187, v187, v250
    v_sub_f32 v188, v188, v250
    v_sub_f32 v189, v189, v250
    v_sub_f32 v190, v190, v250
    v_sub_f32 v191, v191, v250
    v_mul_f32 v236, v236, v251
    v_mul_f32 v65, v65, v251
    v_mul_f32 v0, v0, v251
    v_mul_f32 v1, v1, v251
    v_mul_f32 v2, v2, v251
    v_mul_f32 v3, v3, v251
    v_mul_f32 v4, v4, v251
    v_mul_f32 v5, v5, v251
    v_mul_f32 v6, v6, v251
    v_mul_f32 v7, v7, v251
    v_mul_f32 v8, v8, v251
    v_mul_f32 v9, v9, v251
    v_mul_f32 v10, v10, v251
    v_mul_f32 v11, v11, v251
    v_mul_f32 v12, v12, v251
    v_mul_f32 v13, v13, v251
    v_mul_f32 v14, v14, v251
    v_mul_f32 v15, v15, v251
    v_mul_f32 v16, v16, v251
    v_mul_f32 v17, v17, v251
    v_mul_f32 v18, v18, v251
    v_mul_f32 v19, v19, v251
    v_mul_f32 v20, v20, v251
    v_mul_f32 v21, v21, v251
    v_mul_f32 v22, v22, v251
    v_mul_f32 v23, v23, v251
    v_mul_f32 v24, v24, v251
    v_mul_f32 v25, v25, v251
    v_mul_f32 v26, v26, v251
    v_mul_f32 v27, v27, v251
    v_mul_f32 v28, v28, v251
    v_mul_f32 v29, v29, v251
    v_mul_f32 v30, v30, v251
    v_mul_f32 v31, v31, v251
    v_mul_f32 v32, v32, v251
    v_mul_f32 v33, v33, v251
    v_mul_f32 v34, v34, v251
    v_mul_f32 v35, v35, v251
    v_mul_f32 v36, v36, v251
    v_mul_f32 v37, v37, v251
    v_mul_f32 v38, v38, v251
    v_mul_f32 v39, v39, v251
    v_mul_f32 v40, v40, v251
    v_mul_f32 v41, v41, v251
    v_mul_f32 v42, v42, v251
    v_mul_f32 v43, v43, v251
    v_mul_f32 v44, v44, v251
    v_mul_f32 v45, v45, v251
    v_mul_f32 v46, v46, v251
    v_mul_f32 v47, v47, v251
    v_mul_f32 v48, v48, v251
    v_mul_f32 v49, v49, v251
    v_mul_f32 v50, v50, v251
    v_mul_f32 v51, v51, v251
    v_mul_f32 v52, v52, v251
    v_mul_f32 v53, v53, v251
    v_mul_f32 v54, v54, v251
    v_mul_f32 v55, v55, v251
    v_mul_f32 v56, v56, v251
    v_mul_f32 v57, v57, v251
    v_mul_f32 v58, v58, v251
    v_mul_f32 v59, v59, v251
    v_mul_f32 v60, v60, v251
    v_mul_f32 v61, v61, v251
    v_mul_f32 v62, v62, v251
    v_mul_f32 v63, v63, v251
    v_exp_f32 v160, v160
    v_exp_f32 v161, v161
    v_exp_f32 v162, v162
    v_add_f32 v236, v236, v160
    v_add_f32 v65, v65, v161
    v_cvt_pk_bf16_f32 v160, v160, v161
    v_exp_f32 v163, v163
    v_exp_f32 v164, v164
    v_add_f32 v236, v236, v162
    v_add_f32 v65, v65, v163
    v_cvt_pk_bf16_f32 v161, v162, v163
    v_exp_f32 v165, v165
    v_exp_f32 v166, v166
    v_add_f32 v236, v236, v164
    v_add_f32 v65, v65, v165
    s_branch REJ_AL_first1
RARE_AL_loop0:
    v_mfma_f32_32x32x16_bf16 v[48:63], v[216:219], v[160:163], v[48:63]
    ds_read_b128 v[208:211], v239 offset:0
    s_add_u32 m0, m0, 0x1000
    s_add_u32 s53, s46, 0x1000
    buffer_load_dwordx4 v248, s[12:15], s52 offen nt lds
    v_mfma_f32_32x32x16_bf16 v[0:15], v[220:223], v[168:171], v[0:15]
    ds_read_b128 v[212:215], v240 offset:0
    s_add_u32 m0, m0, 0x1000
    s_nop 0
    buffer_load_dwordx4 v249, s[16:19], s46 offen nt lds
    v_mfma_f32_32x32x16_bf16 v[16:31], v[224:227], v[168:171], v[16:31]
    ds_read_b128 v[216:219], v241 offset:0
    s_add_u32 m0, m0, 0x1000
    s_nop 0
    buffer_load_dwordx4 v249, s[16:19], s53 offen nt lds
    v_mfma_f32_32x32x16_bf16 v[32:47], v[228:231], v[168:171], v[32:47]
    ds_read_b128 v[220:223], v238 offset:512
    v_mfma_f32_32x32x16_bf16 v[48:63], v[232:235], v[168:171], v[48:63]
    v_mov_b32 v251, v250
    v_mov_b32 v252, v250
    s_nop 1
    v_permlane32_swap_b32 v251, v252
    v_max_f32 v250, v251, v252
    v_max_f32 v250, 0, v250
    v_exp_f32 v251, -v250
    v_sub_f32 v144, v144, v250
    v_sub_f32 v145, v145, v250
    v_sub_f32 v146, v146, v250
    v_sub_f32 v147, v147, v250
    v_sub_f32 v148, v148, v250
    v_sub_f32 v149, v149, v250
    v_sub_f32 v150, v150, v250
    v_sub_f32 v151, v151, v250
    v_sub_f32 v152, v152, v250
    v_sub_f32 v153, v153, v250
    v_sub_f32 v154, v154, v250
    v_sub_f32 v155, v155, v250
    v_sub_f32 v156, v156, v250
    v_sub_f32 v157, v157, v250
    v_sub_f32 v158, v158, v250
    v_sub_f32 v159, v159, v250
    v_sub_f32 v176, v176, v250
    v_sub_f32 v177, v177, v250
    v_sub_f32 v178, v178, v250
    v_sub_f32 v179, v179, v250
    v_sub_f32 v180, v180, v250
    v_sub_f32 v181, v181, v250
    v_sub_f32 v182, v182, v250
    v_sub_f32 v183, v183, v250
    v_sub_f32 v184, v184, v250
    v_sub_f32 v185, v185, v250
    v_sub_f32 v186, v186, v250
    v_sub_f32 v187, v187, v250
    v_sub_f32 v188, v188, v250
    v_sub_f32 v189, v189, v250
    v_sub_f32 v190, v190, v250
    v_sub_f32 v191, v191, v250
    v_mul_f32 v236, v236, v251
    v_mul_f32 v65, v65, v251
    v_mul_f32 v0, v0, v251
    v_mul_f32 v1, v1, v251
    v_mul_f32 v2, v2, v251
    v_mul_f32 v3, v3, v251
    v_mul_f32 v4, v4, v251
    v_mul_f32 v5, v5, v251
    v_mul_f32 v6, v6, v251
    v_mul_f32 v7, v7, v251
    v_mul_f32 v8, v8, v251
    v_mul_f32 v9, v9, v251
    v_mul_f32 v10, v10, v251
    v_mul_f32 v11, v11, v251
    v_mul_f32 v12, v12, v251
    v_mul_f32 v13, v13, v251
    v_mul_f32 v14, v14, v251
    v_mul_f32 v15, v15, v251
    v_mul_f32 v16, v16, v251
    v_mul_f32 v17, v17, v251
    v_mul_f32 v18, v18, v251
    v_mul_f32 v19, v19, v251
    v_mul_f32 v20, v20, v251
    v_mul_f32 v21, v21, v251
    v_mul_f32 v22, v22, v251
    v_mul_f32 v23, v23, v251
    v_mul_f32 v24, v24, v251
    v_mul_f32 v25, v25, v251
    v_mul_f32 v26, v26, v251
    v_mul_f32 v27, v27, v251
    v_mul_f32 v28, v28, v251
    v_mul_f32 v29, v29, v251
    v_mul_f32 v30, v30, v251
    v_mul_f32 v31, v31, v251
    v_mul_f32 v32, v32, v251
    v_mul_f32 v33, v33, v251
    v_mul_f32 v34, v34, v251
    v_mul_f32 v35, v35, v251
    v_mul_f32 v36, v36, v251
    v_mul_f32 v37, v37, v251
    v_mul_f32 v38, v38, v251
    v_mul_f32 v39, v39, v251
    v_mul_f32 v40, v40, v251
    v_mul_f32 v41, v41, v251
    v_mul_f32 v42, v42, v251
    v_mul_f32 v43, v43, v251
    v_mul_f32 v44, v44, v251
    v_mul_f32 v45, v45, v251
    v_mul_f32 v46, v46, v251
    v_mul_f32 v47, v47, v251
    v_mul_f32 v48, v48, v251
    v_mul_f32 v49, v49, v251
    v_mul_f32 v50, v50, v251
    v_mul_f32 v51, v51, v251
    v_mul_f32 v52, v52, v251
    v_mul_f32 v53, v53, v251
    v_mul_f32 v54, v54, v251
    v_mul_f32 v55, v55, v251
    v_mul_f32 v56, v56, v251
    v_mul_f32 v57, v57, v251
    v_mul_f32 v58, v58, v251
    v_mul_f32 v59, v59, v251
    v_mul_f32 v60, v60, v251
    v_mul_f32 v61, v61, v251
    v_mul_f32 v62, v62, v251
    v_mul_f32 v63, v63, v251
    v_exp_f32 v144, v144
    v_exp_f32 v145, v145
    v_exp_f32 v146, v146
    v_add_f32 v236, v236, v144
    v_add_f32 v65, v65, v145
    v_cvt_pk_bf16_f32 v144, v144, v145
    v_exp_f32 v147, v147
    v_exp_f32 v148, v148
    v_add_f32 v236, v236, v146
    v_add_f32 v65, v65, v147
    v_cvt_pk_bf16_f32 v145, v146, v147
    v_exp_f32 v149, v149
    v_exp_f32 v150, v150
    v_add_f32 v236, v236, v148
    v_add_f32 v65, v65, v149
    s_branch REJ_AL_loop0
RARE_AL_loop1:
    v_mfma_f32_32x32x16_bf16 v[48:63], v[216:219], v[144:147], v[48:63]
    ds_read_b128 v[208:211], v239 offset:0
    s_add_u32 m0, m0, 0x1000
    s_add_u32 s53, s46, 0x1000
    buffer_load_dwordx4 v248, s[12:15], s52 offen nt lds
    v_mfma_f32_32x32x16_bf16 v[0:15], v[220:223], v[152:155], v[0:15]
    ds_read_b128 v[212:215], v240 offset:0
    s_add_u32 m0, m0, 0x1000
    s_nop 0
    buffer_load_dwordx4 v249, s[16:19], s46 offen nt lds
    v_mfma_f32_32x32x16_bf16 v[16:31], v[224:227], v[152:155], v[16:31]
    ds_read_b128 v[216:219], v241 offset:0
    s_add_u32 m0, m0, 0x1000
    s_nop 0
    buffer_load_dwordx4 v249, s[16:19], s53 offen nt lds
    v_mfma_f32_32x32x16_bf16 v[32:47], v[228:231], v[152:155], v[32:47]
    ds_read_b128 v[220:223], v238 offset:512
    v_mfma_f32_32x32x16_bf16 v[48:63], v[232:235], v[152:155], v[48:63]
    v_mov_b32 v251, v250
    v_mov_b32 v252, v250
    s_nop 1
    v_permlane32_swap_b32 v251, v252
    v_max_f32 v250, v251, v252
    v_max_f32 v250, 0, v250
    v_exp_f32 v251, -v250
    v_sub_f32 v160, v160, v250
    v_sub_f32 v161, v161, v250
    v_sub_f32 v162, v162, v250
    v_sub_f32 v163, v163, v250
    v_sub_f32 v164, v164, v250
    v_sub_f32 v165, v165, v250
    v_sub_f32 v166, v166, v250
    v_sub_f32 v167, v167, v250
    v_sub_f32 v168, v168, v250
    v_sub_f32 v169, v169, v250
    v_sub_f32 v170, v170, v250
    v_sub_f32 v171, v171, v250
    v_sub_f32 v172, v172, v250
    v_sub_f32 v173, v173, v250
    v_sub_f32 v174, v174, v250
    v_sub_f32 v175, v175, v250
    v_sub_f32 v176, v176, v250
    v_sub_f32 v177, v177, v250
    v_sub_f32 v178, v178, v250
    v_sub_f32 v179, v179, v250
    v_sub_f32 v180, v180, v250
    v_sub_f32 v181, v181, v250
    v_sub_f32 v182, v182, v250
    v_sub_f32 v183, v183, v250
    v_sub_f32 v184, v184, v250
    v_sub_f32 v185, v185, v250
    v_sub_f32 v186, v186, v250
    v_sub_f32 v187, v187, v250
    v_sub_f32 v188, v188, v250
    v_sub_f32 v189, v189, v250
    v_sub_f32 v190, v190, v250
    v_sub_f32 v191, v191, v250
    v_mul_f32 v236, v236, v251
    v_mul_f32 v65, v65, v251
    v_mul_f32 v0, v0, v251
    v_mul_f32 v1, v1, v251
    v_mul_f32 v2, v2, v251
    v_mul_f32 v3, v3, v251
    v_mul_f32 v4, v4, v251
    v_mul_f32 v5, v5, v251
    v_mul_f32 v6, v6, v251
    v_mul_f32 v7, v7, v251
    v_mul_f32 v8, v8, v251
    v_mul_f32 v9, v9, v251
    v_mul_f32 v10, v10, v251
    v_mul_f32 v11, v11, v251
    v_mul_f32 v12, v12, v251
    v_mul_f32 v13, v13, v251
    v_mul_f32 v14, v14, v251
    v_mul_f32 v15, v15, v251
    v_mul_f32 v16, v16, v251
    v_mul_f32 v17, v17, v251
    v_mul_f32 v18, v18, v251
    v_mul_f32 v19, v19, v251
    v_mul_f32 v20, v20, v251
    v_mul_f32 v21, v21, v251
    v_mul_f32 v22, v22, v251
    v_mul_f32 v23, v23, v251
    v_mul_f32 v24, v24, v251
    v_mul_f32 v25, v25, v251
    v_mul_f32 v26, v26, v251
    v_mul_f32 v27, v27, v251
    v_mul_f32 v28, v28, v251
    v_mul_f32 v29, v29, v251
    v_mul_f32 v30, v30, v251
    v_mul_f32 v31, v31, v251
    v_mul_f32 v32, v32, v251
    v_mul_f32 v33, v33, v251
    v_mul_f32 v34, v34, v251
    v_mul_f32 v35, v35, v251
    v_mul_f32 v36, v36, v251
    v_mul_f32 v37, v37, v251
    v_mul_f32 v38, v38, v251
    v_mul_f32 v39, v39, v251
    v_mul_f32 v40, v40, v251
    v_mul_f32 v41, v41, v251
    v_mul_f32 v42, v42, v251
    v_mul_f32 v43, v43, v251
    v_mul_f32 v44, v44, v251
    v_mul_f32 v45, v45, v251
    v_mul_f32 v46, v46, v251
    v_mul_f32 v47, v47, v251
    v_mul_f32 v48, v48, v251
    v_mul_f32 v49, v49, v251
    v_mul_f32 v50, v50, v251
    v_mul_f32 v51, v51, v251
    v_mul_f32 v52, v52, v251
    v_mul_f32 v53, v53, v251
    v_mul_f32 v54, v54, v251
    v_mul_f32 v55, v55, v251
    v_mul_f32 v56, v56, v251
    v_mul_f32 v57, v57, v251
    v_mul_f32 v58, v58, v251
    v_mul_f32 v59, v59, v251
    v_mul_f32 v60, v60, v251
    v_mul_f32 v61, v61, v251
    v_mul_f32 v62, v62, v251
    v_mul_f32 v63, v63, v251
    v_exp_f32 v160, v160
    v_exp_f32 v161, v161
    v_exp_f32 v162, v162
    v_add_f32 v236, v236, v160
    v_add_f32 v65, v65, v161
    v_cvt_pk_bf16_f32 v160, v160, v161
    v_exp_f32 v163, v163
    v_exp_f32 v164, v164
    v_add_f32 v236, v236, v162
    v_add_f32 v65, v65, v163
    v_cvt_pk_bf16_f32 v161, v162, v163
    v_exp_f32 v165, v165
    v_exp_f32 v166, v166
    v_add_f32 v236, v236, v164
    v_add_f32 v65, v65, v165
    s_branch REJ_AL_loop1
RARE_AL_last0:
    v_mfma_f32_32x32x16_bf16 v[48:63], v[216:219], v[160:163], v[48:63]
    ds_read_b128 v[208:211], v239 offset:0
    s_add_u32 m0, m0, 0x400
    s_nop 0
    buffer_load_dwordx4 v74, s[20:23], s53 offen lds
    v_mfma_f32_32x32x16_bf16 v[0:15], v[220:223], v[168:171], v[0:15]
    ds_read_b128 v[212:215], v240 offset:0
    s_add_u32 m0, m0, 0x400
    s_nop 0
    buffer_load_dwordx4 v75, s[20:23], s53 offen lds
    v_mfma_f32_32x32x16_bf16 v[16:31], v[224:227], v[168:171], v[16:31]
    ds_read_b128 v[216:219], v241 offset:0
    s_add_u32 m0, m0, 0x400
    s_nop 0
    buffer_load_dwordx4 v76, s[20:23], s53 offen lds
    v_mfma_f32_32x32x16_bf16 v[32:47], v[228:231], v[168:171], v[32:47]
    ds_read_b128 v[220:223], v238 offset:512
    s_add_u32 m0, m0, 0x400
    s_nop 0
    buffer_load_dwordx4 v77, s[20:23], s53 offen lds
    v_mfma_f32_32x32x16_bf16 v[48:63], v[232:235], v[168:171], v[48:63]
    v_mov_b32 v251, v250
    v_mov_b32 v252, v250
    s_nop 1
    v_permlane32_swap_b32 v251, v252
    v_max_f32 v250, v251, v252
    v_max_f32 v250, 0, v250
    v_exp_f32 v251, -v250
    v_sub_f32 v144, v144, v250
    v_sub_f32 v145, v145, v250
    v_sub_f32 v146, v146, v250
    v_sub_f32 v147, v147, v250
    v_sub_f32 v148, v148, v250
    v_sub_f32 v149, v149, v250
    v_sub_f32 v150, v150, v250
    v_sub_f32 v151, v151, v250
    v_sub_f32 v152, v152, v250
    v_sub_f32 v153, v153, v250
    v_sub_f32 v154, v154, v250
    v_sub_f32 v155, v155, v250
    v_sub_f32 v156, v156, v250
    v_sub_f32 v157, v157, v250
    v_sub_f32 v158, v158, v250
    v_sub_f32 v159, v159, v250
    v_sub_f32 v176, v176, v250
    v_sub_f32 v177, v177, v250
    v_sub_f32 v178, v178, v250
    v_sub_f32 v179, v179, v250
    v_sub_f32 v180, v180, v250
    v_sub_f32 v181, v181, v250
    v_sub_f32 v182, v182, v250
    v_sub_f32 v183, v183, v250
    v_sub_f32 v184, v184, v250
    v_sub_f32 v185, v185, v250
    v_sub_f32 v186, v186, v250
    v_sub_f32 v187, v187, v250
    v_sub_f32 v188, v188, v250
    v_sub_f32 v189, v189, v250
    v_sub_f32 v190, v190, v250
    v_sub_f32 v191, v191, v250
    v_mul_f32 v236, v236, v251
    v_mul_f32 v65, v65, v251
    v_mul_f32 v0, v0, v251
    v_mul_f32 v1, v1, v251
    v_mul_f32 v2, v2, v251
    v_mul_f32 v3, v3, v251
    v_mul_f32 v4, v4, v251
    v_mul_f32 v5, v5, v251
    v_mul_f32 v6, v6, v251
    v_mul_f32 v7, v7, v251
    v_mul_f32 v8, v8, v251
    v_mul_f32 v9, v9, v251
    v_mul_f32 v10, v10, v251
    v_mul_f32 v11, v11, v251
    v_mul_f32 v12, v12, v251
    v_mul_f32 v13, v13, v251
    v_mul_f32 v14, v14, v251
    v_mul_f32 v15, v15, v251
    v_mul_f32 v16, v16, v251
    v_mul_f32 v17, v17, v251
    v_mul_f32 v18, v18, v251
    v_mul_f32 v19, v19, v251
    v_mul_f32 v20, v20, v251
    v_mul_f32 v21, v21, v251
    v_mul_f32 v22, v22, v251
    v_mul_f32 v23, v23, v251
    v_mul_f32 v24, v24, v251
    v_mul_f32 v25, v25, v251
    v_mul_f32 v26, v26, v251
    v_mul_f32 v27, v27, v251
    v_mul_f32 v28, v28, v251
    v_mul_f32 v29, v29, v251
    v_mul_f32 v30, v30, v251
    v_mul_f32 v31, v31, v251
    v_mul_f32 v32, v32, v251
    v_mul_f32 v33, v33, v251
    v_mul_f32 v34, v34, v251
    v_mul_f32 v35, v35, v251
    v_mul_f32 v36, v36, v251
    v_mul_f32 v37, v37, v251
    v_mul_f32 v38, v38, v251
    v_mul_f32 v39, v39, v251
    v_mul_f32 v40, v40, v251
    v_mul_f32 v41, v41, v251
    v_mul_f32 v42, v42, v251
    v_mul_f32 v43, v43, v251
    v_mul_f32 v44, v44, v251
    v_mul_f32 v45, v45, v251
    v_mul_f32 v46, v46, v251
    v_mul_f32 v47, v47, v251
    v_mul_f32 v48, v48, v251
    v_mul_f32 v49, v49, v251
    v_mul_f32 v50, v50, v251
    v_mul_f32 v51, v51, v251
    v_mul_f32 v52, v52, v251
    v_mul_f32 v53, v53, v251
    v_mul_f32 v54, v54, v251
    v_mul_f32 v55, v55, v251
    v_mul_f32 v56, v56, v251
    v_mul_f32 v57, v57, v251
    v_mul_f32 v58, v58, v251
    v_mul_f32 v59, v59, v251
    v_mul_f32 v60, v60, v251
    v_mul_f32 v61, v61, v251
    v_mul_f32 v62, v62, v251
    v_mul_f32 v63, v63, v251
    v_exp_f32 v144, v144
    v_exp_f32 v145, v145
    v_exp_f32 v146, v146
    v_add_f32 v236, v236, v144
    v_add_f32 v65, v65, v145
    v_cvt_pk_bf16_f32 v144, v144, v145
    v_exp_f32 v147, v147
    v_exp_f32 v148, v148
    v_add_f32 v236, v236, v146
    v_add_f32 v65, v65, v147
    v_cvt_pk_bf16_f32 v145, v146, v147
    v_exp_f32 v149, v149
    v_exp_f32 v150, v150
    v_add_f32 v236, v236, v148
    v_add_f32 v65, v65, v149
    s_branch REJ_AL_last0
RARE_AL_last1:
    s_waitcnt lgkmcnt(8)
    v_mfma_f32_32x32x16_bf16 v[32:47], v[212:215], v[144:147], v[32:47]
    v_add_u32 v238, s45, v238
    v_add_u32 v239, s45, v239
    v_add_u32 v240, s45, v240
    v_add_u32 v241, s45, v241
    v_add_u32 v242, s45, v242
    v_add_u32 v243, s45, v243
    s_waitcnt vmcnt(9) lgkmcnt(0)
    s_barrier
    s_add_u32 s53, s40, 0
    s_and_b32 s53, s53, 3
    s_mul_i32 s53, s53, 294912
    s_add_u32 s53, s53, 73728
    s_add_u32 m0, s65, s61
    s_nop 0
    buffer_load_dwordx4 v73, s[20:23], s53 offen lds
    v_mfma_f32_32x32x16_bf16 v[48:63], v[216:219], v[144:147], v[48:63]
    s_add_u32 m0, m0, 0x400
    s_nop 0
    buffer_load_dwordx4 v74, s[20:23], s53 offen lds
    v_mfma_f32_32x32x16_bf16 v[0:15], v[220:223], v[152:155], v[0:15]
    s_add_u32 m0, m0, 0x400
    s_nop 0
    buffer_load_dwordx4 v75, s[20:23], s53 offen lds
    v_mfma_f32_32x32x16_bf16 v[16:31], v[224:227], v[152:155], v[16:31]
    s_add_u32 m0, m0, 0x400
    s_nop 0
    buffer_load_dwordx4 v76, s[20:23], s53 offen lds
    v_mfma_f32_32x32x16_bf16 v[32:47], v[228:231], v[152:155], v[32:47]
    s_add_u32 m0, m0, 0x400
    s_nop 0
    buffer_load_dwordx4 v77, s[20:23], s53 offen lds
    v_mfma_f32_32x32x16_bf16 v[48:63], v[232:235], v[152:155], v[48:63]
    v_mov_b32 v251, v250
    v_mov_b32 v252, v250
    s_nop 1
    v_permlane32_swap_b32 v251, v252
    v_max_f32 v250, v251, v252
    v_max_f32 v250, 0, v250
    v_exp_f32 v251, -v250
    v_sub_f32 v160, v160, v250
    v_sub_f32 v161, v161, v250
    v_sub_f32 v162, v162, v250
    v_sub_f32 v163, v163, v250
    v_sub_f32 v164, v164, v250
    v_sub_f32 v165, v165, v250
    v_sub_f32 v166, v166, v250
    v_sub_f32 v167, v167, v250
    v_sub_f32 v168, v168, v250
    v_sub_f32 v169, v169, v250
    v_sub_f32 v170, v170, v250
    v_sub_f32 v171, v171, v250
    v_sub_f32 v172, v172, v250
    v_sub_f32 v173, v173, v250
    v_sub_f32 v174, v174, v250
    v_sub_f32 v175, v175, v250
    v_sub_f32 v176, v176, v250
    v_sub_f32 v177, v177, v250
    v_sub_f32 v178, v178, v250
    v_sub_f32 v179, v179, v250
    v_sub_f32 v180, v180, v250
    v_sub_f32 v181, v181, v250
    v_sub_f32 v182, v182, v250
    v_sub_f32 v183, v183, v250
    v_sub_f32 v184, v184, v250
    v_sub_f32 v185, v185, v250
    v_sub_f32 v186, v186, v250
    v_sub_f32 v187, v187, v250
    v_sub_f32 v188, v188, v250
    v_sub_f32 v189, v189, v250
    v_sub_f32 v190, v190, v250
    v_sub_f32 v191, v191, v250
    v_mul_f32 v236, v236, v251
    v_mul_f32 v65, v65, v251
    v_mul_f32 v0, v0, v251
    v_mul_f32 v1, v1, v251
    v_mul_f32 v2, v2, v251
    v_mul_f32 v3, v3, v251
    v_mul_f32 v4, v4, v251
    v_mul_f32 v5, v5, v251
    v_mul_f32 v6, v6, v251
    v_mul_f32 v7, v7, v251
    v_mul_f32 v8, v8, v251
    v_mul_f32 v9, v9, v251
    v_mul_f32 v10, v10, v251
    v_mul_f32 v11, v11, v251
    v_mul_f32 v12, v12, v251
    v_mul_f32 v13, v13, v251
    v_mul_f32 v14, v14, v251
    v_mul_f32 v15, v15, v251
    v_mul_f32 v16, v16, v251
    v_mul_f32 v17, v17, v251
    v_mul_f32 v18, v18, v251
    v_mul_f32 v19, v19, v251
    v_mul_f32 v20, v20, v251
    v_mul_f32 v21, v21, v251
    v_mul_f32 v22, v22, v251
    v_mul_f32 v23, v23, v251
    v_mul_f32 v24, v24, v251
    v_mul_f32 v25, v25, v251
    v_mul_f32 v26, v26, v251
    v_mul_f32 v27, v27, v251
    v_mul_f32 v28, v28, v251
    v_mul_f32 v29, v29, v251
    v_mul_f32 v30, v30, v251
    v_mul_f32 v31, v31, v251
    v_mul_f32 v32, v32, v251
    v_mul_f32 v33, v33, v251
    v_mul_f32 v34, v34, v251
    v_mul_f32 v35, v35, v251
    v_mul_f32 v36, v36, v251
    v_mul_f32 v37, v37, v251
    v_mul_f32 v38, v38, v251
    v_mul_f32 v39, v39, v251
    v_mul_f32 v40, v40, v251
    v_mul_f32 v41, v41, v251
    v_mul_f32 v42, v42, v251
    v_mul_f32 v43, v43, v251
    v_mul_f32 v44, v44, v251
    v_mul_f32 v45, v45, v251
    v_mul_f32 v46, v46, v251
    v_mul_f32 v47, v47, v251
    v_mul_f32 v48, v48, v251
    v_mul_f32 v49, v49, v251
    v_mul_f32 v50, v50, v251
    v_mul_f32 v51, v51, v251
    v_mul_f32 v52, v52, v251
    v_mul_f32 v53, v53, v251
    v_mul_f32 v54, v54, v251
    v_mul_f32 v55, v55, v251
    v_mul_f32 v56, v56, v251
    v_mul_f32 v57, v57, v251
    v_mul_f32 v58, v58, v251
    v_mul_f32 v59, v59, v251
    v_mul_f32 v60, v60, v251
    v_mul_f32 v61, v61, v251
    v_mul_f32 v62, v62, v251
    v_mul_f32 v63, v63, v251
    v_exp_f32 v160, v160
    v_exp_f32 v161, v161
    v_exp_f32 v162, v162
    v_add_f32 v236, v236, v160
    v_add_f32 v65, v65, v161
    v_cvt_pk_bf16_f32 v160, v160, v161
    v_exp_f32 v163, v163
    v_exp_f32 v164, v164
    v_add_f32 v236, v236, v162
    v_add_f32 v65, v65, v163
    v_cvt_pk_bf16_f32 v161, v162, v163
    v_exp_f32 v165, v165
    v_exp_f32 v166, v166
    v_add_f32 v236, v236, v164
    v_add_f32 v65, v65, v165
    v_cvt_pk_bf16_f32 v162, v164, v165
    v_exp_f32 v167, v167
    v_exp_f32 v168, v168
    v_add_f32 v236, v236, v166
    v_add_f32 v65, v65, v167
    v_cvt_pk_bf16_f32 v163, v166, v167
    v_exp_f32 v169, v169
    v_exp_f32 v170, v170
    v_add_f32 v236, v236, v168
    v_add_f32 v65, v65, v169
    v_cvt_pk_bf16_f32 v168, v168, v169
    v_exp_f32 v171, v171
    v_exp_f32 v172, v172
    v_add_f32 v236, v236, v170
    v_add_f32 v65, v65, v171
    v_cvt_pk_bf16_f32 v169, v170, v171
    v_exp_f32 v173, v173
    v_exp_f32 v174, v174
    s_branch REJ_AL_last1
ATT_AY:
    s_setprio 1
    v_lshlrev_b32 v251, 4, v254
    v_add_u32 v251, s43, v251
    ds_read_b128 v[128:131], v251 offset:0
    ds_read_b128 v[132:135], v251 offset:1024
    ds_read_b128 v[136:139], v251 offset:2048
    ds_read_b128 v[140:143], v251 offset:3072
    ds_read_b128 v[204:207], v238 offset:0
    ds_read_b128 v[208:211], v239 offset:0
    ds_read_b128 v[212:215], v240 offset:0
    ds_read_b128 v[216:219], v241 offset:0
    ds_read_b128 v[220:223], v238 offset:512
    ds_read_b128 v[224:227], v239 offset:512
    ds_read_b128 v[228:231], v240 offset:512
    ds_read_b128 v[232:235], v241 offset:512
    s_waitcnt lgkmcnt(7)
    v_mfma_f32_32x32x16_bf16 v[144:159], v[204:207], v[96:99], 0
    s_waitcnt lgkmcnt(6)
    v_mfma_f32_32x32x16_bf16 v[144:159], v[208:211], v[100:103], v[144:159]
    s_waitcnt lgkmcnt(5)
    v_mfma_f32_32x32x16_bf16 v[144:159], v[212:215], v[104:107], v[144:159]
    s_waitcnt lgkmcnt(4)
    v_mfma_f32_32x32x16_bf16 v[144:159], v[216:219], v[108:111], v[144:159]
    s_waitcnt lgkmcnt(3)
    v_mfma_f32_32x32x16_bf16 v[144:159], v[220:223], v[112:115], v[144:159]
    s_waitcnt lgkmcnt(2)
    v_mfma_f32_32x32x16_bf16 v[144:159], v[224:227], v[116:119], v[144:159]
    s_waitcnt lgkmcnt(1)
    v_mfma_f32_32x32x16_bf16 v[144:159], v[228:231], v[120:123], v[144:159]
    s_waitcnt lgkmcnt(0)
    v_mfma_f32_32x32x16_bf16 v[144:159], v[232:235], v[124:127], v[144:159]
    v_mov_b32 v236, 0
    v_mov_b32 v249, 0
    v_mov_b32 v237, 0
    v_mov_b32 v64, 0
    v_mov_b32 v65, 0
    v_mov_b32 v66, 0
    v_mov_b32 v67, 0
    v_mov_b32 v68, 0
    v_mov_b32 v69, 0
    v_mov_b32 v70, 0
    v_mov_b32 v71, 0
    v_mov_b32 v72, 0
    v_mov_b32 v73, 0
    v_mov_b32 v74, 0
    v_mov_b32 v75, 0
    v_mov_b32 v76, 0
    v_mov_b32 v77, 0
    v_mov_b32 v78, 0
    v_mov_b32 v79, 0
    v_mov_b32 v80, 0
    v_mov_b32 v81, 0
    v_mov_b32 v82, 0
    v_mov_b32 v83, 0
    v_mov_b32 v84, 0
    v_mov_b32 v85, 0
    v_mov_b32 v86, 0
    v_mov_b32 v87, 0
    v_mov_b32 v88, 0
    v_mov_b32 v89, 0
    v_mov_b32 v90, 0
    v_mov_b32 v91, 0
    v_mov_b32 v92, 0
    v_mov_b32 v93, 0
    v_mov_b32 v94, 0
    v_mov_b32 v95, 0
    v_max3_f32 v250, v144, v145, v146
    v_max3_f32 v250, v250, v147, v148
    v_max3_f32 v250, v250, v149, v150
    v_max3_f32 v250, v250, v151, v152
    v_max3_f32 v250, v250, v153, v154
    v_max3_f32 v250, v250, v155, v156
    v_max3_f32 v250, v250, v157, v158
    v_max_f32 v250, v250, v159
    v_mov_b32 v251, v250
    v_mov_b32 v252, v250
    s_nop 1
    v_permlane32_swap_b32 v251, v252
    v_max_f32 v250, v251, v252
    v_sub_f32 v176, 0, v250
    v_sub_f32 v177, 0, v250
    v_sub_f32 v178, 0, v250
    v_sub_f32 v179, 0, v250
    v_sub_f32 v180, 0, v250
    v_sub_f32 v181, 0, v250
    v_sub_f32 v182, 0, v250
    v_sub_f32 v183, 0, v250
    v_sub_f32 v184, 0, v250
    v_sub_f32 v185, 0, v250
    v_sub_f32 v186, 0, v250
    v_sub_f32 v187, 0, v250
    v_sub_f32 v188, 0, v250
    v_sub_f32 v189, 0, v250
    v_sub_f32 v190, 0, v250
    v_sub_f32 v191, 0, v250
    v_sub_f32 v144, v144, v250
    v_sub_f32 v145, v145, v250
    v_sub_f32 v146, v146, v250
    v_sub_f32 v147, v147, v250
    v_sub_f32 v148, v148, v250
    v_sub_f32 v149, v149, v250
    v_sub_f32 v150, v150, v250
    v_sub_f32 v151, v151, v250
    v_sub_f32 v152, v152, v250
    v_sub_f32 v153, v153, v250
    v_sub_f32 v154, v154, v250
    v_sub_f32 v155, v155, v250
    v_sub_f32 v156, v156, v250
    v_sub_f32 v157, v157, v250
    v_sub_f32 v158, v158, v250
    v_sub_f32 v159, v159, v250
    s_mov_b32 s50, 14
    s_mov_b32 s44, s42
    s_add_u32 s42, s42, 0x4000
    s_cmp_ge_u32 s42, 0x28000
    s_cselect_b32 s51, 0x28000, 0
    s_sub_u32 s42, s42, s51
    s_sub_u32 s45, s42, s44
    v_add_u32 v238, s45, v238
    v_add_u32 v239, s45, v239
    v_add_u32 v240, s45, v240
    v_add_u32 v241, s45, v241
    v_add_u32 v242, s45, v242
    v_add_u32 v243, s45, v243
    v_add_u32 v246, s42, v244
    v_xor_b32 v247, 64, v246
    s_waitcnt lgkmcnt(0)
    s_barrier
    ds_read_b128 v[204:207], v238 offset:0
    ds_read_b128 v[208:211], v239 offset:0
    ds_read_b128 v[212:215], v240 offset:0
    ds_read_b128 v[216:219], v241 offset:0
    ds_read_b128 v[220:223], v238 offset:512
    ds_read_b128 v[224:227], v239 offset:512
    s_waitcnt lgkmcnt(4)
    v_mfma_f32_32x32x16_bf16 v[160:175], v[204:207], v[96:99], v[176:191]
    ds_read_b128 v[228:231], v240 offset:512
    v_exp_f32 v144, v144
    v_exp_f32 v145, v145
    v_exp_f32 v146, v146
    v_add_f32 v236, v236, v144
    v_mfma_f32_32x32x16_bf16 v[160:175], v[208:211], v[100:103], v[160:175]
    ds_read_b128 v[232:235], v241 offset:512
    v_add_f32 v249, v249, v145
    v_cvt_pk_bf16_f32 v144, v144, v145
    v_exp_f32 v147, v147
    v_exp_f32 v148, v148
    v_add_f32 v236, v236, v146
    s_waitcnt lgkmcnt(4)
    v_mfma_f32_32x32x16_bf16 v[160:175], v[212:215], v[104:107], v[160:175]
    ds_read_b128 v[204:207], v246 offset:0
    v_add_f32 v249, v249, v147
    v_cvt_pk_bf16_f32 v145, v146, v147
    v_exp_f32 v149, v149
    v_exp_f32 v150, v150
    v_add_f32 v236, v236, v148
    v_mfma_f32_32x32x16_bf16 v[160:175], v[216:219], v[108:111], v[160:175]
    ds_read_b128 v[208:211], v246 offset:4096
    v_add_f32 v249, v249, v149
    v_cvt_pk_bf16_f32 v146, v148, v149
    v_exp_f32 v151, v151
    v_exp_f32 v152, v152
    v_add_f32 v236, v236, v150
    s_waitcnt lgkmcnt(4)
    v_mfma_f32_32x32x16_bf16 v[160:175], v[220:223], v[112:115], v[160:175]
    ds_read_b128 v[212:215], v247 offset:0
    v_add_f32 v249, v249, v151
    v_cvt_pk_bf16_f32 v147, v150, v151
    v_exp_f32 v153, v153
    v_exp_f32 v154, v154
    v_add_f32 v236, v236, v152
    v_mfma_f32_32x32x16_bf16 v[160:175], v[224:227], v[116:119], v[160:175]
    ds_read_b128 v[216:219], v247 offset:4096
    v_add_f32 v249, v249, v153
    v_cvt_pk_bf16_f32 v152, v152, v153
    v_exp_f32 v155, v155
    v_exp_f32 v156, v156
    v_add_f32 v236, v236, v154
    s_waitcnt lgkmcnt(4)
    v_mfma_f32_32x32x16_bf16 v[160:175], v[228:231], v[120:123], v[160:175]
    ds_read_b128 v[220:223], v246 offset:512
    v_add_f32 v249, v249, v155
    v_cvt_pk_bf16_f32 v153, v154, v155
    v_exp_f32 v157, v157
    v_exp_f32 v158, v158
    v_add_f32 v236, v236, v156
    v_mfma_f32_32x32x16_bf16 v[160:175], v[232:235], v[124:127], v[160:175]
    ds_read_b128 v[224:227], v246 offset:4608
    v_add_f32 v249, v249, v157
    v_cvt_pk_bf16_f32 v154, v156, v157
    v_exp_f32 v159, v159
    v_add_f32 v236, v236, v158
    v_add_f32 v249, v249, v159
    v_cvt_pk_bf16_f32 v155, v158, v159
    s_waitcnt lgkmcnt(4)
    v_mfma_f32_16x16x32_bf16 v[192:195], v[204:207], v[128:131], 0
    ds_read_b128 v[228:231], v247 offset:512
    s_mov_b32 s44, s42
    s_add_u32 s42, s42, 0x4000
    s_cmp_ge_u32 s42, 0x28000
    s_cselect_b32 s51, 0x28000, 0
    s_sub_u32 s42, s42, s51
    s_sub_u32 s45, s42, s44
    v_mfma_f32_16x16x32_bf16 v[196:199], v[208:211], v[128:131], 0
    ds_read_b128 v[232:235], v247 offset:4608
    v_max3_f32 v250, v160, v161, v162
    v_max3_f32 v250, v250, v163, v164
    v_max3_f32 v250, v250, v165, v166
    s_waitcnt lgkmcnt(4)
    v_mfma_f32_16x16x32_bf16 v[192:195], v[212:215], v[132:135], v[192:195]
    ds_read_b64_tr_b16 v[204:205], v242 offset:0
    ds_read_b64_tr_b16 v[206:207], v242 offset:2048
    v_max3_f32 v250, v250, v167, v168
    v_max3_f32 v250, v250, v169, v170
    v_max3_f32 v250, v250, v171, v172
    v_mfma_f32_16x16x32_bf16 v[196:199], v[216:219], v[132:135], v[196:199]
    ds_read_b64_tr_b16 v[208:209], v243 offset:0
    ds_read_b64_tr_b16 v[210:211], v243 offset:2048
    v_max3_f32 v250, v250, v173, v174
    v_max_f32 v250, v250, v175
    v_cmp_lt_f32 vcc, s58, v250
    s_cbranch_vccnz RARE_AY_first1
    s_waitcnt lgkmcnt(6)
    v_mfma_f32_16x16x32_bf16 v[192:195], v[220:223], v[136:139], v[192:195]
    ds_read_b64_tr_b16 v[212:213], v242 offset:512
    ds_read_b64_tr_b16 v[214:215], v242 offset:2560
    v_exp_f32 v160, v160
    v_exp_f32 v161, v161
    v_mfma_f32_16x16x32_bf16 v[196:199], v[224:227], v[136:139], v[196:199]
    ds_read_b64_tr_b16 v[216:217], v243 offset:512
    ds_read_b64_tr_b16 v[218:219], v243 offset:2560
    v_exp_f32 v162, v162
    v_add_f32 v236, v236, v160
    s_waitcnt lgkmcnt(8)
    v_mfma_f32_16x16x32_bf16 v[192:195], v[228:231], v[140:143], v[192:195]
    ds_read_b64_tr_b16 v[220:221], v242 offset:4096
    ds_read_b64_tr_b16 v[222:223], v242 offset:6144
    v_add_f32 v249, v249, v161
    v_cvt_pk_bf16_f32 v160, v160, v161
    v_mfma_f32_16x16x32_bf16 v[196:199], v[232:235], v[140:143], v[196:199]
    ds_read_b64_tr_b16 v[224:225], v243 offset:4096
    ds_read_b64_tr_b16 v[226:227], v243 offset:6144
    v_exp_f32 v163, v163
    s_waitcnt lgkmcnt(8)
    v_mfma_f32_32x32x16_bf16 v[0:15], v[204:207], v[144:147], 0
    ds_read_b64_tr_b16 v[228:229], v242 offset:4608
    ds_read_b64_tr_b16 v[230:231], v242 offset:6656
    v_exp_f32 v164, v164
    v_add_f32 v236, v236, v162
    v_add_f32 v249, v249, v163
    v_cvt_pk_bf16_f32 v161, v162, v163
    v_exp_f32 v165, v165
    v_mfma_f32_32x32x16_bf16 v[16:31], v[208:211], v[144:147], 0
    ds_read_b64_tr_b16 v[232:233], v243 offset:4608
    ds_read_b64_tr_b16 v[234:235], v243 offset:6656
    v_exp_f32 v166, v166
    v_add_f32 v236, v236, v164
    v_add_f32 v249, v249, v165
    v_cvt_pk_bf16_f32 v162, v164, v165
    v_exp_f32 v167, v167
    s_waitcnt lgkmcnt(8)
    v_mfma_f32_32x32x16_bf16 v[32:47], v[212:215], v[144:147], 0
    v_add_u32 v238, s45, v238
    v_add_u32 v239, s45, v239
    v_add_u32 v240, s45, v240
    v_add_u32 v241, s45, v241
    v_add_u32 v242, s45, v242
    v_add_u32 v243, s45, v243
    v_add_u32 v246, s42, v245
    v_xor_b32 v247, 64, v246
    s_waitcnt lgkmcnt(0)
    s_barrier
    ds_read_b128 v[204:207], v238 offset:0
    v_exp_f32 v168, v168
    v_add_f32 v236, v236, v166
    v_add_f32 v249, v249, v167
    v_cvt_pk_bf16_f32 v163, v166, v167
    v_exp_f32 v169, v169
    v_mfma_f32_32x32x16_bf16 v[48:63], v[216:219], v[144:147], 0
    ds_read_b128 v[208:211], v239 offset:0
    v_exp_f32 v170, v170
    v_add_f32 v236, v236, v168
    v_add_f32 v249, v249, v169
    v_cvt_pk_bf16_f32 v168, v168, v169
    v_exp_f32 v171, v171
    v_mfma_f32_32x32x16_bf16 v[0:15], v[220:223], v[152:155], v[0:15]
    ds_read_b128 v[212:215], v240 offset:0
    v_exp_f32 v172, v172
    v_add_f32 v236, v236, v170
    v_add_f32 v249, v249, v171
    v_cvt_pk_bf16_f32 v169, v170, v171
    v_exp_f32 v173, v173
    v_mfma_f32_32x32x16_bf16 v[16:31], v[224:227], v[152:155], v[16:31]
    ds_read_b128 v[216:219], v241 offset:0
    v_exp_f32 v174, v174
    v_add_f32 v236, v236, v172
    v_add_f32 v249, v249, v173
    v_cvt_pk_bf16_f32 v170, v172, v173
    v_exp_f32 v175, v175
    v_mfma_f32_32x32x16_bf16 v[32:47], v[228:231], v[152:155], v[32:47]
    ds_read_b128 v[220:223], v238 offset:512
    v_add_f32 v236, v236, v174
    v_add_f32 v249, v249, v175
    v_cvt_pk_bf16_f32 v171, v174, v175
    v_mfma_f32_32x32x16_bf16 v[48:63], v[232:235], v[152:155], v[48:63]
REJ_AY_first1:
    ds_read_b128 v[224:227], v239 offset:512
    v_max3_f32 v253, v192, v193, v194
    v_max3_f32 v253, v253, v195, v196
    v_max3_f32 v253, v253, v197, v198
    v_max_f32 v253, v253, v199
    ds_swizzle_b32 v251, v253 offset:0x401F
    s_waitcnt lgkmcnt(0)
    v_mfma_f32_32x32x16_bf16 v[144:159], v[204:207], v[96:99], v[176:191]
    ds_read_b128 v[228:231], v240 offset:512
    v_max_f32 v253, v253, v251
    v_mov_b32 v251, v253
    v_mov_b32 v252, v253
    s_nop 1
    v_permlane32_swap_b32 v251, v252
    v_max_f32 v253, v251, v252
    v_sub_f32 v200, 0, v253
    v_mfma_f32_32x32x16_bf16 v[144:159], v[208:211], v[100:103], v[144:159]
    ds_read_b128 v[232:235], v241 offset:512
    v_sub_f32 v201, 0, v253
    v_sub_f32 v202, 0, v253
    v_sub_f32 v203, 0, v253
    v_sub_f32 v192, v192, v253
    v_sub_f32 v193, v193, v253
    v_sub_f32 v194, v194, v253
    v_mfma_f32_32x32x16_bf16 v[144:159], v[212:215], v[104:107], v[144:159]
    ds_read_b64_tr_b16 v[204:205], v246 offset:0
    ds_read_b64_tr_b16 v[206:207], v246 offset:4096
    v_sub_f32 v195, v195, v253
    v_sub_f32 v196, v196, v253
    v_sub_f32 v197, v197, v253
    v_sub_f32 v198, v198, v253
    v_sub_f32 v199, v199, v253
    v_exp_f32 v192, v192
    v_mfma_f32_32x32x16_bf16 v[144:159], v[216:219], v[108:111], v[144:159]
    ds_read_b64_tr_b16 v[208:209], v246 offset:32
    ds_read_b64_tr_b16 v[210:211], v246 offset:4128
    v_exp_f32 v193, v193
    v_exp_f32 v194, v194
    v_add_f32 v237, v237, v192
    v_add_f32 v237, v237, v193
    v_mfma_f32_32x32x16_bf16 v[144:159], v[220:223], v[112:115], v[144:159]
    ds_read_b64_tr_b16 v[212:213], v247 offset:0
    ds_read_b64_tr_b16 v[214:215], v247 offset:4096
    v_cvt_pk_bf16_f32 v192, v192, v193
    v_exp_f32 v195, v195
    v_exp_f32 v196, v196
    v_mfma_f32_32x32x16_bf16 v[144:159], v[224:227], v[116:119], v[144:159]
    ds_read_b64_tr_b16 v[216:217], v247 offset:32
    ds_read_b64_tr_b16 v[218:219], v247 offset:4128
    v_add_f32 v237, v237, v194
    v_add_f32 v237, v237, v195
    v_cvt_pk_bf16_f32 v193, v194, v195
    v_exp_f32 v197, v197
    s_waitcnt lgkmcnt(8)
    v_mfma_f32_32x32x16_bf16 v[144:159], v[228:231], v[120:123], v[144:159]
    ds_read_b64_tr_b16 v[220:221], v246 offset:512
    ds_read_b64_tr_b16 v[222:223], v246 offset:4608
    v_exp_f32 v198, v198
    v_add_f32 v237, v237, v196
    v_add_f32 v237, v237, v197
    v_cvt_pk_bf16_f32 v194, v196, v197
    v_mfma_f32_32x32x16_bf16 v[144:159], v[232:235], v[124:127], v[144:159]
    ds_read_b64_tr_b16 v[224:225], v246 offset:544
    ds_read_b64_tr_b16 v[226:227], v246 offset:4640
    v_exp_f32 v199, v199
    v_add_f32 v237, v237, v198
    v_add_f32 v237, v237, v199
    v_cvt_pk_bf16_f32 v195, v198, v199
LOOP_AY:
    s_waitcnt lgkmcnt(8)
    s_nop 0
    v_mfma_f32_16x16x32_bf16 v[64:67], v[204:207], v[192:195], v[64:67]
    ds_read_b64_tr_b16 v[228:229], v247 offset:512
    ds_read_b64_tr_b16 v[230:231], v247 offset:4608
    s_mov_b32 s44, s42
    s_add_u32 s42, s42, 0x4000
    s_cmp_ge_u32 s42, 0x28000
    s_cselect_b32 s51, 0x28000, 0
    s_sub_u32 s42, s42, s51
    s_sub_u32 s45, s42, s44
    v_mfma_f32_16x16x32_bf16 v[68:71], v[208:211], v[192:195], v[68:71]
    ds_read_b64_tr_b16 v[232:233], v247 offset:544
    ds_read_b64_tr_b16 v[234:235], v247 offset:4640
    v_max3_f32 v250, v144, v145, v146
    v_max3_f32 v250, v250, v147, v148
    s_waitcnt lgkmcnt(8)
    v_mfma_f32_16x16x32_bf16 v[72:75], v[212:215], v[192:195], v[72:75]
    ds_read_b64_tr_b16 v[204:205], v242 offset:0
    ds_read_b64_tr_b16 v[206:207], v242 offset:2048
    v_max3_f32 v250, v250, v149, v150
    v_max3_f32 v250, v250, v151, v152
    v_mfma_f32_16x16x32_bf16 v[76:79], v[216:219], v[192:195], v[76:79]
    ds_read_b64_tr_b16 v[208:209], v243 offset:0
    ds_read_b64_tr_b16 v[210:211], v243 offset:2048
    v_max3_f32 v250, v250, v153, v154
    v_max3_f32 v250, v250, v155, v156
    s_waitcnt lgkmcnt(8)
    v_mfma_f32_16x16x32_bf16 v[80:83], v[220:223], v[192:195], v[80:83]
    ds_read_b64_tr_b16 v[212:213], v242 offset:512
    ds_read_b64_tr_b16 v[214:215], v242 offset:2560
    v_max3_f32 v250, v250, v157, v158
    v_max_f32 v250, v250, v159
    v_mfma_f32_16x16x32_bf16 v[84:87], v[224:227], v[192:195], v[84:87]
    ds_read_b64_tr_b16 v[216:217], v243 offset:512
    ds_read_b64_tr_b16 v[218:219], v243 offset:2560
    v_cmp_lt_f32 vcc, s58, v250
    s_cbranch_vccnz RARE_AY_loop0
    v_exp_f32 v144, v144
    s_waitcnt lgkmcnt(8)
    v_mfma_f32_16x16x32_bf16 v[88:91], v[228:231], v[192:195], v[88:91]
    ds_read_b64_tr_b16 v[220:221], v242 offset:4096
    ds_read_b64_tr_b16 v[222:223], v242 offset:6144
    v_exp_f32 v145, v145
    v_mfma_f32_16x16x32_bf16 v[92:95], v[232:235], v[192:195], v[92:95]
    ds_read_b64_tr_b16 v[224:225], v243 offset:4096
    ds_read_b64_tr_b16 v[226:227], v243 offset:6144
    v_exp_f32 v146, v146
    s_waitcnt lgkmcnt(8)
    v_mfma_f32_32x32x16_bf16 v[0:15], v[204:207], v[160:163], v[0:15]
    ds_read_b64_tr_b16 v[228:229], v242 offset:4608
    ds_read_b64_tr_b16 v[230:231], v242 offset:6656
    v_add_f32 v236, v236, v144
    v_add_f32 v249, v249, v145
    v_cvt_pk_bf16_f32 v144, v144, v145
    v_exp_f32 v147, v147
    v_mfma_f32_32x32x16_bf16 v[16:31], v[208:211], v[160:163], v[16:31]
    ds_read_b64_tr_b16 v[232:233], v243 offset:4608
    ds_read_b64_tr_b16 v[234:235], v243 offset:6656
    v_exp_f32 v148, v148
    v_add_f32 v236, v236, v146
    s_waitcnt lgkmcnt(8)
    v_mfma_f32_32x32x16_bf16 v[32:47], v[212:215], v[160:163], v[32:47]
    v_add_u32 v238, s45, v238
    v_add_u32 v239, s45, v239
    v_add_u32 v240, s45, v240
    v_add_u32 v241, s45, v241
    v_add_u32 v242, s45, v242
    v_add_u32 v243, s45, v243
    v_add_u32 v246, s42, v244
    v_xor_b32 v247, 64, v246
    s_waitcnt lgkmcnt(0)
    s_barrier
    ds_read_b128 v[204:207], v238 offset:0
    v_add_f32 v249, v249, v147
    v_cvt_pk_bf16_f32 v145, v146, v147
    v_exp_f32 v149, v149
    v_mfma_f32_32x32x16_bf16 v[48:63], v[216:219], v[160:163], v[48:63]
    ds_read_b128 v[208:211], v239 offset:0
    v_exp_f32 v150, v150
    v_add_f32 v236, v236, v148
    v_mfma_f32_32x32x16_bf16 v[0:15], v[220:223], v[168:171], v[0:15]
    ds_read_b128 v[212:215], v240 offset:0
    v_add_f32 v249, v249, v149
    v_cvt_pk_bf16_f32 v146, v148, v149
    v_exp_f32 v151, v151
    v_mfma_f32_32x32x16_bf16 v[16:31], v[224:227], v[168:171], v[16:31]
    ds_read_b128 v[216:219], v241 offset:0
    v_exp_f32 v152, v152
    v_add_f32 v236, v236, v150
    v_mfma_f32_32x32x16_bf16 v[32:47], v[228:231], v[168:171], v[32:47]
    ds_read_b128 v[220:223], v238 offset:512
    v_add_f32 v249, v249, v151
    v_cvt_pk_bf16_f32 v147, v150, v151
    v_exp_f32 v153, v153
    v_mfma_f32_32x32x16_bf16 v[48:63], v[232:235], v[168:171], v[48:63]
REJ_AY_loop0:
    ds_read_b128 v[224:227], v239 offset:512
    v_exp_f32 v154, v154
    v_add_f32 v236, v236, v152
    s_waitcnt lgkmcnt(4)
    v_mfma_f32_32x32x16_bf16 v[160:175], v[204:207], v[96:99], v[176:191]
    ds_read_b128 v[228:231], v240 offset:512
    v_add_f32 v249, v249, v153
    v_cvt_pk_bf16_f32 v152, v152, v153
    v_exp_f32 v155, v155
    v_mfma_f32_32x32x16_bf16 v[160:175], v[208:211], v[100:103], v[160:175]
    ds_read_b128 v[232:235], v241 offset:512
    v_exp_f32 v156, v156
    v_add_f32 v236, v236, v154
    s_waitcnt lgkmcnt(4)
    v_mfma_f32_32x32x16_bf16 v[160:175], v[212:215], v[104:107], v[160:175]
    ds_read_b128 v[204:207], v246 offset:0
    v_add_f32 v249, v249, v155
    v_cvt_pk_bf16_f32 v153, v154, v155
    v_exp_f32 v157, v157
    v_mfma_f32_32x32x16_bf16 v[160:175], v[216:219], v[108:111], v[160:175]
    ds_read_b128 v[208:211], v246 offset:4096
    v_exp_f32 v158, v158
    s_waitcnt lgkmcnt(4)
    v_mfma_f32_32x32x16_bf16 v[160:175], v[220:223], v[112:115], v[160:175]
    ds_read_b128 v[212:215], v247 offset:0
    v_add_f32 v236, v236, v156
    v_add_f32 v249, v249, v157
    v_mfma_f32_32x32x16_bf16 v[160:175], v[224:227], v[116:119], v[160:175]
    ds_read_b128 v[216:219], v247 offset:4096
    v_cvt_pk_bf16_f32 v154, v156, v157
    v_exp_f32 v159, v159
    s_waitcnt lgkmcnt(4)
    v_mfma_f32_32x32x16_bf16 v[160:175], v[228:231], v[120:123], v[160:175]
    ds_read_b128 v[220:223], v246 offset:512
    v_add_f32 v236, v236, v158
    v_add_f32 v249, v249, v159
    v_mfma_f32_32x32x16_bf16 v[160:175], v[232:235], v[124:127], v[160:175]
    ds_read_b128 v[224:227], v246 offset:4608
    v_cvt_pk_bf16_f32 v155, v158, v159
    s_waitcnt lgkmcnt(4)
    v_mfma_f32_16x16x32_bf16 v[192:195], v[204:207], v[128:131], v[200:203]
    ds_read_b128 v[228:231], v247 offset:512
    s_mov_b32 s44, s42
    s_add_u32 s42, s42, 0x4000
    s_cmp_ge_u32 s42, 0x28000
    s_cselect_b32 s51, 0x28000, 0
    s_sub_u32 s42, s42, s51
    s_sub_u32 s45, s42, s44
    v_mfma_f32_16x16x32_bf16 v[196:199], v[208:211], v[128:131], v[200:203]
    ds_read_b128 v[232:235], v247 offset:4608
    v_max3_f32 v250, v160, v161, v162
    v_max3_f32 v250, v250, v163, v164
    s_waitcnt lgkmcnt(4)
    v_mfma_f32_16x16x32_bf16 v[192:195], v[212:215], v[132:135], v[192:195]
    ds_read_b64_tr_b16 v[204:205], v242 offset:0
    ds_read_b64_tr_b16 v[206:207], v242 offset:2048
    v_max3_f32 v250, v250, v165, v166
    v_max3_f32 v250, v250, v167, v168
    v_mfma_f32_16x16x32_bf16 v[196:199], v[216:219], v[132:135], v[196:199]
    ds_read_b64_tr_b16 v[208:209], v243 offset:0
    ds_read_b64_tr_b16 v[210:211], v243 offset:2048
    v_max3_f32 v250, v250, v169, v170
    v_max3_f32 v250, v250, v171, v172
    s_waitcnt lgkmcnt(6)
    v_mfma_f32_16x16x32_bf16 v[192:195], v[220:223], v[136:139], v[192:195]
    ds_read_b64_tr_b16 v[212:213], v242 offset:512
    ds_read_b64_tr_b16 v[214:215], v242 offset:2560
    v_max3_f32 v250, v250, v173, v174
    v_max_f32 v250, v250, v175
    v_mfma_f32_16x16x32_bf16 v[196:199], v[224:227], v[136:139], v[196:199]
    ds_read_b64_tr_b16 v[216:217], v243 offset:512
    ds_read_b64_tr_b16 v[218:219], v243 offset:2560
    v_cmp_lt_f32 vcc, s58, v250
    s_cbranch_vccnz RARE_AY_loop1
    v_exp_f32 v160, v160
    s_waitcnt lgkmcnt(8)
    v_mfma_f32_16x16x32_bf16 v[192:195], v[228:231], v[140:143], v[192:195]
    ds_read_b64_tr_b16 v[220:221], v242 offset:4096
    ds_read_b64_tr_b16 v[222:223], v242 offset:6144
    v_exp_f32 v161, v161
    v_mfma_f32_16x16x32_bf16 v[196:199], v[232:235], v[140:143], v[196:199]
    ds_read_b64_tr_b16 v[224:225], v243 offset:4096
    ds_read_b64_tr_b16 v[226:227], v243 offset:6144
    v_exp_f32 v162, v162
    s_waitcnt lgkmcnt(8)
    v_mfma_f32_32x32x16_bf16 v[0:15], v[204:207], v[144:147], v[0:15]
    ds_read_b64_tr_b16 v[228:229], v242 offset:4608
    ds_read_b64_tr_b16 v[230:231], v242 offset:6656
    v_add_f32 v236, v236, v160
    v_add_f32 v249, v249, v161
    v_cvt_pk_bf16_f32 v160, v160, v161
    v_exp_f32 v163, v163
    v_exp_f32 v164, v164
    v_mfma_f32_32x32x16_bf16 v[16:31], v[208:211], v[144:147], v[16:31]
    ds_read_b64_tr_b16 v[232:233], v243 offset:4608
    ds_read_b64_tr_b16 v[234:235], v243 offset:6656
    v_add_f32 v236, v236, v162
    v_add_f32 v249, v249, v163
    v_cvt_pk_bf16_f32 v161, v162, v163
    v_exp_f32 v165, v165
    v_exp_f32 v166, v166
    s_waitcnt lgkmcnt(8)
    v_mfma_f32_32x32x16_bf16 v[32:47], v[212:215], v[144:147], v[32:47]
    v_add_u32 v238, s45, v238
    v_add_u32 v239, s45, v239
    v_add_u32 v240, s45, v240
    v_add_u32 v241, s45, v241
    v_add_u32 v242, s45, v242
    v_add_u32 v243, s45, v243
    v_add_u32 v246, s42, v245
    v_xor_b32 v247, 64, v246
    s_waitcnt lgkmcnt(0)
    s_barrier
    ds_read_b128 v[204:207], v238 offset:0
    v_add_f32 v236, v236, v164
    v_add_f32 v249, v249, v165
    v_cvt_pk_bf16_f32 v162, v164, v165
    v_exp_f32 v167, v167
    v_mfma_f32_32x32x16_bf16 v[48:63], v[216:219], v[144:147], v[48:63]
    ds_read_b128 v[208:211], v239 offset:0
    v_exp_f32 v168, v168
    v_add_f32 v236, v236, v166
    v_add_f32 v249, v249, v167
    v_cvt_pk_bf16_f32 v163, v166, v167
    v_mfma_f32_32x32x16_bf16 v[0:15], v[220:223], v[152:155], v[0:15]
    ds_read_b128 v[212:215], v240 offset:0
    v_exp_f32 v169, v169
    v_exp_f32 v170, v170
    v_add_f32 v236, v236, v168
    v_mfma_f32_32x32x16_bf16 v[16:31], v[224:227], v[152:155], v[16:31]
    ds_read_b128 v[216:219], v241 offset:0
    v_add_f32 v249, v249, v169
    v_cvt_pk_bf16_f32 v168, v168, v169
    v_exp_f32 v171, v171
    v_exp_f32 v172, v172
    v_mfma_f32_32x32x16_bf16 v[32:47], v[228:231], v[152:155], v[32:47]
    ds_read_b128 v[220:223], v238 offset:512
    v_add_f32 v236, v236, v170
    v_add_f32 v249, v249, v171
    v_cvt_pk_bf16_f32 v169, v170, v171
    v_exp_f32 v173, v173
    v_mfma_f32_32x32x16_bf16 v[48:63], v[232:235], v[152:155], v[48:63]
REJ_AY_loop1:
    ds_read_b128 v[224:227], v239 offset:512
    v_max3_f32 v253, v192, v193, v194
    v_max3_f32 v253, v253, v195, v196
    v_max3_f32 v253, v253, v197, v198
    v_max_f32 v253, v253, v199
    v_cmp_lt_f32 vcc, s58, v253
    s_cbranch_vccnz RRARE_AY_loop
RREJ_AY_loop:
    s_waitcnt lgkmcnt(4)
    v_mfma_f32_32x32x16_bf16 v[144:159], v[204:207], v[96:99], v[176:191]
    ds_read_b128 v[228:231], v240 offset:512
    v_exp_f32 v192, v192
    v_exp_f32 v193, v193
    v_exp_f32 v194, v194
    v_mfma_f32_32x32x16_bf16 v[144:159], v[208:211], v[100:103], v[144:159]
    ds_read_b128 v[232:235], v241 offset:512
    v_add_f32 v237, v237, v192
    v_add_f32 v237, v237, v193
    v_cvt_pk_bf16_f32 v192, v192, v193
    v_exp_f32 v195, v195
    s_waitcnt lgkmcnt(4)
    v_mfma_f32_32x32x16_bf16 v[144:159], v[212:215], v[104:107], v[144:159]
    ds_read_b64_tr_b16 v[204:205], v246 offset:0
    ds_read_b64_tr_b16 v[206:207], v246 offset:4096
    v_exp_f32 v196, v196
    v_add_f32 v237, v237, v194
    v_add_f32 v237, v237, v195
    v_cvt_pk_bf16_f32 v193, v194, v195
    v_mfma_f32_32x32x16_bf16 v[144:159], v[216:219], v[108:111], v[144:159]
    ds_read_b64_tr_b16 v[208:209], v246 offset:32
    ds_read_b64_tr_b16 v[210:211], v246 offset:4128
    v_exp_f32 v197, v197
    v_exp_f32 v198, v198
    v_add_f32 v237, v237, v196
    s_waitcnt lgkmcnt(6)
    v_mfma_f32_32x32x16_bf16 v[144:159], v[220:223], v[112:115], v[144:159]
    ds_read_b64_tr_b16 v[212:213], v247 offset:0
    ds_read_b64_tr_b16 v[214:215], v247 offset:4096
    v_add_f32 v237, v237, v197
    v_cvt_pk_bf16_f32 v194, v196, v197
    v_exp_f32 v199, v199
    v_exp_f32 v174, v174
    v_mfma_f32_32x32x16_bf16 v[144:159], v[224:227], v[116:119], v[144:159]
    ds_read_b64_tr_b16 v[216:217], v247 offset:32
    ds_read_b64_tr_b16 v[218:219], v247 offset:4128
    v_add_f32 v237, v237, v198
    v_add_f32 v237, v237, v199
    v_cvt_pk_bf16_f32 v195, v198, v199
    v_add_f32 v236, v236, v172
    s_waitcnt lgkmcnt(8)
    v_mfma_f32_32x32x16_bf16 v[144:159], v[228:231], v[120:123], v[144:159]
    ds_read_b64_tr_b16 v[220:221], v246 offset:512
    ds_read_b64_tr_b16 v[222:223], v246 offset:4608
    v_add_f32 v249, v249, v173
    v_cvt_pk_bf16_f32 v170, v172, v173
    v_exp_f32 v175, v175
    v_mfma_f32_32x32x16_bf16 v[144:159], v[232:235], v[124:127], v[144:159]
    ds_read_b64_tr_b16 v[224:225], v246 offset:544
    ds_read_b64_tr_b16 v[226:227], v246 offset:4640
    v_add_f32 v236, v236, v174
    v_add_f32 v249, v249, v175
    v_cvt_pk_bf16_f32 v171, v174, v175
    s_cmp_lg_u32 s50, 3
    s_cbranch_scc1 NOT_AY
    v_and_b32 v251, 3, v254
    v_lshlrev_b32 v251, 7, v251
    v_min_u32 v251, 0x13c, v251
    v_lshrrev_b32 v252, 2, v254
    v_mul_u32_u24 v252, 0x480, v252
    v_add_u32 v251, v251, v252
    s_add_u32 s51, s36, 2
    s_and_b32 s51, s51, 3
    s_mul_i32 s51, s51, 36864
    s_mul_i32 s52, s39, 147456
    s_add_u32 s51, s51, s52
    buffer_load_dword v255, v251, s[20:23], s51 offen
    s_add_u32 s51, s51, 18432
    buffer_load_dword v255, v251, s[20:23], s51 offen
NOT_AY:
    s_sub_u32 s50, s50, 1
    s_cmp_lg_u32 s50, 0
    s_cbranch_scc1 LOOP_AY
    s_waitcnt lgkmcnt(8)
    v_mfma_f32_16x16x32_bf16 v[64:67], v[204:207], v[192:195], v[64:67]
    ds_read_b64_tr_b16 v[228:229], v247 offset:512
    ds_read_b64_tr_b16 v[230:231], v247 offset:4608
    s_mov_b32 s44, s42
    s_add_u32 s42, s42, 0x4000
    s_cmp_ge_u32 s42, 0x28000
    s_cselect_b32 s51, 0x28000, 0
    s_sub_u32 s42, s42, s51
    s_sub_u32 s45, s42, s44
    v_mfma_f32_16x16x32_bf16 v[68:71], v[208:211], v[192:195], v[68:71]
    ds_read_b64_tr_b16 v[232:233], v247 offset:544
    ds_read_b64_tr_b16 v[234:235], v247 offset:4640
    v_max3_f32 v250, v144, v145, v146
    v_max3_f32 v250, v250, v147, v148
    s_waitcnt lgkmcnt(8)
    v_mfma_f32_16x16x32_bf16 v[72:75], v[212:215], v[192:195], v[72:75]
    ds_read_b64_tr_b16 v[204:205], v242 offset:0
    ds_read_b64_tr_b16 v[206:207], v242 offset:2048
    v_max3_f32 v250, v250, v149, v150
    v_max3_f32 v250, v250, v151, v152
    v_mfma_f32_16x16x32_bf16 v[76:79], v[216:219], v[192:195], v[76:79]
    ds_read_b64_tr_b16 v[208:209], v243 offset:0
    ds_read_b64_tr_b16 v[210:211], v243 offset:2048
    v_max3_f32 v250, v250, v153, v154
    v_max3_f32 v250, v250, v155, v156
    s_waitcnt lgkmcnt(8)
    v_mfma_f32_16x16x32_bf16 v[80:83], v[220:223], v[192:195], v[80:83]
    ds_read_b64_tr_b16 v[212:213], v242 offset:512
    ds_read_b64_tr_b16 v[214:215], v242 offset:2560
    v_max3_f32 v250, v250, v157, v158
    v_max_f32 v250, v250, v159
    v_mfma_f32_16x16x32_bf16 v[84:87], v[224:227], v[192:195], v[84:87]
    ds_read_b64_tr_b16 v[216:217], v243 offset:512
    ds_read_b64_tr_b16 v[218:219], v243 offset:2560
    v_cmp_lt_f32 vcc, s58, v250
    s_cbranch_vccnz RARE_AY_last0
    v_exp_f32 v144, v144
    s_waitcnt lgkmcnt(8)
    v_mfma_f32_16x16x32_bf16 v[88:91], v[228:231], v[192:195], v[88:91]
    ds_read_b64_tr_b16 v[220:221], v242 offset:4096
    ds_read_b64_tr_b16 v[222:223], v242 offset:6144
    v_exp_f32 v145, v145
    v_mfma_f32_16x16x32_bf16 v[92:95], v[232:235], v[192:195], v[92:95]
    ds_read_b64_tr_b16 v[224:225], v243 offset:4096
    ds_read_b64_tr_b16 v[226:227], v243 offset:6144
    v_exp_f32 v146, v146
    s_waitcnt lgkmcnt(8)
    v_mfma_f32_32x32x16_bf16 v[0:15], v[204:207], v[160:163], v[0:15]
    ds_read_b64_tr_b16 v[228:229], v242 offset:4608
    ds_read_b64_tr_b16 v[230:231], v242 offset:6656
    v_add_f32 v236, v236, v144
    v_add_f32 v249, v249, v145
    v_cvt_pk_bf16_f32 v144, v144, v145
    v_exp_f32 v147, v147
    v_mfma_f32_32x32x16_bf16 v[16:31], v[208:211], v[160:163], v[16:31]
    ds_read_b64_tr_b16 v[232:233], v243 offset:4608
    ds_read_b64_tr_b16 v[234:235], v243 offset:6656
    v_exp_f32 v148, v148
    v_add_f32 v236, v236, v146
    s_waitcnt lgkmcnt(8)
    v_mfma_f32_32x32x16_bf16 v[32:47], v[212:215], v[160:163], v[32:47]
    v_add_u32 v238, s45, v238
    v_add_u32 v239, s45, v239
    v_add_u32 v240, s45, v240
    v_add_u32 v241, s45, v241
    v_add_u32 v242, s45, v242
    v_add_u32 v243, s45, v243
    v_add_u32 v246, s42, v244
    v_xor_b32 v247, 64, v246
    s_waitcnt lgkmcnt(0)
    s_barrier
    ds_read_b128 v[204:207], v238 offset:0
    v_add_f32 v249, v249, v147
    v_cvt_pk_bf16_f32 v145, v146, v147
    v_exp_f32 v149, v149
    v_mfma_f32_32x32x16_bf16 v[48:63], v[216:219], v[160:163], v[48:63]
    ds_read_b128 v[208:211], v239 offset:0
    v_exp_f32 v150, v150
    v_add_f32 v236, v236, v148
    v_mfma_f32_32x32x16_bf16 v[0:15], v[220:223], v[168:171], v[0:15]
    ds_read_b128 v[212:215], v240 offset:0
    v_add_f32 v249, v249, v149
    v_cvt_pk_bf16_f32 v146, v148, v149
    v_exp_f32 v151, v151
    v_mfma_f32_32x32x16_bf16 v[16:31], v[224:227], v[168:171], v[16:31]
    ds_read_b128 v[216:219], v241 offset:0
    v_exp_f32 v152, v152
    v_add_f32 v236, v236, v150
    v_mfma_f32_32x32x16_bf16 v[32:47], v[228:231], v[168:171], v[32:47]
    ds_read_b128 v[220:223], v238 offset:512
    v_add_f32 v249, v249, v151
    v_cvt_pk_bf16_f32 v147, v150, v151
    v_exp_f32 v153, v153
    v_mfma_f32_32x32x16_bf16 v[48:63], v[232:235], v[168:171], v[48:63]
REJ_AY_last0:
    ds_read_b128 v[224:227], v239 offset:512
    v_exp_f32 v154, v154
    v_add_f32 v236, v236, v152
    s_waitcnt lgkmcnt(4)
    v_mfma_f32_32x32x16_bf16 v[160:175], v[204:207], v[96:99], v[176:191]
    ds_read_b128 v[228:231], v240 offset:512
    v_add_f32 v249, v249, v153
    v_cvt_pk_bf16_f32 v152, v152, v153
    v_exp_f32 v155, v155
    v_mfma_f32_32x32x16_bf16 v[160:175], v[208:211], v[100:103], v[160:175]
    ds_read_b128 v[232:235], v241 offset:512
    v_exp_f32 v156, v156
    v_add_f32 v236, v236, v154
    s_waitcnt lgkmcnt(4)
    v_mfma_f32_32x32x16_bf16 v[160:175], v[212:215], v[104:107], v[160:175]
    ds_read_b128 v[204:207], v246 offset:0
    v_add_f32 v249, v249, v155
    v_cvt_pk_bf16_f32 v153, v154, v155
    v_exp_f32 v157, v157
    v_mfma_f32_32x32x16_bf16 v[160:175], v[216:219], v[108:111], v[160:175]
    ds_read_b128 v[208:211], v246 offset:4096
    v_exp_f32 v158, v158
    s_waitcnt lgkmcnt(4)
    v_mfma_f32_32x32x16_bf16 v[160:175], v[220:223], v[112:115], v[160:175]
    ds_read_b128 v[212:215], v247 offset:0
    v_add_f32 v236, v236, v156
    v_add_f32 v249, v249, v157
    v_mfma_f32_32x32x16_bf16 v[160:175], v[224:227], v[116:119], v[160:175]
    ds_read_b128 v[216:219], v247 offset:4096
    v_cvt_pk_bf16_f32 v154, v156, v157
    v_exp_f32 v159, v159
    s_waitcnt lgkmcnt(4)
    v_mfma_f32_32x32x16_bf16 v[160:175], v[228:231], v[120:123], v[160:175]
    ds_read_b128 v[220:223], v246 offset:512
    v_add_f32 v236, v236, v158
    v_add_f32 v249, v249, v159
    v_mfma_f32_32x32x16_bf16 v[160:175], v[232:235], v[124:127], v[160:175]
    ds_read_b128 v[224:227], v246 offset:4608
    v_cvt_pk_bf16_f32 v155, v158, v159
    s_waitcnt lgkmcnt(4)
    v_mfma_f32_16x16x32_bf16 v[192:195], v[204:207], v[128:131], v[200:203]
    ds_read_b128 v[228:231], v247 offset:512
    s_mov_b32 s44, s42
    s_add_u32 s42, s42, 0x4000
    s_cmp_ge_u32 s42, 0x28000
    s_cselect_b32 s51, 0x28000, 0
    s_sub_u32 s42, s42, s51
    s_sub_u32 s45, s42, s44
    v_mfma_f32_16x16x32_bf16 v[196:199], v[208:211], v[128:131], v[200:203]
    ds_read_b128 v[232:235], v247 offset:4608
    v_max3_f32 v250, v160, v161, v162
    v_max3_f32 v250, v250, v163, v164
    v_max3_f32 v250, v250, v165, v166
    v_max3_f32 v250, v250, v167, v168
    s_waitcnt lgkmcnt(4)
    v_mfma_f32_16x16x32_bf16 v[192:195], v[212:215], v[132:135], v[192:195]
    ds_read_b64_tr_b16 v[204:205], v242 offset:0
    ds_read_b64_tr_b16 v[206:207], v242 offset:2048
    v_max3_f32 v250, v250, v169, v170
    v_max3_f32 v250, v250, v171, v172
    v_max3_f32 v250, v250, v173, v174
    v_max_f32 v250, v250, v175
    v_mfma_f32_16x16x32_bf16 v[196:199], v[216:219], v[132:135], v[196:199]
    ds_read_b64_tr_b16 v[208:209], v243 offset:0
    ds_read_b64_tr_b16 v[210:211], v243 offset:2048
    v_cmp_lt_f32 vcc, s58, v250
    s_cbranch_vccnz RARE_AY_last1
    v_exp_f32 v160, v160
    v_exp_f32 v161, v161
    s_waitcnt lgkmcnt(6)
    v_mfma_f32_16x16x32_bf16 v[192:195], v[220:223], v[136:139], v[192:195]
    ds_read_b64_tr_b16 v[212:213], v242 offset:512
    ds_read_b64_tr_b16 v[214:215], v242 offset:2560
    v_exp_f32 v162, v162
    v_add_f32 v236, v236, v160
    v_add_f32 v249, v249, v161
    v_mfma_f32_16x16x32_bf16 v[196:199], v[224:227], v[136:139], v[196:199]
    ds_read_b64_tr_b16 v[216:217], v243 offset:512
    ds_read_b64_tr_b16 v[218:219], v243 offset:2560
    v_cvt_pk_bf16_f32 v160, v160, v161
    v_exp_f32 v163, v163
    s_waitcnt lgkmcnt(8)
    v_mfma_f32_16x16x32_bf16 v[192:195], v[228:231], v[140:143], v[192:195]
    ds_read_b64_tr_b16 v[220:221], v242 offset:4096
    ds_read_b64_tr_b16 v[222:223], v242 offset:6144
    v_exp_f32 v164, v164
    v_add_f32 v236, v236, v162
    v_mfma_f32_16x16x32_bf16 v[196:199], v[232:235], v[140:143], v[196:199]
    ds_read_b64_tr_b16 v[224:225], v243 offset:4096
    ds_read_b64_tr_b16 v[226:227], v243 offset:6144
    v_add_f32 v249, v249, v163
    v_cvt_pk_bf16_f32 v161, v162, v163
    v_exp_f32 v165, v165
    s_waitcnt lgkmcnt(8)
    v_mfma_f32_32x32x16_bf16 v[0:15], v[204:207], v[144:147], v[0:15]
    ds_read_b64_tr_b16 v[228:229], v242 offset:4608
    ds_read_b64_tr_b16 v[230:231], v242 offset:6656
    v_exp_f32 v166, v166
    v_add_f32 v236, v236, v164
    v_add_f32 v249, v249, v165
    v_cvt_pk_bf16_f32 v162, v164, v165
    v_exp_f32 v167, v167
    v_exp_f32 v168, v168
    v_mfma_f32_32x32x16_bf16 v[16:31], v[208:211], v[144:147], v[16:31]
    ds_read_b64_tr_b16 v[232:233], v243 offset:4608
    ds_read_b64_tr_b16 v[234:235], v243 offset:6656
    v_add_f32 v236, v236, v166
    v_add_f32 v249, v249, v167
    v_cvt_pk_bf16_f32 v163, v166, v167
    v_exp_f32 v169, v169
    v_exp_f32 v170, v170
    v_add_f32 v236, v236, v168
    v_add_f32 v249, v249, v169
    s_waitcnt lgkmcnt(8)
    v_mfma_f32_32x32x16_bf16 v[32:47], v[212:215], v[144:147], v[32:47]
    v_add_u32 v238, s45, v238
    v_add_u32 v239, s45, v239
    v_add_u32 v240, s45, v240
    v_add_u32 v241, s45, v241
    v_add_u32 v242, s45, v242
    v_add_u32 v243, s45, v243
    v_add_u32 v246, s42, v245
    v_xor_b32 v247, 64, v246
    s_waitcnt lgkmcnt(0)
    s_barrier
    v_cvt_pk_bf16_f32 v168, v168, v169
    v_exp_f32 v171, v171
    v_exp_f32 v172, v172
    v_add_f32 v236, v236, v170
    v_add_f32 v249, v249, v171
    v_cvt_pk_bf16_f32 v169, v170, v171
    v_exp_f32 v173, v173
    v_mfma_f32_32x32x16_bf16 v[48:63], v[216:219], v[144:147], v[48:63]
    v_exp_f32 v174, v174
    v_add_f32 v236, v236, v172
    v_add_f32 v249, v249, v173
    v_cvt_pk_bf16_f32 v170, v172, v173
    v_exp_f32 v175, v175
    v_add_f32 v236, v236, v174
    v_add_f32 v249, v249, v175
    v_mfma_f32_32x32x16_bf16 v[0:15], v[220:223], v[152:155], v[0:15]
    v_cvt_pk_bf16_f32 v171, v174, v175
    v_mfma_f32_32x32x16_bf16 v[16:31], v[224:227], v[152:155], v[16:31]
    v_mfma_f32_32x32x16_bf16 v[32:47], v[228:231], v[152:155], v[32:47]
    v_mfma_f32_32x32x16_bf16 v[48:63], v[232:235], v[152:155], v[48:63]
REJ_AY_last1:
    v_max3_f32 v253, v192, v193, v194
    v_max3_f32 v253, v253, v195, v196
    v_max3_f32 v253, v253, v197, v198
    v_max_f32 v253, v253, v199
    v_cmp_lt_f32 vcc, s58, v253
    s_cbranch_vccnz RRARE_AY_last
RREJ_AY_last:
    v_exp_f32 v192, v192
    v_exp_f32 v193, v193
    v_exp_f32 v194, v194
    v_add_f32 v237, v237, v192
    v_add_f32 v237, v237, v193
    v_cvt_pk_bf16_f32 v192, v192, v193
    v_exp_f32 v195, v195
    v_exp_f32 v196, v196
    v_add_f32 v237, v237, v194
    v_add_f32 v237, v237, v195
    v_cvt_pk_bf16_f32 v193, v194, v195
    v_exp_f32 v197, v197
    v_exp_f32 v198, v198
    v_add_f32 v237, v237, v196
    v_add_f32 v237, v237, v197
    v_cvt_pk_bf16_f32 v194, v196, v197
    v_exp_f32 v199, v199
    v_add_f32 v237, v237, v198
    v_add_f32 v237, v237, v199
    v_cvt_pk_bf16_f32 v195, v198, v199
    ds_read_b64_tr_b16 v[204:205], v246 offset:0
    ds_read_b64_tr_b16 v[206:207], v246 offset:4096
    ds_read_b64_tr_b16 v[208:209], v246 offset:32
    ds_read_b64_tr_b16 v[210:211], v246 offset:4128
    ds_read_b64_tr_b16 v[212:213], v247 offset:0
    ds_read_b64_tr_b16 v[214:215], v247 offset:4096
    ds_read_b64_tr_b16 v[216:217], v247 offset:32
    ds_read_b64_tr_b16 v[218:219], v247 offset:4128
    ds_read_b64_tr_b16 v[220:221], v246 offset:512
    ds_read_b64_tr_b16 v[222:223], v246 offset:4608
    ds_read_b64_tr_b16 v[224:225], v246 offset:544
    ds_read_b64_tr_b16 v[226:227], v246 offset:4640
    s_waitcnt lgkmcnt(10)
    v_mfma_f32_16x16x32_bf16 v[64:67], v[204:207], v[192:195], v[64:67]
    ds_read_b64_tr_b16 v[228:229], v247 offset:512
    ds_read_b64_tr_b16 v[230:231], v247 offset:4608
    s_waitcnt lgkmcnt(10)
    v_mfma_f32_16x16x32_bf16 v[68:71], v[208:211], v[192:195], v[68:71]
    ds_read_b64_tr_b16 v[232:233], v247 offset:544
    ds_read_b64_tr_b16 v[234:235], v247 offset:4640
    s_waitcnt lgkmcnt(10)
    v_mfma_f32_16x16x32_bf16 v[72:75], v[212:215], v[192:195], v[72:75]
    ds_read_b64_tr_b16 v[204:205], v242 offset:0
    ds_read_b64_tr_b16 v[206:207], v242 offset:2048
    s_waitcnt lgkmcnt(10)
    v_mfma_f32_16x16x32_bf16 v[76:79], v[216:219], v[192:195], v[76:79]
    ds_read_b64_tr_b16 v[208:209], v243 offset:0
    ds_read_b64_tr_b16 v[210:211], v243 offset:2048
    s_waitcnt lgkmcnt(10)
    v_mfma_f32_16x16x32_bf16 v[80:83], v[220:223], v[192:195], v[80:83]
    ds_read_b64_tr_b16 v[212:213], v242 offset:512
    ds_read_b64_tr_b16 v[214:215], v242 offset:2560
    s_waitcnt lgkmcnt(10)
    v_mfma_f32_16x16x32_bf16 v[84:87], v[224:227], v[192:195], v[84:87]
    ds_read_b64_tr_b16 v[216:217], v243 offset:512
    ds_read_b64_tr_b16 v[218:219], v243 offset:2560
    s_waitcnt lgkmcnt(10)
    v_mfma_f32_16x16x32_bf16 v[88:91], v[228:231], v[192:195], v[88:91]
    ds_read_b64_tr_b16 v[220:221], v242 offset:4096
    ds_read_b64_tr_b16 v[222:223], v242 offset:6144
    s_waitcnt lgkmcnt(10)
    v_mfma_f32_16x16x32_bf16 v[92:95], v[232:235], v[192:195], v[92:95]
    ds_read_b64_tr_b16 v[224:225], v243 offset:4096
    ds_read_b64_tr_b16 v[226:227], v243 offset:6144
    s_waitcnt lgkmcnt(10)
    v_mfma_f32_32x32x16_bf16 v[0:15], v[204:207], v[160:163], v[0:15]
    ds_read_b64_tr_b16 v[228:229], v242 offset:4608
    ds_read_b64_tr_b16 v[230:231], v242 offset:6656
    s_waitcnt lgkmcnt(10)
    v_mfma_f32_32x32x16_bf16 v[16:31], v[208:211], v[160:163], v[16:31]
    ds_read_b64_tr_b16 v[232:233], v243 offset:4608
    ds_read_b64_tr_b16 v[234:235], v243 offset:6656
    s_waitcnt lgkmcnt(10)
    v_mfma_f32_32x32x16_bf16 v[32:47], v[212:215], v[160:163], v[32:47]
    s_waitcnt lgkmcnt(8)
    v_mfma_f32_32x32x16_bf16 v[48:63], v[216:219], v[160:163], v[48:63]
    s_waitcnt lgkmcnt(6)
    v_mfma_f32_32x32x16_bf16 v[0:15], v[220:223], v[168:171], v[0:15]
    s_waitcnt lgkmcnt(4)
    v_mfma_f32_32x32x16_bf16 v[16:31], v[224:227], v[168:171], v[16:31]
    s_waitcnt lgkmcnt(2)
    v_mfma_f32_32x32x16_bf16 v[32:47], v[228:231], v[168:171], v[32:47]
    s_waitcnt lgkmcnt(0)
    v_mfma_f32_32x32x16_bf16 v[48:63], v[232:235], v[168:171], v[48:63]
    v_add_f32 v236, v236, v249
    s_branch TAIL_Y
RARE_AY_first1:
    s_waitcnt lgkmcnt(6)
    v_mfma_f32_16x16x32_bf16 v[192:195], v[220:223], v[136:139], v[192:195]
    ds_read_b64_tr_b16 v[212:213], v242 offset:512
    ds_read_b64_tr_b16 v[214:215], v242 offset:2560
    v_mfma_f32_16x16x32_bf16 v[196:199], v[224:227], v[136:139], v[196:199]
    ds_read_b64_tr_b16 v[216:217], v243 offset:512
    ds_read_b64_tr_b16 v[218:219], v243 offset:2560
    s_waitcnt lgkmcnt(8)
    v_mfma_f32_16x16x32_bf16 v[192:195], v[228:231], v[140:143], v[192:195]
    ds_read_b64_tr_b16 v[220:221], v242 offset:4096
    ds_read_b64_tr_b16 v[222:223], v242 offset:6144
    v_mfma_f32_16x16x32_bf16 v[196:199], v[232:235], v[140:143], v[196:199]
    ds_read_b64_tr_b16 v[224:225], v243 offset:4096
    ds_read_b64_tr_b16 v[226:227], v243 offset:6144
    s_waitcnt lgkmcnt(8)
    v_mfma_f32_32x32x16_bf16 v[0:15], v[204:207], v[144:147], 0
    ds_read_b64_tr_b16 v[228:229], v242 offset:4608
    ds_read_b64_tr_b16 v[230:231], v242 offset:6656
    v_mfma_f32_32x32x16_bf16 v[16:31], v[208:211], v[144:147], 0
    ds_read_b64_tr_b16 v[232:233], v243 offset:4608
    ds_read_b64_tr_b16 v[234:235], v243 offset:6656
    s_waitcnt lgkmcnt(8)
    v_mfma_f32_32x32x16_bf16 v[32:47], v[212:215], v[144:147], 0
    v_add_u32 v238, s45, v238
    v_add_u32 v239, s45, v239
    v_add_u32 v240, s45, v240
    v_add_u32 v241, s45, v241
    v_add_u32 v242, s45, v242
    v_add_u32 v243, s45, v243
    v_add_u32 v246, s42, v245
    v_xor_b32 v247, 64, v246
    s_waitcnt lgkmcnt(0)
    s_barrier
    ds_read_b128 v[204:207], v238 offset:0
    v_mfma_f32_32x32x16_bf16 v[48:63], v[216:219], v[144:147], 0
    ds_read_b128 v[208:211], v239 offset:0
    v_mfma_f32_32x32x16_bf16 v[0:15], v[220:223], v[152:155], v[0:15]
    ds_read_b128 v[212:215], v240 offset:0
    v_mfma_f32_32x32x16_bf16 v[16:31], v[224:227], v[152:155], v[16:31]
    ds_read_b128 v[216:219], v241 offset:0
    v_mfma_f32_32x32x16_bf16 v[32:47], v[228:231], v[152:155], v[32:47]
    ds_read_b128 v[220:223], v238 offset:512
    v_mfma_f32_32x32x16_bf16 v[48:63], v[232:235], v[152:155], v[48:63]
    v_mov_b32 v251, v250
    v_mov_b32 v252, v250
    s_nop 1
    v_permlane32_swap_b32 v251, v252
    v_max_f32 v250, v251, v252
    v_max_f32 v250, 0, v250
    v_exp_f32 v251, -v250
    v_sub_f32 v160, v160, v250
    v_sub_f32 v161, v161, v250
    v_sub_f32 v162, v162, v250
    v_sub_f32 v163, v163, v250
    v_sub_f32 v164, v164, v250
    v_sub_f32 v165, v165, v250
    v_sub_f32 v166, v166, v250
    v_sub_f32 v167, v167, v250
    v_sub_f32 v168, v168, v250
    v_sub_f32 v169, v169, v250
    v_sub_f32 v170, v170, v250
    v_sub_f32 v171, v171, v250
    v_sub_f32 v172, v172, v250
    v_sub_f32 v173, v173, v250
    v_sub_f32 v174, v174, v250
    v_sub_f32 v175, v175, v250
    v_sub_f32 v176, v176, v250
    v_sub_f32 v177, v177, v250
    v_sub_f32 v178, v178, v250
    v_sub_f32 v179, v179, v250
    v_sub_f32 v180, v180, v250
    v_sub_f32 v181, v181, v250
    v_sub_f32 v182, v182, v250
    v_sub_f32 v183, v183, v250
    v_sub_f32 v184, v184, v250
    v_sub_f32 v185, v185, v250
    v_sub_f32 v186, v186, v250
    v_sub_f32 v187, v187, v250
    v_sub_f32 v188, v188, v250
    v_sub_f32 v189, v189, v250
    v_sub_f32 v190, v190, v250
    v_sub_f32 v191, v191, v250
    v_mul_f32 v236, v236, v251
    v_mul_f32 v249, v249, v251
    v_mul_f32 v0, v0, v251
    v_mul_f32 v1, v1, v251
    v_mul_f32 v2, v2, v251
    v_mul_f32 v3, v3, v251
    v_mul_f32 v4, v4, v251
    v_mul_f32 v5, v5, v251
    v_mul_f32 v6, v6, v251
    v_mul_f32 v7, v7, v251
    v_mul_f32 v8, v8, v251
    v_mul_f32 v9, v9, v251
    v_mul_f32 v10, v10, v251
    v_mul_f32 v11, v11, v251
    v_mul_f32 v12, v12, v251
    v_mul_f32 v13, v13, v251
    v_mul_f32 v14, v14, v251
    v_mul_f32 v15, v15, v251
    v_mul_f32 v16, v16, v251
    v_mul_f32 v17, v17, v251
    v_mul_f32 v18, v18, v251
    v_mul_f32 v19, v19, v251
    v_mul_f32 v20, v20, v251
    v_mul_f32 v21, v21, v251
    v_mul_f32 v22, v22, v251
    v_mul_f32 v23, v23, v251
    v_mul_f32 v24, v24, v251
    v_mul_f32 v25, v25, v251
    v_mul_f32 v26, v26, v251
    v_mul_f32 v27, v27, v251
    v_mul_f32 v28, v28, v251
    v_mul_f32 v29, v29, v251
    v_mul_f32 v30, v30, v251
    v_mul_f32 v31, v31, v251
    v_mul_f32 v32, v32, v251
    v_mul_f32 v33, v33, v251
    v_mul_f32 v34, v34, v251
    v_mul_f32 v35, v35, v251
    v_mul_f32 v36, v36, v251
    v_mul_f32 v37, v37, v251
    v_mul_f32 v38, v38, v251
    v_mul_f32 v39, v39, v251
    v_mul_f32 v40, v40, v251
    v_mul_f32 v41, v41, v251
    v_mul_f32 v42, v42, v251
    v_mul_f32 v43, v43, v251
    v_mul_f32 v44, v44, v251
    v_mul_f32 v45, v45, v251
    v_mul_f32 v46, v46, v251
    v_mul_f32 v47, v47, v251
    v_mul_f32 v48, v48, v251
    v_mul_f32 v49, v49, v251
    v_mul_f32 v50, v50, v251
    v_mul_f32 v51, v51, v251
    v_mul_f32 v52, v52, v251
    v_mul_f32 v53, v53, v251
    v_mul_f32 v54, v54, v251
    v_mul_f32 v55, v55, v251
    v_mul_f32 v56, v56, v251
    v_mul_f32 v57, v57, v251
    v_mul_f32 v58, v58, v251
    v_mul_f32 v59, v59, v251
    v_mul_f32 v60, v60, v251
    v_mul_f32 v61, v61, v251
    v_mul_f32 v62, v62, v251
    v_mul_f32 v63, v63, v251
    v_exp_f32 v160, v160
    v_exp_f32 v161, v161
    v_exp_f32 v162, v162
    v_add_f32 v236, v236, v160
    v_add_f32 v249, v249, v161
    v_cvt_pk_bf16_f32 v160, v160, v161
    v_exp_f32 v163, v163
    v_exp_f32 v164, v164
    v_add_f32 v236, v236, v162
    v_add_f32 v249, v249, v163
    v_cvt_pk_bf16_f32 v161, v162, v163
    v_exp_f32 v165, v165
    v_exp_f32 v166, v166
    v_add_f32 v236, v236, v164
    v_add_f32 v249, v249, v165
    v_cvt_pk_bf16_f32 v162, v164, v165
    v_exp_f32 v167, v167
    v_exp_f32 v168, v168
    v_add_f32 v236, v236, v166
    v_add_f32 v249, v249, v167
    v_cvt_pk_bf16_f32 v163, v166, v167
    v_exp_f32 v169, v169
    v_exp_f32 v170, v170
    v_add_f32 v236, v236, v168
    v_add_f32 v249, v249, v169
    v_cvt_pk_bf16_f32 v168, v168, v169
    v_exp_f32 v171, v171
    v_exp_f32 v172, v172
    v_add_f32 v236, v236, v170
    v_add_f32 v249, v249, v171
    v_cvt_pk_bf16_f32 v169, v170, v171
    v_exp_f32 v173, v173
    v_exp_f32 v174, v174
    v_add_f32 v236, v236, v172
    v_add_f32 v249, v249, v173
    v_cvt_pk_bf16_f32 v170, v172, v173
    v_exp_f32 v175, v175
    v_add_f32 v236, v236, v174
    v_add_f32 v249, v249, v175
    v_cvt_pk_bf16_f32 v171, v174, v175
    s_branch REJ_AY_first1
RARE_AY_loop0:
    s_waitcnt lgkmcnt(8)
    v_mfma_f32_16x16x32_bf16 v[88:91], v[228:231], v[192:195], v[88:91]
    ds_read_b64_tr_b16 v[220:221], v242 offset:4096
    ds_read_b64_tr_b16 v[222:223], v242 offset:6144
    v_mfma_f32_16x16x32_bf16 v[92:95], v[232:235], v[192:195], v[92:95]
    ds_read_b64_tr_b16 v[224:225], v243 offset:4096
    ds_read_b64_tr_b16 v[226:227], v243 offset:6144
    s_waitcnt lgkmcnt(8)
    v_mfma_f32_32x32x16_bf16 v[0:15], v[204:207], v[160:163], v[0:15]
    ds_read_b64_tr_b16 v[228:229], v242 offset:4608
    ds_read_b64_tr_b16 v[230:231], v242 offset:6656
    v_mfma_f32_32x32x16_bf16 v[16:31], v[208:211], v[160:163], v[16:31]
    ds_read_b64_tr_b16 v[232:233], v243 offset:4608
    ds_read_b64_tr_b16 v[234:235], v243 offset:6656
    s_waitcnt lgkmcnt(8)
    v_mfma_f32_32x32x16_bf16 v[32:47], v[212:215], v[160:163], v[32:47]
    v_add_u32 v238, s45, v238
    v_add_u32 v239, s45, v239
    v_add_u32 v240, s45, v240
    v_add_u32 v241, s45, v241
    v_add_u32 v242, s45, v242
    v_add_u32 v243, s45, v243
    v_add_u32 v246, s42, v244
    v_xor_b32 v247, 64, v246
    s_waitcnt lgkmcnt(0)
    s_barrier
    ds_read_b128 v[204:207], v238 offset:0
    v_mfma_f32_32x32x16_bf16 v[48:63], v[216:219], v[160:163], v[48:63]
    ds_read_b128 v[208:211], v239 offset:0
    v_mfma_f32_32x32x16_bf16 v[0:15], v[220:223], v[168:171], v[0:15]
    ds_read_b128 v[212:215], v240 offset:0
    v_mfma_f32_32x32x16_bf16 v[16:31], v[224:227], v[168:171], v[16:31]
    ds_read_b128 v[216:219], v241 offset:0
    v_mfma_f32_32x32x16_bf16 v[32:47], v[228:231], v[168:171], v[32:47]
    ds_read_b128 v[220:223], v238 offset:512
    v_mfma_f32_32x32x16_bf16 v[48:63], v[232:235], v[168:171], v[48:63]
    v_mov_b32 v251, v250
    v_mov_b32 v252, v250
    s_nop 1
    v_permlane32_swap_b32 v251, v252
    v_max_f32 v250, v251, v252
    v_max_f32 v250, 0, v250
    v_exp_f32 v251, -v250
    v_sub_f32 v144, v144, v250
    v_sub_f32 v145, v145, v250
    v_sub_f32 v146, v146, v250
    v_sub_f32 v147, v147, v250
    v_sub_f32 v148, v148, v250
    v_sub_f32 v149, v149, v250
    v_sub_f32 v150, v150, v250
    v_sub_f32 v151, v151, v250
    v_sub_f32 v152, v152, v250
    v_sub_f32 v153, v153, v250
    v_sub_f32 v154, v154, v250
    v_sub_f32 v155, v155, v250
    v_sub_f32 v156, v156, v250
    v_sub_f32 v157, v157, v250
    v_sub_f32 v158, v158, v250
    v_sub_f32 v159, v159, v250
    v_sub_f32 v176, v176, v250
    v_sub_f32 v177, v177, v250
    v_sub_f32 v178, v178, v250
    v_sub_f32 v179, v179, v250
    v_sub_f32 v180, v180, v250
    v_sub_f32 v181, v181, v250
    v_sub_f32 v182, v182, v250
    v_sub_f32 v183, v183, v250
    v_sub_f32 v184, v184, v250
    v_sub_f32 v185, v185, v250
    v_sub_f32 v186, v186, v250
    v_sub_f32 v187, v187, v250
    v_sub_f32 v188, v188, v250
    v_sub_f32 v189, v189, v250
    v_sub_f32 v190, v190, v250
    v_sub_f32 v191, v191, v250
    v_mul_f32 v236, v236, v251
    v_mul_f32 v249, v249, v251
    v_mul_f32 v0, v0, v251
    v_mul_f32 v1, v1, v251
    v_mul_f32 v2, v2, v251
    v_mul_f32 v3, v3, v251
    v_mul_f32 v4, v4, v251
    v_mul_f32 v5, v5, v251
    v_mul_f32 v6, v6, v251
    v_mul_f32 v7, v7, v251
    v_mul_f32 v8, v8, v251
    v_mul_f32 v9, v9, v251
    v_mul_f32 v10, v10, v251
    v_mul_f32 v11, v11, v251
    v_mul_f32 v12, v12, v251
    v_mul_f32 v13, v13, v251
    v_mul_f32 v14, v14, v251
    v_mul_f32 v15, v15, v251
    v_mul_f32 v16, v16, v251
    v_mul_f32 v17, v17, v251
    v_mul_f32 v18, v18, v251
    v_mul_f32 v19, v19, v251
    v_mul_f32 v20, v20, v251
    v_mul_f32 v21, v21, v251
    v_mul_f32 v22, v22, v251
    v_mul_f32 v23, v23, v251
    v_mul_f32 v24, v24, v251
    v_mul_f32 v25, v25, v251
    v_mul_f32 v26, v26, v251
    v_mul_f32 v27, v27, v251
    v_mul_f32 v28, v28, v251
    v_mul_f32 v29, v29, v251
    v_mul_f32 v30, v30, v251
    v_mul_f32 v31, v31, v251
    v_mul_f32 v32, v32, v251
    v_mul_f32 v33, v33, v251
    v_mul_f32 v34, v34, v251
    v_mul_f32 v35, v35, v251
    v_mul_f32 v36, v36, v251
    v_mul_f32 v37, v37, v251
    v_mul_f32 v38, v38, v251
    v_mul_f32 v39, v39, v251
    v_mul_f32 v40, v40, v251
    v_mul_f32 v41, v41, v251
    v_mul_f32 v42, v42, v251
    v_mul_f32 v43, v43, v251
    v_mul_f32 v44, v44, v251
    v_mul_f32 v45, v45, v251
    v_mul_f32 v46, v46, v251
    v_mul_f32 v47, v47, v251
    v_mul_f32 v48, v48, v251
    v_mul_f32 v49, v49, v251
    v_mul_f32 v50, v50, v251
    v_mul_f32 v51, v51, v251
    v_mul_f32 v52, v52, v251
    v_mul_f32 v53, v53, v251
    v_mul_f32 v54, v54, v251
    v_mul_f32 v55, v55, v251
    v_mul_f32 v56, v56, v251
    v_mul_f32 v57, v57, v251
    v_mul_f32 v58, v58, v251
    v_mul_f32 v59, v59, v251
    v_mul_f32 v60, v60, v251
    v_mul_f32 v61, v61, v251
    v_mul_f32 v62, v62, v251
    v_mul_f32 v63, v63, v251
    v_exp_f32 v144, v144
    v_exp_f32 v145, v145
    v_exp_f32 v146, v146
    v_add_f32 v236, v236, v144
    v_add_f32 v249, v249, v145
    v_cvt_pk_bf16_f32 v144, v144, v145
    v_exp_f32 v147, v147
    v_exp_f32 v148, v148
    v_add_f32 v236, v236, v146
    v_add_f32 v249, v249, v147
    v_cvt_pk_bf16_f32 v145, v146, v147
    v_exp_f32 v149, v149
    v_exp_f32 v150, v150
    v_add_f32 v236, v236, v148
    v_add_f32 v249, v249, v149
    v_cvt_pk_bf16_f32 v146, v148, v149
    v_exp_f32 v151, v151
    v_exp_f32 v152, v152
    v_add_f32 v236, v236, v150
    v_add_f32 v249, v249, v151
    v_cvt_pk_bf16_f32 v147, v150, v151
    v_exp_f32 v153, v153
    s_branch REJ_AY_loop0
RARE_AY_loop1:
    s_waitcnt lgkmcnt(8)
    v_mfma_f32_16x16x32_bf16 v[192:195], v[228:231], v[140:143], v[192:195]
    ds_read_b64_tr_b16 v[220:221], v242 offset:4096
    ds_read_b64_tr_b16 v[222:223], v242 offset:6144
    v_mfma_f32_16x16x32_bf16 v[196:199], v[232:235], v[140:143], v[196:199]
    ds_read_b64_tr_b16 v[224:225], v243 offset:4096
    ds_read_b64_tr_b16 v[226:227], v243 offset:6144
    s_waitcnt lgkmcnt(8)
    v_mfma_f32_32x32x16_bf16 v[0:15], v[204:207], v[144:147], v[0:15]
    ds_read_b64_tr_b16 v[228:229], v242 offset:4608
    ds_read_b64_tr_b16 v[230:231], v242 offset:6656
    v_mfma_f32_32x32x16_bf16 v[16:31], v[208:211], v[144:147], v[16:31]
    ds_read_b64_tr_b16 v[232:233], v243 offset:4608
    ds_read_b64_tr_b16 v[234:235], v243 offset:6656
    s_waitcnt lgkmcnt(8)
    v_mfma_f32_32x32x16_bf16 v[32:47], v[212:215], v[144:147], v[32:47]
    v_add_u32 v238, s45, v238
    v_add_u32 v239, s45, v239
    v_add_u32 v240, s45, v240
    v_add_u32 v241, s45, v241
    v_add_u32 v242, s45, v242
    v_add_u32 v243, s45, v243
    v_add_u32 v246, s42, v245
    v_xor_b32 v247, 64, v246
    s_waitcnt lgkmcnt(0)
    s_barrier
    ds_read_b128 v[204:207], v238 offset:0
    v_mfma_f32_32x32x16_bf16 v[48:63], v[216:219], v[144:147], v[48:63]
    ds_read_b128 v[208:211], v239 offset:0
    v_mfma_f32_32x32x16_bf16 v[0:15], v[220:223], v[152:155], v[0:15]
    ds_read_b128 v[212:215], v240 offset:0
    v_mfma_f32_32x32x16_bf16 v[16:31], v[224:227], v[152:155], v[16:31]
    ds_read_b128 v[216:219], v241 offset:0
    v_mfma_f32_32x32x16_bf16 v[32:47], v[228:231], v[152:155], v[32:47]
    ds_read_b128 v[220:223], v238 offset:512
    v_mfma_f32_32x32x16_bf16 v[48:63], v[232:235], v[152:155], v[48:63]
    v_mov_b32 v251, v250
    v_mov_b32 v252, v250
    s_nop 1
    v_permlane32_swap_b32 v251, v252
    v_max_f32 v250, v251, v252
    v_max_f32 v250, 0, v250
    v_exp_f32 v251, -v250
    v_sub_f32 v160, v160, v250
    v_sub_f32 v161, v161, v250
    v_sub_f32 v162, v162, v250
    v_sub_f32 v163, v163, v250
    v_sub_f32 v164, v164, v250
    v_sub_f32 v165, v165, v250
    v_sub_f32 v166, v166, v250
    v_sub_f32 v167, v167, v250
    v_sub_f32 v168, v168, v250
    v_sub_f32 v169, v169, v250
    v_sub_f32 v170, v170, v250
    v_sub_f32 v171, v171, v250
    v_sub_f32 v172, v172, v250
    v_sub_f32 v173, v173, v250
    v_sub_f32 v174, v174, v250
    v_sub_f32 v175, v175, v250
    v_sub_f32 v176, v176, v250
    v_sub_f32 v177, v177, v250
    v_sub_f32 v178, v178, v250
    v_sub_f32 v179, v179, v250
    v_sub_f32 v180, v180, v250
    v_sub_f32 v181, v181, v250
    v_sub_f32 v182, v182, v250
    v_sub_f32 v183, v183, v250
    v_sub_f32 v184, v184, v250
    v_sub_f32 v185, v185, v250
    v_sub_f32 v186, v186, v250
    v_sub_f32 v187, v187, v250
    v_sub_f32 v188, v188, v250
    v_sub_f32 v189, v189, v250
    v_sub_f32 v190, v190, v250
    v_sub_f32 v191, v191, v250
    v_mul_f32 v236, v236, v251
    v_mul_f32 v249, v249, v251
    v_mul_f32 v0, v0, v251
    v_mul_f32 v1, v1, v251
    v_mul_f32 v2, v2, v251
    v_mul_f32 v3, v3, v251
    v_mul_f32 v4, v4, v251
    v_mul_f32 v5, v5, v251
    v_mul_f32 v6, v6, v251
    v_mul_f32 v7, v7, v251
    v_mul_f32 v8, v8, v251
    v_mul_f32 v9, v9, v251
    v_mul_f32 v10, v10, v251
    v_mul_f32 v11, v11, v251
    v_mul_f32 v12, v12, v251
    v_mul_f32 v13, v13, v251
    v_mul_f32 v14, v14, v251
    v_mul_f32 v15, v15, v251
    v_mul_f32 v16, v16, v251
    v_mul_f32 v17, v17, v251
    v_mul_f32 v18, v18, v251
    v_mul_f32 v19, v19, v251
    v_mul_f32 v20, v20, v251
    v_mul_f32 v21, v21, v251
    v_mul_f32 v22, v22, v251
    v_mul_f32 v23, v23, v251
    v_mul_f32 v24, v24, v251
    v_mul_f32 v25, v25, v251
    v_mul_f32 v26, v26, v251
    v_mul_f32 v27, v27, v251
    v_mul_f32 v28, v28, v251
    v_mul_f32 v29, v29, v251
    v_mul_f32 v30, v30, v251
    v_mul_f32 v31, v31, v251
    v_mul_f32 v32, v32, v251
    v_mul_f32 v33, v33, v251
    v_mul_f32 v34, v34, v251
    v_mul_f32 v35, v35, v251
    v_mul_f32 v36, v36, v251
    v_mul_f32 v37, v37, v251
    v_mul_f32 v38, v38, v251
    v_mul_f32 v39, v39, v251
    v_mul_f32 v40, v40, v251
    v_mul_f32 v41, v41, v251
    v_mul_f32 v42, v42, v251
    v_mul_f32 v43, v43, v251
    v_mul_f32 v44, v44, v251
    v_mul_f32 v45, v45, v251
    v_mul_f32 v46, v46, v251
    v_mul_f32 v47, v47, v251
    v_mul_f32 v48, v48, v251
    v_mul_f32 v49, v49, v251
    v_mul_f32 v50, v50, v251
    v_mul_f32 v51, v51, v251
    v_mul_f32 v52, v52, v251
    v_mul_f32 v53, v53, v251
    v_mul_f32 v54, v54, v251
    v_mul_f32 v55, v55, v251
    v_mul_f32 v56, v56, v251
    v_mul_f32 v57, v57, v251
    v_mul_f32 v58, v58, v251
    v_mul_f32 v59, v59, v251
    v_mul_f32 v60, v60, v251
    v_mul_f32 v61, v61, v251
    v_mul_f32 v62, v62, v251
    v_mul_f32 v63, v63, v251
    v_exp_f32 v160, v160
    v_exp_f32 v161, v161
    v_exp_f32 v162, v162
    v_add_f32 v236, v236, v160
    v_add_f32 v249, v249, v161
    v_cvt_pk_bf16_f32 v160, v160, v161
    v_exp_f32 v163, v163
    v_exp_f32 v164, v164
    v_add_f32 v236, v236, v162
    v_add_f32 v249, v249, v163
    v_cvt_pk_bf16_f32 v161, v162, v163
    v_exp_f32 v165, v165
    v_exp_f32 v166, v166
    v_add_f32 v236, v236, v164
    v_add_f32 v249, v249, v165
    v_cvt_pk_bf16_f32 v162, v164, v165
    v_exp_f32 v167, v167
    v_exp_f32 v168, v168
    v_add_f32 v236, v236, v166
    v_add_f32 v249, v249, v167
    v_cvt_pk_bf16_f32 v163, v166, v167
    v_exp_f32 v169, v169
    v_exp_f32 v170, v170
    v_add_f32 v236, v236, v168
    v_add_f32 v249, v249, v169
    v_cvt_pk_bf16_f32 v168, v168, v169
    v_exp_f32 v171, v171
    v_exp_f32 v172, v172
    v_add_f32 v236, v236, v170
    v_add_f32 v249, v249, v171
    v_cvt_pk_bf16_f32 v169, v170, v171
    v_exp_f32 v173, v173
    s_branch REJ_AY_loop1
RRARE_AY_loop:
    ds_swizzle_b32 v251, v253 offset:0x401F
    s_waitcnt lgkmcnt(0)
    v_max_f32 v253, v253, v251
    v_mov_b32 v251, v253
    v_mov_b32 v252, v253
    s_nop 1
    v_permlane32_swap_b32 v251, v252
    v_max_f32 v253, v251, v252
    v_max_f32 v253, 0, v253
    v_exp_f32 v251, -v253
    v_sub_f32 v192, v192, v253
    v_sub_f32 v193, v193, v253
    v_sub_f32 v194, v194, v253
    v_sub_f32 v195, v195, v253
    v_sub_f32 v196, v196, v253
    v_sub_f32 v197, v197, v253
    v_sub_f32 v198, v198, v253
    v_sub_f32 v199, v199, v253
    v_sub_f32 v200, v200, v253
    v_sub_f32 v201, v201, v253
    v_sub_f32 v202, v202, v253
    v_sub_f32 v203, v203, v253
    v_mul_f32 v237, v237, v251
    v_mul_f32 v64, v64, v251
    v_mul_f32 v65, v65, v251
    v_mul_f32 v66, v66, v251
    v_mul_f32 v67, v67, v251
    v_mul_f32 v68, v68, v251
    v_mul_f32 v69, v69, v251
    v_mul_f32 v70, v70, v251
    v_mul_f32 v71, v71, v251
    v_mul_f32 v72, v72, v251
    v_mul_f32 v73, v73, v251
    v_mul_f32 v74, v74, v251
    v_mul_f32 v75, v75, v251
    v_mul_f32 v76, v76, v251
    v_mul_f32 v77, v77, v251
    v_mul_f32 v78, v78, v251
    v_mul_f32 v79, v79, v251
    v_mul_f32 v80, v80, v251
    v_mul_f32 v81, v81, v251
    v_mul_f32 v82, v82, v251
    v_mul_f32 v83, v83, v251
    v_mul_f32 v84, v84, v251
    v_mul_f32 v85, v85, v251
    v_mul_f32 v86, v86, v251
    v_mul_f32 v87, v87, v251
    v_mul_f32 v88, v88, v251
    v_mul_f32 v89, v89, v251
    v_mul_f32 v90, v90, v251
    v_mul_f32 v91, v91, v251
    v_mul_f32 v92, v92, v251
    v_mul_f32 v93, v93, v251
    v_mul_f32 v94, v94, v251
    v_mul_f32 v95, v95, v251
    s_branch RREJ_AY_loop
RARE_AY_last0:
    s_waitcnt lgkmcnt(8)
    v_mfma_f32_16x16x32_bf16 v[88:91], v[228:231], v[192:195], v[88:91]
    ds_read_b64_tr_b16 v[220:221], v242 offset:4096
    ds_read_b64_tr_b16 v[222:223], v242 offset:6144
    v_mfma_f32_16x16x32_bf16 v[92:95], v[232:235], v[192:195], v[92:95]
    ds_read_b64_tr_b16 v[224:225], v243 offset:4096
    ds_read_b64_tr_b16 v[226:227], v243 offset:6144
    s_waitcnt lgkmcnt(8)
    v_mfma_f32_32x32x16_bf16 v[0:15], v[204:207], v[160:163], v[0:15]
    ds_read_b64_tr_b16 v[228:229], v242 offset:4608
    ds_read_b64_tr_b16 v[230:231], v242 offset:6656
    v_mfma_f32_32x32x16_bf16 v[16:31], v[208:211], v[160:163], v[16:31]
    ds_read_b64_tr_b16 v[232:233], v243 offset:4608
    ds_read_b64_tr_b16 v[234:235], v243 offset:6656
    s_waitcnt lgkmcnt(8)
    v_mfma_f32_32x32x16_bf16 v[32:47], v[212:215], v[160:163], v[32:47]
    v_add_u32 v238, s45, v238
    v_add_u32 v239, s45, v239
    v_add_u32 v240, s45, v240
    v_add_u32 v241, s45, v241
    v_add_u32 v242, s45, v242
    v_add_u32 v243, s45, v243
    v_add_u32 v246, s42, v244
    v_xor_b32 v247, 64, v246
    s_waitcnt lgkmcnt(0)
    s_barrier
    ds_read_b128 v[204:207], v238 offset:0
    v_mfma_f32_32x32x16_bf16 v[48:63], v[216:219], v[160:163], v[48:63]
    ds_read_b128 v[208:211], v239 offset:0
    v_mfma_f32_32x32x16_bf16 v[0:15], v[220:223], v[168:171], v[0:15]
    ds_read_b128 v[212:215], v240 offset:0
    v_mfma_f32_32x32x16_bf16 v[16:31], v[224:227], v[168:171], v[16:31]
    ds_read_b128 v[216:219], v241 offset:0
    v_mfma_f32_32x32x16_bf16 v[32:47], v[228:231], v[168:171], v[32:47]
    ds_read_b128 v[220:223], v238 offset:512
    v_mfma_f32_32x32x16_bf16 v[48:63], v[232:235], v[168:171], v[48:63]
    v_mov_b32 v251, v250
    v_mov_b32 v252, v250
    s_nop 1
    v_permlane32_swap_b32 v251, v252
    v_max_f32 v250, v251, v252
    v_max_f32 v250, 0, v250
    v_exp_f32 v251, -v250
    v_sub_f32 v144, v144, v250
    v_sub_f32 v145, v145, v250
    v_sub_f32 v146, v146, v250
    v_sub_f32 v147, v147, v250
    v_sub_f32 v148, v148, v250
    v_sub_f32 v149, v149, v250
    v_sub_f32 v150, v150, v250
    v_sub_f32 v151, v151, v250
    v_sub_f32 v152, v152, v250
    v_sub_f32 v153, v153, v250
    v_sub_f32 v154, v154, v250
    v_sub_f32 v155, v155, v250
    v_sub_f32 v156, v156, v250
    v_sub_f32 v157, v157, v250
    v_sub_f32 v158, v158, v250
    v_sub_f32 v159, v159, v250
    v_sub_f32 v176, v176, v250
    v_sub_f32 v177, v177, v250
    v_sub_f32 v178, v178, v250
    v_sub_f32 v179, v179, v250
    v_sub_f32 v180, v180, v250
    v_sub_f32 v181, v181, v250
    v_sub_f32 v182, v182, v250
    v_sub_f32 v183, v183, v250
    v_sub_f32 v184, v184, v250
    v_sub_f32 v185, v185, v250
    v_sub_f32 v186, v186, v250
    v_sub_f32 v187, v187, v250
    v_sub_f32 v188, v188, v250
    v_sub_f32 v189, v189, v250
    v_sub_f32 v190, v190, v250
    v_sub_f32 v191, v191, v250
    v_mul_f32 v236, v236, v251
    v_mul_f32 v249, v249, v251
    v_mul_f32 v0, v0, v251
    v_mul_f32 v1, v1, v251
    v_mul_f32 v2, v2, v251
    v_mul_f32 v3, v3, v251
    v_mul_f32 v4, v4, v251
    v_mul_f32 v5, v5, v251
    v_mul_f32 v6, v6, v251
    v_mul_f32 v7, v7, v251
    v_mul_f32 v8, v8, v251
    v_mul_f32 v9, v9, v251
    v_mul_f32 v10, v10, v251
    v_mul_f32 v11, v11, v251
    v_mul_f32 v12, v12, v251
    v_mul_f32 v13, v13, v251
    v_mul_f32 v14, v14, v251
    v_mul_f32 v15, v15, v251
    v_mul_f32 v16, v16, v251
    v_mul_f32 v17, v17, v251
    v_mul_f32 v18, v18, v251
    v_mul_f32 v19, v19, v251
    v_mul_f32 v20, v20, v251
    v_mul_f32 v21, v21, v251
    v_mul_f32 v22, v22, v251
    v_mul_f32 v23, v23, v251
    v_mul_f32 v24, v24, v251
    v_mul_f32 v25, v25, v251
    v_mul_f32 v26, v26, v251
    v_mul_f32 v27, v27, v251
    v_mul_f32 v28, v28, v251
    v_mul_f32 v29, v29, v251
    v_mul_f32 v30, v30, v251
    v_mul_f32 v31, v31, v251
    v_mul_f32 v32, v32, v251
    v_mul_f32 v33, v33, v251
    v_mul_f32 v34, v34, v251
    v_mul_f32 v35, v35, v251
    v_mul_f32 v36, v36, v251
    v_mul_f32 v37, v37, v251
    v_mul_f32 v38, v38, v251
    v_mul_f32 v39, v39, v251
    v_mul_f32 v40, v40, v251
    v_mul_f32 v41, v41, v251
    v_mul_f32 v42, v42, v251
    v_mul_f32 v43, v43, v251
    v_mul_f32 v44, v44, v251
    v_mul_f32 v45, v45, v251
    v_mul_f32 v46, v46, v251
    v_mul_f32 v47, v47, v251
    v_mul_f32 v48, v48, v251
    v_mul_f32 v49, v49, v251
    v_mul_f32 v50, v50, v251
    v_mul_f32 v51, v51, v251
    v_mul_f32 v52, v52, v251
    v_mul_f32 v53, v53, v251
    v_mul_f32 v54, v54, v251
    v_mul_f32 v55, v55, v251
    v_mul_f32 v56, v56, v251
    v_mul_f32 v57, v57, v251
    v_mul_f32 v58, v58, v251
    v_mul_f32 v59, v59, v251
    v_mul_f32 v60, v60, v251
    v_mul_f32 v61, v61, v251
    v_mul_f32 v62, v62, v251
    v_mul_f32 v63, v63, v251
    v_exp_f32 v144, v144
    v_exp_f32 v145, v145
    v_exp_f32 v146, v146
    v_add_f32 v236, v236, v144
    v_add_f32 v249, v249, v145
    v_cvt_pk_bf16_f32 v144, v144, v145
    v_exp_f32 v147, v147
    v_exp_f32 v148, v148
    v_add_f32 v236, v236, v146
    v_add_f32 v249, v249, v147
    v_cvt_pk_bf16_f32 v145, v146, v147
    v_exp_f32 v149, v149
    v_exp_f32 v150, v150
    v_add_f32 v236, v236, v148
    v_add_f32 v249, v249, v149
    v_cvt_pk_bf16_f32 v146, v148, v149
    v_exp_f32 v151, v151
    v_exp_f32 v152, v152
    v_add_f32 v236, v236, v150
    v_add_f32 v249, v249, v151
    v_cvt_pk_bf16_f32 v147, v150, v151
    v_exp_f32 v153, v153
    s_branch REJ_AY_last0
RARE_AY_last1:
    s_waitcnt lgkmcnt(6)
    v_mfma_f32_16x16x32_bf16 v[192:195], v[220:223], v[136:139], v[192:195]
    ds_read_b64_tr_b16 v[212:213], v242 offset:512
    ds_read_b64_tr_b16 v[214:215], v242 offset:2560
    v_mfma_f32_16x16x32_bf16 v[196:199], v[224:227], v[136:139], v[196:199]
    ds_read_b64_tr_b16 v[216:217], v243 offset:512
    ds_read_b64_tr_b16 v[218:219], v243 offset:2560
    s_waitcnt lgkmcnt(8)
    v_mfma_f32_16x16x32_bf16 v[192:195], v[228:231], v[140:143], v[192:195]
    ds_read_b64_tr_b16 v[220:221], v242 offset:4096
    ds_read_b64_tr_b16 v[222:223], v242 offset:6144
    v_mfma_f32_16x16x32_bf16 v[196:199], v[232:235], v[140:143], v[196:199]
    ds_read_b64_tr_b16 v[224:225], v243 offset:4096
    ds_read_b64_tr_b16 v[226:227], v243 offset:6144
    s_waitcnt lgkmcnt(8)
    v_mfma_f32_32x32x16_bf16 v[0:15], v[204:207], v[144:147], v[0:15]
    ds_read_b64_tr_b16 v[228:229], v242 offset:4608
    ds_read_b64_tr_b16 v[230:231], v242 offset:6656
    v_mfma_f32_32x32x16_bf16 v[16:31], v[208:211], v[144:147], v[16:31]
    ds_read_b64_tr_b16 v[232:233], v243 offset:4608
    ds_read_b64_tr_b16 v[234:235], v243 offset:6656
    s_waitcnt lgkmcnt(8)
    v_mfma_f32_32x32x16_bf16 v[32:47], v[212:215], v[144:147], v[32:47]
    v_add_u32 v238, s45, v238
    v_add_u32 v239, s45, v239
    v_add_u32 v240, s45, v240
    v_add_u32 v241, s45, v241
    v_add_u32 v242, s45, v242
    v_add_u32 v243, s45, v243
    v_add_u32 v246, s42, v245
    v_xor_b32 v247, 64, v246
    s_waitcnt lgkmcnt(0)
    s_barrier
    v_mfma_f32_32x32x16_bf16 v[48:63], v[216:219], v[144:147], v[48:63]
    v_mfma_f32_32x32x16_bf16 v[0:15], v[220:223], v[152:155], v[0:15]
    v_mfma_f32_32x32x16_bf16 v[16:31], v[224:227], v[152:155], v[16:31]
    v_mfma_f32_32x32x16_bf16 v[32:47], v[228:231], v[152:155], v[32:47]
    v_mfma_f32_32x32x16_bf16 v[48:63], v[232:235], v[152:155], v[48:63]
    v_mov_b32 v251, v250
    v_mov_b32 v252, v250
    s_nop 1
    v_permlane32_swap_b32 v251, v252
    v_max_f32 v250, v251, v252
    v_max_f32 v250, 0, v250
    v_exp_f32 v251, -v250
    v_sub_f32 v160, v160, v250
    v_sub_f32 v161, v161, v250
    v_sub_f32 v162, v162, v250
    v_sub_f32 v163, v163, v250
    v_sub_f32 v164, v164, v250
    v_sub_f32 v165, v165, v250
    v_sub_f32 v166, v166, v250
    v_sub_f32 v167, v167, v250
    v_sub_f32 v168, v168, v250
    v_sub_f32 v169, v169, v250
    v_sub_f32 v170, v170, v250
    v_sub_f32 v171, v171, v250
    v_sub_f32 v172, v172, v250
    v_sub_f32 v173, v173, v250
    v_sub_f32 v174, v174, v250
    v_sub_f32 v175, v175, v250
    v_sub_f32 v176, v176, v250
    v_sub_f32 v177, v177, v250
    v_sub_f32 v178, v178, v250
    v_sub_f32 v179, v179, v250
    v_sub_f32 v180, v180, v250
    v_sub_f32 v181, v181, v250
    v_sub_f32 v182, v182, v250
    v_sub_f32 v183, v183, v250
    v_sub_f32 v184, v184, v250
    v_sub_f32 v185, v185, v250
    v_sub_f32 v186, v186, v250
    v_sub_f32 v187, v187, v250
    v_sub_f32 v188, v188, v250
    v_sub_f32 v189, v189, v250
    v_sub_f32 v190, v190, v250
    v_sub_f32 v191, v191, v250
    v_mul_f32 v236, v236, v251
    v_mul_f32 v249, v249, v251
    v_mul_f32 v0, v0, v251
    v_mul_f32 v1, v1, v251
    v_mul_f32 v2, v2, v251
    v_mul_f32 v3, v3, v251
    v_mul_f32 v4, v4, v251
    v_mul_f32 v5, v5, v251
    v_mul_f32 v6, v6, v251
    v_mul_f32 v7, v7, v251
    v_mul_f32 v8, v8, v251
    v_mul_f32 v9, v9, v251
    v_mul_f32 v10, v10, v251
    v_mul_f32 v11, v11, v251
    v_mul_f32 v12, v12, v251
    v_mul_f32 v13, v13, v251
    v_mul_f32 v14, v14, v251
    v_mul_f32 v15, v15, v251
    v_mul_f32 v16, v16, v251
    v_mul_f32 v17, v17, v251
    v_mul_f32 v18, v18, v251
    v_mul_f32 v19, v19, v251
    v_mul_f32 v20, v20, v251
    v_mul_f32 v21, v21, v251
    v_mul_f32 v22, v22, v251
    v_mul_f32 v23, v23, v251
    v_mul_f32 v24, v24, v251
    v_mul_f32 v25, v25, v251
    v_mul_f32 v26, v26, v251
    v_mul_f32 v27, v27, v251
    v_mul_f32 v28, v28, v251
    v_mul_f32 v29, v29, v251
    v_mul_f32 v30, v30, v251
    v_mul_f32 v31, v31, v251
    v_mul_f32 v32, v32, v251
    v_mul_f32 v33, v33, v251
    v_mul_f32 v34, v34, v251
    v_mul_f32 v35, v35, v251
    v_mul_f32 v36, v36, v251
    v_mul_f32 v37, v37, v251
    v_mul_f32 v38, v38, v251
    v_mul_f32 v39, v39, v251
    v_mul_f32 v40, v40, v251
    v_mul_f32 v41, v41, v251
    v_mul_f32 v42, v42, v251
    v_mul_f32 v43, v43, v251
    v_mul_f32 v44, v44, v251
    v_mul_f32 v45, v45, v251
    v_mul_f32 v46, v46, v251
    v_mul_f32 v47, v47, v251
    v_mul_f32 v48, v48, v251
    v_mul_f32 v49, v49, v251
    v_mul_f32 v50, v50, v251
    v_mul_f32 v51, v51, v251
    v_mul_f32 v52, v52, v251
    v_mul_f32 v53, v53, v251
    v_mul_f32 v54, v54, v251
    v_mul_f32 v55, v55, v251
    v_mul_f32 v56, v56, v251
    v_mul_f32 v57, v57, v251
    v_mul_f32 v58, v58, v251
    v_mul_f32 v59, v59, v251
    v_mul_f32 v60, v60, v251
    v_mul_f32 v61, v61, v251
    v_mul_f32 v62, v62, v251
    v_mul_f32 v63, v63, v251
    v_exp_f32 v160, v160
    v_exp_f32 v161, v161
    v_exp_f32 v162, v162
    v_add_f32 v236, v236, v160
    v_add_f32 v249, v249, v161
    v_cvt_pk_bf16_f32 v160, v160, v161
    v_exp_f32 v163, v163
    v_exp_f32 v164, v164
    v_add_f32 v236, v236, v162
    v_add_f32 v249, v249, v163
    v_cvt_pk_bf16_f32 v161, v162, v163
    v_exp_f32 v165, v165
    v_exp_f32 v166, v166
    v_add_f32 v236, v236, v164
    v_add_f32 v249, v249, v165
    v_cvt_pk_bf16_f32 v162, v164, v165
    v_exp_f32 v167, v167
    v_exp_f32 v168, v168
    v_add_f32 v236, v236, v166
    v_add_f32 v249, v249, v167
    v_cvt_pk_bf16_f32 v163, v166, v167
    v_exp_f32 v169, v169
    v_exp_f32 v170, v170
    v_add_f32 v236, v236, v168
    v_add_f32 v249, v249, v169
    v_cvt_pk_bf16_f32 v168, v168, v169
    v_exp_f32 v171, v171
    v_exp_f32 v172, v172
    v_add_f32 v236, v236, v170
    v_add_f32 v249, v249, v171
    v_cvt_pk_bf16_f32 v169, v170, v171
    v_exp_f32 v173, v173
    v_exp_f32 v174, v174
    v_add_f32 v236, v236, v172
    v_add_f32 v249, v249, v173
    v_cvt_pk_bf16_f32 v170, v172, v173
    v_exp_f32 v175, v175
    v_add_f32 v236, v236, v174
    v_add_f32 v249, v249, v175
    v_cvt_pk_bf16_f32 v171, v174, v175
    s_branch REJ_AY_last1
RRARE_AY_last:
    ds_swizzle_b32 v251, v253 offset:0x401F
    s_waitcnt lgkmcnt(0)
    v_max_f32 v253, v253, v251
    v_mov_b32 v251, v253
    v_mov_b32 v252, v253
    s_nop 1
    v_permlane32_swap_b32 v251, v252
    v_max_f32 v253, v251, v252
    v_max_f32 v253, 0, v253
    v_exp_f32 v251, -v253
    v_sub_f32 v192, v192, v253
    v_sub_f32 v193, v193, v253
    v_sub_f32 v194, v194, v253
    v_sub_f32 v195, v195, v253
    v_sub_f32 v196, v196, v253
    v_sub_f32 v197, v197, v253
    v_sub_f32 v198, v198, v253
    v_sub_f32 v199, v199, v253
    v_sub_f32 v200, v200, v253
    v_sub_f32 v201, v201, v253
    v_sub_f32 v202, v202, v253
    v_sub_f32 v203, v203, v253
    v_mul_f32 v237, v237, v251
    v_mul_f32 v64, v64, v251
    v_mul_f32 v65, v65, v251
    v_mul_f32 v66, v66, v251
    v_mul_f32 v67, v67, v251
    v_mul_f32 v68, v68, v251
    v_mul_f32 v69, v69, v251
    v_mul_f32 v70, v70, v251
    v_mul_f32 v71, v71, v251
    v_mul_f32 v72, v72, v251
    v_mul_f32 v73, v73, v251
    v_mul_f32 v74, v74, v251
    v_mul_f32 v75, v75, v251
    v_mul_f32 v76, v76, v251
    v_mul_f32 v77, v77, v251
    v_mul_f32 v78, v78, v251
    v_mul_f32 v79, v79, v251
    v_mul_f32 v80, v80, v251
    v_mul_f32 v81, v81, v251
    v_mul_f32 v82, v82, v251
    v_mul_f32 v83, v83, v251
    v_mul_f32 v84, v84, v251
    v_mul_f32 v85, v85, v251
    v_mul_f32 v86, v86, v251
    v_mul_f32 v87, v87, v251
    v_mul_f32 v88, v88, v251
    v_mul_f32 v89, v89, v251
    v_mul_f32 v90, v90, v251
    v_mul_f32 v91, v91, v251
    v_mul_f32 v92, v92, v251
    v_mul_f32 v93, v93, v251
    v_mul_f32 v94, v94, v251
    v_mul_f32 v95, v95, v251
    s_branch RREJ_AY_last
FILL_B:
    s_cmp_lt_u32 s50, 4
    s_cbranch_scc1 NOFILL_B
    s_add_u32 s46, s63, 0x4000
    s_and_b32 s46, s46, 0x3ffff
    s_mov_b32 s44, 0x8000
    s_add_u32 s53, s44, 0x14000
    s_add_u32 m0, s53, s59
    s_add_u32 s53, s46, 0x1000
    buffer_load_dwordx4 v249, s[16:19], s46 offen nt lds
    buffer_load_dwordx4 v249, s[16:19], s46 offen offset:2048 nt lds
    s_add_u32 m0, m0, 0x1000
    s_nop 0
    buffer_load_dwordx4 v249, s[16:19], s53 offen nt lds
    buffer_load_dwordx4 v249, s[16:19], s53 offen offset:2048 nt lds
    s_add_u32 s48, s63, 0x8000
    s_and_b32 s48, s48, 0x3ffff
    s_mov_b32 s44, 0x10000
    s_add_u32 m0, s44, s59
    s_add_u32 s52, s48, 0x1000
    buffer_load_dwordx4 v248, s[12:15], s48 offen nt lds
    buffer_load_dwordx4 v72, s[12:15], s48 offen offset:2048 nt lds
    s_add_u32 m0, m0, 0x1000
    s_nop 0
    buffer_load_dwordx4 v248, s[12:15], s52 offen nt lds
    buffer_load_dwordx4 v72, s[12:15], s52 offen offset:2048 nt lds
NOFILL_B:
    s_nop 0
    v_pk_mul_f32 v[0:1], v[0:1], s[56:57]
    v_pk_mul_f32 v[2:3], v[2:3], s[56:57]
    v_pk_mul_f32 v[4:5], v[4:5], s[56:57]
    v_pk_mul_f32 v[6:7], v[6:7], s[56:57]
    v_pk_mul_f32 v[8:9], v[8:9], s[56:57]
    v_pk_mul_f32 v[10:11], v[10:11], s[56:57]
    v_pk_mul_f32 v[12:13], v[12:13], s[56:57]
    v_pk_mul_f32 v[14:15], v[14:15], s[56:57]
    v_pk_mul_f32 v[16:17], v[16:17], s[56:57]
    v_pk_mul_f32 v[18:19], v[18:19], s[56:57]
    v_pk_mul_f32 v[20:21], v[20:21], s[56:57]
    v_pk_mul_f32 v[22:23], v[22:23], s[56:57]
    v_pk_mul_f32 v[24:25], v[24:25], s[56:57]
    v_pk_mul_f32 v[26:27], v[26:27], s[56:57]
    v_pk_mul_f32 v[28:29], v[28:29], s[56:57]
    v_pk_mul_f32 v[30:31], v[30:31], s[56:57]
    v_pk_mul_f32 v[32:33], v[32:33], s[56:57]
    v_pk_mul_f32 v[34:35], v[34:35], s[56:57]
    v_pk_mul_f32 v[36:37], v[36:37], s[56:57]
    v_pk_mul_f32 v[38:39], v[38:39], s[56:57]
    v_pk_mul_f32 v[40:41], v[40:41], s[56:57]
    v_pk_mul_f32 v[42:43], v[42:43], s[56:57]
    v_pk_mul_f32 v[44:45], v[44:45], s[56:57]
    v_pk_mul_f32 v[46:47], v[46:47], s[56:57]
    v_pk_mul_f32 v[48:49], v[48:49], s[56:57]
    v_pk_mul_f32 v[50:51], v[50:51], s[56:57]
    v_pk_mul_f32 v[52:53], v[52:53], s[56:57]
    v_pk_mul_f32 v[54:55], v[54:55], s[56:57]
    v_pk_mul_f32 v[56:57], v[56:57], s[56:57]
    v_pk_mul_f32 v[58:59], v[58:59], s[56:57]
    v_pk_mul_f32 v[60:61], v[60:61], s[56:57]
    v_pk_mul_f32 v[62:63], v[62:63], s[56:57]
    v_pk_mul_f32 v[64:65], v[64:65], s[56:57]
    v_pk_mul_f32 v[66:67], v[66:67], s[56:57]
    v_pk_mul_f32 v[68:69], v[68:69], s[56:57]
    v_pk_mul_f32 v[70:71], v[70:71], s[56:57]
    v_cvt_pk_bf16_f32 v96, v0, v1
    v_cvt_pk_bf16_f32 v97, v2, v3
    v_cvt_pk_bf16_f32 v98, v4, v5
    v_cvt_pk_bf16_f32 v99, v6, v7
    v_cvt_pk_bf16_f32 v100, v8, v9
    v_cvt_pk_bf16_f32 v101, v10, v11
    v_cvt_pk_bf16_f32 v102, v12, v13
    v_cvt_pk_bf16_f32 v103, v14, v15
    v_cvt_pk_bf16_f32 v104, v16, v17
    v_cvt_pk_bf16_f32 v105, v18, v19
    v_cvt_pk_bf16_f32 v106, v20, v21
    v_cvt_pk_bf16_f32 v107, v22, v23
    v_cvt_pk_bf16_f32 v108, v24, v25
    v_cvt_pk_bf16_f32 v109, v26, v27
    v_cvt_pk_bf16_f32 v110, v28, v29
    v_cvt_pk_bf16_f32 v111, v30, v31
    v_cvt_pk_bf16_f32 v112, v32, v33
    v_cvt_pk_bf16_f32 v113, v34, v35
    v_cvt_pk_bf16_f32 v114, v36, v37
    v_cvt_pk_bf16_f32 v115, v38, v39
    v_cvt_pk_bf16_f32 v116, v40, v41
    v_cvt_pk_bf16_f32 v117, v42, v43
    v_cvt_pk_bf16_f32 v118, v44, v45
    v_cvt_pk_bf16_f32 v119, v46, v47
    v_cvt_pk_bf16_f32 v120, v48, v49
    v_cvt_pk_bf16_f32 v121, v50, v51
    v_cvt_pk_bf16_f32 v122, v52, v53
    v_cvt_pk_bf16_f32 v123, v54, v55
    v_cvt_pk_bf16_f32 v124, v56, v57
    v_cvt_pk_bf16_f32 v125, v58, v59
    v_cvt_pk_bf16_f32 v126, v60, v61
    v_cvt_pk_bf16_f32 v127, v62, v63
    v_cvt_pk_bf16_f32 v128, v64, v65
    v_cvt_pk_bf16_f32 v129, v66, v67
    v_cvt_pk_bf16_f32 v130, v68, v69
    v_cvt_pk_bf16_f32 v131, v70, v71
    v_lshlrev_b32 v251, 4, v254
    s_lshl_b32 s51, s38, 10
    s_add_u32 s51, s51, s43
    v_add_u32 v251, s51, v251
    ds_write_b128 v251, v[128:131]
    s_waitcnt vmcnt(32) lgkmcnt(0)
    s_barrier
    s_add_u32 s51, s36, 2
    s_and_b32 s51, s51, 7
    s_cmp_ge_u32 s51, 4
    s_cbranch_scc1 ATT_BL
    s_bitcmp1_b32 s36, 0
    s_cbranch_scc1 ATT_BY
ATT_BX:
    s_setprio 1
    v_lshlrev_b32 v251, 4, v254
    v_add_u32 v251, s43, v251
    ds_read_b128 v[128:131], v251 offset:0
    ds_read_b128 v[132:135], v251 offset:1024
    ds_read_b128 v[136:139], v251 offset:2048
    ds_read_b128 v[140:143], v251 offset:3072
    ds_read_b128 v[204:207], v238 offset:0
    ds_read_b128 v[208:211], v239 offset:0
    ds_read_b128 v[212:215], v240 offset:0
    ds_read_b128 v[216:219], v241 offset:0
    ds_read_b128 v[220:223], v238 offset:512
    ds_read_b128 v[224:227], v239 offset:512
    ds_read_b128 v[228:231], v240 offset:512
    ds_read_b128 v[232:235], v241 offset:512
    s_waitcnt lgkmcnt(7)
    v_mfma_f32_32x32x16_bf16 v[144:159], v[204:207], v[96:99], 0
    s_waitcnt lgkmcnt(6)
    v_mfma_f32_32x32x16_bf16 v[144:159], v[208:211], v[100:103], v[144:159]
    s_waitcnt lgkmcnt(5)
    v_mfma_f32_32x32x16_bf16 v[144:159], v[212:215], v[104:107], v[144:159]
    s_waitcnt lgkmcnt(4)
    v_mfma_f32_32x32x16_bf16 v[144:159], v[216:219], v[108:111], v[144:159]
    s_waitcnt lgkmcnt(3)
    v_mfma_f32_32x32x16_bf16 v[144:159], v[220:223], v[112:115], v[144:159]
    s_waitcnt lgkmcnt(2)
    v_mfma_f32_32x32x16_bf16 v[144:159], v[224:227], v[116:119], v[144:159]
    s_waitcnt lgkmcnt(1)
    v_mfma_f32_32x32x16_bf16 v[144:159], v[228:231], v[120:123], v[144:159]
    s_waitcnt lgkmcnt(0)
    v_mfma_f32_32x32x16_bf16 v[144:159], v[232:235], v[124:127], v[144:159]
    v_mov_b32 v236, 0
    v_mov_b32 v249, 0
    v_mov_b32 v237, 0
    v_mov_b32 v64, 0
    v_mov_b32 v65, 0
    v_mov_b32 v66, 0
    v_mov_b32 v67, 0
    v_mov_b32 v68, 0
    v_mov_b32 v69, 0
    v_mov_b32 v70, 0
    v_mov_b32 v71, 0
    v_mov_b32 v72, 0
    v_mov_b32 v73, 0
    v_mov_b32 v74, 0
    v_mov_b32 v75, 0
    v_mov_b32 v76, 0
    v_mov_b32 v77, 0
    v_mov_b32 v78, 0
    v_mov_b32 v79, 0
    v_mov_b32 v80, 0
    v_mov_b32 v81, 0
    v_mov_b32 v82, 0
    v_mov_b32 v83, 0
    v_mov_b32 v84, 0
    v_mov_b32 v85, 0
    v_mov_b32 v86, 0
    v_mov_b32 v87, 0
    v_mov_b32 v88, 0
    v_mov_b32 v89, 0
    v_mov_b32 v90, 0
    v_mov_b32 v91, 0
    v_mov_b32 v92, 0
    v_mov_b32 v93, 0
    v_mov_b32 v94, 0
    v_mov_b32 v95, 0
    v_add_u32 v246, s42, v244
    v_xor_b32 v247, 64, v246
    s_waitcnt vmcnt(0)
    s_lshl_b32 s51, s37, 6
    s_add_u32 s51, s51, 0x24000
    s_lshl_b32 s52, s38, 2
    s_add_u32 s52, s52, s51
    s_mov_b32 s71, 0
    s_mov_b32 s47, 0xc000
    v_max3_f32 v250, v144, v145, v146
    v_max3_f32 v250, v250, v147, v148
    v_max3_f32 v250, v250, v149, v150
    v_max3_f32 v250, v250, v151, v152
    v_max3_f32 v250, v250, v153, v154
    v_max3_f32 v250, v250, v155, v156
    v_max3_f32 v250, v250, v157, v158
    v_max_f32 v250, v250, v159
    v_mov_b32 v251, v250
    v_mov_b32 v252, v250
    s_nop 1
    v_permlane32_swap_b32 v251, v252
    v_max_f32 v250, v251, v252
    v_sub_f32 v176, 0, v250
    v_sub_f32 v177, 0, v250
    v_sub_f32 v178, 0, v250
    v_sub_f32 v179, 0, v250
    v_sub_f32 v180, 0, v250
    v_sub_f32 v181, 0, v250
    v_sub_f32 v182, 0, v250
    v_sub_f32 v183, 0, v250
    v_sub_f32 v184, 0, v250
    v_sub_f32 v185, 0, v250
    v_sub_f32 v186, 0, v250
    v_sub_f32 v187, 0, v250
    v_sub_f32 v188, 0, v250
    v_sub_f32 v189, 0, v250
    v_sub_f32 v190, 0, v250
    v_sub_f32 v191, 0, v250
    v_sub_f32 v144, v144, v250
    v_sub_f32 v145, v145, v250
    v_sub_f32 v146, v146, v250
    v_sub_f32 v147, v147, v250
    v_sub_f32 v148, v148, v250
    v_sub_f32 v149, v149, v250
    v_sub_f32 v150, v150, v250
    v_sub_f32 v151, v151, v250
    v_sub_f32 v152, v152, v250
    v_sub_f32 v153, v153, v250
    v_sub_f32 v154, v154, v250
    v_sub_f32 v155, v155, v250
    v_sub_f32 v156, v156, v250
    v_sub_f32 v157, v157, v250
    v_sub_f32 v158, v158, v250
    v_sub_f32 v159, v159, v250
    s_mov_b32 s50, 14
    s_add_u32 s71, s71, 1
    ds_read_b128 v[204:207], v246 offset:0
    ds_read_b128 v[208:211], v246 offset:4096
    ds_read_b128 v[212:215], v247 offset:0
    ds_read_b128 v[216:219], v247 offset:4096
    ds_read_b128 v[220:223], v246 offset:512
    ds_read_b128 v[224:227], v246 offset:4608
    s_waitcnt lgkmcnt(4)
    v_mfma_f32_16x16x32_bf16 v[192:195], v[204:207], v[128:131], 0
    ds_read_b128 v[228:231], v247 offset:512
    s_mov_b32 s44, s42
    s_add_u32 s42, s42, 0x4000
    s_cmp_ge_u32 s42, 0x14000
    s_cselect_b32 s42, 0, s42
    s_sub_u32 s45, s42, s44
    s_mov_b32 s69, s47
    v_exp_f32 v144, v144
    v_exp_f32 v145, v145
    v_mfma_f32_16x16x32_bf16 v[196:199], v[208:211], v[128:131], 0
    ds_read_b128 v[232:235], v247 offset:4608
    s_add_u32 s47, s47, 0x4000
    s_cmp_ge_u32 s47, 0x10000
    s_cselect_b32 s47, 0, s47
    s_sub_u32 s70, s47, s69
    v_exp_f32 v146, v146
    v_add_f32 v236, v236, v144
    v_add_f32 v249, v249, v145
    s_waitcnt lgkmcnt(4)
    v_mfma_f32_16x16x32_bf16 v[192:195], v[212:215], v[132:135], v[192:195]
    v_cvt_pk_bf16_f32 v144, v144, v145
    v_exp_f32 v147, v147
    v_exp_f32 v148, v148
    v_mfma_f32_16x16x32_bf16 v[196:199], v[216:219], v[132:135], v[196:199]
    v_add_f32 v236, v236, v146
    v_add_f32 v249, v249, v147
    v_cvt_pk_bf16_f32 v145, v146, v147
    v_exp_f32 v149, v149
    s_waitcnt lgkmcnt(2)
    v_mfma_f32_16x16x32_bf16 v[192:195], v[220:223], v[136:139], v[192:195]
    v_exp_f32 v150, v150
    v_add_f32 v236, v236, v148
    v_add_f32 v249, v249, v149
    v_mfma_f32_16x16x32_bf16 v[196:199], v[224:227], v[136:139], v[196:199]
    v_cvt_pk_bf16_f32 v146, v148, v149
    v_exp_f32 v151, v151
    v_exp_f32 v152, v152
    s_waitcnt lgkmcnt(0)
    v_mfma_f32_16x16x32_bf16 v[192:195], v[228:231], v[140:143], v[192:195]
    v_add_f32 v236, v236, v150
    v_add_f32 v249, v249, v151
    v_cvt_pk_bf16_f32 v147, v150, v151
    v_exp_f32 v153, v153
    v_mfma_f32_16x16x32_bf16 v[196:199], v[232:235], v[140:143], v[196:199]
    v_exp_f32 v154, v154
    v_add_f32 v236, v236, v152
    v_add_u32 v238, s45, v238
    v_add_u32 v239, s45, v239
    v_add_u32 v240, s45, v240
    v_add_u32 v241, s45, v241
    v_add_u32 v242, s70, v242
    v_add_u32 v243, s70, v243
    v_add_u32 v246, s47, v245
    v_xor_b32 v247, 64, v246
    s_waitcnt lgkmcnt(0)
    s_barrier
    s_barrier
    ds_read_b128 v[204:207], v238 offset:0
    ds_read_b128 v[208:211], v239 offset:0
    ds_read_b128 v[212:215], v240 offset:0
    ds_read_b128 v[216:219], v241 offset:0
    ds_read_b128 v[220:223], v238 offset:512
    ds_read_b128 v[224:227], v239 offset:512
    s_waitcnt lgkmcnt(4)
    v_mfma_f32_32x32x16_bf16 v[160:175], v[204:207], v[96:99], v[176:191]
    ds_read_b128 v[228:231], v240 offset:512
    v_max3_f32 v253, v192, v193, v194
    v_max3_f32 v253, v253, v195, v196
    v_max3_f32 v253, v253, v197, v198
    v_max_f32 v253, v253, v199
    ds_swizzle_b32 v251, v253 offset:0x401F
    s_waitcnt lgkmcnt(0)
    v_max_f32 v253, v253, v251
    v_mov_b32 v251, v253
    v_mov_b32 v252, v253
    v_mfma_f32_32x32x16_bf16 v[160:175], v[208:211], v[100:103], v[160:175]
    ds_read_b128 v[232:235], v241 offset:512
    v_permlane32_swap_b32 v251, v252
    v_max_f32 v253, v251, v252
    v_sub_f32 v200, 0, v253
    v_sub_f32 v201, 0, v253
    v_sub_f32 v202, 0, v253
    v_sub_f32 v203, 0, v253
    v_sub_f32 v192, v192, v253
    v_sub_f32 v193, v193, v253
    v_sub_f32 v194, v194, v253
    v_mfma_f32_32x32x16_bf16 v[160:175], v[212:215], v[104:107], v[160:175]
    ds_read_b64_tr_b16 v[204:205], v246 offset:0
    ds_read_b64_tr_b16 v[206:207], v246 offset:4096
    v_sub_f32 v195, v195, v253
    v_sub_f32 v196, v196, v253
    v_sub_f32 v197, v197, v253
    v_sub_f32 v198, v198, v253
    v_sub_f32 v199, v199, v253
    v_exp_f32 v192, v192
    v_exp_f32 v193, v193
    v_mfma_f32_32x32x16_bf16 v[160:175], v[216:219], v[108:111], v[160:175]
    ds_read_b64_tr_b16 v[208:209], v246 offset:32
    ds_read_b64_tr_b16 v[210:211], v246 offset:4128
    v_exp_f32 v194, v194
    v_add_f32 v237, v237, v192
    v_add_f32 v237, v237, v193
    v_cvt_pk_bf16_f32 v192, v192, v193
    v_exp_f32 v195, v195
    v_exp_f32 v196, v196
    v_mfma_f32_32x32x16_bf16 v[160:175], v[220:223], v[112:115], v[160:175]
    ds_read_b64_tr_b16 v[212:213], v247 offset:0
    ds_read_b64_tr_b16 v[214:215], v247 offset:4096
    v_add_f32 v237, v237, v194
    v_add_f32 v237, v237, v195
    v_cvt_pk_bf16_f32 v193, v194, v195
    v_exp_f32 v197, v197
    v_add_f32 v249, v249, v153
    v_exp_f32 v198, v198
    v_cvt_pk_bf16_f32 v152, v152, v153
    v_mfma_f32_32x32x16_bf16 v[160:175], v[224:227], v[116:119], v[160:175]
    ds_read_b64_tr_b16 v[216:217], v247 offset:32
    ds_read_b64_tr_b16 v[218:219], v247 offset:4128
    v_add_f32 v237, v237, v196
    v_add_f32 v237, v237, v197
    v_cvt_pk_bf16_f32 v194, v196, v197
    v_exp_f32 v199, v199
    v_add_f32 v237, v237, v198
    v_add_f32 v237, v237, v199
    v_cvt_pk_bf16_f32 v195, v198, v199
    v_exp_f32 v155, v155
    s_waitcnt lgkmcnt(8)
    v_mfma_f32_32x32x16_bf16 v[160:175], v[228:231], v[120:123], v[160:175]
    ds_read_b64_tr_b16 v[220:221], v246 offset:512
    ds_read_b64_tr_b16 v[222:223], v246 offset:4608
    v_exp_f32 v156, v156
    v_add_f32 v236, v236, v154
    v_add_f32 v249, v249, v155
    v_cvt_pk_bf16_f32 v153, v154, v155
    v_exp_f32 v157, v157
    v_exp_f32 v158, v158
    v_mfma_f32_32x32x16_bf16 v[160:175], v[232:235], v[124:127], v[160:175]
    ds_read_b64_tr_b16 v[224:225], v246 offset:544
    ds_read_b64_tr_b16 v[226:227], v246 offset:4640
    v_add_f32 v236, v236, v156
    v_add_f32 v249, v249, v157
    v_cvt_pk_bf16_f32 v154, v156, v157
    v_exp_f32 v159, v159
    v_add_f32 v236, v236, v158
    v_add_f32 v249, v249, v159
    v_cvt_pk_bf16_f32 v155, v158, v159
    s_add_u32 s71, s71, 1
    s_waitcnt lgkmcnt(8)
    v_mfma_f32_16x16x32_bf16 v[64:67], v[204:207], v[192:195], v[64:67]
    ds_read_b64_tr_b16 v[228:229], v247 offset:512
    ds_read_b64_tr_b16 v[230:231], v247 offset:4608
    s_mov_b32 s44, s42
    s_add_u32 s42, s42, 0x4000
    s_cmp_ge_u32 s42, 0x14000
    s_cselect_b32 s42, 0, s42
    s_sub_u32 s45, s42, s44
    s_mov_b32 s69, s47
    v_mfma_f32_16x16x32_bf16 v[68:71], v[208:211], v[192:195], v[68:71]
    ds_read_b64_tr_b16 v[232:233], v247 offset:544
    ds_read_b64_tr_b16 v[234:235], v247 offset:4640
    s_add_u32 s47, s47, 0x4000
    s_cmp_ge_u32 s47, 0x10000
    s_cselect_b32 s47, 0, s47
    s_sub_u32 s70, s47, s69
    v_max3_f32 v250, v160, v161, v162
    v_max3_f32 v250, v250, v163, v164
    s_waitcnt lgkmcnt(8)
    v_mfma_f32_16x16x32_bf16 v[72:75], v[212:215], v[192:195], v[72:75]
    ds_read_b64_tr_b16 v[204:205], v242 offset:0
    ds_read_b64_tr_b16 v[206:207], v242 offset:2048
    v_max3_f32 v250, v250, v165, v166
    v_max3_f32 v250, v250, v167, v168
    v_mfma_f32_16x16x32_bf16 v[76:79], v[216:219], v[192:195], v[76:79]
    ds_read_b64_tr_b16 v[208:209], v243 offset:0
    ds_read_b64_tr_b16 v[210:211], v243 offset:2048
    v_max3_f32 v250, v250, v169, v170
    v_max3_f32 v250, v250, v171, v172
    s_waitcnt lgkmcnt(8)
    v_mfma_f32_16x16x32_bf16 v[80:83], v[220:223], v[192:195], v[80:83]
    ds_read_b64_tr_b16 v[212:213], v242 offset:512
    ds_read_b64_tr_b16 v[214:215], v242 offset:2560
    v_max3_f32 v250, v250, v173, v174
    v_max_f32 v250, v250, v175
    v_mfma_f32_16x16x32_bf16 v[84:87], v[224:227], v[192:195], v[84:87]
    ds_read_b64_tr_b16 v[216:217], v243 offset:512
    ds_read_b64_tr_b16 v[218:219], v243 offset:2560
    v_cmp_lt_f32 vcc, s58, v250
    s_cbranch_vccnz RARE_BX_first1
    v_exp_f32 v160, v160
    s_waitcnt lgkmcnt(8)
    v_mfma_f32_16x16x32_bf16 v[88:91], v[228:231], v[192:195], v[88:91]
    ds_read_b64_tr_b16 v[220:221], v242 offset:4096
    ds_read_b64_tr_b16 v[222:223], v242 offset:6144
    v_exp_f32 v161, v161
    v_mfma_f32_16x16x32_bf16 v[92:95], v[232:235], v[192:195], v[92:95]
    ds_read_b64_tr_b16 v[224:225], v243 offset:4096
    ds_read_b64_tr_b16 v[226:227], v243 offset:6144
    v_exp_f32 v162, v162
    s_waitcnt lgkmcnt(8)
    v_mfma_f32_32x32x16_bf16 v[0:15], v[204:207], v[144:147], 0
    ds_read_b64_tr_b16 v[228:229], v242 offset:4608
    ds_read_b64_tr_b16 v[230:231], v242 offset:6656
    v_add_f32 v236, v236, v160
    v_add_f32 v249, v249, v161
    v_cvt_pk_bf16_f32 v160, v160, v161
    v_exp_f32 v163, v163
    v_mfma_f32_32x32x16_bf16 v[16:31], v[208:211], v[144:147], 0
    ds_read_b64_tr_b16 v[232:233], v243 offset:4608
    ds_read_b64_tr_b16 v[234:235], v243 offset:6656
    v_exp_f32 v164, v164
    v_add_f32 v236, v236, v162
    s_waitcnt lgkmcnt(8)
    v_mfma_f32_32x32x16_bf16 v[32:47], v[212:215], v[144:147], 0
    v_add_u32 v238, s45, v238
    v_add_u32 v239, s45, v239
    v_add_u32 v240, s45, v240
    v_add_u32 v241, s45, v241
    v_add_u32 v242, s70, v242
    v_add_u32 v243, s70, v243
    v_add_u32 v246, s42, v244
    v_xor_b32 v247, 64, v246
    s_waitcnt lgkmcnt(0)
    s_barrier
    v_add_f32 v249, v249, v163
    v_cvt_pk_bf16_f32 v161, v162, v163
    v_exp_f32 v165, v165
    v_mfma_f32_32x32x16_bf16 v[48:63], v[216:219], v[144:147], 0
    v_exp_f32 v166, v166
    v_add_f32 v236, v236, v164
    v_mfma_f32_32x32x16_bf16 v[0:15], v[220:223], v[152:155], v[0:15]
    s_barrier
    ds_read_b128 v[204:207], v238 offset:0
    ds_read_b128 v[208:211], v239 offset:0
    ds_read_b128 v[212:215], v240 offset:0
    v_add_f32 v249, v249, v165
    v_cvt_pk_bf16_f32 v162, v164, v165
    v_exp_f32 v167, v167
    v_mfma_f32_32x32x16_bf16 v[16:31], v[224:227], v[152:155], v[16:31]
    ds_read_b128 v[216:219], v241 offset:0
    v_exp_f32 v168, v168
    v_add_f32 v236, v236, v166
    v_mfma_f32_32x32x16_bf16 v[32:47], v[228:231], v[152:155], v[32:47]
    ds_read_b128 v[220:223], v238 offset:512
    v_add_f32 v249, v249, v167
    v_cvt_pk_bf16_f32 v163, v166, v167
    v_exp_f32 v169, v169
    v_mfma_f32_32x32x16_bf16 v[48:63], v[232:235], v[152:155], v[48:63]
REJ_BX_first1:
    ds_read_b128 v[224:227], v239 offset:512
    v_exp_f32 v170, v170
    v_add_f32 v236, v236, v168
    s_waitcnt lgkmcnt(4)
    v_mfma_f32_32x32x16_bf16 v[144:159], v[204:207], v[96:99], v[176:191]
    ds_read_b128 v[228:231], v240 offset:512
    v_add_f32 v249, v249, v169
    v_cvt_pk_bf16_f32 v168, v168, v169
    v_exp_f32 v171, v171
    v_mfma_f32_32x32x16_bf16 v[144:159], v[208:211], v[100:103], v[144:159]
    ds_read_b128 v[232:235], v241 offset:512
    v_exp_f32 v172, v172
    v_add_f32 v236, v236, v170
    s_waitcnt lgkmcnt(4)
    v_mfma_f32_32x32x16_bf16 v[144:159], v[212:215], v[104:107], v[144:159]
    ds_read_b128 v[204:207], v246 offset:0
    v_add_f32 v249, v249, v171
    v_cvt_pk_bf16_f32 v169, v170, v171
    v_exp_f32 v173, v173
    v_mfma_f32_32x32x16_bf16 v[144:159], v[216:219], v[108:111], v[144:159]
    ds_read_b128 v[208:211], v246 offset:4096
    v_exp_f32 v174, v174
    s_waitcnt lgkmcnt(4)
    v_mfma_f32_32x32x16_bf16 v[144:159], v[220:223], v[112:115], v[144:159]
    ds_read_b128 v[212:215], v247 offset:0
    v_add_f32 v236, v236, v172
    v_add_f32 v249, v249, v173
    v_mfma_f32_32x32x16_bf16 v[144:159], v[224:227], v[116:119], v[144:159]
    ds_read_b128 v[216:219], v247 offset:4096
    v_cvt_pk_bf16_f32 v170, v172, v173
    v_exp_f32 v175, v175
    s_waitcnt lgkmcnt(4)
    v_mfma_f32_32x32x16_bf16 v[144:159], v[228:231], v[120:123], v[144:159]
    ds_read_b128 v[220:223], v246 offset:512
    v_add_f32 v236, v236, v174
    v_add_f32 v249, v249, v175
    v_mfma_f32_32x32x16_bf16 v[144:159], v[232:235], v[124:127], v[144:159]
    ds_read_b128 v[224:227], v246 offset:4608
    v_cvt_pk_bf16_f32 v171, v174, v175
LOOP_BX:
    s_add_u32 s71, s71, 1
    s_waitcnt lgkmcnt(4)
    v_mfma_f32_16x16x32_bf16 v[192:195], v[204:207], v[128:131], v[200:203]
    ds_read_b128 v[228:231], v247 offset:512
    s_mov_b32 s44, s42
    s_add_u32 s42, s42, 0x4000
    s_cmp_ge_u32 s42, 0x14000
    s_cselect_b32 s42, 0, s42
    s_sub_u32 s45, s42, s44
    s_mov_b32 s69, s47
    v_mfma_f32_16x16x32_bf16 v[196:199], v[208:211], v[128:131], v[200:203]
    ds_read_b128 v[232:235], v247 offset:4608
    s_add_u32 s47, s47, 0x4000
    s_cmp_ge_u32 s47, 0x10000
    s_cselect_b32 s47, 0, s47
    s_sub_u32 s70, s47, s69
    v_max3_f32 v250, v144, v145, v146
    v_max3_f32 v250, v250, v147, v148
    s_waitcnt lgkmcnt(4)
    v_mfma_f32_16x16x32_bf16 v[192:195], v[212:215], v[132:135], v[192:195]
    ds_read_b64_tr_b16 v[204:205], v242 offset:0
    ds_read_b64_tr_b16 v[206:207], v242 offset:2048
    v_max3_f32 v250, v250, v149, v150
    v_max3_f32 v250, v250, v151, v152
    v_mfma_f32_16x16x32_bf16 v[196:199], v[216:219], v[132:135], v[196:199]
    ds_read_b64_tr_b16 v[208:209], v243 offset:0
    ds_read_b64_tr_b16 v[210:211], v243 offset:2048
    v_max3_f32 v250, v250, v153, v154
    v_max3_f32 v250, v250, v155, v156
    s_waitcnt lgkmcnt(6)
    v_mfma_f32_16x16x32_bf16 v[192:195], v[220:223], v[136:139], v[192:195]
    ds_read_b64_tr_b16 v[212:213], v242 offset:512
    ds_read_b64_tr_b16 v[214:215], v242 offset:2560
    v_max3_f32 v250, v250, v157, v158
    v_max_f32 v250, v250, v159
    v_mfma_f32_16x16x32_bf16 v[196:199], v[224:227], v[136:139], v[196:199]
    ds_read_b64_tr_b16 v[216:217], v243 offset:512
    ds_read_b64_tr_b16 v[218:219], v243 offset:2560
    v_cmp_lt_f32 vcc, s58, v250
    s_cbranch_vccnz RARE_BX_loop0
    v_exp_f32 v144, v144
    s_waitcnt lgkmcnt(8)
    v_mfma_f32_16x16x32_bf16 v[192:195], v[228:231], v[140:143], v[192:195]
    ds_read_b64_tr_b16 v[220:221], v242 offset:4096
    ds_read_b64_tr_b16 v[222:223], v242 offset:6144
    v_exp_f32 v145, v145
    v_mfma_f32_16x16x32_bf16 v[196:199], v[232:235], v[140:143], v[196:199]
    ds_read_b64_tr_b16 v[224:225], v243 offset:4096
    ds_read_b64_tr_b16 v[226:227], v243 offset:6144
    v_exp_f32 v146, v146
    s_waitcnt lgkmcnt(8)
    v_mfma_f32_32x32x16_bf16 v[0:15], v[204:207], v[160:163], v[0:15]
    ds_read_b64_tr_b16 v[228:229], v242 offset:4608
    ds_read_b64_tr_b16 v[230:231], v242 offset:6656
    v_add_f32 v236, v236, v144
    v_add_f32 v249, v249, v145
    v_cvt_pk_bf16_f32 v144, v144, v145
    v_exp_f32 v147, v147
    v_exp_f32 v148, v148
    v_mfma_f32_32x32x16_bf16 v[16:31], v[208:211], v[160:163], v[16:31]
    ds_read_b64_tr_b16 v[232:233], v243 offset:4608
    ds_read_b64_tr_b16 v[234:235], v243 offset:6656
    v_add_f32 v236, v236, v146
    v_add_f32 v249, v249, v147
    v_cvt_pk_bf16_f32 v145, v146, v147
    v_exp_f32 v149, v149
    v_exp_f32 v150, v150
    s_waitcnt lgkmcnt(8)
    v_mfma_f32_32x32x16_bf16 v[32:47], v[212:215], v[160:163], v[32:47]
    v_add_u32 v238, s45, v238
    v_add_u32 v239, s45, v239
    v_add_u32 v240, s45, v240
    v_add_u32 v241, s45, v241
    v_add_u32 v242, s70, v242
    v_add_u32 v243, s70, v243
    v_add_u32 v246, s47, v245
    v_xor_b32 v247, 64, v246
    s_waitcnt lgkmcnt(0)
    s_barrier
    v_add_f32 v236, v236, v148
    v_add_f32 v249, v249, v149
    v_cvt_pk_bf16_f32 v146, v148, v149
    v_exp_f32 v151, v151
    v_mfma_f32_32x32x16_bf16 v[48:63], v[216:219], v[160:163], v[48:63]
    v_exp_f32 v152, v152
    v_add_f32 v236, v236, v150
    v_add_f32 v249, v249, v151
    v_cvt_pk_bf16_f32 v147, v150, v151
    v_mfma_f32_32x32x16_bf16 v[0:15], v[220:223], v[168:171], v[0:15]
    s_barrier
    ds_read_b128 v[204:207], v238 offset:0
    ds_read_b128 v[208:211], v239 offset:0
    ds_read_b128 v[212:215], v240 offset:0
    v_exp_f32 v153, v153
    v_exp_f32 v154, v154
    v_add_f32 v236, v236, v152
    v_mfma_f32_32x32x16_bf16 v[16:31], v[224:227], v[168:171], v[16:31]
    ds_read_b128 v[216:219], v241 offset:0
    v_add_f32 v249, v249, v153
    v_cvt_pk_bf16_f32 v152, v152, v153
    v_exp_f32 v155, v155
    v_exp_f32 v156, v156
    v_mfma_f32_32x32x16_bf16 v[32:47], v[228:231], v[168:171], v[32:47]
    ds_read_b128 v[220:223], v238 offset:512
    v_add_f32 v236, v236, v154
    v_add_f32 v249, v249, v155
    v_cvt_pk_bf16_f32 v153, v154, v155
    v_exp_f32 v157, v157
    v_mfma_f32_32x32x16_bf16 v[48:63], v[232:235], v[168:171], v[48:63]
REJ_BX_loop0:
    ds_read_b128 v[224:227], v239 offset:512
    v_max3_f32 v253, v192, v193, v194
    v_max3_f32 v253, v253, v195, v196
    v_max3_f32 v253, v253, v197, v198
    v_max_f32 v253, v253, v199
    v_cmp_lt_f32 vcc, s58, v253
    s_cbranch_vccnz RRARE_BX_loop
RREJ_BX_loop:
    s_waitcnt lgkmcnt(4)
    v_mfma_f32_32x32x16_bf16 v[160:175], v[204:207], v[96:99], v[176:191]
    ds_read_b128 v[228:231], v240 offset:512
    v_exp_f32 v192, v192
    v_exp_f32 v193, v193
    v_exp_f32 v194, v194
    v_mfma_f32_32x32x16_bf16 v[160:175], v[208:211], v[100:103], v[160:175]
    ds_read_b128 v[232:235], v241 offset:512
    v_add_f32 v237, v237, v192
    v_add_f32 v237, v237, v193
    v_cvt_pk_bf16_f32 v192, v192, v193
    v_exp_f32 v195, v195
    s_waitcnt lgkmcnt(4)
    v_mfma_f32_32x32x16_bf16 v[160:175], v[212:215], v[104:107], v[160:175]
    ds_read_b64_tr_b16 v[204:205], v246 offset:0
    ds_read_b64_tr_b16 v[206:207], v246 offset:4096
    v_exp_f32 v196, v196
    v_add_f32 v237, v237, v194
    v_add_f32 v237, v237, v195
    v_cvt_pk_bf16_f32 v193, v194, v195
    v_mfma_f32_32x32x16_bf16 v[160:175], v[216:219], v[108:111], v[160:175]
    ds_read_b64_tr_b16 v[208:209], v246 offset:32
    ds_read_b64_tr_b16 v[210:211], v246 offset:4128
    v_exp_f32 v197, v197
    v_exp_f32 v198, v198
    v_add_f32 v237, v237, v196
    s_waitcnt lgkmcnt(6)
    v_mfma_f32_32x32x16_bf16 v[160:175], v[220:223], v[112:115], v[160:175]
    ds_read_b64_tr_b16 v[212:213], v247 offset:0
    ds_read_b64_tr_b16 v[214:215], v247 offset:4096
    v_add_f32 v237, v237, v197
    v_cvt_pk_bf16_f32 v194, v196, v197
    v_exp_f32 v199, v199
    v_exp_f32 v158, v158
    v_mfma_f32_32x32x16_bf16 v[160:175], v[224:227], v[116:119], v[160:175]
    ds_read_b64_tr_b16 v[216:217], v247 offset:32
    ds_read_b64_tr_b16 v[218:219], v247 offset:4128
    v_add_f32 v237, v237, v198
    v_add_f32 v237, v237, v199
    v_cvt_pk_bf16_f32 v195, v198, v199
    v_add_f32 v236, v236, v156
    s_waitcnt lgkmcnt(8)
    v_mfma_f32_32x32x16_bf16 v[160:175], v[228:231], v[120:123], v[160:175]
    ds_read_b64_tr_b16 v[220:221], v246 offset:512
    ds_read_b64_tr_b16 v[222:223], v246 offset:4608
    v_add_f32 v249, v249, v157
    v_cvt_pk_bf16_f32 v154, v156, v157
    v_exp_f32 v159, v159
    v_mfma_f32_32x32x16_bf16 v[160:175], v[232:235], v[124:127], v[160:175]
    ds_read_b64_tr_b16 v[224:225], v246 offset:544
    ds_read_b64_tr_b16 v[226:227], v246 offset:4640
    v_add_f32 v236, v236, v158
    v_add_f32 v249, v249, v159
    v_cvt_pk_bf16_f32 v155, v158, v159
    s_add_u32 s71, s71, 1
    s_waitcnt lgkmcnt(8)
    v_mfma_f32_16x16x32_bf16 v[64:67], v[204:207], v[192:195], v[64:67]
    ds_read_b64_tr_b16 v[228:229], v247 offset:512
    ds_read_b64_tr_b16 v[230:231], v247 offset:4608
    s_mov_b32 s44, s42
    s_add_u32 s42, s42, 0x4000
    s_cmp_ge_u32 s42, 0x14000
    s_cselect_b32 s42, 0, s42
    s_sub_u32 s45, s42, s44
    s_mov_b32 s69, s47
    v_mfma_f32_16x16x32_bf16 v[68:71], v[208:211], v[192:195], v[68:71]
    ds_read_b64_tr_b16 v[232:233], v247 offset:544
    ds_read_b64_tr_b16 v[234:235], v247 offset:4640
    s_add_u32 s47, s47, 0x4000
    s_cmp_ge_u32 s47, 0x10000
    s_cselect_b32 s47, 0, s47
    s_sub_u32 s70, s47, s69
    v_max3_f32 v250, v160, v161, v162
    v_max3_f32 v250, v250, v163, v164
    s_waitcnt lgkmcnt(8)
    v_mfma_f32_16x16x32_bf16 v[72:75], v[212:215], v[192:195], v[72:75]
    ds_read_b64_tr_b16 v[204:205], v242 offset:0
    ds_read_b64_tr_b16 v[206:207], v242 offset:2048
    v_max3_f32 v250, v250, v165, v166
    v_max3_f32 v250, v250, v167, v168
    v_mfma_f32_16x16x32_bf16 v[76:79], v[216:219], v[192:195], v[76:79]
    ds_read_b64_tr_b16 v[208:209], v243 offset:0
    ds_read_b64_tr_b16 v[210:211], v243 offset:2048
    v_max3_f32 v250, v250, v169, v170
    v_max3_f32 v250, v250, v171, v172
    s_waitcnt lgkmcnt(8)
    v_mfma_f32_16x16x32_bf16 v[80:83], v[220:223], v[192:195], v[80:83]
    ds_read_b64_tr_b16 v[212:213], v242 offset:512
    ds_read_b64_tr_b16 v[214:215], v242 offset:2560
    v_max3_f32 v250, v250, v173, v174
    v_max_f32 v250, v250, v175
    v_mfma_f32_16x16x32_bf16 v[84:87], v[224:227], v[192:195], v[84:87]
    ds_read_b64_tr_b16 v[216:217], v243 offset:512
    ds_read_b64_tr_b16 v[218:219], v243 offset:2560
    v_cmp_lt_f32 vcc, s58, v250
    s_cbranch_vccnz RARE_BX_loop1
    v_exp_f32 v160, v160
    s_waitcnt lgkmcnt(8)
    v_mfma_f32_16x16x32_bf16 v[88:91], v[228:231], v[192:195], v[88:91]
    ds_read_b64_tr_b16 v[220:221], v242 offset:4096
    ds_read_b64_tr_b16 v[222:223], v242 offset:6144
    v_exp_f32 v161, v161
    v_mfma_f32_16x16x32_bf16 v[92:95], v[232:235], v[192:195], v[92:95]
    ds_read_b64_tr_b16 v[224:225], v243 offset:4096
    ds_read_b64_tr_b16 v[226:227], v243 offset:6144
    v_exp_f32 v162, v162
    s_waitcnt lgkmcnt(8)
    v_mfma_f32_32x32x16_bf16 v[0:15], v[204:207], v[144:147], v[0:15]
    ds_read_b64_tr_b16 v[228:229], v242 offset:4608
    ds_read_b64_tr_b16 v[230:231], v242 offset:6656
    v_add_f32 v236, v236, v160
    v_add_f32 v249, v249, v161
    v_cvt_pk_bf16_f32 v160, v160, v161
    v_exp_f32 v163, v163
    v_mfma_f32_32x32x16_bf16 v[16:31], v[208:211], v[144:147], v[16:31]
    ds_read_b64_tr_b16 v[232:233], v243 offset:4608
    ds_read_b64_tr_b16 v[234:235], v243 offset:6656
    v_exp_f32 v164, v164
    v_add_f32 v236, v236, v162
    s_waitcnt lgkmcnt(8)
    v_mfma_f32_32x32x16_bf16 v[32:47], v[212:215], v[144:147], v[32:47]
    v_add_u32 v238, s45, v238
    v_add_u32 v239, s45, v239
    v_add_u32 v240, s45, v240
    v_add_u32 v241, s45, v241
    v_add_u32 v242, s70, v242
    v_add_u32 v243, s70, v243
    v_add_u32 v246, s42, v244
    v_xor_b32 v247, 64, v246
    s_waitcnt lgkmcnt(0)
    s_barrier
    v_add_f32 v249, v249, v163
    v_cvt_pk_bf16_f32 v161, v162, v163
    v_exp_f32 v165, v165
    v_mfma_f32_32x32x16_bf16 v[48:63], v[216:219], v[144:147], v[48:63]
    v_exp_f32 v166, v166
    v_add_f32 v236, v236, v164
    v_mfma_f32_32x32x16_bf16 v[0:15], v[220:223], v[152:155], v[0:15]
    s_barrier
    ds_read_b128 v[204:207], v238 offset:0
    ds_read_b128 v[208:211], v239 offset:0
    ds_read_b128 v[212:215], v240 offset:0
    v_add_f32 v249, v249, v165
    v_cvt_pk_bf16_f32 v162, v164, v165
    v_exp_f32 v167, v167
    v_mfma_f32_32x32x16_bf16 v[16:31], v[224:227], v[152:155], v[16:31]
    ds_read_b128 v[216:219], v241 offset:0
    v_exp_f32 v168, v168
    v_add_f32 v236, v236, v166
    v_mfma_f32_32x32x16_bf16 v[32:47], v[228:231], v[152:155], v[32:47]
    ds_read_b128 v[220:223], v238 offset:512
    v_add_f32 v249, v249, v167
    v_cvt_pk_bf16_f32 v163, v166, v167
    v_exp_f32 v169, v169
    v_mfma_f32_32x32x16_bf16 v[48:63], v[232:235], v[152:155], v[48:63]
REJ_BX_loop1:
    ds_read_b128 v[224:227], v239 offset:512
    v_exp_f32 v170, v170
    v_add_f32 v236, v236, v168
    s_waitcnt lgkmcnt(4)
    v_mfma_f32_32x32x16_bf16 v[144:159], v[204:207], v[96:99], v[176:191]
    ds_read_b128 v[228:231], v240 offset:512
    v_add_f32 v249, v249, v169
    v_cvt_pk_bf16_f32 v168, v168, v169
    v_exp_f32 v171, v171
    v_mfma_f32_32x32x16_bf16 v[144:159], v[208:211], v[100:103], v[144:159]
    ds_read_b128 v[232:235], v241 offset:512
    v_exp_f32 v172, v172
    v_add_f32 v236, v236, v170
    s_waitcnt lgkmcnt(4)
    v_mfma_f32_32x32x16_bf16 v[144:159], v[212:215], v[104:107], v[144:159]
    ds_read_b128 v[204:207], v246 offset:0
    v_add_f32 v249, v249, v171
    v_cvt_pk_bf16_f32 v169, v170, v171
    v_exp_f32 v173, v173
    v_mfma_f32_32x32x16_bf16 v[144:159], v[216:219], v[108:111], v[144:159]
    ds_read_b128 v[208:211], v246 offset:4096
    v_exp_f32 v174, v174
    s_waitcnt lgkmcnt(4)
    v_mfma_f32_32x32x16_bf16 v[144:159], v[220:223], v[112:115], v[144:159]
    ds_read_b128 v[212:215], v247 offset:0
    v_add_f32 v236, v236, v172
    v_add_f32 v249, v249, v173
    v_mfma_f32_32x32x16_bf16 v[144:159], v[224:227], v[116:119], v[144:159]
    ds_read_b128 v[216:219], v247 offset:4096
    v_cvt_pk_bf16_f32 v170, v172, v173
    v_exp_f32 v175, v175
    s_waitcnt lgkmcnt(4)
    v_mfma_f32_32x32x16_bf16 v[144:159], v[228:231], v[120:123], v[144:159]
    ds_read_b128 v[220:223], v246 offset:512
    v_add_f32 v236, v236, v174
    v_add_f32 v249, v249, v175
    v_mfma_f32_32x32x16_bf16 v[144:159], v[232:235], v[124:127], v[144:159]
    ds_read_b128 v[224:227], v246 offset:4608
    v_cvt_pk_bf16_f32 v171, v174, v175
    s_cmp_lg_u32 s50, 3
    s_cbranch_scc1 NOT_BX
    v_and_b32 v251, 3, v254
    v_lshlrev_b32 v251, 7, v251
    v_min_u32 v251, 0x13c, v251
    v_lshrrev_b32 v252, 2, v254
    v_mul_u32_u24 v252, 0x480, v252
    v_add_u32 v251, v251, v252
    s_add_u32 s51, s36, 2
    s_and_b32 s51, s51, 3
    s_mul_i32 s51, s51, 36864
    s_mul_i32 s52, s39, 147456
    s_add_u32 s51, s51, s52
    buffer_load_dword v255, v251, s[20:23], s51 offen
    s_add_u32 s51, s51, 18432
    buffer_load_dword v255, v251, s[20:23], s51 offen
NOT_BX:
    s_sub_u32 s50, s50, 1
    s_cmp_lg_u32 s50, 0
    s_cbranch_scc1 LOOP_BX
    s_add_u32 s71, s71, 1
    s_waitcnt lgkmcnt(4)
    v_mfma_f32_16x16x32_bf16 v[192:195], v[204:207], v[128:131], v[200:203]
    ds_read_b128 v[228:231], v247 offset:512
    s_mov_b32 s44, s42
    s_add_u32 s42, s42, 0x4000
    s_cmp_ge_u32 s42, 0x14000
    s_cselect_b32 s42, 0, s42
    s_sub_u32 s45, s42, s44
    s_mov_b32 s69, s47
    v_mfma_f32_16x16x32_bf16 v[196:199], v[208:211], v[128:131], v[200:203]
    ds_read_b128 v[232:235], v247 offset:4608
    s_add_u32 s47, s47, 0x4000
    s_cmp_ge_u32 s47, 0x10000
    s_cselect_b32 s47, 0, s47
    s_sub_u32 s70, s47, s69
    v_max3_f32 v250, v144, v145, v146
    v_max3_f32 v250, v250, v147, v148
    s_waitcnt lgkmcnt(4)
    v_mfma_f32_16x16x32_bf16 v[192:195], v[212:215], v[132:135], v[192:195]
    ds_read_b64_tr_b16 v[204:205], v242 offset:0
    ds_read_b64_tr_b16 v[206:207], v242 offset:2048
    v_max3_f32 v250, v250, v149, v150
    v_max3_f32 v250, v250, v151, v152
    v_mfma_f32_16x16x32_bf16 v[196:199], v[216:219], v[132:135], v[196:199]
    ds_read_b64_tr_b16 v[208:209], v243 offset:0
    ds_read_b64_tr_b16 v[210:211], v243 offset:2048
    v_max3_f32 v250, v250, v153, v154
    v_max3_f32 v250, v250, v155, v156
    s_waitcnt lgkmcnt(6)
    v_mfma_f32_16x16x32_bf16 v[192:195], v[220:223], v[136:139], v[192:195]
    ds_read_b64_tr_b16 v[212:213], v242 offset:512
    ds_read_b64_tr_b16 v[214:215], v242 offset:2560
    v_max3_f32 v250, v250, v157, v158
    v_max_f32 v250, v250, v159
    v_mfma_f32_16x16x32_bf16 v[196:199], v[224:227], v[136:139], v[196:199]
    ds_read_b64_tr_b16 v[216:217], v243 offset:512
    ds_read_b64_tr_b16 v[218:219], v243 offset:2560
    v_cmp_lt_f32 vcc, s58, v250
    s_cbranch_vccnz RARE_BX_last0
    v_exp_f32 v144, v144
    s_waitcnt lgkmcnt(8)
    v_mfma_f32_16x16x32_bf16 v[192:195], v[228:231], v[140:143], v[192:195]
    ds_read_b64_tr_b16 v[220:221], v242 offset:4096
    ds_read_b64_tr_b16 v[222:223], v242 offset:6144
    v_exp_f32 v145, v145
    v_mfma_f32_16x16x32_bf16 v[196:199], v[232:235], v[140:143], v[196:199]
    ds_read_b64_tr_b16 v[224:225], v243 offset:4096
    ds_read_b64_tr_b16 v[226:227], v243 offset:6144
    v_exp_f32 v146, v146
    s_waitcnt lgkmcnt(8)
    v_mfma_f32_32x32x16_bf16 v[0:15], v[204:207], v[160:163], v[0:15]
    ds_read_b64_tr_b16 v[228:229], v242 offset:4608
    ds_read_b64_tr_b16 v[230:231], v242 offset:6656
    v_add_f32 v236, v236, v144
    v_add_f32 v249, v249, v145
    v_cvt_pk_bf16_f32 v144, v144, v145
    v_exp_f32 v147, v147
    v_exp_f32 v148, v148
    v_mfma_f32_32x32x16_bf16 v[16:31], v[208:211], v[160:163], v[16:31]
    ds_read_b64_tr_b16 v[232:233], v243 offset:4608
    ds_read_b64_tr_b16 v[234:235], v243 offset:6656
    v_add_f32 v236, v236, v146
    v_add_f32 v249, v249, v147
    v_cvt_pk_bf16_f32 v145, v146, v147
    v_exp_f32 v149, v149
    v_exp_f32 v150, v150
    s_waitcnt lgkmcnt(8)
    v_mfma_f32_32x32x16_bf16 v[32:47], v[212:215], v[160:163], v[32:47]
    v_add_u32 v238, s45, v238
    v_add_u32 v239, s45, v239
    v_add_u32 v240, s45, v240
    v_add_u32 v241, s45, v241
    v_add_u32 v242, s70, v242
    v_add_u32 v243, s70, v243
    v_add_u32 v246, s47, v245
    v_xor_b32 v247, 64, v246
    s_waitcnt lgkmcnt(0)
    s_barrier
    v_add_f32 v236, v236, v148
    v_add_f32 v249, v249, v149
    v_cvt_pk_bf16_f32 v146, v148, v149
    v_exp_f32 v151, v151
    v_mfma_f32_32x32x16_bf16 v[48:63], v[216:219], v[160:163], v[48:63]
    v_exp_f32 v152, v152
    v_add_f32 v236, v236, v150
    v_add_f32 v249, v249, v151
    v_cvt_pk_bf16_f32 v147, v150, v151
    v_mfma_f32_32x32x16_bf16 v[0:15], v[220:223], v[168:171], v[0:15]
    s_barrier
    ds_read_b128 v[204:207], v238 offset:0
    ds_read_b128 v[208:211], v239 offset:0
    ds_read_b128 v[212:215], v240 offset:0
    v_exp_f32 v153, v153
    v_exp_f32 v154, v154
    v_add_f32 v236, v236, v152
    v_mfma_f32_32x32x16_bf16 v[16:31], v[224:227], v[168:171], v[16:31]
    ds_read_b128 v[216:219], v241 offset:0
    v_add_f32 v249, v249, v153
    v_cvt_pk_bf16_f32 v152, v152, v153
    v_exp_f32 v155, v155
    v_exp_f32 v156, v156
    v_mfma_f32_32x32x16_bf16 v[32:47], v[228:231], v[168:171], v[32:47]
    ds_read_b128 v[220:223], v238 offset:512
    v_add_f32 v236, v236, v154
    v_add_f32 v249, v249, v155
    v_cvt_pk_bf16_f32 v153, v154, v155
    v_exp_f32 v157, v157
    v_mfma_f32_32x32x16_bf16 v[48:63], v[232:235], v[168:171], v[48:63]
REJ_BX_last0:
    ds_read_b128 v[224:227], v239 offset:512
    v_max3_f32 v253, v192, v193, v194
    v_max3_f32 v253, v253, v195, v196
    v_max3_f32 v253, v253, v197, v198
    v_max_f32 v253, v253, v199
    v_cmp_lt_f32 vcc, s58, v253
    s_cbranch_vccnz RRARE_BX_last
RREJ_BX_last:
    s_waitcnt lgkmcnt(4)
    v_mfma_f32_32x32x16_bf16 v[160:175], v[204:207], v[96:99], v[176:191]
    ds_read_b128 v[228:231], v240 offset:512
    v_exp_f32 v192, v192
    v_exp_f32 v193, v193
    v_exp_f32 v194, v194
    v_mfma_f32_32x32x16_bf16 v[160:175], v[208:211], v[100:103], v[160:175]
    ds_read_b128 v[232:235], v241 offset:512
    v_add_f32 v237, v237, v192
    v_add_f32 v237, v237, v193
    v_cvt_pk_bf16_f32 v192, v192, v193
    v_exp_f32 v195, v195
    s_waitcnt lgkmcnt(4)
    v_mfma_f32_32x32x16_bf16 v[160:175], v[212:215], v[104:107], v[160:175]
    ds_read_b64_tr_b16 v[204:205], v246 offset:0
    ds_read_b64_tr_b16 v[206:207], v246 offset:4096
    v_exp_f32 v196, v196
    v_add_f32 v237, v237, v194
    v_add_f32 v237, v237, v195
    v_cvt_pk_bf16_f32 v193, v194, v195
    v_mfma_f32_32x32x16_bf16 v[160:175], v[216:219], v[108:111], v[160:175]
    ds_read_b64_tr_b16 v[208:209], v246 offset:32
    ds_read_b64_tr_b16 v[210:211], v246 offset:4128
    v_exp_f32 v197, v197
    v_exp_f32 v198, v198
    v_add_f32 v237, v237, v196
    s_waitcnt lgkmcnt(6)
    v_mfma_f32_32x32x16_bf16 v[160:175], v[220:223], v[112:115], v[160:175]
    ds_read_b64_tr_b16 v[212:213], v247 offset:0
    ds_read_b64_tr_b16 v[214:215], v247 offset:4096
    v_add_f32 v237, v237, v197
    v_cvt_pk_bf16_f32 v194, v196, v197
    v_exp_f32 v199, v199
    v_exp_f32 v158, v158
    v_mfma_f32_32x32x16_bf16 v[160:175], v[224:227], v[116:119], v[160:175]
    ds_read_b64_tr_b16 v[216:217], v247 offset:32
    ds_read_b64_tr_b16 v[218:219], v247 offset:4128
    v_add_f32 v237, v237, v198
    v_add_f32 v237, v237, v199
    v_cvt_pk_bf16_f32 v195, v198, v199
    v_add_f32 v236, v236, v156
    s_waitcnt lgkmcnt(8)
    v_mfma_f32_32x32x16_bf16 v[160:175], v[228:231], v[120:123], v[160:175]
    ds_read_b64_tr_b16 v[220:221], v246 offset:512
    ds_read_b64_tr_b16 v[222:223], v246 offset:4608
    v_add_f32 v249, v249, v157
    v_cvt_pk_bf16_f32 v154, v156, v157
    v_exp_f32 v159, v159
    v_mfma_f32_32x32x16_bf16 v[160:175], v[232:235], v[124:127], v[160:175]
    ds_read_b64_tr_b16 v[224:225], v246 offset:544
    ds_read_b64_tr_b16 v[226:227], v246 offset:4640
    v_add_f32 v236, v236, v158
    v_add_f32 v249, v249, v159
    v_cvt_pk_bf16_f32 v155, v158, v159
    s_add_u32 s71, s71, 1
    s_waitcnt lgkmcnt(8)
    v_mfma_f32_16x16x32_bf16 v[64:67], v[204:207], v[192:195], v[64:67]
    ds_read_b64_tr_b16 v[228:229], v247 offset:512
    ds_read_b64_tr_b16 v[230:231], v247 offset:4608
    s_mov_b32 s44, s42
    s_add_u32 s42, s42, 0x4000
    s_cmp_ge_u32 s42, 0x14000
    s_cselect_b32 s42, 0, s42
    s_sub_u32 s45, s42, s44
    s_mov_b32 s69, s47
    v_mfma_f32_16x16x32_bf16 v[68:71], v[208:211], v[192:195], v[68:71]
    ds_read_b64_tr_b16 v[232:233], v247 offset:544
    ds_read_b64_tr_b16 v[234:235], v247 offset:4640
    s_add_u32 s47, s47, 0x4000
    s_cmp_ge_u32 s47, 0x10000
    s_cselect_b32 s47, 0, s47
    s_sub_u32 s70, s47, s69
    v_max3_f32 v250, v160, v161, v162
    v_max3_f32 v250, v250, v163, v164
    v_max3_f32 v250, v250, v165, v166
    s_waitcnt lgkmcnt(8)
    v_mfma_f32_16x16x32_bf16 v[72:75], v[212:215], v[192:195], v[72:75]
    ds_read_b64_tr_b16 v[204:205], v242 offset:0
    ds_read_b64_tr_b16 v[206:207], v242 offset:2048
    v_max3_f32 v250, v250, v167, v168
    v_max3_f32 v250, v250, v169, v170
    v_max3_f32 v250, v250, v171, v172
    v_mfma_f32_16x16x32_bf16 v[76:79], v[216:219], v[192:195], v[76:79]
    ds_read_b64_tr_b16 v[208:209], v243 offset:0
    ds_read_b64_tr_b16 v[210:211], v243 offset:2048
    v_max3_f32 v250, v250, v173, v174
    v_max_f32 v250, v250, v175
    v_cmp_lt_f32 vcc, s58, v250
    s_cbranch_vccnz RARE_BX_last1
    s_waitcnt lgkmcnt(8)
    v_mfma_f32_16x16x32_bf16 v[80:83], v[220:223], v[192:195], v[80:83]
    ds_read_b64_tr_b16 v[212:213], v242 offset:512
    ds_read_b64_tr_b16 v[214:215], v242 offset:2560
    v_exp_f32 v160, v160
    v_mfma_f32_16x16x32_bf16 v[84:87], v[224:227], v[192:195], v[84:87]
    ds_read_b64_tr_b16 v[216:217], v243 offset:512
    ds_read_b64_tr_b16 v[218:219], v243 offset:2560
    v_exp_f32 v161, v161
    s_waitcnt lgkmcnt(8)
    v_mfma_f32_16x16x32_bf16 v[88:91], v[228:231], v[192:195], v[88:91]
    ds_read_b64_tr_b16 v[220:221], v242 offset:4096
    ds_read_b64_tr_b16 v[222:223], v242 offset:6144
    v_exp_f32 v162, v162
    v_mfma_f32_16x16x32_bf16 v[92:95], v[232:235], v[192:195], v[92:95]
    ds_read_b64_tr_b16 v[224:225], v243 offset:4096
    ds_read_b64_tr_b16 v[226:227], v243 offset:6144
    v_add_f32 v236, v236, v160
    v_add_f32 v249, v249, v161
    s_waitcnt lgkmcnt(8)
    v_mfma_f32_32x32x16_bf16 v[0:15], v[204:207], v[144:147], v[0:15]
    ds_read_b64_tr_b16 v[228:229], v242 offset:4608
    ds_read_b64_tr_b16 v[230:231], v242 offset:6656
    v_cvt_pk_bf16_f32 v160, v160, v161
    v_exp_f32 v163, v163
    v_exp_f32 v164, v164
    v_add_f32 v236, v236, v162
    v_mfma_f32_32x32x16_bf16 v[16:31], v[208:211], v[144:147], v[16:31]
    ds_read_b64_tr_b16 v[232:233], v243 offset:4608
    ds_read_b64_tr_b16 v[234:235], v243 offset:6656
    v_add_f32 v249, v249, v163
    v_cvt_pk_bf16_f32 v161, v162, v163
    v_exp_f32 v165, v165
    v_exp_f32 v166, v166
    s_waitcnt lgkmcnt(8)
    v_mfma_f32_32x32x16_bf16 v[32:47], v[212:215], v[144:147], v[32:47]
    v_add_u32 v238, s45, v238
    v_add_u32 v239, s45, v239
    v_add_u32 v240, s45, v240
    v_add_u32 v241, s45, v241
    v_add_u32 v242, s70, v242
    v_add_u32 v243, s70, v243
    v_add_u32 v246, s42, v244
    v_xor_b32 v247, 64, v246
    s_waitcnt lgkmcnt(0)
    s_barrier
    v_add_f32 v236, v236, v164
    v_add_f32 v249, v249, v165
    v_cvt_pk_bf16_f32 v162, v164, v165
    v_exp_f32 v167, v167
    v_exp_f32 v168, v168
    v_mfma_f32_32x32x16_bf16 v[48:63], v[216:219], v[144:147], v[48:63]
    v_add_f32 v236, v236, v166
    v_add_f32 v249, v249, v167
    v_cvt_pk_bf16_f32 v163, v166, v167
    v_exp_f32 v169, v169
    v_exp_f32 v170, v170
    v_mfma_f32_32x32x16_bf16 v[0:15], v[220:223], v[152:155], v[0:15]
    s_barrier
    v_add_f32 v236, v236, v168
    v_add_f32 v249, v249, v169
    v_cvt_pk_bf16_f32 v168, v168, v169
    v_exp_f32 v171, v171
    v_exp_f32 v172, v172
    v_mfma_f32_32x32x16_bf16 v[16:31], v[224:227], v[152:155], v[16:31]
    v_add_f32 v236, v236, v170
    v_add_f32 v249, v249, v171
    v_cvt_pk_bf16_f32 v169, v170, v171
    v_exp_f32 v173, v173
    v_mfma_f32_32x32x16_bf16 v[32:47], v[228:231], v[152:155], v[32:47]
    v_exp_f32 v174, v174
    v_add_f32 v236, v236, v172
    v_add_f32 v249, v249, v173
    v_cvt_pk_bf16_f32 v170, v172, v173
    v_mfma_f32_32x32x16_bf16 v[48:63], v[232:235], v[152:155], v[48:63]
REJ_BX_last1:
    v_exp_f32 v175, v175
    v_add_f32 v236, v236, v174
    v_add_f32 v249, v249, v175
    v_cvt_pk_bf16_f32 v171, v174, v175
    ds_read_b64_tr_b16 v[204:205], v242 offset:0
    ds_read_b64_tr_b16 v[206:207], v242 offset:2048
    ds_read_b64_tr_b16 v[208:209], v243 offset:0
    ds_read_b64_tr_b16 v[210:211], v243 offset:2048
    ds_read_b64_tr_b16 v[212:213], v242 offset:512
    ds_read_b64_tr_b16 v[214:215], v242 offset:2560
    ds_read_b64_tr_b16 v[216:217], v243 offset:512
    ds_read_b64_tr_b16 v[218:219], v243 offset:2560
    ds_read_b64_tr_b16 v[220:221], v242 offset:4096
    ds_read_b64_tr_b16 v[222:223], v242 offset:6144
    ds_read_b64_tr_b16 v[224:225], v243 offset:4096
    ds_read_b64_tr_b16 v[226:227], v243 offset:6144
    s_waitcnt lgkmcnt(10)
    v_mfma_f32_32x32x16_bf16 v[0:15], v[204:207], v[160:163], v[0:15]
    ds_read_b64_tr_b16 v[228:229], v242 offset:4608
    ds_read_b64_tr_b16 v[230:231], v242 offset:6656
    s_waitcnt lgkmcnt(10)
    v_mfma_f32_32x32x16_bf16 v[16:31], v[208:211], v[160:163], v[16:31]
    ds_read_b64_tr_b16 v[232:233], v243 offset:4608
    ds_read_b64_tr_b16 v[234:235], v243 offset:6656
    s_waitcnt lgkmcnt(10)
    v_mfma_f32_32x32x16_bf16 v[32:47], v[212:215], v[160:163], v[32:47]
    s_waitcnt lgkmcnt(8)
    v_mfma_f32_32x32x16_bf16 v[48:63], v[216:219], v[160:163], v[48:63]
    s_waitcnt lgkmcnt(6)
    v_mfma_f32_32x32x16_bf16 v[0:15], v[220:223], v[168:171], v[0:15]
    s_waitcnt lgkmcnt(4)
    v_mfma_f32_32x32x16_bf16 v[16:31], v[224:227], v[168:171], v[16:31]
    s_waitcnt lgkmcnt(2)
    v_mfma_f32_32x32x16_bf16 v[32:47], v[228:231], v[168:171], v[32:47]
    s_waitcnt lgkmcnt(0)
    v_mfma_f32_32x32x16_bf16 v[48:63], v[232:235], v[168:171], v[48:63]
    v_add_f32 v236, v236, v249
    s_branch TAIL_X
RARE_BX_first1:
    s_waitcnt lgkmcnt(8)
    v_mfma_f32_16x16x32_bf16 v[88:91], v[228:231], v[192:195], v[88:91]
    ds_read_b64_tr_b16 v[220:221], v242 offset:4096
    ds_read_b64_tr_b16 v[222:223], v242 offset:6144
    v_mfma_f32_16x16x32_bf16 v[92:95], v[232:235], v[192:195], v[92:95]
    ds_read_b64_tr_b16 v[224:225], v243 offset:4096
    ds_read_b64_tr_b16 v[226:227], v243 offset:6144
    s_waitcnt lgkmcnt(8)
    v_mfma_f32_32x32x16_bf16 v[0:15], v[204:207], v[144:147], 0
    ds_read_b64_tr_b16 v[228:229], v242 offset:4608
    ds_read_b64_tr_b16 v[230:231], v242 offset:6656
    v_mfma_f32_32x32x16_bf16 v[16:31], v[208:211], v[144:147], 0
    ds_read_b64_tr_b16 v[232:233], v243 offset:4608
    ds_read_b64_tr_b16 v[234:235], v243 offset:6656
    s_waitcnt lgkmcnt(8)
    v_mfma_f32_32x32x16_bf16 v[32:47], v[212:215], v[144:147], 0
    v_add_u32 v238, s45, v238
    v_add_u32 v239, s45, v239
    v_add_u32 v240, s45, v240
    v_add_u32 v241, s45, v241
    v_add_u32 v242, s70, v242
    v_add_u32 v243, s70, v243
    v_add_u32 v246, s42, v244
    v_xor_b32 v247, 64, v246
    s_waitcnt lgkmcnt(0)
    s_barrier
    v_mfma_f32_32x32x16_bf16 v[48:63], v[216:219], v[144:147], 0
    v_mfma_f32_32x32x16_bf16 v[0:15], v[220:223], v[152:155], v[0:15]
    s_barrier
    ds_read_b128 v[204:207], v238 offset:0
    ds_read_b128 v[208:211], v239 offset:0
    ds_read_b128 v[212:215], v240 offset:0
    v_mfma_f32_32x32x16_bf16 v[16:31], v[224:227], v[152:155], v[16:31]
    ds_read_b128 v[216:219], v241 offset:0
    v_mfma_f32_32x32x16_bf16 v[32:47], v[228:231], v[152:155], v[32:47]
    ds_read_b128 v[220:223], v238 offset:512
    v_mfma_f32_32x32x16_bf16 v[48:63], v[232:235], v[152:155], v[48:63]
    v_mov_b32 v251, v250
    v_mov_b32 v252, v250
    s_nop 1
    v_permlane32_swap_b32 v251, v252
    v_max_f32 v250, v251, v252
    v_max_f32 v250, 0, v250
    v_exp_f32 v251, -v250
    v_sub_f32 v160, v160, v250
    v_sub_f32 v161, v161, v250
    v_sub_f32 v162, v162, v250
    v_sub_f32 v163, v163, v250
    v_sub_f32 v164, v164, v250
    v_sub_f32 v165, v165, v250
    v_sub_f32 v166, v166, v250
    v_sub_f32 v167, v167, v250
    v_sub_f32 v168, v168, v250
    v_sub_f32 v169, v169, v250
    v_sub_f32 v170, v170, v250
    v_sub_f32 v171, v171, v250
    v_sub_f32 v172, v172, v250
    v_sub_f32 v173, v173, v250
    v_sub_f32 v174, v174, v250
    v_sub_f32 v175, v175, v250
    v_sub_f32 v176, v176, v250
    v_sub_f32 v177, v177, v250
    v_sub_f32 v178, v178, v250
    v_sub_f32 v179, v179, v250
    v_sub_f32 v180, v180, v250
    v_sub_f32 v181, v181, v250
    v_sub_f32 v182, v182, v250
    v_sub_f32 v183, v183, v250
    v_sub_f32 v184, v184, v250
    v_sub_f32 v185, v185, v250
    v_sub_f32 v186, v186, v250
    v_sub_f32 v187, v187, v250
    v_sub_f32 v188, v188, v250
    v_sub_f32 v189, v189, v250
    v_sub_f32 v190, v190, v250
    v_sub_f32 v191, v191, v250
    v_mul_f32 v236, v236, v251
    v_mul_f32 v249, v249, v251
    v_mul_f32 v0, v0, v251
    v_mul_f32 v1, v1, v251
    v_mul_f32 v2, v2, v251
    v_mul_f32 v3, v3, v251
    v_mul_f32 v4, v4, v251
    v_mul_f32 v5, v5, v251
    v_mul_f32 v6, v6, v251
    v_mul_f32 v7, v7, v251
    v_mul_f32 v8, v8, v251
    v_mul_f32 v9, v9, v251
    v_mul_f32 v10, v10, v251
    v_mul_f32 v11, v11, v251
    v_mul_f32 v12, v12, v251
    v_mul_f32 v13, v13, v251
    v_mul_f32 v14, v14, v251
    v_mul_f32 v15, v15, v251
    v_mul_f32 v16, v16, v251
    v_mul_f32 v17, v17, v251
    v_mul_f32 v18, v18, v251
    v_mul_f32 v19, v19, v251
    v_mul_f32 v20, v20, v251
    v_mul_f32 v21, v21, v251
    v_mul_f32 v22, v22, v251
    v_mul_f32 v23, v23, v251
    v_mul_f32 v24, v24, v251
    v_mul_f32 v25, v25, v251
    v_mul_f32 v26, v26, v251
    v_mul_f32 v27, v27, v251
    v_mul_f32 v28, v28, v251
    v_mul_f32 v29, v29, v251
    v_mul_f32 v30, v30, v251
    v_mul_f32 v31, v31, v251
    v_mul_f32 v32, v32, v251
    v_mul_f32 v33, v33, v251
    v_mul_f32 v34, v34, v251
    v_mul_f32 v35, v35, v251
    v_mul_f32 v36, v36, v251
    v_mul_f32 v37, v37, v251
    v_mul_f32 v38, v38, v251
    v_mul_f32 v39, v39, v251
    v_mul_f32 v40, v40, v251
    v_mul_f32 v41, v41, v251
    v_mul_f32 v42, v42, v251
    v_mul_f32 v43, v43, v251
    v_mul_f32 v44, v44, v251
    v_mul_f32 v45, v45, v251
    v_mul_f32 v46, v46, v251
    v_mul_f32 v47, v47, v251
    v_mul_f32 v48, v48, v251
    v_mul_f32 v49, v49, v251
    v_mul_f32 v50, v50, v251
    v_mul_f32 v51, v51, v251
    v_mul_f32 v52, v52, v251
    v_mul_f32 v53, v53, v251
    v_mul_f32 v54, v54, v251
    v_mul_f32 v55, v55, v251
    v_mul_f32 v56, v56, v251
    v_mul_f32 v57, v57, v251
    v_mul_f32 v58, v58, v251
    v_mul_f32 v59, v59, v251
    v_mul_f32 v60, v60, v251
    v_mul_f32 v61, v61, v251
    v_mul_f32 v62, v62, v251
    v_mul_f32 v63, v63, v251
    v_exp_f32 v160, v160
    v_exp_f32 v161, v161
    v_exp_f32 v162, v162
    v_add_f32 v236, v236, v160
    v_add_f32 v249, v249, v161
    v_cvt_pk_bf16_f32 v160, v160, v161
    v_exp_f32 v163, v163
    v_exp_f32 v164, v164
    v_add_f32 v236, v236, v162
    v_add_f32 v249, v249, v163
    v_cvt_pk_bf16_f32 v161, v162, v163
    v_exp_f32 v165, v165
    v_exp_f32 v166, v166
    v_add_f32 v236, v236, v164
    v_add_f32 v249, v249, v165
    v_cvt_pk_bf16_f32 v162, v164, v165
    v_exp_f32 v167, v167
    v_exp_f32 v168, v168
    v_add_f32 v236, v236, v166
    v_add_f32 v249, v249, v167
    v_cvt_pk_bf16_f32 v163, v166, v167
    v_exp_f32 v169, v169
    s_branch REJ_BX_first1
RARE_BX_loop0:
    s_waitcnt lgkmcnt(8)
    v_mfma_f32_16x16x32_bf16 v[192:195], v[228:231], v[140:143], v[192:195]
    ds_read_b64_tr_b16 v[220:221], v242 offset:4096
    ds_read_b64_tr_b16 v[222:223], v242 offset:6144
    v_mfma_f32_16x16x32_bf16 v[196:199], v[232:235], v[140:143], v[196:199]
    ds_read_b64_tr_b16 v[224:225], v243 offset:4096
    ds_read_b64_tr_b16 v[226:227], v243 offset:6144
    s_waitcnt lgkmcnt(8)
    v_mfma_f32_32x32x16_bf16 v[0:15], v[204:207], v[160:163], v[0:15]
    ds_read_b64_tr_b16 v[228:229], v242 offset:4608
    ds_read_b64_tr_b16 v[230:231], v242 offset:6656
    v_mfma_f32_32x32x16_bf16 v[16:31], v[208:211], v[160:163], v[16:31]
    ds_read_b64_tr_b16 v[232:233], v243 offset:4608
    ds_read_b64_tr_b16 v[234:235], v243 offset:6656
    s_waitcnt lgkmcnt(8)
    v_mfma_f32_32x32x16_bf16 v[32:47], v[212:215], v[160:163], v[32:47]
    v_add_u32 v238, s45, v238
    v_add_u32 v239, s45, v239
    v_add_u32 v240, s45, v240
    v_add_u32 v241, s45, v241
    v_add_u32 v242, s70, v242
    v_add_u32 v243, s70, v243
    v_add_u32 v246, s47, v245
    v_xor_b32 v247, 64, v246
    s_waitcnt lgkmcnt(0)
    s_barrier
    v_mfma_f32_32x32x16_bf16 v[48:63], v[216:219], v[160:163], v[48:63]
    v_mfma_f32_32x32x16_bf16 v[0:15], v[220:223], v[168:171], v[0:15]
    s_barrier
    ds_read_b128 v[204:207], v238 offset:0
    ds_read_b128 v[208:211], v239 offset:0
    ds_read_b128 v[212:215], v240 offset:0
    v_mfma_f32_32x32x16_bf16 v[16:31], v[224:227], v[168:171], v[16:31]
    ds_read_b128 v[216:219], v241 offset:0
    v_mfma_f32_32x32x16_bf16 v[32:47], v[228:231], v[168:171], v[32:47]
    ds_read_b128 v[220:223], v238 offset:512
    v_mfma_f32_32x32x16_bf16 v[48:63], v[232:235], v[168:171], v[48:63]
    v_mov_b32 v251, v250
    v_mov_b32 v252, v250
    s_nop 1
    v_permlane32_swap_b32 v251, v252
    v_max_f32 v250, v251, v252
    v_max_f32 v250, 0, v250
    v_exp_f32 v251, -v250
    v_sub_f32 v144, v144, v250
    v_sub_f32 v145, v145, v250
    v_sub_f32 v146, v146, v250
    v_sub_f32 v147, v147, v250
    v_sub_f32 v148, v148, v250
    v_sub_f32 v149, v149, v250
    v_sub_f32 v150, v150, v250
    v_sub_f32 v151, v151, v250
    v_sub_f32 v152, v152, v250
    v_sub_f32 v153, v153, v250
    v_sub_f32 v154, v154, v250
    v_sub_f32 v155, v155, v250
    v_sub_f32 v156, v156, v250
    v_sub_f32 v157, v157, v250
    v_sub_f32 v158, v158, v250
    v_sub_f32 v159, v159, v250
    v_sub_f32 v176, v176, v250
    v_sub_f32 v177, v177, v250
    v_sub_f32 v178, v178, v250
    v_sub_f32 v179, v179, v250
    v_sub_f32 v180, v180, v250
    v_sub_f32 v181, v181, v250
    v_sub_f32 v182, v182, v250
    v_sub_f32 v183, v183, v250
    v_sub_f32 v184, v184, v250
    v_sub_f32 v185, v185, v250
    v_sub_f32 v186, v186, v250
    v_sub_f32 v187, v187, v250
    v_sub_f32 v188, v188, v250
    v_sub_f32 v189, v189, v250
    v_sub_f32 v190, v190, v250
    v_sub_f32 v191, v191, v250
    v_mul_f32 v236, v236, v251
    v_mul_f32 v249, v249, v251
    v_mul_f32 v0, v0, v251
    v_mul_f32 v1, v1, v251
    v_mul_f32 v2, v2, v251
    v_mul_f32 v3, v3, v251
    v_mul_f32 v4, v4, v251
    v_mul_f32 v5, v5, v251
    v_mul_f32 v6, v6, v251
    v_mul_f32 v7, v7, v251
    v_mul_f32 v8, v8, v251
    v_mul_f32 v9, v9, v251
    v_mul_f32 v10, v10, v251
    v_mul_f32 v11, v11, v251
    v_mul_f32 v12, v12, v251
    v_mul_f32 v13, v13, v251
    v_mul_f32 v14, v14, v251
    v_mul_f32 v15, v15, v251
    v_mul_f32 v16, v16, v251
    v_mul_f32 v17, v17, v251
    v_mul_f32 v18, v18, v251
    v_mul_f32 v19, v19, v251
    v_mul_f32 v20, v20, v251
    v_mul_f32 v21, v21, v251
    v_mul_f32 v22, v22, v251
    v_mul_f32 v23, v23, v251
    v_mul_f32 v24, v24, v251
    v_mul_f32 v25, v25, v251
    v_mul_f32 v26, v26, v251
    v_mul_f32 v27, v27, v251
    v_mul_f32 v28, v28, v251
    v_mul_f32 v29, v29, v251
    v_mul_f32 v30, v30, v251
    v_mul_f32 v31, v31, v251
    v_mul_f32 v32, v32, v251
    v_mul_f32 v33, v33, v251
    v_mul_f32 v34, v34, v251
    v_mul_f32 v35, v35, v251
    v_mul_f32 v36, v36, v251
    v_mul_f32 v37, v37, v251
    v_mul_f32 v38, v38, v251
    v_mul_f32 v39, v39, v251
    v_mul_f32 v40, v40, v251
    v_mul_f32 v41, v41, v251
    v_mul_f32 v42, v42, v251
    v_mul_f32 v43, v43, v251
    v_mul_f32 v44, v44, v251
    v_mul_f32 v45, v45, v251
    v_mul_f32 v46, v46, v251
    v_mul_f32 v47, v47, v251
    v_mul_f32 v48, v48, v251
    v_mul_f32 v49, v49, v251
    v_mul_f32 v50, v50, v251
    v_mul_f32 v51, v51, v251
    v_mul_f32 v52, v52, v251
    v_mul_f32 v53, v53, v251
    v_mul_f32 v54, v54, v251
    v_mul_f32 v55, v55, v251
    v_mul_f32 v56, v56, v251
    v_mul_f32 v57, v57, v251
    v_mul_f32 v58, v58, v251
    v_mul_f32 v59, v59, v251
    v_mul_f32 v60, v60, v251
    v_mul_f32 v61, v61, v251
    v_mul_f32 v62, v62, v251
    v_mul_f32 v63, v63, v251
    v_exp_f32 v144, v144
    v_exp_f32 v145, v145
    v_exp_f32 v146, v146
    v_add_f32 v236, v236, v144
    v_add_f32 v249, v249, v145
    v_cvt_pk_bf16_f32 v144, v144, v145
    v_exp_f32 v147, v147
    v_exp_f32 v148, v148
    v_add_f32 v236, v236, v146
    v_add_f32 v249, v249, v147
    v_cvt_pk_bf16_f32 v145, v146, v147
    v_exp_f32 v149, v149
    v_exp_f32 v150, v150
    v_add_f32 v236, v236, v148
    v_add_f32 v249, v249, v149
    v_cvt_pk_bf16_f32 v146, v148, v149
    v_exp_f32 v151, v151
    v_exp_f32 v152, v152
    v_add_f32 v236, v236, v150
    v_add_f32 v249, v249, v151
    v_cvt_pk_bf16_f32 v147, v150, v151
    v_exp_f32 v153, v153
    v_exp_f32 v154, v154
    v_add_f32 v236, v236, v152
    v_add_f32 v249, v249, v153
    v_cvt_pk_bf16_f32 v152, v152, v153
    v_exp_f32 v155, v155
    v_exp_f32 v156, v156
    v_add_f32 v236, v236, v154
    v_add_f32 v249, v249, v155
    v_cvt_pk_bf16_f32 v153, v154, v155
    v_exp_f32 v157, v157
    s_branch REJ_BX_loop0
RRARE_BX_loop:
    ds_swizzle_b32 v251, v253 offset:0x401F
    s_waitcnt lgkmcnt(0)
    v_max_f32 v253, v253, v251
    v_mov_b32 v251, v253
    v_mov_b32 v252, v253
    s_nop 1
    v_permlane32_swap_b32 v251, v252
    v_max_f32 v253, v251, v252
    v_max_f32 v253, 0, v253
    v_exp_f32 v251, -v253
    v_sub_f32 v192, v192, v253
    v_sub_f32 v193, v193, v253
    v_sub_f32 v194, v194, v253
    v_sub_f32 v195, v195, v253
    v_sub_f32 v196, v196, v253
    v_sub_f32 v197, v197, v253
    v_sub_f32 v198, v198, v253
    v_sub_f32 v199, v199, v253
    v_sub_f32 v200, v200, v253
    v_sub_f32 v201, v201, v253
    v_sub_f32 v202, v202, v253
    v_sub_f32 v203, v203, v253
    v_mul_f32 v237, v237, v251
    v_mul_f32 v64, v64, v251
    v_mul_f32 v65, v65, v251
    v_mul_f32 v66, v66, v251
    v_mul_f32 v67, v67, v251
    v_mul_f32 v68, v68, v251
    v_mul_f32 v69, v69, v251
    v_mul_f32 v70, v70, v251
    v_mul_f32 v71, v71, v251
    v_mul_f32 v72, v72, v251
    v_mul_f32 v73, v73, v251
    v_mul_f32 v74, v74, v251
    v_mul_f32 v75, v75, v251
    v_mul_f32 v76, v76, v251
    v_mul_f32 v77, v77, v251
    v_mul_f32 v78, v78, v251
    v_mul_f32 v79, v79, v251
    v_mul_f32 v80, v80, v251
    v_mul_f32 v81, v81, v251
    v_mul_f32 v82, v82, v251
    v_mul_f32 v83, v83, v251
    v_mul_f32 v84, v84, v251
    v_mul_f32 v85, v85, v251
    v_mul_f32 v86, v86, v251
    v_mul_f32 v87, v87, v251
    v_mul_f32 v88, v88, v251
    v_mul_f32 v89, v89, v251
    v_mul_f32 v90, v90, v251
    v_mul_f32 v91, v91, v251
    v_mul_f32 v92, v92, v251
    v_mul_f32 v93, v93, v251
    v_mul_f32 v94, v94, v251
    v_mul_f32 v95, v95, v251
    s_branch RREJ_BX_loop
RARE_BX_loop1:
    s_waitcnt lgkmcnt(8)
    v_mfma_f32_16x16x32_bf16 v[88:91], v[228:231], v[192:195], v[88:91]
    ds_read_b64_tr_b16 v[220:221], v242 offset:4096
    ds_read_b64_tr_b16 v[222:223], v242 offset:6144
    v_mfma_f32_16x16x32_bf16 v[92:95], v[232:235], v[192:195], v[92:95]
    ds_read_b64_tr_b16 v[224:225], v243 offset:4096
    ds_read_b64_tr_b16 v[226:227], v243 offset:6144
    s_waitcnt lgkmcnt(8)
    v_mfma_f32_32x32x16_bf16 v[0:15], v[204:207], v[144:147], v[0:15]
    ds_read_b64_tr_b16 v[228:229], v242 offset:4608
    ds_read_b64_tr_b16 v[230:231], v242 offset:6656
    v_mfma_f32_32x32x16_bf16 v[16:31], v[208:211], v[144:147], v[16:31]
    ds_read_b64_tr_b16 v[232:233], v243 offset:4608
    ds_read_b64_tr_b16 v[234:235], v243 offset:6656
    s_waitcnt lgkmcnt(8)
    v_mfma_f32_32x32x16_bf16 v[32:47], v[212:215], v[144:147], v[32:47]
    v_add_u32 v238, s45, v238
    v_add_u32 v239, s45, v239
    v_add_u32 v240, s45, v240
    v_add_u32 v241, s45, v241
    v_add_u32 v242, s70, v242
    v_add_u32 v243, s70, v243
    v_add_u32 v246, s42, v244
    v_xor_b32 v247, 64, v246
    s_waitcnt lgkmcnt(0)
    s_barrier
    v_mfma_f32_32x32x16_bf16 v[48:63], v[216:219], v[144:147], v[48:63]
    v_mfma_f32_32x32x16_bf16 v[0:15], v[220:223], v[152:155], v[0:15]
    s_barrier
    ds_read_b128 v[204:207], v238 offset:0
    ds_read_b128 v[208:211], v239 offset:0
    ds_read_b128 v[212:215], v240 offset:0
    v_mfma_f32_32x32x16_bf16 v[16:31], v[224:227], v[152:155], v[16:31]
    ds_read_b128 v[216:219], v241 offset:0
    v_mfma_f32_32x32x16_bf16 v[32:47], v[228:231], v[152:155], v[32:47]
    ds_read_b128 v[220:223], v238 offset:512
    v_mfma_f32_32x32x16_bf16 v[48:63], v[232:235], v[152:155], v[48:63]
    v_mov_b32 v251, v250
    v_mov_b32 v252, v250
    s_nop 1
    v_permlane32_swap_b32 v251, v252
    v_max_f32 v250, v251, v252
    v_max_f32 v250, 0, v250
    v_exp_f32 v251, -v250
    v_sub_f32 v160, v160, v250
    v_sub_f32 v161, v161, v250
    v_sub_f32 v162, v162, v250
    v_sub_f32 v163, v163, v250
    v_sub_f32 v164, v164, v250
    v_sub_f32 v165, v165, v250
    v_sub_f32 v166, v166, v250
    v_sub_f32 v167, v167, v250
    v_sub_f32 v168, v168, v250
    v_sub_f32 v169, v169, v250
    v_sub_f32 v170, v170, v250
    v_sub_f32 v171, v171, v250
    v_sub_f32 v172, v172, v250
    v_sub_f32 v173, v173, v250
    v_sub_f32 v174, v174, v250
    v_sub_f32 v175, v175, v250
    v_sub_f32 v176, v176, v250
    v_sub_f32 v177, v177, v250
    v_sub_f32 v178, v178, v250
    v_sub_f32 v179, v179, v250
    v_sub_f32 v180, v180, v250
    v_sub_f32 v181, v181, v250
    v_sub_f32 v182, v182, v250
    v_sub_f32 v183, v183, v250
    v_sub_f32 v184, v184, v250
    v_sub_f32 v185, v185, v250
    v_sub_f32 v186, v186, v250
    v_sub_f32 v187, v187, v250
    v_sub_f32 v188, v188, v250
    v_sub_f32 v189, v189, v250
    v_sub_f32 v190, v190, v250
    v_sub_f32 v191, v191, v250
    v_mul_f32 v236, v236, v251
    v_mul_f32 v249, v249, v251
    v_mul_f32 v0, v0, v251
    v_mul_f32 v1, v1, v251
    v_mul_f32 v2, v2, v251
    v_mul_f32 v3, v3, v251
    v_mul_f32 v4, v4, v251
    v_mul_f32 v5, v5, v251
    v_mul_f32 v6, v6, v251
    v_mul_f32 v7, v7, v251
    v_mul_f32 v8, v8, v251
    v_mul_f32 v9, v9, v251
    v_mul_f32 v10, v10, v251
    v_mul_f32 v11, v11, v251
    v_mul_f32 v12, v12, v251
    v_mul_f32 v13, v13, v251
    v_mul_f32 v14, v14, v251
    v_mul_f32 v15, v15, v251
    v_mul_f32 v16, v16, v251
    v_mul_f32 v17, v17, v251
    v_mul_f32 v18, v18, v251
    v_mul_f32 v19, v19, v251
    v_mul_f32 v20, v20, v251
    v_mul_f32 v21, v21, v251
    v_mul_f32 v22, v22, v251
    v_mul_f32 v23, v23, v251
    v_mul_f32 v24, v24, v251
    v_mul_f32 v25, v25, v251
    v_mul_f32 v26, v26, v251
    v_mul_f32 v27, v27, v251
    v_mul_f32 v28, v28, v251
    v_mul_f32 v29, v29, v251
    v_mul_f32 v30, v30, v251
    v_mul_f32 v31, v31, v251
    v_mul_f32 v32, v32, v251
    v_mul_f32 v33, v33, v251
    v_mul_f32 v34, v34, v251
    v_mul_f32 v35, v35, v251
    v_mul_f32 v36, v36, v251
    v_mul_f32 v37, v37, v251
    v_mul_f32 v38, v38, v251
    v_mul_f32 v39, v39, v251
    v_mul_f32 v40, v40, v251
    v_mul_f32 v41, v41, v251
    v_mul_f32 v42, v42, v251
    v_mul_f32 v43, v43, v251
    v_mul_f32 v44, v44, v251
    v_mul_f32 v45, v45, v251
    v_mul_f32 v46, v46, v251
    v_mul_f32 v47, v47, v251
    v_mul_f32 v48, v48, v251
    v_mul_f32 v49, v49, v251
    v_mul_f32 v50, v50, v251
    v_mul_f32 v51, v51, v251
    v_mul_f32 v52, v52, v251
    v_mul_f32 v53, v53, v251
    v_mul_f32 v54, v54, v251
    v_mul_f32 v55, v55, v251
    v_mul_f32 v56, v56, v251
    v_mul_f32 v57, v57, v251
    v_mul_f32 v58, v58, v251
    v_mul_f32 v59, v59, v251
    v_mul_f32 v60, v60, v251
    v_mul_f32 v61, v61, v251
    v_mul_f32 v62, v62, v251
    v_mul_f32 v63, v63, v251
    v_exp_f32 v160, v160
    v_exp_f32 v161, v161
    v_exp_f32 v162, v162
    v_add_f32 v236, v236, v160
    v_add_f32 v249, v249, v161
    v_cvt_pk_bf16_f32 v160, v160, v161
    v_exp_f32 v163, v163
    v_exp_f32 v164, v164
    v_add_f32 v236, v236, v162
    v_add_f32 v249, v249, v163
    v_cvt_pk_bf16_f32 v161, v162, v163
    v_exp_f32 v165, v165
    v_exp_f32 v166, v166
    v_add_f32 v236, v236, v164
    v_add_f32 v249, v249, v165
    v_cvt_pk_bf16_f32 v162, v164, v165
    v_exp_f32 v167, v167
    v_exp_f32 v168, v168
    v_add_f32 v236, v236, v166
    v_add_f32 v249, v249, v167
    v_cvt_pk_bf16_f32 v163, v166, v167
    v_exp_f32 v169, v169
    s_branch REJ_BX_loop1
RARE_BX_last0:
    s_waitcnt lgkmcnt(8)
    v_mfma_f32_16x16x32_bf16 v[192:195], v[228:231], v[140:143], v[192:195]
    ds_read_b64_tr_b16 v[220:221], v242 offset:4096
    ds_read_b64_tr_b16 v[222:223], v242 offset:6144
    v_mfma_f32_16x16x32_bf16 v[196:199], v[232:235], v[140:143], v[196:199]
    ds_read_b64_tr_b16 v[224:225], v243 offset:4096
    ds_read_b64_tr_b16 v[226:227], v243 offset:6144
    s_waitcnt lgkmcnt(8)
    v_mfma_f32_32x32x16_bf16 v[0:15], v[204:207], v[160:163], v[0:15]
    ds_read_b64_tr_b16 v[228:229], v242 offset:4608
    ds_read_b64_tr_b16 v[230:231], v242 offset:6656
    v_mfma_f32_32x32x16_bf16 v[16:31], v[208:211], v[160:163], v[16:31]
    ds_read_b64_tr_b16 v[232:233], v243 offset:4608
    ds_read_b64_tr_b16 v[234:235], v243 offset:6656
    s_waitcnt lgkmcnt(8)
    v_mfma_f32_32x32x16_bf16 v[32:47], v[212:215], v[160:163], v[32:47]
    v_add_u32 v238, s45, v238
    v_add_u32 v239, s45, v239
    v_add_u32 v240, s45, v240
    v_add_u32 v241, s45, v241
    v_add_u32 v242, s70, v242
    v_add_u32 v243, s70, v243
    v_add_u32 v246, s47, v245
    v_xor_b32 v247, 64, v246
    s_waitcnt lgkmcnt(0)
    s_barrier
    v_mfma_f32_32x32x16_bf16 v[48:63], v[216:219], v[160:163], v[48:63]
    v_mfma_f32_32x32x16_bf16 v[0:15], v[220:223], v[168:171], v[0:15]
    s_barrier
    ds_read_b128 v[204:207], v238 offset:0
    ds_read_b128 v[208:211], v239 offset:0
    ds_read_b128 v[212:215], v240 offset:0
    v_mfma_f32_32x32x16_bf16 v[16:31], v[224:227], v[168:171], v[16:31]
    ds_read_b128 v[216:219], v241 offset:0
    v_mfma_f32_32x32x16_bf16 v[32:47], v[228:231], v[168:171], v[32:47]
    ds_read_b128 v[220:223], v238 offset:512
    v_mfma_f32_32x32x16_bf16 v[48:63], v[232:235], v[168:171], v[48:63]
    v_mov_b32 v251, v250
    v_mov_b32 v252, v250
    s_nop 1
    v_permlane32_swap_b32 v251, v252
    v_max_f32 v250, v251, v252
    v_max_f32 v250, 0, v250
    v_exp_f32 v251, -v250
    v_sub_f32 v144, v144, v250
    v_sub_f32 v145, v145, v250
    v_sub_f32 v146, v146, v250
    v_sub_f32 v147, v147, v250
    v_sub_f32 v148, v148, v250
    v_sub_f32 v149, v149, v250
    v_sub_f32 v150, v150, v250
    v_sub_f32 v151, v151, v250
    v_sub_f32 v152, v152, v250
    v_sub_f32 v153, v153, v250
    v_sub_f32 v154, v154, v250
    v_sub_f32 v155, v155, v250
    v_sub_f32 v156, v156, v250
    v_sub_f32 v157, v157, v250
    v_sub_f32 v158, v158, v250
    v_sub_f32 v159, v159, v250
    v_sub_f32 v176, v176, v250
    v_sub_f32 v177, v177, v250
    v_sub_f32 v178, v178, v250
    v_sub_f32 v179, v179, v250
    v_sub_f32 v180, v180, v250
    v_sub_f32 v181, v181, v250
    v_sub_f32 v182, v182, v250
    v_sub_f32 v183, v183, v250
    v_sub_f32 v184, v184, v250
    v_sub_f32 v185, v185, v250
    v_sub_f32 v186, v186, v250
    v_sub_f32 v187, v187, v250
    v_sub_f32 v188, v188, v250
    v_sub_f32 v189, v189, v250
    v_sub_f32 v190, v190, v250
    v_sub_f32 v191, v191, v250
    v_mul_f32 v236, v236, v251
    v_mul_f32 v249, v249, v251
    v_mul_f32 v0, v0, v251
    v_mul_f32 v1, v1, v251
    v_mul_f32 v2, v2, v251
    v_mul_f32 v3, v3, v251
    v_mul_f32 v4, v4, v251
    v_mul_f32 v5, v5, v251
    v_mul_f32 v6, v6, v251
    v_mul_f32 v7, v7, v251
    v_mul_f32 v8, v8, v251
    v_mul_f32 v9, v9, v251
    v_mul_f32 v10, v10, v251
    v_mul_f32 v11, v11, v251
    v_mul_f32 v12, v12, v251
    v_mul_f32 v13, v13, v251
    v_mul_f32 v14, v14, v251
    v_mul_f32 v15, v15, v251
    v_mul_f32 v16, v16, v251
    v_mul_f32 v17, v17, v251
    v_mul_f32 v18, v18, v251
    v_mul_f32 v19, v19, v251
    v_mul_f32 v20, v20, v251
    v_mul_f32 v21, v21, v251
    v_mul_f32 v22, v22, v251
    v_mul_f32 v23, v23, v251
    v_mul_f32 v24, v24, v251
    v_mul_f32 v25, v25, v251
    v_mul_f32 v26, v26, v251
    v_mul_f32 v27, v27, v251
    v_mul_f32 v28, v28, v251
    v_mul_f32 v29, v29, v251
    v_mul_f32 v30, v30, v251
    v_mul_f32 v31, v31, v251
    v_mul_f32 v32, v32, v251
    v_mul_f32 v33, v33, v251
    v_mul_f32 v34, v34, v251
    v_mul_f32 v35, v35, v251
    v_mul_f32 v36, v36, v251
    v_mul_f32 v37, v37, v251
    v_mul_f32 v38, v38, v251
    v_mul_f32 v39, v39, v251
    v_mul_f32 v40, v40, v251
    v_mul_f32 v41, v41, v251
    v_mul_f32 v42, v42, v251
    v_mul_f32 v43, v43, v251
    v_mul_f32 v44, v44, v251
    v_mul_f32 v45, v45, v251
    v_mul_f32 v46, v46, v251
    v_mul_f32 v47, v47, v251
    v_mul_f32 v48, v48, v251
    v_mul_f32 v49, v49, v251
    v_mul_f32 v50, v50, v251
    v_mul_f32 v51, v51, v251
    v_mul_f32 v52, v52, v251
    v_mul_f32 v53, v53, v251
    v_mul_f32 v54, v54, v251
    v_mul_f32 v55, v55, v251
    v_mul_f32 v56, v56, v251
    v_mul_f32 v57, v57, v251
    v_mul_f32 v58, v58, v251
    v_mul_f32 v59, v59, v251
    v_mul_f32 v60, v60, v251
    v_mul_f32 v61, v61, v251
    v_mul_f32 v62, v62, v251
    v_mul_f32 v63, v63, v251
    v_exp_f32 v144, v144
    v_exp_f32 v145, v145
    v_exp_f32 v146, v146
    v_add_f32 v236, v236, v144
    v_add_f32 v249, v249, v145
    v_cvt_pk_bf16_f32 v144, v144, v145
    v_exp_f32 v147, v147
    v_exp_f32 v148, v148
    v_add_f32 v236, v236, v146
    v_add_f32 v249, v249, v147
    v_cvt_pk_bf16_f32 v145, v146, v147
    v_exp_f32 v149, v149
    v_exp_f32 v150, v150
    v_add_f32 v236, v236, v148
    v_add_f32 v249, v249, v149
    v_cvt_pk_bf16_f32 v146, v148, v149
    v_exp_f32 v151, v151
    v_exp_f32 v152, v152
    v_add_f32 v236, v236, v150
    v_add_f32 v249, v249, v151
    v_cvt_pk_bf16_f32 v147, v150, v151
    v_exp_f32 v153, v153
    v_exp_f32 v154, v154
    v_add_f32 v236, v236, v152
    v_add_f32 v249, v249, v153
    v_cvt_pk_bf16_f32 v152, v152, v153
    v_exp_f32 v155, v155
    v_exp_f32 v156, v156
    v_add_f32 v236, v236, v154
    v_add_f32 v249, v249, v155
    v_cvt_pk_bf16_f32 v153, v154, v155
    v_exp_f32 v157, v157
    s_branch REJ_BX_last0
RRARE_BX_last:
    ds_swizzle_b32 v251, v253 offset:0x401F
    s_waitcnt lgkmcnt(0)
    v_max_f32 v253, v253, v251
    v_mov_b32 v251, v253
    v_mov_b32 v252, v253
    s_nop 1
    v_permlane32_swap_b32 v251, v252
    v_max_f32 v253, v251, v252
    v_max_f32 v253, 0, v253
    v_exp_f32 v251, -v253
    v_sub_f32 v192, v192, v253
    v_sub_f32 v193, v193, v253
    v_sub_f32 v194, v194, v253
    v_sub_f32 v195, v195, v253
    v_sub_f32 v196, v196, v253
    v_sub_f32 v197, v197, v253
    v_sub_f32 v198, v198, v253
    v_sub_f32 v199, v199, v253
    v_sub_f32 v200, v200, v253
    v_sub_f32 v201, v201, v253
    v_sub_f32 v202, v202, v253
    v_sub_f32 v203, v203, v253
    v_mul_f32 v237, v237, v251
    v_mul_f32 v64, v64, v251
    v_mul_f32 v65, v65, v251
    v_mul_f32 v66, v66, v251
    v_mul_f32 v67, v67, v251
    v_mul_f32 v68, v68, v251
    v_mul_f32 v69, v69, v251
    v_mul_f32 v70, v70, v251
    v_mul_f32 v71, v71, v251
    v_mul_f32 v72, v72, v251
    v_mul_f32 v73, v73, v251
    v_mul_f32 v74, v74, v251
    v_mul_f32 v75, v75, v251
    v_mul_f32 v76, v76, v251
    v_mul_f32 v77, v77, v251
    v_mul_f32 v78, v78, v251
    v_mul_f32 v79, v79, v251
    v_mul_f32 v80, v80, v251
    v_mul_f32 v81, v81, v251
    v_mul_f32 v82, v82, v251
    v_mul_f32 v83, v83, v251
    v_mul_f32 v84, v84, v251
    v_mul_f32 v85, v85, v251
    v_mul_f32 v86, v86, v251
    v_mul_f32 v87, v87, v251
    v_mul_f32 v88, v88, v251
    v_mul_f32 v89, v89, v251
    v_mul_f32 v90, v90, v251
    v_mul_f32 v91, v91, v251
    v_mul_f32 v92, v92, v251
    v_mul_f32 v93, v93, v251
    v_mul_f32 v94, v94, v251
    v_mul_f32 v95, v95, v251
    s_branch RREJ_BX_last
RARE_BX_last1:
    s_waitcnt lgkmcnt(8)
    v_mfma_f32_16x16x32_bf16 v[80:83], v[220:223], v[192:195], v[80:83]
    ds_read_b64_tr_b16 v[212:213], v242 offset:512
    ds_read_b64_tr_b16 v[214:215], v242 offset:2560
    v_mfma_f32_16x16x32_bf16 v[84:87], v[224:227], v[192:195], v[84:87]
    ds_read_b64_tr_b16 v[216:217], v243 offset:512
    ds_read_b64_tr_b16 v[218:219], v243 offset:2560
    s_waitcnt lgkmcnt(8)
    v_mfma_f32_16x16x32_bf16 v[88:91], v[228:231], v[192:195], v[88:91]
    ds_read_b64_tr_b16 v[220:221], v242 offset:4096
    ds_read_b64_tr_b16 v[222:223], v242 offset:6144
    v_mfma_f32_16x16x32_bf16 v[92:95], v[232:235], v[192:195], v[92:95]
    ds_read_b64_tr_b16 v[224:225], v243 offset:4096
    ds_read_b64_tr_b16 v[226:227], v243 offset:6144
    s_waitcnt lgkmcnt(8)
    v_mfma_f32_32x32x16_bf16 v[0:15], v[204:207], v[144:147], v[0:15]
    ds_read_b64_tr_b16 v[228:229], v242 offset:4608
    ds_read_b64_tr_b16 v[230:231], v242 offset:6656
    v_mfma_f32_32x32x16_bf16 v[16:31], v[208:211], v[144:147], v[16:31]
    ds_read_b64_tr_b16 v[232:233], v243 offset:4608
    ds_read_b64_tr_b16 v[234:235], v243 offset:6656
    s_waitcnt lgkmcnt(8)
    v_mfma_f32_32x32x16_bf16 v[32:47], v[212:215], v[144:147], v[32:47]
    v_add_u32 v238, s45, v238
    v_add_u32 v239, s45, v239
    v_add_u32 v240, s45, v240
    v_add_u32 v241, s45, v241
    v_add_u32 v242, s70, v242
    v_add_u32 v243, s70, v243
    v_add_u32 v246, s42, v244
    v_xor_b32 v247, 64, v246
    s_waitcnt lgkmcnt(0)
    s_barrier
    v_mfma_f32_32x32x16_bf16 v[48:63], v[216:219], v[144:147], v[48:63]
    v_mfma_f32_32x32x16_bf16 v[0:15], v[220:223], v[152:155], v[0:15]
    s_barrier
    v_mfma_f32_32x32x16_bf16 v[16:31], v[224:227], v[152:155], v[16:31]
    v_mfma_f32_32x32x16_bf16 v[32:47], v[228:231], v[152:155], v[32:47]
    v_mfma_f32_32x32x16_bf16 v[48:63], v[232:235], v[152:155], v[48:63]
    v_mov_b32 v251, v250
    v_mov_b32 v252, v250
    s_nop 1
    v_permlane32_swap_b32 v251, v252
    v_max_f32 v250, v251, v252
    v_max_f32 v250, 0, v250
    v_exp_f32 v251, -v250
    v_sub_f32 v160, v160, v250
    v_sub_f32 v161, v161, v250
    v_sub_f32 v162, v162, v250
    v_sub_f32 v163, v163, v250
    v_sub_f32 v164, v164, v250
    v_sub_f32 v165, v165, v250
    v_sub_f32 v166, v166, v250
    v_sub_f32 v167, v167, v250
    v_sub_f32 v168, v168, v250
    v_sub_f32 v169, v169, v250
    v_sub_f32 v170, v170, v250
    v_sub_f32 v171, v171, v250
    v_sub_f32 v172, v172, v250
    v_sub_f32 v173, v173, v250
    v_sub_f32 v174, v174, v250
    v_sub_f32 v175, v175, v250
    v_sub_f32 v176, v176, v250
    v_sub_f32 v177, v177, v250
    v_sub_f32 v178, v178, v250
    v_sub_f32 v179, v179, v250
    v_sub_f32 v180, v180, v250
    v_sub_f32 v181, v181, v250
    v_sub_f32 v182, v182, v250
    v_sub_f32 v183, v183, v250
    v_sub_f32 v184, v184, v250
    v_sub_f32 v185, v185, v250
    v_sub_f32 v186, v186, v250
    v_sub_f32 v187, v187, v250
    v_sub_f32 v188, v188, v250
    v_sub_f32 v189, v189, v250
    v_sub_f32 v190, v190, v250
    v_sub_f32 v191, v191, v250
    v_mul_f32 v236, v236, v251
    v_mul_f32 v249, v249, v251
    v_mul_f32 v0, v0, v251
    v_mul_f32 v1, v1, v251
    v_mul_f32 v2, v2, v251
    v_mul_f32 v3, v3, v251
    v_mul_f32 v4, v4, v251
    v_mul_f32 v5, v5, v251
    v_mul_f32 v6, v6, v251
    v_mul_f32 v7, v7, v251
    v_mul_f32 v8, v8, v251
    v_mul_f32 v9, v9, v251
    v_mul_f32 v10, v10, v251
    v_mul_f32 v11, v11, v251
    v_mul_f32 v12, v12, v251
    v_mul_f32 v13, v13, v251
    v_mul_f32 v14, v14, v251
    v_mul_f32 v15, v15, v251
    v_mul_f32 v16, v16, v251
    v_mul_f32 v17, v17, v251
    v_mul_f32 v18, v18, v251
    v_mul_f32 v19, v19, v251
    v_mul_f32 v20, v20, v251
    v_mul_f32 v21, v21, v251
    v_mul_f32 v22, v22, v251
    v_mul_f32 v23, v23, v251
    v_mul_f32 v24, v24, v251
    v_mul_f32 v25, v25, v251
    v_mul_f32 v26, v26, v251
    v_mul_f32 v27, v27, v251
    v_mul_f32 v28, v28, v251
    v_mul_f32 v29, v29, v251
    v_mul_f32 v30, v30, v251
    v_mul_f32 v31, v31, v251
    v_mul_f32 v32, v32, v251
    v_mul_f32 v33, v33, v251
    v_mul_f32 v34, v34, v251
    v_mul_f32 v35, v35, v251
    v_mul_f32 v36, v36, v251
    v_mul_f32 v37, v37, v251
    v_mul_f32 v38, v38, v251
    v_mul_f32 v39, v39, v251
    v_mul_f32 v40, v40, v251
    v_mul_f32 v41, v41, v251
    v_mul_f32 v42, v42, v251
    v_mul_f32 v43, v43, v251
    v_mul_f32 v44, v44, v251
    v_mul_f32 v45, v45, v251
    v_mul_f32 v46, v46, v251
    v_mul_f32 v47, v47, v251
    v_mul_f32 v48, v48, v251
    v_mul_f32 v49, v49, v251
    v_mul_f32 v50, v50, v251
    v_mul_f32 v51, v51, v251
    v_mul_f32 v52, v52, v251
    v_mul_f32 v53, v53, v251
    v_mul_f32 v54, v54, v251
    v_mul_f32 v55, v55, v251
    v_mul_f32 v56, v56, v251
    v_mul_f32 v57, v57, v251
    v_mul_f32 v58, v58, v251
    v_mul_f32 v59, v59, v251
    v_mul_f32 v60, v60, v251
    v_mul_f32 v61, v61, v251
    v_mul_f32 v62, v62, v251
    v_mul_f32 v63, v63, v251
    v_exp_f32 v160, v160
    v_exp_f32 v161, v161
    v_exp_f32 v162, v162
    v_add_f32 v236, v236, v160
    v_add_f32 v249, v249, v161
    v_cvt_pk_bf16_f32 v160, v160, v161
    v_exp_f32 v163, v163
    v_exp_f32 v164, v164
    v_add_f32 v236, v236, v162
    v_add_f32 v249, v249, v163
    v_cvt_pk_bf16_f32 v161, v162, v163
    v_exp_f32 v165, v165
    v_exp_f32 v166, v166
    v_add_f32 v236, v236, v164
    v_add_f32 v249, v249, v165
    v_cvt_pk_bf16_f32 v162, v164, v165
    v_exp_f32 v167, v167
    v_exp_f32 v168, v168
    v_add_f32 v236, v236, v166
    v_add_f32 v249, v249, v167
    v_cvt_pk_bf16_f32 v163, v166, v167
    v_exp_f32 v169, v169
    v_exp_f32 v170, v170
    v_add_f32 v236, v236, v168
    v_add_f32 v249, v249, v169
    v_cvt_pk_bf16_f32 v168, v168, v169
    v_exp_f32 v171, v171
    v_exp_f32 v172, v172
    v_add_f32 v236, v236, v170
    v_add_f32 v249, v249, v171
    v_cvt_pk_bf16_f32 v169, v170, v171
    v_exp_f32 v173, v173
    v_exp_f32 v174, v174
    v_add_f32 v236, v236, v172
    v_add_f32 v249, v249, v173
    v_cvt_pk_bf16_f32 v170, v172, v173
    s_branch REJ_BX_last1
ATT_BL:
    s_setprio 0
    ds_read_b128 v[204:207], v238 offset:0
    ds_read_b128 v[208:211], v239 offset:0
    ds_read_b128 v[212:215], v240 offset:0
    ds_read_b128 v[216:219], v241 offset:0
    ds_read_b128 v[220:223], v238 offset:512
    ds_read_b128 v[224:227], v239 offset:512
    ds_read_b128 v[228:231], v240 offset:512
    ds_read_b128 v[232:235], v241 offset:512
    s_waitcnt lgkmcnt(7)
    v_mfma_f32_32x32x16_bf16 v[144:159], v[204:207], v[96:99], 0
    s_waitcnt lgkmcnt(6)
    v_mfma_f32_32x32x16_bf16 v[144:159], v[208:211], v[100:103], v[144:159]
    s_waitcnt lgkmcnt(5)
    v_mfma_f32_32x32x16_bf16 v[144:159], v[212:215], v[104:107], v[144:159]
    s_waitcnt lgkmcnt(4)
    v_mfma_f32_32x32x16_bf16 v[144:159], v[216:219], v[108:111], v[144:159]
    s_waitcnt lgkmcnt(3)
    v_mfma_f32_32x32x16_bf16 v[144:159], v[220:223], v[112:115], v[144:159]
    s_waitcnt lgkmcnt(2)
    v_mfma_f32_32x32x16_bf16 v[144:159], v[224:227], v[116:119], v[144:159]
    s_waitcnt lgkmcnt(1)
    v_mfma_f32_32x32x16_bf16 v[144:159], v[228:231], v[120:123], v[144:159]
    s_waitcnt lgkmcnt(0)
    v_mfma_f32_32x32x16_bf16 v[144:159], v[232:235], v[124:127], v[144:159]
    v_mov_b32 v236, 0
    v_mov_b32 v65, 0
    v_mov_b32 v237, 0
    v_xor_b32 v64, 64, v248
    s_lshl_b32 s51, s37, 6
    s_add_u32 s51, s51, 0x24000
    s_lshl_b32 s52, s38, 2
    s_add_u32 s52, s52, s51
    s_and_b32 s52, s36, 1
    s_lshl_b32 s52, s52, 2
    s_add_u32 s52, s52, s51
    v_mov_b32 v72, s52
    s_mov_b32 s71, 0
    s_mov_b32 s47, 0xc000
    v_max3_f32 v250, v144, v145, v146
    v_max3_f32 v250, v250, v147, v148
    v_max3_f32 v250, v250, v149, v150
    v_max3_f32 v250, v250, v151, v152
    v_max3_f32 v250, v250, v153, v154
    v_max3_f32 v250, v250, v155, v156
    v_max3_f32 v250, v250, v157, v158
    v_max_f32 v250, v250, v159
    v_mov_b32 v251, v250
    v_mov_b32 v252, v250
    s_nop 1
    v_permlane32_swap_b32 v251, v252
    v_max_f32 v250, v251, v252
    v_sub_f32 v176, 0, v250
    v_sub_f32 v177, 0, v250
    v_sub_f32 v178, 0, v250
    v_sub_f32 v179, 0, v250
    v_sub_f32 v180, 0, v250
    v_sub_f32 v181, 0, v250
    v_sub_f32 v182, 0, v250
    v_sub_f32 v183, 0, v250
    v_sub_f32 v184, 0, v250
    v_sub_f32 v185, 0, v250
    v_sub_f32 v186, 0, v250
    v_sub_f32 v187, 0, v250
    v_sub_f32 v188, 0, v250
    v_sub_f32 v189, 0, v250
    v_sub_f32 v190, 0, v250
    v_sub_f32 v191, 0, v250
    v_sub_f32 v144, v144, v250
    v_sub_f32 v145, v145, v250
    v_sub_f32 v146, v146, v250
    v_sub_f32 v147, v147, v250
    v_sub_f32 v148, v148, v250
    v_sub_f32 v149, v149, v250
    v_sub_f32 v150, v150, v250
    v_sub_f32 v151, v151, v250
    v_sub_f32 v152, v152, v250
    v_sub_f32 v153, v153, v250
    v_sub_f32 v154, v154, v250
    v_sub_f32 v155, v155, v250
    v_sub_f32 v156, v156, v250
    v_sub_f32 v157, v157, v250
    v_sub_f32 v158, v158, v250
    v_sub_f32 v159, v159, v250
    s_mov_b32 s50, 14
    s_add_u32 s71, s71, 1
    s_mov_b32 s44, s42
    s_add_u32 s42, s42, 0x4000
    s_cmp_ge_u32 s42, 0x14000
    s_cselect_b32 s42, 0, s42
    s_sub_u32 s45, s42, s44
    s_mov_b32 s69, s47
    s_add_u32 s47, s47, 0x4000
    s_cmp_ge_u32 s47, 0x10000
    s_cselect_b32 s47, 0, s47
    s_sub_u32 s70, s47, s69
    s_add_u32 s48, s48, 0x2000
    s_and_b32 s48, s48, 0x3ffff
    s_add_u32 s46, s46, 0x2000
    s_and_b32 s46, s46, 0x3ffff
    s_cmp_lt_u32 s71, 28
    s_cselect_b32 s14, 0x40000, 0
    s_cselect_b32 s44, s44, 0x30000
    s_cmp_lt_u32 s71, 30
    s_cselect_b32 s18, 0x40000, 0
    s_cselect_b32 s69, s69, 0x1c000
    v_add_u32 v238, s45, v238
    v_add_u32 v239, s45, v239
    v_add_u32 v240, s45, v240
    v_add_u32 v241, s45, v241
    v_add_u32 v242, s70, v242
    v_add_u32 v243, s70, v243
    s_waitcnt lgkmcnt(0)
    s_barrier
    s_waitcnt vmcnt(12)
    s_barrier
    ds_read_b128 v[204:207], v238 offset:0
    ds_read_b128 v[208:211], v239 offset:0
    ds_read_b128 v[212:215], v240 offset:0
    ds_read_b128 v[216:219], v241 offset:0
    ds_read_b128 v[220:223], v238 offset:512
    ds_read_b128 v[224:227], v239 offset:512
    s_waitcnt lgkmcnt(4)
    v_mfma_f32_32x32x16_bf16 v[160:175], v[204:207], v[96:99], v[176:191]
    ds_read_b128 v[228:231], v240 offset:512
    s_add_u32 s53, s69, 0x14000
    s_add_u32 m0, s53, s59
    s_add_u32 s53, s46, 0x1000
    buffer_load_dwordx4 v249, s[16:19], s46 offen nt lds
    v_exp_f32 v144, v144
    v_exp_f32 v145, v145
    v_exp_f32 v146, v146
    v_add_f32 v236, v236, v144
    v_mfma_f32_32x32x16_bf16 v[160:175], v[208:211], v[100:103], v[160:175]
    ds_read_b128 v[232:235], v241 offset:512
    buffer_load_dwordx4 v249, s[16:19], s46 offen offset:2048 nt lds
    v_add_f32 v65, v65, v145
    v_cvt_pk_bf16_f32 v144, v144, v145
    v_exp_f32 v147, v147
    v_exp_f32 v148, v148
    v_add_f32 v236, v236, v146
    s_waitcnt lgkmcnt(4)
    v_mfma_f32_32x32x16_bf16 v[160:175], v[212:215], v[104:107], v[160:175]
    ds_read_b64_tr_b16 v[204:205], v242 offset:0
    ds_read_b64_tr_b16 v[206:207], v242 offset:2048
    s_add_u32 m0, m0, 0x1000
    s_nop 0
    buffer_load_dwordx4 v249, s[16:19], s53 offen nt lds
    v_add_f32 v65, v65, v147
    v_cvt_pk_bf16_f32 v145, v146, v147
    v_exp_f32 v149, v149
    v_exp_f32 v150, v150
    v_add_f32 v236, v236, v148
    v_mfma_f32_32x32x16_bf16 v[160:175], v[216:219], v[108:111], v[160:175]
    ds_read_b64_tr_b16 v[208:209], v243 offset:0
    ds_read_b64_tr_b16 v[210:211], v243 offset:2048
    buffer_load_dwordx4 v249, s[16:19], s53 offen offset:2048 nt lds
    v_add_f32 v65, v65, v149
    v_cvt_pk_bf16_f32 v146, v148, v149
    v_exp_f32 v151, v151
    v_exp_f32 v152, v152
    v_add_f32 v236, v236, v150
    s_waitcnt lgkmcnt(6)
    v_mfma_f32_32x32x16_bf16 v[160:175], v[220:223], v[112:115], v[160:175]
    ds_read_b64_tr_b16 v[212:213], v242 offset:512
    ds_read_b64_tr_b16 v[214:215], v242 offset:2560
    s_add_u32 m0, s44, s59
    s_add_u32 s52, s48, 0x1000
    buffer_load_dwordx4 v248, s[12:15], s48 offen nt lds
    v_add_f32 v65, v65, v151
    v_cvt_pk_bf16_f32 v147, v150, v151
    v_exp_f32 v153, v153
    v_exp_f32 v154, v154
    v_add_f32 v236, v236, v152
    v_mfma_f32_32x32x16_bf16 v[160:175], v[224:227], v[116:119], v[160:175]
    ds_read_b64_tr_b16 v[216:217], v243 offset:512
    ds_read_b64_tr_b16 v[218:219], v243 offset:2560
    buffer_load_dwordx4 v64, s[12:15], s48 offen offset:2048 nt lds
    v_add_f32 v65, v65, v153
    v_cvt_pk_bf16_f32 v152, v152, v153
    v_exp_f32 v155, v155
    v_exp_f32 v156, v156
    v_add_f32 v236, v236, v154
    s_waitcnt lgkmcnt(8)
    v_mfma_f32_32x32x16_bf16 v[160:175], v[228:231], v[120:123], v[160:175]
    ds_read_b64_tr_b16 v[220:221], v242 offset:4096
    ds_read_b64_tr_b16 v[222:223], v242 offset:6144
    s_add_u32 m0, m0, 0x1000
    s_nop 0
    buffer_load_dwordx4 v248, s[12:15], s52 offen nt lds
    v_add_f32 v65, v65, v155
    v_cvt_pk_bf16_f32 v153, v154, v155
    v_exp_f32 v157, v157
    v_exp_f32 v158, v158
    v_add_f32 v236, v236, v156
    v_mfma_f32_32x32x16_bf16 v[160:175], v[232:235], v[124:127], v[160:175]
    ds_read_b64_tr_b16 v[224:225], v243 offset:4096
    ds_read_b64_tr_b16 v[226:227], v243 offset:6144
    buffer_load_dwordx4 v64, s[12:15], s52 offen offset:2048 nt lds
    v_add_f32 v65, v65, v157
    v_cvt_pk_bf16_f32 v154, v156, v157
    v_exp_f32 v159, v159
    v_add_f32 v236, v236, v158
    v_add_f32 v65, v65, v159
    v_cvt_pk_bf16_f32 v155, v158, v159
    s_add_u32 s71, s71, 1
    s_waitcnt lgkmcnt(8)
    v_mfma_f32_32x32x16_bf16 v[0:15], v[204:207], v[144:147], 0
    ds_read_b64_tr_b16 v[228:229], v242 offset:4608
    ds_read_b64_tr_b16 v[230:231], v242 offset:6656
    s_mov_b32 s44, s42
    s_add_u32 s42, s42, 0x4000
    s_cmp_ge_u32 s42, 0x14000
    s_cselect_b32 s42, 0, s42
    s_sub_u32 s45, s42, s44
    s_mov_b32 s69, s47
    v_mfma_f32_32x32x16_bf16 v[16:31], v[208:211], v[144:147], 0
    ds_read_b64_tr_b16 v[232:233], v243 offset:4608
    ds_read_b64_tr_b16 v[234:235], v243 offset:6656
    s_add_u32 s47, s47, 0x4000
    s_cmp_ge_u32 s47, 0x10000
    s_cselect_b32 s47, 0, s47
    s_sub_u32 s70, s47, s69
    s_add_u32 s48, s48, 0x2000
    s_and_b32 s48, s48, 0x3ffff
    v_max3_f32 v250, v160, v161, v162
    v_max3_f32 v250, v250, v163, v164
    v_max3_f32 v250, v250, v165, v166
    v_max3_f32 v250, v250, v167, v168
    v_max3_f32 v250, v250, v169, v170
    s_waitcnt lgkmcnt(8)
    v_mfma_f32_32x32x16_bf16 v[32:47], v[212:215], v[144:147], 0
    s_add_u32 s46, s46, 0x2000
    s_and_b32 s46, s46, 0x3ffff
    s_cmp_lt_u32 s71, 28
    s_cselect_b32 s14, 0x40000, 0
    s_cselect_b32 s44, s44, 0x30000
    s_cmp_lt_u32 s71, 30
    s_cselect_b32 s18, 0x40000, 0
    s_cselect_b32 s69, s69, 0x1c000
    v_add_u32 v238, s45, v238
    v_add_u32 v239, s45, v239
    v_add_u32 v240, s45, v240
    v_add_u32 v241, s45, v241
    v_add_u32 v242, s70, v242
    v_add_u32 v243, s70, v243
    s_waitcnt lgkmcnt(0)
    s_barrier
    s_add_u32 s53, s69, 0x14000
    s_add_u32 m0, s53, s59
    s_add_u32 s53, s46, 0x1000
    buffer_load_dwordx4 v249, s[16:19], s46 offen nt lds
    v_max3_f32 v250, v250, v171, v172
    v_max3_f32 v250, v250, v173, v174
    v_max_f32 v250, v250, v175
    v_cmp_lt_f32 vcc, s58, v250
    s_cbranch_vccnz RARE_BL_first1
    v_exp_f32 v160, v160
    v_mfma_f32_32x32x16_bf16 v[48:63], v[216:219], v[144:147], 0
    buffer_load_dwordx4 v249, s[16:19], s46 offen offset:2048 nt lds
    v_exp_f32 v161, v161
    v_exp_f32 v162, v162
    v_add_f32 v236, v236, v160
    v_mfma_f32_32x32x16_bf16 v[0:15], v[220:223], v[152:155], v[0:15]
    s_waitcnt vmcnt(18)
    s_barrier
    ds_read_b128 v[204:207], v238 offset:0
    ds_read_b128 v[208:211], v239 offset:0
    ds_read_b128 v[212:215], v240 offset:0
    s_add_u32 m0, m0, 0x1000
    s_nop 0
    buffer_load_dwordx4 v249, s[16:19], s53 offen nt lds
    v_add_f32 v65, v65, v161
    v_cvt_pk_bf16_f32 v160, v160, v161
    v_exp_f32 v163, v163
    v_exp_f32 v164, v164
    v_mfma_f32_32x32x16_bf16 v[16:31], v[224:227], v[152:155], v[16:31]
    ds_read_b128 v[216:219], v241 offset:0
    buffer_load_dwordx4 v249, s[16:19], s53 offen offset:2048 nt lds
    v_add_f32 v236, v236, v162
    v_add_f32 v65, v65, v163
    v_cvt_pk_bf16_f32 v161, v162, v163
    v_exp_f32 v165, v165
    v_mfma_f32_32x32x16_bf16 v[32:47], v[228:231], v[152:155], v[32:47]
    ds_read_b128 v[220:223], v238 offset:512
    s_add_u32 m0, s44, s59
    s_add_u32 s52, s48, 0x1000
    buffer_load_dwordx4 v248, s[12:15], s48 offen nt lds
    v_exp_f32 v166, v166
    v_add_f32 v236, v236, v164
    v_add_f32 v65, v65, v165
    v_mfma_f32_32x32x16_bf16 v[48:63], v[232:235], v[152:155], v[48:63]
REJ_BL_first1:
    ds_read_b128 v[224:227], v239 offset:512
    buffer_load_dwordx4 v64, s[12:15], s48 offen offset:2048 nt lds
    v_cvt_pk_bf16_f32 v162, v164, v165
    v_exp_f32 v167, v167
    v_exp_f32 v168, v168
    s_waitcnt lgkmcnt(4)
    v_mfma_f32_32x32x16_bf16 v[144:159], v[204:207], v[96:99], v[176:191]
    ds_read_b128 v[228:231], v240 offset:512
    s_add_u32 m0, m0, 0x1000
    s_nop 0
    buffer_load_dwordx4 v248, s[12:15], s52 offen nt lds
    v_add_f32 v236, v236, v166
    v_add_f32 v65, v65, v167
    v_cvt_pk_bf16_f32 v163, v166, v167
    v_exp_f32 v169, v169
    v_mfma_f32_32x32x16_bf16 v[144:159], v[208:211], v[100:103], v[144:159]
    ds_read_b128 v[232:235], v241 offset:512
    buffer_load_dwordx4 v64, s[12:15], s52 offen offset:2048 nt lds
    v_exp_f32 v170, v170
    v_add_f32 v236, v236, v168
    v_add_f32 v65, v65, v169
    s_waitcnt lgkmcnt(4)
    v_mfma_f32_32x32x16_bf16 v[144:159], v[212:215], v[104:107], v[144:159]
    ds_read_b64_tr_b16 v[204:205], v242 offset:0
    ds_read_b64_tr_b16 v[206:207], v242 offset:2048
    v_cvt_pk_bf16_f32 v168, v168, v169
    v_exp_f32 v171, v171
    v_exp_f32 v172, v172
    v_mfma_f32_32x32x16_bf16 v[144:159], v[216:219], v[108:111], v[144:159]
    ds_read_b64_tr_b16 v[208:209], v243 offset:0
    ds_read_b64_tr_b16 v[210:211], v243 offset:2048
    v_add_f32 v236, v236, v170
    v_add_f32 v65, v65, v171
    v_cvt_pk_bf16_f32 v169, v170, v171
    s_waitcnt lgkmcnt(6)
    v_mfma_f32_32x32x16_bf16 v[144:159], v[220:223], v[112:115], v[144:159]
    ds_read_b64_tr_b16 v[212:213], v242 offset:512
    ds_read_b64_tr_b16 v[214:215], v242 offset:2560
    v_exp_f32 v173, v173
    v_exp_f32 v174, v174
    v_mfma_f32_32x32x16_bf16 v[144:159], v[224:227], v[116:119], v[144:159]
    ds_read_b64_tr_b16 v[216:217], v243 offset:512
    ds_read_b64_tr_b16 v[218:219], v243 offset:2560
    v_add_f32 v236, v236, v172
    v_add_f32 v65, v65, v173
    v_cvt_pk_bf16_f32 v170, v172, v173
    s_waitcnt lgkmcnt(8)
    v_mfma_f32_32x32x16_bf16 v[144:159], v[228:231], v[120:123], v[144:159]
    ds_read_b64_tr_b16 v[220:221], v242 offset:4096
    ds_read_b64_tr_b16 v[222:223], v242 offset:6144
    v_exp_f32 v175, v175
    v_add_f32 v236, v236, v174
    v_mfma_f32_32x32x16_bf16 v[144:159], v[232:235], v[124:127], v[144:159]
    ds_read_b64_tr_b16 v[224:225], v243 offset:4096
    ds_read_b64_tr_b16 v[226:227], v243 offset:6144
    v_add_f32 v65, v65, v175
    v_cvt_pk_bf16_f32 v171, v174, v175
LOOP_BL:
    s_add_u32 s71, s71, 1
    s_waitcnt lgkmcnt(8)
    v_mfma_f32_32x32x16_bf16 v[0:15], v[204:207], v[160:163], v[0:15]
    ds_read_b64_tr_b16 v[228:229], v242 offset:4608
    ds_read_b64_tr_b16 v[230:231], v242 offset:6656
    s_mov_b32 s44, s42
    s_add_u32 s42, s42, 0x4000
    s_cmp_ge_u32 s42, 0x14000
    s_cselect_b32 s42, 0, s42
    s_sub_u32 s45, s42, s44
    s_mov_b32 s69, s47
    v_mfma_f32_32x32x16_bf16 v[16:31], v[208:211], v[160:163], v[16:31]
    ds_read_b64_tr_b16 v[232:233], v243 offset:4608
    ds_read_b64_tr_b16 v[234:235], v243 offset:6656
    s_add_u32 s47, s47, 0x4000
    s_cmp_ge_u32 s47, 0x10000
    s_cselect_b32 s47, 0, s47
    s_sub_u32 s70, s47, s69
    s_add_u32 s48, s48, 0x2000
    s_and_b32 s48, s48, 0x3ffff
    v_max3_f32 v250, v144, v145, v146
    v_max3_f32 v250, v250, v147, v148
    v_max3_f32 v250, v250, v149, v150
    v_max3_f32 v250, v250, v151, v152
    v_max3_f32 v250, v250, v153, v154
    s_waitcnt lgkmcnt(8)
    v_mfma_f32_32x32x16_bf16 v[32:47], v[212:215], v[160:163], v[32:47]
    s_add_u32 s46, s46, 0x2000
    s_and_b32 s46, s46, 0x3ffff
    s_cmp_lt_u32 s71, 28
    s_cselect_b32 s14, 0x40000, 0
    s_cselect_b32 s44, s44, 0x30000
    s_cmp_lt_u32 s71, 30
    s_cselect_b32 s18, 0x40000, 0
    s_cselect_b32 s69, s69, 0x1c000
    v_add_u32 v238, s45, v238
    v_add_u32 v239, s45, v239
    v_add_u32 v240, s45, v240
    v_add_u32 v241, s45, v241
    v_add_u32 v242, s70, v242
    v_add_u32 v243, s70, v243
    s_waitcnt lgkmcnt(0)
    s_barrier
    s_add_u32 s53, s69, 0x14000
    s_add_u32 m0, s53, s59
    s_add_u32 s53, s46, 0x1000
    buffer_load_dwordx4 v249, s[16:19], s46 offen nt lds
    v_max3_f32 v250, v250, v155, v156
    v_max3_f32 v250, v250, v157, v158
    v_max_f32 v250, v250, v159
    v_cmp_lt_f32 vcc, s58, v250
    s_cbranch_vccnz RARE_BL_loop0
    v_exp_f32 v144, v144
    v_mfma_f32_32x32x16_bf16 v[48:63], v[216:219], v[160:163], v[48:63]
    buffer_load_dwordx4 v249, s[16:19], s46 offen offset:2048 nt lds
    v_exp_f32 v145, v145
    v_exp_f32 v146, v146
    v_add_f32 v236, v236, v144
    v_mfma_f32_32x32x16_bf16 v[0:15], v[220:223], v[168:171], v[0:15]
    s_waitcnt vmcnt(22)
    s_barrier
    ds_read_b128 v[204:207], v238 offset:0
    ds_read_b128 v[208:211], v239 offset:0
    ds_read_b128 v[212:215], v240 offset:0
    s_add_u32 m0, m0, 0x1000
    s_nop 0
    buffer_load_dwordx4 v249, s[16:19], s53 offen nt lds
    v_add_f32 v65, v65, v145
    v_cvt_pk_bf16_f32 v144, v144, v145
    v_exp_f32 v147, v147
    v_exp_f32 v148, v148
    v_mfma_f32_32x32x16_bf16 v[16:31], v[224:227], v[168:171], v[16:31]
    ds_read_b128 v[216:219], v241 offset:0
    buffer_load_dwordx4 v249, s[16:19], s53 offen offset:2048 nt lds
    v_add_f32 v236, v236, v146
    v_add_f32 v65, v65, v147
    v_cvt_pk_bf16_f32 v145, v146, v147
    v_exp_f32 v149, v149
    v_mfma_f32_32x32x16_bf16 v[32:47], v[228:231], v[168:171], v[32:47]
    ds_read_b128 v[220:223], v238 offset:512
    s_add_u32 m0, s44, s59
    s_add_u32 s52, s48, 0x1000
    buffer_load_dwordx4 v248, s[12:15], s48 offen nt lds
    v_exp_f32 v150, v150
    v_add_f32 v236, v236, v148
    v_add_f32 v65, v65, v149
    v_mfma_f32_32x32x16_bf16 v[48:63], v[232:235], v[168:171], v[48:63]
REJ_BL_loop0:
    ds_read_b128 v[224:227], v239 offset:512
    buffer_load_dwordx4 v64, s[12:15], s48 offen offset:2048 nt lds
    v_cvt_pk_bf16_f32 v146, v148, v149
    v_exp_f32 v151, v151
    v_exp_f32 v152, v152
    s_waitcnt lgkmcnt(4)
    v_mfma_f32_32x32x16_bf16 v[160:175], v[204:207], v[96:99], v[176:191]
    ds_read_b128 v[228:231], v240 offset:512
    s_add_u32 m0, m0, 0x1000
    s_nop 0
    buffer_load_dwordx4 v248, s[12:15], s52 offen nt lds
    v_add_f32 v236, v236, v150
    v_add_f32 v65, v65, v151
    v_cvt_pk_bf16_f32 v147, v150, v151
    v_exp_f32 v153, v153
    v_mfma_f32_32x32x16_bf16 v[160:175], v[208:211], v[100:103], v[160:175]
    ds_read_b128 v[232:235], v241 offset:512
    buffer_load_dwordx4 v64, s[12:15], s52 offen offset:2048 nt lds
    v_exp_f32 v154, v154
    v_add_f32 v236, v236, v152
    v_add_f32 v65, v65, v153
    s_waitcnt lgkmcnt(4)
    v_mfma_f32_32x32x16_bf16 v[160:175], v[212:215], v[104:107], v[160:175]
    ds_read_b64_tr_b16 v[204:205], v242 offset:0
    ds_read_b64_tr_b16 v[206:207], v242 offset:2048
    v_cvt_pk_bf16_f32 v152, v152, v153
    v_exp_f32 v155, v155
    v_exp_f32 v156, v156
    v_mfma_f32_32x32x16_bf16 v[160:175], v[216:219], v[108:111], v[160:175]
    ds_read_b64_tr_b16 v[208:209], v243 offset:0
    ds_read_b64_tr_b16 v[210:211], v243 offset:2048
    v_add_f32 v236, v236, v154
    v_add_f32 v65, v65, v155
    v_cvt_pk_bf16_f32 v153, v154, v155
    s_waitcnt lgkmcnt(6)
    v_mfma_f32_32x32x16_bf16 v[160:175], v[220:223], v[112:115], v[160:175]
    ds_read_b64_tr_b16 v[212:213], v242 offset:512
    ds_read_b64_tr_b16 v[214:215], v242 offset:2560
    v_exp_f32 v157, v157
    v_exp_f32 v158, v158
    v_mfma_f32_32x32x16_bf16 v[160:175], v[224:227], v[116:119], v[160:175]
    ds_read_b64_tr_b16 v[216:217], v243 offset:512
    ds_read_b64_tr_b16 v[218:219], v243 offset:2560
    v_add_f32 v236, v236, v156
    v_add_f32 v65, v65, v157
    v_cvt_pk_bf16_f32 v154, v156, v157
    s_waitcnt lgkmcnt(8)
    v_mfma_f32_32x32x16_bf16 v[160:175], v[228:231], v[120:123], v[160:175]
    ds_read_b64_tr_b16 v[220:221], v242 offset:4096
    ds_read_b64_tr_b16 v[222:223], v242 offset:6144
    v_exp_f32 v159, v159
    v_add_f32 v236, v236, v158
    v_mfma_f32_32x32x16_bf16 v[160:175], v[232:235], v[124:127], v[160:175]
    ds_read_b64_tr_b16 v[224:225], v243 offset:4096
    ds_read_b64_tr_b16 v[226:227], v243 offset:6144
    v_add_f32 v65, v65, v159
    v_cvt_pk_bf16_f32 v155, v158, v159
    s_add_u32 s71, s71, 1
    s_waitcnt lgkmcnt(8)
    v_mfma_f32_32x32x16_bf16 v[0:15], v[204:207], v[144:147], v[0:15]
    ds_read_b64_tr_b16 v[228:229], v242 offset:4608
    ds_read_b64_tr_b16 v[230:231], v242 offset:6656
    s_mov_b32 s44, s42
    s_add_u32 s42, s42, 0x4000
    s_cmp_ge_u32 s42, 0x14000
    s_cselect_b32 s42, 0, s42
    s_sub_u32 s45, s42, s44
    s_mov_b32 s69, s47
    v_mfma_f32_32x32x16_bf16 v[16:31], v[208:211], v[144:147], v[16:31]
    ds_read_b64_tr_b16 v[232:233], v243 offset:4608
    ds_read_b64_tr_b16 v[234:235], v243 offset:6656
    s_add_u32 s47, s47, 0x4000
    s_cmp_ge_u32 s47, 0x10000
    s_cselect_b32 s47, 0, s47
    s_sub_u32 s70, s47, s69
    s_add_u32 s48, s48, 0x2000
    s_and_b32 s48, s48, 0x3ffff
    v_max3_f32 v250, v160, v161, v162
    v_max3_f32 v250, v250, v163, v164
    v_max3_f32 v250, v250, v165, v166
    v_max3_f32 v250, v250, v167, v168
    v_max3_f32 v250, v250, v169, v170
    s_waitcnt lgkmcnt(8)
    v_mfma_f32_32x32x16_bf16 v[32:47], v[212:215], v[144:147], v[32:47]
    s_add_u32 s46, s46, 0x2000
    s_and_b32 s46, s46, 0x3ffff
    s_cmp_lt_u32 s71, 28
    s_cselect_b32 s14, 0x40000, 0
    s_cselect_b32 s44, s44, 0x30000
    s_cmp_lt_u32 s71, 30
    s_cselect_b32 s18, 0x40000, 0
    s_cselect_b32 s69, s69, 0x1c000
    v_add_u32 v238, s45, v238
    v_add_u32 v239, s45, v239
    v_add_u32 v240, s45, v240
    v_add_u32 v241, s45, v241
    v_add_u32 v242, s70, v242
    v_add_u32 v243, s70, v243
    s_waitcnt lgkmcnt(0)
    s_barrier
    s_add_u32 s53, s69, 0x14000
    s_add_u32 m0, s53, s59
    s_add_u32 s53, s46, 0x1000
    buffer_load_dwordx4 v249, s[16:19], s46 offen nt lds
    v_max3_f32 v250, v250, v171, v172
    v_max3_f32 v250, v250, v173, v174
    v_max_f32 v250, v250, v175
    v_cmp_lt_f32 vcc, s58, v250
    s_cbranch_vccnz RARE_BL_loop1
    v_exp_f32 v160, v160
    v_mfma_f32_32x32x16_bf16 v[48:63], v[216:219], v[144:147], v[48:63]
    buffer_load_dwordx4 v249, s[16:19], s46 offen offset:2048 nt lds
    v_exp_f32 v161, v161
    v_exp_f32 v162, v162
    v_add_f32 v236, v236, v160
    v_mfma_f32_32x32x16_bf16 v[0:15], v[220:223], v[152:155], v[0:15]
    s_waitcnt vmcnt(22)
    s_barrier
    ds_read_b128 v[204:207], v238 offset:0
    ds_read_b128 v[208:211], v239 offset:0
    ds_read_b128 v[212:215], v240 offset:0
    s_add_u32 m0, m0, 0x1000
    s_nop 0
    buffer_load_dwordx4 v249, s[16:19], s53 offen nt lds
    v_add_f32 v65, v65, v161
    v_cvt_pk_bf16_f32 v160, v160, v161
    v_exp_f32 v163, v163
    v_exp_f32 v164, v164
    v_mfma_f32_32x32x16_bf16 v[16:31], v[224:227], v[152:155], v[16:31]
    ds_read_b128 v[216:219], v241 offset:0
    buffer_load_dwordx4 v249, s[16:19], s53 offen offset:2048 nt lds
    v_add_f32 v236, v236, v162
    v_add_f32 v65, v65, v163
    v_cvt_pk_bf16_f32 v161, v162, v163
    v_exp_f32 v165, v165
    v_mfma_f32_32x32x16_bf16 v[32:47], v[228:231], v[152:155], v[32:47]
    ds_read_b128 v[220:223], v238 offset:512
    s_add_u32 m0, s44, s59
    s_add_u32 s52, s48, 0x1000
    buffer_load_dwordx4 v248, s[12:15], s48 offen nt lds
    v_exp_f32 v166, v166
    v_add_f32 v236, v236, v164
    v_add_f32 v65, v65, v165
    v_mfma_f32_32x32x16_bf16 v[48:63], v[232:235], v[152:155], v[48:63]
REJ_BL_loop1:
    ds_read_b128 v[224:227], v239 offset:512
    buffer_load_dwordx4 v64, s[12:15], s48 offen offset:2048 nt lds
    v_cvt_pk_bf16_f32 v162, v164, v165
    v_exp_f32 v167, v167
    v_exp_f32 v168, v168
    s_waitcnt lgkmcnt(4)
    v_mfma_f32_32x32x16_bf16 v[144:159], v[204:207], v[96:99], v[176:191]
    ds_read_b128 v[228:231], v240 offset:512
    s_add_u32 m0, m0, 0x1000
    s_nop 0
    buffer_load_dwordx4 v248, s[12:15], s52 offen nt lds
    v_add_f32 v236, v236, v166
    v_add_f32 v65, v65, v167
    v_cvt_pk_bf16_f32 v163, v166, v167
    v_exp_f32 v169, v169
    v_mfma_f32_32x32x16_bf16 v[144:159], v[208:211], v[100:103], v[144:159]
    ds_read_b128 v[232:235], v241 offset:512
    buffer_load_dwordx4 v64, s[12:15], s52 offen offset:2048 nt lds
    v_exp_f32 v170, v170
    v_add_f32 v236, v236, v168
    v_add_f32 v65, v65, v169
    s_waitcnt lgkmcnt(4)
    v_mfma_f32_32x32x16_bf16 v[144:159], v[212:215], v[104:107], v[144:159]
    ds_read_b64_tr_b16 v[204:205], v242 offset:0
    ds_read_b64_tr_b16 v[206:207], v242 offset:2048
    v_cvt_pk_bf16_f32 v168, v168, v169
    v_exp_f32 v171, v171
    v_exp_f32 v172, v172
    v_mfma_f32_32x32x16_bf16 v[144:159], v[216:219], v[108:111], v[144:159]
    ds_read_b64_tr_b16 v[208:209], v243 offset:0
    ds_read_b64_tr_b16 v[210:211], v243 offset:2048
    v_add_f32 v236, v236, v170
    v_add_f32 v65, v65, v171
    v_cvt_pk_bf16_f32 v169, v170, v171
    s_waitcnt lgkmcnt(6)
    v_mfma_f32_32x32x16_bf16 v[144:159], v[220:223], v[112:115], v[144:159]
    ds_read_b64_tr_b16 v[212:213], v242 offset:512
    ds_read_b64_tr_b16 v[214:215], v242 offset:2560
    v_exp_f32 v173, v173
    v_exp_f32 v174, v174
    v_mfma_f32_32x32x16_bf16 v[144:159], v[224:227], v[116:119], v[144:159]
    ds_read_b64_tr_b16 v[216:217], v243 offset:512
    ds_read_b64_tr_b16 v[218:219], v243 offset:2560
    v_add_f32 v236, v236, v172
    v_add_f32 v65, v65, v173
    v_cvt_pk_bf16_f32 v170, v172, v173
    s_waitcnt lgkmcnt(8)
    v_mfma_f32_32x32x16_bf16 v[144:159], v[228:231], v[120:123], v[144:159]
    ds_read_b64_tr_b16 v[220:221], v242 offset:4096
    ds_read_b64_tr_b16 v[222:223], v242 offset:6144
    v_exp_f32 v175, v175
    v_add_f32 v236, v236, v174
    v_mfma_f32_32x32x16_bf16 v[144:159], v[232:235], v[124:127], v[144:159]
    ds_read_b64_tr_b16 v[224:225], v243 offset:4096
    ds_read_b64_tr_b16 v[226:227], v243 offset:6144
    v_add_f32 v65, v65, v175
    v_cvt_pk_bf16_f32 v171, v174, v175
    s_sub_u32 s50, s50, 1
    s_cmp_lg_u32 s50, 0
    s_cbranch_scc1 LOOP_BL
    s_sub_u32 s51, s36, 2
    s_mul_i32 s61, s51, 5120
    s_add_u32 s61, s61, 18432
    s_mul_i32 s51, s51, 18432
    v_add_u32 v251, 0, v254
    v_mul_u32_u24 v252, 0xccd, v251
    v_lshrrev_b32 v252, 16, v252
    v_mul_u32_u24 v73, 20, v252
    v_sub_u32 v251, v251, v73
    v_mul_u32_u24 v252, 0x480, v252
    v_lshl_add_u32 v251, v251, 4, v252
    v_add_u32 v73, s51, v251
    v_add_u32 v251, 64, v254
    v_mul_u32_u24 v252, 0xccd, v251
    v_lshrrev_b32 v252, 16, v252
    v_mul_u32_u24 v74, 20, v252
    v_sub_u32 v251, v251, v74
    v_mul_u32_u24 v252, 0x480, v252
    v_lshl_add_u32 v251, v251, 4, v252
    v_add_u32 v74, s51, v251
    v_add_u32 v251, 128, v254
    v_mul_u32_u24 v252, 0xccd, v251
    v_lshrrev_b32 v252, 16, v252
    v_mul_u32_u24 v75, 20, v252
    v_sub_u32 v251, v251, v75
    v_mul_u32_u24 v252, 0x480, v252
    v_lshl_add_u32 v251, v251, 4, v252
    v_add_u32 v75, s51, v251
    v_add_u32 v251, 192, v254
    v_mul_u32_u24 v252, 0xccd, v251
    v_lshrrev_b32 v252, 16, v252
    v_mul_u32_u24 v76, 20, v252
    v_sub_u32 v251, v251, v76
    v_mul_u32_u24 v252, 0x480, v252
    v_lshl_add_u32 v251, v251, 4, v252
    v_add_u32 v76, s51, v251
    v_add_u32 v251, 256, v254
    v_mul_u32_u24 v252, 0xccd, v251
    v_lshrrev_b32 v252, 16, v252
    v_mul_u32_u24 v77, 20, v252
    v_sub_u32 v251, v251, v77
    v_mul_u32_u24 v252, 0x480, v252
    v_lshl_add_u32 v251, v251, 4, v252
    v_add_u32 v77, s51, v251
    s_add_u32 s71, s71, 1
    s_waitcnt lgkmcnt(8)
    v_mfma_f32_32x32x16_bf16 v[0:15], v[204:207], v[160:163], v[0:15]
    ds_read_b64_tr_b16 v[228:229], v242 offset:4608
    ds_read_b64_tr_b16 v[230:231], v242 offset:6656
    s_mov_b32 s44, s42
    s_add_u32 s42, s42, 0x4000
    s_cmp_ge_u32 s42, 0x14000
    s_cselect_b32 s42, 0, s42
    s_sub_u32 s45, s42, s44
    s_mov_b32 s69, s47
    v_mfma_f32_32x32x16_bf16 v[16:31], v[208:211], v[160:163], v[16:31]
    ds_read_b64_tr_b16 v[232:233], v243 offset:4608
    ds_read_b64_tr_b16 v[234:235], v243 offset:6656
    s_add_u32 s47, s47, 0x4000
    s_cmp_ge_u32 s47, 0x10000
    s_cselect_b32 s47, 0, s47
    s_sub_u32 s70, s47, s69
    v_max3_f32 v250, v144, v145, v146
    v_max3_f32 v250, v250, v147, v148
    v_max3_f32 v250, v250, v149, v150
    v_max3_f32 v250, v250, v151, v152
    v_max3_f32 v250, v250, v153, v154
    s_waitcnt lgkmcnt(8)
    v_mfma_f32_32x32x16_bf16 v[32:47], v[212:215], v[160:163], v[32:47]
    v_add_u32 v238, s45, v238
    v_add_u32 v239, s45, v239
    v_add_u32 v240, s45, v240
    v_add_u32 v241, s45, v241
    v_add_u32 v242, s70, v242
    v_add_u32 v243, s70, v243
    s_waitcnt lgkmcnt(0)
    s_barrier
    s_add_u32 s53, s40, 0
    s_and_b32 s53, s53, 3
    s_mul_i32 s53, s53, 294912
    s_add_u32 s53, s53, 0
    s_add_u32 m0, s64, s61
    s_nop 0
    buffer_load_dwordx4 v73, s[20:23], s53 offen lds
    v_max3_f32 v250, v250, v155, v156
    v_max3_f32 v250, v250, v157, v158
    v_max_f32 v250, v250, v159
    v_cmp_lt_f32 vcc, s58, v250
    s_cbranch_vccnz RARE_BL_last0
    v_exp_f32 v144, v144
    v_mfma_f32_32x32x16_bf16 v[48:63], v[216:219], v[160:163], v[48:63]
    s_add_u32 m0, m0, 0x400
    s_nop 0
    buffer_load_dwordx4 v74, s[20:23], s53 offen lds
    v_exp_f32 v145, v145
    v_exp_f32 v146, v146
    v_add_f32 v236, v236, v144
    v_mfma_f32_32x32x16_bf16 v[0:15], v[220:223], v[168:171], v[0:15]
    s_waitcnt vmcnt(22)
    s_barrier
    ds_read_b128 v[204:207], v238 offset:0
    ds_read_b128 v[208:211], v239 offset:0
    ds_read_b128 v[212:215], v240 offset:0
    s_add_u32 m0, m0, 0x400
    s_nop 0
    buffer_load_dwordx4 v75, s[20:23], s53 offen lds
    v_add_f32 v65, v65, v145
    v_cvt_pk_bf16_f32 v144, v144, v145
    v_exp_f32 v147, v147
    v_exp_f32 v148, v148
    v_mfma_f32_32x32x16_bf16 v[16:31], v[224:227], v[168:171], v[16:31]
    ds_read_b128 v[216:219], v241 offset:0
    s_add_u32 m0, m0, 0x400
    s_nop 0
    buffer_load_dwordx4 v76, s[20:23], s53 offen lds
    v_add_f32 v236, v236, v146
    v_add_f32 v65, v65, v147
    v_cvt_pk_bf16_f32 v145, v146, v147
    v_exp_f32 v149, v149
    v_mfma_f32_32x32x16_bf16 v[32:47], v[228:231], v[168:171], v[32:47]
    ds_read_b128 v[220:223], v238 offset:512
    s_add_u32 m0, m0, 0x400
    s_nop 0
    buffer_load_dwordx4 v77, s[20:23], s53 offen lds
    v_exp_f32 v150, v150
    v_add_f32 v236, v236, v148
    v_add_f32 v65, v65, v149
    v_mfma_f32_32x32x16_bf16 v[48:63], v[232:235], v[168:171], v[48:63]
REJ_BL_last0:
    ds_read_b128 v[224:227], v239 offset:512
    v_cvt_pk_bf16_f32 v146, v148, v149
    v_exp_f32 v151, v151
    v_exp_f32 v152, v152
    s_waitcnt lgkmcnt(4)
    v_mfma_f32_32x32x16_bf16 v[160:175], v[204:207], v[96:99], v[176:191]
    ds_read_b128 v[228:231], v240 offset:512
    v_add_f32 v236, v236, v150
    v_add_f32 v65, v65, v151
    v_cvt_pk_bf16_f32 v147, v150, v151
    v_exp_f32 v153, v153
    v_mfma_f32_32x32x16_bf16 v[160:175], v[208:211], v[100:103], v[160:175]
    ds_read_b128 v[232:235], v241 offset:512
    v_exp_f32 v154, v154
    v_add_f32 v236, v236, v152
    v_add_f32 v65, v65, v153
    s_waitcnt lgkmcnt(4)
    v_mfma_f32_32x32x16_bf16 v[160:175], v[212:215], v[104:107], v[160:175]
    ds_read_b64_tr_b16 v[204:205], v242 offset:0
    ds_read_b64_tr_b16 v[206:207], v242 offset:2048
    v_cvt_pk_bf16_f32 v152, v152, v153
    v_exp_f32 v155, v155
    v_exp_f32 v156, v156
    v_mfma_f32_32x32x16_bf16 v[160:175], v[216:219], v[108:111], v[160:175]
    ds_read_b64_tr_b16 v[208:209], v243 offset:0
    ds_read_b64_tr_b16 v[210:211], v243 offset:2048
    v_add_f32 v236, v236, v154
    v_add_f32 v65, v65, v155
    v_cvt_pk_bf16_f32 v153, v154, v155
    s_waitcnt lgkmcnt(6)
    v_mfma_f32_32x32x16_bf16 v[160:175], v[220:223], v[112:115], v[160:175]
    ds_read_b64_tr_b16 v[212:213], v242 offset:512
    ds_read_b64_tr_b16 v[214:215], v242 offset:2560
    v_exp_f32 v157, v157
    v_exp_f32 v158, v158
    v_mfma_f32_32x32x16_bf16 v[160:175], v[224:227], v[116:119], v[160:175]
    ds_read_b64_tr_b16 v[216:217], v243 offset:512
    ds_read_b64_tr_b16 v[218:219], v243 offset:2560
    v_add_f32 v236, v236, v156
    v_add_f32 v65, v65, v157
    v_cvt_pk_bf16_f32 v154, v156, v157
    s_waitcnt lgkmcnt(8)
    v_mfma_f32_32x32x16_bf16 v[160:175], v[228:231], v[120:123], v[160:175]
    ds_read_b64_tr_b16 v[220:221], v242 offset:4096
    ds_read_b64_tr_b16 v[222:223], v242 offset:6144
    v_exp_f32 v159, v159
    v_add_f32 v236, v236, v158
    v_mfma_f32_32x32x16_bf16 v[160:175], v[232:235], v[124:127], v[160:175]
    ds_read_b64_tr_b16 v[224:225], v243 offset:4096
    ds_read_b64_tr_b16 v[226:227], v243 offset:6144
    v_add_f32 v65, v65, v159
    v_cvt_pk_bf16_f32 v155, v158, v159
    s_add_u32 s71, s71, 1
    s_waitcnt lgkmcnt(8)
    v_mfma_f32_32x32x16_bf16 v[0:15], v[204:207], v[144:147], v[0:15]
    ds_read_b64_tr_b16 v[228:229], v242 offset:4608
    ds_read_b64_tr_b16 v[230:231], v242 offset:6656
    s_mov_b32 s44, s42
    s_add_u32 s42, s42, 0x4000
    s_cmp_ge_u32 s42, 0x14000
    s_cselect_b32 s42, 0, s42
    s_sub_u32 s45, s42, s44
    s_mov_b32 s69, s47
    v_mfma_f32_32x32x16_bf16 v[16:31], v[208:211], v[144:147], v[16:31]
    ds_read_b64_tr_b16 v[232:233], v243 offset:4608
    ds_read_b64_tr_b16 v[234:235], v243 offset:6656
    s_add_u32 s47, s47, 0x4000
    s_cmp_ge_u32 s47, 0x10000
    s_cselect_b32 s47, 0, s47
    s_sub_u32 s70, s47, s69
    v_max3_f32 v250, v160, v161, v162
    v_max3_f32 v250, v250, v163, v164
    v_max3_f32 v250, v250, v165, v166
    v_max3_f32 v250, v250, v167, v168
    v_max3_f32 v250, v250, v169, v170
    v_max3_f32 v250, v250, v171, v172
    v_max3_f32 v250, v250, v173, v174
    v_max_f32 v250, v250, v175
    v_cmp_lt_f32 vcc, s58, v250
    s_cbranch_vccnz RARE_BL_last1
    v_exp_f32 v160, v160
    s_waitcnt lgkmcnt(8)
    v_mfma_f32_32x32x16_bf16 v[32:47], v[212:215], v[144:147], v[32:47]
    v_add_u32 v238, s45, v238
    v_add_u32 v239, s45, v239
    v_add_u32 v240, s45, v240
    v_add_u32 v241, s45, v241
    v_add_u32 v242, s70, v242
    v_add_u32 v243, s70, v243
    s_waitcnt lgkmcnt(0)
    s_barrier
    s_add_u32 s53, s40, 0
    s_and_b32 s53, s53, 3
    s_mul_i32 s53, s53, 294912
    s_add_u32 s53, s53, 73728
    s_add_u32 m0, s65, s61
    s_nop 0
    buffer_load_dwordx4 v73, s[20:23], s53 offen lds
    v_exp_f32 v161, v161
    v_exp_f32 v162, v162
    v_add_f32 v236, v236, v160
    v_add_f32 v65, v65, v161
    v_cvt_pk_bf16_f32 v160, v160, v161
    v_exp_f32 v163, v163
    v_mfma_f32_32x32x16_bf16 v[48:63], v[216:219], v[144:147], v[48:63]
    s_add_u32 m0, m0, 0x400
    s_nop 0
    buffer_load_dwordx4 v74, s[20:23], s53 offen lds
    v_exp_f32 v164, v164
    v_add_f32 v236, v236, v162
    v_add_f32 v65, v65, v163
    v_cvt_pk_bf16_f32 v161, v162, v163
    v_exp_f32 v165, v165
    v_exp_f32 v166, v166
    v_mfma_f32_32x32x16_bf16 v[0:15], v[220:223], v[152:155], v[0:15]
    s_waitcnt vmcnt(19)
    s_barrier
    s_add_u32 m0, m0, 0x400
    s_nop 0
    buffer_load_dwordx4 v75, s[20:23], s53 offen lds
    v_add_f32 v236, v236, v164
    v_add_f32 v65, v65, v165
    v_cvt_pk_bf16_f32 v162, v164, v165
    v_exp_f32 v167, v167
    v_exp_f32 v168, v168
    v_add_f32 v236, v236, v166
    v_add_f32 v65, v65, v167
    v_mfma_f32_32x32x16_bf16 v[16:31], v[224:227], v[152:155], v[16:31]
    s_add_u32 m0, m0, 0x400
    s_nop 0
    buffer_load_dwordx4 v76, s[20:23], s53 offen lds
    v_cvt_pk_bf16_f32 v163, v166, v167
    v_exp_f32 v169, v169
    v_exp_f32 v170, v170
    v_add_f32 v236, v236, v168
    v_add_f32 v65, v65, v169
    v_cvt_pk_bf16_f32 v168, v168, v169
    v_exp_f32 v171, v171
    v_mfma_f32_32x32x16_bf16 v[32:47], v[228:231], v[152:155], v[32:47]
    s_add_u32 m0, m0, 0x400
    s_nop 0
    buffer_load_dwordx4 v77, s[20:23], s53 offen lds
    v_exp_f32 v172, v172
    v_add_f32 v236, v236, v170
    v_add_f32 v65, v65, v171
    v_cvt_pk_bf16_f32 v169, v170, v171
    v_exp_f32 v173, v173
    v_exp_f32 v174, v174
    v_mfma_f32_32x32x16_bf16 v[48:63], v[232:235], v[152:155], v[48:63]
REJ_BL_last1:
    v_add_f32 v236, v236, v172
    v_add_f32 v65, v65, v173
    v_cvt_pk_bf16_f32 v170, v172, v173
    v_exp_f32 v175, v175
    v_add_f32 v236, v236, v174
    v_add_f32 v65, v65, v175
    v_cvt_pk_bf16_f32 v171, v174, v175
    ds_read_b64_tr_b16 v[204:205], v242 offset:0
    ds_read_b64_tr_b16 v[206:207], v242 offset:2048
    ds_read_b64_tr_b16 v[208:209], v243 offset:0
    ds_read_b64_tr_b16 v[210:211], v243 offset:2048
    ds_read_b64_tr_b16 v[212:213], v242 offset:512
    ds_read_b64_tr_b16 v[214:215], v242 offset:2560
    ds_read_b64_tr_b16 v[216:217], v243 offset:512
    ds_read_b64_tr_b16 v[218:219], v243 offset:2560
    ds_read_b64_tr_b16 v[220:221], v242 offset:4096
    ds_read_b64_tr_b16 v[222:223], v242 offset:6144
    ds_read_b64_tr_b16 v[224:225], v243 offset:4096
    ds_read_b64_tr_b16 v[226:227], v243 offset:6144
    s_waitcnt lgkmcnt(10)
    v_mfma_f32_32x32x16_bf16 v[0:15], v[204:207], v[160:163], v[0:15]
    ds_read_b64_tr_b16 v[228:229], v242 offset:4608
    ds_read_b64_tr_b16 v[230:231], v242 offset:6656
    s_waitcnt lgkmcnt(10)
    v_mfma_f32_32x32x16_bf16 v[16:31], v[208:211], v[160:163], v[16:31]
    ds_read_b64_tr_b16 v[232:233], v243 offset:4608
    ds_read_b64_tr_b16 v[234:235], v243 offset:6656
    s_waitcnt lgkmcnt(10)
    v_mfma_f32_32x32x16_bf16 v[32:47], v[212:215], v[160:163], v[32:47]
    s_waitcnt lgkmcnt(8)
    v_mfma_f32_32x32x16_bf16 v[48:63], v[216:219], v[160:163], v[48:63]
    s_waitcnt lgkmcnt(6)
    v_mfma_f32_32x32x16_bf16 v[0:15], v[220:223], v[168:171], v[0:15]
    s_waitcnt lgkmcnt(4)
    v_mfma_f32_32x32x16_bf16 v[16:31], v[224:227], v[168:171], v[16:31]
    s_waitcnt lgkmcnt(2)
    v_mfma_f32_32x32x16_bf16 v[32:47], v[228:231], v[168:171], v[32:47]
    s_waitcnt lgkmcnt(0)
    v_mfma_f32_32x32x16_bf16 v[48:63], v[232:235], v[168:171], v[48:63]
    v_add_f32 v236, v236, v65
    s_branch TAIL_L
RARE_BL_first1:
    v_mfma_f32_32x32x16_bf16 v[48:63], v[216:219], v[144:147], 0
    buffer_load_dwordx4 v249, s[16:19], s46 offen offset:2048 nt lds
    v_mfma_f32_32x32x16_bf16 v[0:15], v[220:223], v[152:155], v[0:15]
    s_waitcnt vmcnt(18)
    s_barrier
    ds_read_b128 v[204:207], v238 offset:0
    ds_read_b128 v[208:211], v239 offset:0
    ds_read_b128 v[212:215], v240 offset:0
    s_add_u32 m0, m0, 0x1000
    s_nop 0
    buffer_load_dwordx4 v249, s[16:19], s53 offen nt lds
    v_mfma_f32_32x32x16_bf16 v[16:31], v[224:227], v[152:155], v[16:31]
    ds_read_b128 v[216:219], v241 offset:0
    buffer_load_dwordx4 v249, s[16:19], s53 offen offset:2048 nt lds
    v_mfma_f32_32x32x16_bf16 v[32:47], v[228:231], v[152:155], v[32:47]
    ds_read_b128 v[220:223], v238 offset:512
    s_add_u32 m0, s44, s59
    s_add_u32 s52, s48, 0x1000
    buffer_load_dwordx4 v248, s[12:15], s48 offen nt lds
    v_mfma_f32_32x32x16_bf16 v[48:63], v[232:235], v[152:155], v[48:63]
    v_mov_b32 v251, v250
    v_mov_b32 v252, v250
    s_nop 1
    v_permlane32_swap_b32 v251, v252
    v_max_f32 v250, v251, v252
    v_max_f32 v250, 0, v250
    v_exp_f32 v251, -v250
    v_sub_f32 v160, v160, v250
    v_sub_f32 v161, v161, v250
    v_sub_f32 v162, v162, v250
    v_sub_f32 v163, v163, v250
    v_sub_f32 v164, v164, v250
    v_sub_f32 v165, v165, v250
    v_sub_f32 v166, v166, v250
    v_sub_f32 v167, v167, v250
    v_sub_f32 v168, v168, v250
    v_sub_f32 v169, v169, v250
    v_sub_f32 v170, v170, v250
    v_sub_f32 v171, v171, v250
    v_sub_f32 v172, v172, v250
    v_sub_f32 v173, v173, v250
    v_sub_f32 v174, v174, v250
    v_sub_f32 v175, v175, v250
    v_sub_f32 v176, v176, v250
    v_sub_f32 v177, v177, v250
    v_sub_f32 v178, v178, v250
    v_sub_f32 v179, v179, v250
    v_sub_f32 v180, v180, v250
    v_sub_f32 v181, v181, v250
    v_sub_f32 v182, v182, v250
    v_sub_f32 v183, v183, v250
    v_sub_f32 v184, v184, v250
    v_sub_f32 v185, v185, v250
    v_sub_f32 v186, v186, v250
    v_sub_f32 v187, v187, v250
    v_sub_f32 v188, v188, v250
    v_sub_f32 v189, v189, v250
    v_sub_f32 v190, v190, v250
    v_sub_f32 v191, v191, v250
    v_mul_f32 v236, v236, v251
    v_mul_f32 v65, v65, v251
    v_mul_f32 v0, v0, v251
    v_mul_f32 v1, v1, v251
    v_mul_f32 v2, v2, v251
    v_mul_f32 v3, v3, v251
    v_mul_f32 v4, v4, v251
    v_mul_f32 v5, v5, v251
    v_mul_f32 v6, v6, v251
    v_mul_f32 v7, v7, v251
    v_mul_f32 v8, v8, v251
    v_mul_f32 v9, v9, v251
    v_mul_f32 v10, v10, v251
    v_mul_f32 v11, v11, v251
    v_mul_f32 v12, v12, v251
    v_mul_f32 v13, v13, v251
    v_mul_f32 v14, v14, v251
    v_mul_f32 v15, v15, v251
    v_mul_f32 v16, v16, v251
    v_mul_f32 v17, v17, v251
    v_mul_f32 v18, v18, v251
    v_mul_f32 v19, v19, v251
    v_mul_f32 v20, v20, v251
    v_mul_f32 v21, v21, v251
    v_mul_f32 v22, v22, v251
    v_mul_f32 v23, v23, v251
    v_mul_f32 v24, v24, v251
    v_mul_f32 v25, v25, v251
    v_mul_f32 v26, v26, v251
    v_mul_f32 v27, v27, v251
    v_mul_f32 v28, v28, v251
    v_mul_f32 v29, v29, v251
    v_mul_f32 v30, v30, v251
    v_mul_f32 v31, v31, v251
    v_mul_f32 v32, v32, v251
    v_mul_f32 v33, v33, v251
    v_mul_f32 v34, v34, v251
    v_mul_f32 v35, v35, v251
    v_mul_f32 v36, v36, v251
    v_mul_f32 v37, v37, v251
    v_mul_f32 v38, v38, v251
    v_mul_f32 v39, v39, v251
    v_mul_f32 v40, v40, v251
    v_mul_f32 v41, v41, v251
    v_mul_f32 v42, v42, v251
    v_mul_f32 v43, v43, v251
    v_mul_f32 v44, v44, v251
    v_mul_f32 v45, v45, v251
    v_mul_f32 v46, v46, v251
    v_mul_f32 v47, v47, v251
    v_mul_f32 v48, v48, v251
    v_mul_f32 v49, v49, v251
    v_mul_f32 v50, v50, v251
    v_mul_f32 v51, v51, v251
    v_mul_f32 v52, v52, v251
    v_mul_f32 v53, v53, v251
    v_mul_f32 v54, v54, v251
    v_mul_f32 v55, v55, v251
    v_mul_f32 v56, v56, v251
    v_mul_f32 v57, v57, v251
    v_mul_f32 v58, v58, v251
    v_mul_f32 v59, v59, v251
    v_mul_f32 v60, v60, v251
    v_mul_f32 v61, v61, v251
    v_mul_f32 v62, v62, v251
    v_mul_f32 v63, v63, v251
    v_exp_f32 v160, v160
    v_exp_f32 v161, v161
    v_exp_f32 v162, v162
    v_add_f32 v236, v236, v160
    v_add_f32 v65, v65, v161
    v_cvt_pk_bf16_f32 v160, v160, v161
    v_exp_f32 v163, v163
    v_exp_f32 v164, v164
    v_add_f32 v236, v236, v162
    v_add_f32 v65, v65, v163
    v_cvt_pk_bf16_f32 v161, v162, v163
    v_exp_f32 v165, v165
    v_exp_f32 v166, v166
    v_add_f32 v236, v236, v164
    v_add_f32 v65, v65, v165
    s_branch REJ_BL_first1
RARE_BL_loop0:
    v_mfma_f32_32x32x16_bf16 v[48:63], v[216:219], v[160:163], v[48:63]
    buffer_load_dwordx4 v249, s[16:19], s46 offen offset:2048 nt lds
    v_mfma_f32_32x32x16_bf16 v[0:15], v[220:223], v[168:171], v[0:15]
    s_waitcnt vmcnt(22)
    s_barrier
    ds_read_b128 v[204:207], v238 offset:0
    ds_read_b128 v[208:211], v239 offset:0
    ds_read_b128 v[212:215], v240 offset:0
    s_add_u32 m0, m0, 0x1000
    s_nop 0
    buffer_load_dwordx4 v249, s[16:19], s53 offen nt lds
    v_mfma_f32_32x32x16_bf16 v[16:31], v[224:227], v[168:171], v[16:31]
    ds_read_b128 v[216:219], v241 offset:0
    buffer_load_dwordx4 v249, s[16:19], s53 offen offset:2048 nt lds
    v_mfma_f32_32x32x16_bf16 v[32:47], v[228:231], v[168:171], v[32:47]
    ds_read_b128 v[220:223], v238 offset:512
    s_add_u32 m0, s44, s59
    s_add_u32 s52, s48, 0x1000
    buffer_load_dwordx4 v248, s[12:15], s48 offen nt lds
    v_mfma_f32_32x32x16_bf16 v[48:63], v[232:235], v[168:171], v[48:63]
    v_mov_b32 v251, v250
    v_mov_b32 v252, v250
    s_nop 1
    v_permlane32_swap_b32 v251, v252
    v_max_f32 v250, v251, v252
    v_max_f32 v250, 0, v250
    v_exp_f32 v251, -v250
    v_sub_f32 v144, v144, v250
    v_sub_f32 v145, v145, v250
    v_sub_f32 v146, v146, v250
    v_sub_f32 v147, v147, v250
    v_sub_f32 v148, v148, v250
    v_sub_f32 v149, v149, v250
    v_sub_f32 v150, v150, v250
    v_sub_f32 v151, v151, v250
    v_sub_f32 v152, v152, v250
    v_sub_f32 v153, v153, v250
    v_sub_f32 v154, v154, v250
    v_sub_f32 v155, v155, v250
    v_sub_f32 v156, v156, v250
    v_sub_f32 v157, v157, v250
    v_sub_f32 v158, v158, v250
    v_sub_f32 v159, v159, v250
    v_sub_f32 v176, v176, v250
    v_sub_f32 v177, v177, v250
    v_sub_f32 v178, v178, v250
    v_sub_f32 v179, v179, v250
    v_sub_f32 v180, v180, v250
    v_sub_f32 v181, v181, v250
    v_sub_f32 v182, v182, v250
    v_sub_f32 v183, v183, v250
    v_sub_f32 v184, v184, v250
    v_sub_f32 v185, v185, v250
    v_sub_f32 v186, v186, v250
    v_sub_f32 v187, v187, v250
    v_sub_f32 v188, v188, v250
    v_sub_f32 v189, v189, v250
    v_sub_f32 v190, v190, v250
    v_sub_f32 v191, v191, v250
    v_mul_f32 v236, v236, v251
    v_mul_f32 v65, v65, v251
    v_mul_f32 v0, v0, v251
    v_mul_f32 v1, v1, v251
    v_mul_f32 v2, v2, v251
    v_mul_f32 v3, v3, v251
    v_mul_f32 v4, v4, v251
    v_mul_f32 v5, v5, v251
    v_mul_f32 v6, v6, v251
    v_mul_f32 v7, v7, v251
    v_mul_f32 v8, v8, v251
    v_mul_f32 v9, v9, v251
    v_mul_f32 v10, v10, v251
    v_mul_f32 v11, v11, v251
    v_mul_f32 v12, v12, v251
    v_mul_f32 v13, v13, v251
    v_mul_f32 v14, v14, v251
    v_mul_f32 v15, v15, v251
    v_mul_f32 v16, v16, v251
    v_mul_f32 v17, v17, v251
    v_mul_f32 v18, v18, v251
    v_mul_f32 v19, v19, v251
    v_mul_f32 v20, v20, v251
    v_mul_f32 v21, v21, v251
    v_mul_f32 v22, v22, v251
    v_mul_f32 v23, v23, v251
    v_mul_f32 v24, v24, v251
    v_mul_f32 v25, v25, v251
    v_mul_f32 v26, v26, v251
    v_mul_f32 v27, v27, v251
    v_mul_f32 v28, v28, v251
    v_mul_f32 v29, v29, v251
    v_mul_f32 v30, v30, v251
    v_mul_f32 v31, v31, v251
    v_mul_f32 v32, v32, v251
    v_mul_f32 v33, v33, v251
    v_mul_f32 v34, v34, v251
    v_mul_f32 v35, v35, v251
    v_mul_f32 v36, v36, v251
    v_mul_f32 v37, v37, v251
    v_mul_f32 v38, v38, v251
    v_mul_f32 v39, v39, v251
    v_mul_f32 v40, v40, v251
    v_mul_f32 v41, v41, v251
    v_mul_f32 v42, v42, v251
    v_mul_f32 v43, v43, v251
    v_mul_f32 v44, v44, v251
    v_mul_f32 v45, v45, v251
    v_mul_f32 v46, v46, v251
    v_mul_f32 v47, v47, v251
    v_mul_f32 v48, v48, v251
    v_mul_f32 v49, v49, v251
    v_mul_f32 v50, v50, v251
    v_mul_f32 v51, v51, v251
    v_mul_f32 v52, v52, v251
    v_mul_f32 v53, v53, v251
    v_mul_f32 v54, v54, v251
    v_mul_f32 v55, v55, v251
    v_mul_f32 v56, v56, v251
    v_mul_f32 v57, v57, v251
    v_mul_f32 v58, v58, v251
    v_mul_f32 v59, v59, v251
    v_mul_f32 v60, v60, v251
    v_mul_f32 v61, v61, v251
    v_mul_f32 v62, v62, v251
    v_mul_f32 v63, v63, v251
    v_exp_f32 v144, v144
    v_exp_f32 v145, v145
    v_exp_f32 v146, v146
    v_add_f32 v236, v236, v144
    v_add_f32 v65, v65, v145
    v_cvt_pk_bf16_f32 v144, v144, v145
    v_exp_f32 v147, v147
    v_exp_f32 v148, v148
    v_add_f32 v236, v236, v146
    v_add_f32 v65, v65, v147
    v_cvt_pk_bf16_f32 v145, v146, v147
    v_exp_f32 v149, v149
    v_exp_f32 v150, v150
    v_add_f32 v236, v236, v148
    v_add_f32 v65, v65, v149
    s_branch REJ_BL_loop0
RARE_BL_loop1:
    v_mfma_f32_32x32x16_bf16 v[48:63], v[216:219], v[144:147], v[48:63]
    buffer_load_dwordx4 v249, s[16:19], s46 offen offset:2048 nt lds
    v_mfma_f32_32x32x16_bf16 v[0:15], v[220:223], v[152:155], v[0:15]
    s_waitcnt vmcnt(22)
    s_barrier
    ds_read_b128 v[204:207], v238 offset:0
    ds_read_b128 v[208:211], v239 offset:0
    ds_read_b128 v[212:215], v240 offset:0
    s_add_u32 m0, m0, 0x1000
    s_nop 0
    buffer_load_dwordx4 v249, s[16:19], s53 offen nt lds
    v_mfma_f32_32x32x16_bf16 v[16:31], v[224:227], v[152:155], v[16:31]
    ds_read_b128 v[216:219], v241 offset:0
    buffer_load_dwordx4 v249, s[16:19], s53 offen offset:2048 nt lds
    v_mfma_f32_32x32x16_bf16 v[32:47], v[228:231], v[152:155], v[32:47]
    ds_read_b128 v[220:223], v238 offset:512
    s_add_u32 m0, s44, s59
    s_add_u32 s52, s48, 0x1000
    buffer_load_dwordx4 v248, s[12:15], s48 offen nt lds
    v_mfma_f32_32x32x16_bf16 v[48:63], v[232:235], v[152:155], v[48:63]
    v_mov_b32 v251, v250
    v_mov_b32 v252, v250
    s_nop 1
    v_permlane32_swap_b32 v251, v252
    v_max_f32 v250, v251, v252
    v_max_f32 v250, 0, v250
    v_exp_f32 v251, -v250
    v_sub_f32 v160, v160, v250
    v_sub_f32 v161, v161, v250
    v_sub_f32 v162, v162, v250
    v_sub_f32 v163, v163, v250
    v_sub_f32 v164, v164, v250
    v_sub_f32 v165, v165, v250
    v_sub_f32 v166, v166, v250
    v_sub_f32 v167, v167, v250
    v_sub_f32 v168, v168, v250
    v_sub_f32 v169, v169, v250
    v_sub_f32 v170, v170, v250
    v_sub_f32 v171, v171, v250
    v_sub_f32 v172, v172, v250
    v_sub_f32 v173, v173, v250
    v_sub_f32 v174, v174, v250
    v_sub_f32 v175, v175, v250
    v_sub_f32 v176, v176, v250
    v_sub_f32 v177, v177, v250
    v_sub_f32 v178, v178, v250
    v_sub_f32 v179, v179, v250
    v_sub_f32 v180, v180, v250
    v_sub_f32 v181, v181, v250
    v_sub_f32 v182, v182, v250
    v_sub_f32 v183, v183, v250
    v_sub_f32 v184, v184, v250
    v_sub_f32 v185, v185, v250
    v_sub_f32 v186, v186, v250
    v_sub_f32 v187, v187, v250
    v_sub_f32 v188, v188, v250
    v_sub_f32 v189, v189, v250
    v_sub_f32 v190, v190, v250
    v_sub_f32 v191, v191, v250
    v_mul_f32 v236, v236, v251
    v_mul_f32 v65, v65, v251
    v_mul_f32 v0, v0, v251
    v_mul_f32 v1, v1, v251
    v_mul_f32 v2, v2, v251
    v_mul_f32 v3, v3, v251
    v_mul_f32 v4, v4, v251
    v_mul_f32 v5, v5, v251
    v_mul_f32 v6, v6, v251
    v_mul_f32 v7, v7, v251
    v_mul_f32 v8, v8, v251
    v_mul_f32 v9, v9, v251
    v_mul_f32 v10, v10, v251
    v_mul_f32 v11, v11, v251
    v_mul_f32 v12, v12, v251
    v_mul_f32 v13, v13, v251
    v_mul_f32 v14, v14, v251
    v_mul_f32 v15, v15, v251
    v_mul_f32 v16, v16, v251
    v_mul_f32 v17, v17, v251
    v_mul_f32 v18, v18, v251
    v_mul_f32 v19, v19, v251
    v_mul_f32 v20, v20, v251
    v_mul_f32 v21, v21, v251
    v_mul_f32 v22, v22, v251
    v_mul_f32 v23, v23, v251
    v_mul_f32 v24, v24, v251
    v_mul_f32 v25, v25, v251
    v_mul_f32 v26, v26, v251
    v_mul_f32 v27, v27, v251
    v_mul_f32 v28, v28, v251
    v_mul_f32 v29, v29, v251
    v_mul_f32 v30, v30, v251
    v_mul_f32 v31, v31, v251
    v_mul_f32 v32, v32, v251
    v_mul_f32 v33, v33, v251
    v_mul_f32 v34, v34, v251
    v_mul_f32 v35, v35, v251
    v_mul_f32 v36, v36, v251
    v_mul_f32 v37, v37, v251
    v_mul_f32 v38, v38, v251
    v_mul_f32 v39, v39, v251
    v_mul_f32 v40, v40, v251
    v_mul_f32 v41, v41, v251
    v_mul_f32 v42, v42, v251
    v_mul_f32 v43, v43, v251
    v_mul_f32 v44, v44, v251
    v_mul_f32 v45, v45, v251
    v_mul_f32 v46, v46, v251
    v_mul_f32 v47, v47, v251
    v_mul_f32 v48, v48, v251
    v_mul_f32 v49, v49, v251
    v_mul_f32 v50, v50, v251
    v_mul_f32 v51, v51, v251
    v_mul_f32 v52, v52, v251
    v_mul_f32 v53, v53, v251
    v_mul_f32 v54, v54, v251
    v_mul_f32 v55, v55, v251
    v_mul_f32 v56, v56, v251
    v_mul_f32 v57, v57, v251
    v_mul_f32 v58, v58, v251
    v_mul_f32 v59, v59, v251
    v_mul_f32 v60, v60, v251
    v_mul_f32 v61, v61, v251
    v_mul_f32 v62, v62, v251
    v_mul_f32 v63, v63, v251
    v_exp_f32 v160, v160
    v_exp_f32 v161, v161
    v_exp_f32 v162, v162
    v_add_f32 v236, v236, v160
    v_add_f32 v65, v65, v161
    v_cvt_pk_bf16_f32 v160, v160, v161
    v_exp_f32 v163, v163
    v_exp_f32 v164, v164
    v_add_f32 v236, v236, v162
    v_add_f32 v65, v65, v163
    v_cvt_pk_bf16_f32 v161, v162, v163
    v_exp_f32 v165, v165
    v_exp_f32 v166, v166
    v_add_f32 v236, v236, v164
    v_add_f32 v65, v65, v165
    s_branch REJ_BL_loop1
RARE_BL_last0:
    v_mfma_f32_32x32x16_bf16 v[48:63], v[216:219], v[160:163], v[48:63]
    s_add_u32 m0, m0, 0x400
    s_nop 0
    buffer_load_dwordx4 v74, s[20:23], s53 offen lds
    v_mfma_f32_32x32x16_bf16 v[0:15], v[220:223], v[168:171], v[0:15]
    s_waitcnt vmcnt(22)
    s_barrier
    ds_read_b128 v[204:207], v238 offset:0
    ds_read_b128 v[208:211], v239 offset:0
    ds_read_b128 v[212:215], v240 offset:0
    s_add_u32 m0, m0, 0x400
    s_nop 0
    buffer_load_dwordx4 v75, s[20:23], s53 offen lds
    v_mfma_f32_32x32x16_bf16 v[16:31], v[224:227], v[168:171], v[16:31]
    ds_read_b128 v[216:219], v241 offset:0
    s_add_u32 m0, m0, 0x400
    s_nop 0
    buffer_load_dwordx4 v76, s[20:23], s53 offen lds
    v_mfma_f32_32x32x16_bf16 v[32:47], v[228:231], v[168:171], v[32:47]
    ds_read_b128 v[220:223], v238 offset:512
    s_add_u32 m0, m0, 0x400
    s_nop 0
    buffer_load_dwordx4 v77, s[20:23], s53 offen lds
    v_mfma_f32_32x32x16_bf16 v[48:63], v[232:235], v[168:171], v[48:63]
    v_mov_b32 v251, v250
    v_mov_b32 v252, v250
    s_nop 1
    v_permlane32_swap_b32 v251, v252
    v_max_f32 v250, v251, v252
    v_max_f32 v250, 0, v250
    v_exp_f32 v251, -v250
    v_sub_f32 v144, v144, v250
    v_sub_f32 v145, v145, v250
    v_sub_f32 v146, v146, v250
    v_sub_f32 v147, v147, v250
    v_sub_f32 v148, v148, v250
    v_sub_f32 v149, v149, v250
    v_sub_f32 v150, v150, v250
    v_sub_f32 v151, v151, v250
    v_sub_f32 v152, v152, v250
    v_sub_f32 v153, v153, v250
    v_sub_f32 v154, v154, v250
    v_sub_f32 v155, v155, v250
    v_sub_f32 v156, v156, v250
    v_sub_f32 v157, v157, v250
    v_sub_f32 v158, v158, v250
    v_sub_f32 v159, v159, v250
    v_sub_f32 v176, v176, v250
    v_sub_f32 v177, v177, v250
    v_sub_f32 v178, v178, v250
    v_sub_f32 v179, v179, v250
    v_sub_f32 v180, v180, v250
    v_sub_f32 v181, v181, v250
    v_sub_f32 v182, v182, v250
    v_sub_f32 v183, v183, v250
    v_sub_f32 v184, v184, v250
    v_sub_f32 v185, v185, v250
    v_sub_f32 v186, v186, v250
    v_sub_f32 v187, v187, v250
    v_sub_f32 v188, v188, v250
    v_sub_f32 v189, v189, v250
    v_sub_f32 v190, v190, v250
    v_sub_f32 v191, v191, v250
    v_mul_f32 v236, v236, v251
    v_mul_f32 v65, v65, v251
    v_mul_f32 v0, v0, v251
    v_mul_f32 v1, v1, v251
    v_mul_f32 v2, v2, v251
    v_mul_f32 v3, v3, v251
    v_mul_f32 v4, v4, v251
    v_mul_f32 v5, v5, v251
    v_mul_f32 v6, v6, v251
    v_mul_f32 v7, v7, v251
    v_mul_f32 v8, v8, v251
    v_mul_f32 v9, v9, v251
    v_mul_f32 v10, v10, v251
    v_mul_f32 v11, v11, v251
    v_mul_f32 v12, v12, v251
    v_mul_f32 v13, v13, v251
    v_mul_f32 v14, v14, v251
    v_mul_f32 v15, v15, v251
    v_mul_f32 v16, v16, v251
    v_mul_f32 v17, v17, v251
    v_mul_f32 v18, v18, v251
    v_mul_f32 v19, v19, v251
    v_mul_f32 v20, v20, v251
    v_mul_f32 v21, v21, v251
    v_mul_f32 v22, v22, v251
    v_mul_f32 v23, v23, v251
    v_mul_f32 v24, v24, v251
    v_mul_f32 v25, v25, v251
    v_mul_f32 v26, v26, v251
    v_mul_f32 v27, v27, v251
    v_mul_f32 v28, v28, v251
    v_mul_f32 v29, v29, v251
    v_mul_f32 v30, v30, v251
    v_mul_f32 v31, v31, v251
    v_mul_f32 v32, v32, v251
    v_mul_f32 v33, v33, v251
    v_mul_f32 v34, v34, v251
    v_mul_f32 v35, v35, v251
    v_mul_f32 v36, v36, v251
    v_mul_f32 v37, v37, v251
    v_mul_f32 v38, v38, v251
    v_mul_f32 v39, v39, v251
    v_mul_f32 v40, v40, v251
    v_mul_f32 v41, v41, v251
    v_mul_f32 v42, v42, v251
    v_mul_f32 v43, v43, v251
    v_mul_f32 v44, v44, v251
    v_mul_f32 v45, v45, v251
    v_mul_f32 v46, v46, v251
    v_mul_f32 v47, v47, v251
    v_mul_f32 v48, v48, v251
    v_mul_f32 v49, v49, v251
    v_mul_f32 v50, v50, v251
    v_mul_f32 v51, v51, v251
    v_mul_f32 v52, v52, v251
    v_mul_f32 v53, v53, v251
    v_mul_f32 v54, v54, v251
    v_mul_f32 v55, v55, v251
    v_mul_f32 v56, v56, v251
    v_mul_f32 v57, v57, v251
    v_mul_f32 v58, v58, v251
    v_mul_f32 v59, v59, v251
    v_mul_f32 v60, v60, v251
    v_mul_f32 v61, v61, v251
    v_mul_f32 v62, v62, v251
    v_mul_f32 v63, v63, v251
    v_exp_f32 v144, v144
    v_exp_f32 v145, v145
    v_exp_f32 v146, v146
    v_add_f32 v236, v236, v144
    v_add_f32 v65, v65, v145
    v_cvt_pk_bf16_f32 v144, v144, v145
    v_exp_f32 v147, v147
    v_exp_f32 v148, v148
    v_add_f32 v236, v236, v146
    v_add_f32 v65, v65, v147
    v_cvt_pk_bf16_f32 v145, v146, v147
    v_exp_f32 v149, v149
    v_exp_f32 v150, v150
    v_add_f32 v236, v236, v148
    v_add_f32 v65, v65, v149
    s_branch REJ_BL_last0
RARE_BL_last1:
    s_waitcnt lgkmcnt(8)
    v_mfma_f32_32x32x16_bf16 v[32:47], v[212:215], v[144:147], v[32:47]
    v_add_u32 v238, s45, v238
    v_add_u32 v239, s45, v239
    v_add_u32 v240, s45, v240
    v_add_u32 v241, s45, v241
    v_add_u32 v242, s70, v242
    v_add_u32 v243, s70, v243
    s_waitcnt lgkmcnt(0)
    s_barrier
    s_add_u32 s53, s40, 0
    s_and_b32 s53, s53, 3
    s_mul_i32 s53, s53, 294912
    s_add_u32 s53, s53, 73728
    s_add_u32 m0, s65, s61
    s_nop 0
    buffer_load_dwordx4 v73, s[20:23], s53 offen lds
    v_mfma_f32_32x32x16_bf16 v[48:63], v[216:219], v[144:147], v[48:63]
    s_add_u32 m0, m0, 0x400
    s_nop 0
    buffer_load_dwordx4 v74, s[20:23], s53 offen lds
    v_mfma_f32_32x32x16_bf16 v[0:15], v[220:223], v[152:155], v[0:15]
    s_waitcnt vmcnt(19)
    s_barrier
    s_add_u32 m0, m0, 0x400
    s_nop 0
    buffer_load_dwordx4 v75, s[20:23], s53 offen lds
    v_mfma_f32_32x32x16_bf16 v[16:31], v[224:227], v[152:155], v[16:31]
    s_add_u32 m0, m0, 0x400
    s_nop 0
    buffer_load_dwordx4 v76, s[20:23], s53 offen lds
    v_mfma_f32_32x32x16_bf16 v[32:47], v[228:231], v[152:155], v[32:47]
    s_add_u32 m0, m0, 0x400
    s_nop 0
    buffer_load_dwordx4 v77, s[20:23], s53 offen lds
    v_mfma_f32_32x32x16_bf16 v[48:63], v[232:235], v[152:155], v[48:63]
    v_mov_b32 v251, v250
    v_mov_b32 v252, v250
    s_nop 1
    v_permlane32_swap_b32 v251, v252
    v_max_f32 v250, v251, v252
    v_max_f32 v250, 0, v250
    v_exp_f32 v251, -v250
    v_sub_f32 v160, v160, v250
    v_sub_f32 v161, v161, v250
    v_sub_f32 v162, v162, v250
    v_sub_f32 v163, v163, v250
    v_sub_f32 v164, v164, v250
    v_sub_f32 v165, v165, v250
    v_sub_f32 v166, v166, v250
    v_sub_f32 v167, v167, v250
    v_sub_f32 v168, v168, v250
    v_sub_f32 v169, v169, v250
    v_sub_f32 v170, v170, v250
    v_sub_f32 v171, v171, v250
    v_sub_f32 v172, v172, v250
    v_sub_f32 v173, v173, v250
    v_sub_f32 v174, v174, v250
    v_sub_f32 v175, v175, v250
    v_sub_f32 v176, v176, v250
    v_sub_f32 v177, v177, v250
    v_sub_f32 v178, v178, v250
    v_sub_f32 v179, v179, v250
    v_sub_f32 v180, v180, v250
    v_sub_f32 v181, v181, v250
    v_sub_f32 v182, v182, v250
    v_sub_f32 v183, v183, v250
    v_sub_f32 v184, v184, v250
    v_sub_f32 v185, v185, v250
    v_sub_f32 v186, v186, v250
    v_sub_f32 v187, v187, v250
    v_sub_f32 v188, v188, v250
    v_sub_f32 v189, v189, v250
    v_sub_f32 v190, v190, v250
    v_sub_f32 v191, v191, v250
    v_mul_f32 v236, v236, v251
    v_mul_f32 v65, v65, v251
    v_mul_f32 v0, v0, v251
    v_mul_f32 v1, v1, v251
    v_mul_f32 v2, v2, v251
    v_mul_f32 v3, v3, v251
    v_mul_f32 v4, v4, v251
    v_mul_f32 v5, v5, v251
    v_mul_f32 v6, v6, v251
    v_mul_f32 v7, v7, v251
    v_mul_f32 v8, v8, v251
    v_mul_f32 v9, v9, v251
    v_mul_f32 v10, v10, v251
    v_mul_f32 v11, v11, v251
    v_mul_f32 v12, v12, v251
    v_mul_f32 v13, v13, v251
    v_mul_f32 v14, v14, v251
    v_mul_f32 v15, v15, v251
    v_mul_f32 v16, v16, v251
    v_mul_f32 v17, v17, v251
    v_mul_f32 v18, v18, v251
    v_mul_f32 v19, v19, v251
    v_mul_f32 v20, v20, v251
    v_mul_f32 v21, v21, v251
    v_mul_f32 v22, v22, v251
    v_mul_f32 v23, v23, v251
    v_mul_f32 v24, v24, v251
    v_mul_f32 v25, v25, v251
    v_mul_f32 v26, v26, v251
    v_mul_f32 v27, v27, v251
    v_mul_f32 v28, v28, v251
    v_mul_f32 v29, v29, v251
    v_mul_f32 v30, v30, v251
    v_mul_f32 v31, v31, v251
    v_mul_f32 v32, v32, v251
    v_mul_f32 v33, v33, v251
    v_mul_f32 v34, v34, v251
    v_mul_f32 v35, v35, v251
    v_mul_f32 v36, v36, v251
    v_mul_f32 v37, v37, v251
    v_mul_f32 v38, v38, v251
    v_mul_f32 v39, v39, v251
    v_mul_f32 v40, v40, v251
    v_mul_f32 v41, v41, v251
    v_mul_f32 v42, v42, v251
    v_mul_f32 v43, v43, v251
    v_mul_f32 v44, v44, v251
    v_mul_f32 v45, v45, v251
    v_mul_f32 v46, v46, v251
    v_mul_f32 v47, v47, v251
    v_mul_f32 v48, v48, v251
    v_mul_f32 v49, v49, v251
    v_mul_f32 v50, v50, v251
    v_mul_f32 v51, v51, v251
    v_mul_f32 v52, v52, v251
    v_mul_f32 v53, v53, v251
    v_mul_f32 v54, v54, v251
    v_mul_f32 v55, v55, v251
    v_mul_f32 v56, v56, v251
    v_mul_f32 v57, v57, v251
    v_mul_f32 v58, v58, v251
    v_mul_f32 v59, v59, v251
    v_mul_f32 v60, v60, v251
    v_mul_f32 v61, v61, v251
    v_mul_f32 v62, v62, v251
    v_mul_f32 v63, v63, v251
    v_exp_f32 v160, v160
    v_exp_f32 v161, v161
    v_exp_f32 v162, v162
    v_add_f32 v236, v236, v160
    v_add_f32 v65, v65, v161
    v_cvt_pk_bf16_f32 v160, v160, v161
    v_exp_f32 v163, v163
    v_exp_f32 v164, v164
    v_add_f32 v236, v236, v162
    v_add_f32 v65, v65, v163
    v_cvt_pk_bf16_f32 v161, v162, v163
    v_exp_f32 v165, v165
    v_exp_f32 v166, v166
    v_add_f32 v236, v236, v164
    v_add_f32 v65, v65, v165
    v_cvt_pk_bf16_f32 v162, v164, v165
    v_exp_f32 v167, v167
    v_exp_f32 v168, v168
    v_add_f32 v236, v236, v166
    v_add_f32 v65, v65, v167
    v_cvt_pk_bf16_f32 v163, v166, v167
    v_exp_f32 v169, v169
    v_exp_f32 v170, v170
    v_add_f32 v236, v236, v168
    v_add_f32 v65, v65, v169
    v_cvt_pk_bf16_f32 v168, v168, v169
    v_exp_f32 v171, v171
    v_exp_f32 v172, v172
    v_add_f32 v236, v236, v170
    v_add_f32 v65, v65, v171
    v_cvt_pk_bf16_f32 v169, v170, v171
    v_exp_f32 v173, v173
    v_exp_f32 v174, v174
    s_branch REJ_BL_last1
ATT_BY:
    s_setprio 1
    v_lshlrev_b32 v251, 4, v254
    v_add_u32 v251, s43, v251
    ds_read_b128 v[128:131], v251 offset:0
    ds_read_b128 v[132:135], v251 offset:1024
    ds_read_b128 v[136:139], v251 offset:2048
    ds_read_b128 v[140:143], v251 offset:3072
    ds_read_b128 v[204:207], v238 offset:0
    ds_read_b128 v[208:211], v239 offset:0
    ds_read_b128 v[212:215], v240 offset:0
    ds_read_b128 v[216:219], v241 offset:0
    ds_read_b128 v[220:223], v238 offset:512
    ds_read_b128 v[224:227], v239 offset:512
    ds_read_b128 v[228:231], v240 offset:512
    ds_read_b128 v[232:235], v241 offset:512
    s_waitcnt lgkmcnt(7)
    v_mfma_f32_32x32x16_bf16 v[144:159], v[204:207], v[96:99], 0
    s_waitcnt lgkmcnt(6)
    v_mfma_f32_32x32x16_bf16 v[144:159], v[208:211], v[100:103], v[144:159]
    s_waitcnt lgkmcnt(5)
    v_mfma_f32_32x32x16_bf16 v[144:159], v[212:215], v[104:107], v[144:159]
    s_waitcnt lgkmcnt(4)
    v_mfma_f32_32x32x16_bf16 v[144:159], v[216:219], v[108:111], v[144:159]
    s_waitcnt lgkmcnt(3)
    v_mfma_f32_32x32x16_bf16 v[144:159], v[220:223], v[112:115], v[144:159]
    s_waitcnt lgkmcnt(2)
    v_mfma_f32_32x32x16_bf16 v[144:159], v[224:227], v[116:119], v[144:159]
    s_waitcnt lgkmcnt(1)
    v_mfma_f32_32x32x16_bf16 v[144:159], v[228:231], v[120:123], v[144:159]
    s_waitcnt lgkmcnt(0)
    v_mfma_f32_32x32x16_bf16 v[144:159], v[232:235], v[124:127], v[144:159]
    v_mov_b32 v236, 0
    v_mov_b32 v249, 0
    v_mov_b32 v237, 0
    v_mov_b32 v64, 0
    v_mov_b32 v65, 0
    v_mov_b32 v66, 0
    v_mov_b32 v67, 0
    v_mov_b32 v68, 0
    v_mov_b32 v69, 0
    v_mov_b32 v70, 0
    v_mov_b32 v71, 0
    v_mov_b32 v72, 0
    v_mov_b32 v73, 0
    v_mov_b32 v74, 0
    v_mov_b32 v75, 0
    v_mov_b32 v76, 0
    v_mov_b32 v77, 0
    v_mov_b32 v78, 0
    v_mov_b32 v79, 0
    v_mov_b32 v80, 0
    v_mov_b32 v81, 0
    v_mov_b32 v82, 0
    v_mov_b32 v83, 0
    v_mov_b32 v84, 0
    v_mov_b32 v85, 0
    v_mov_b32 v86, 0
    v_mov_b32 v87, 0
    v_mov_b32 v88, 0
    v_mov_b32 v89, 0
    v_mov_b32 v90, 0
    v_mov_b32 v91, 0
    v_mov_b32 v92, 0
    v_mov_b32 v93, 0
    v_mov_b32 v94, 0
    v_mov_b32 v95, 0
    s_waitcnt vmcnt(0)
    s_lshl_b32 s51, s37, 6
    s_add_u32 s51, s51, 0x24000
    s_lshl_b32 s52, s38, 2
    s_add_u32 s52, s52, s51
    s_mov_b32 s71, 0
    s_mov_b32 s47, 0xc000
    v_max3_f32 v250, v144, v145, v146
    v_max3_f32 v250, v250, v147, v148
    v_max3_f32 v250, v250, v149, v150
    v_max3_f32 v250, v250, v151, v152
    v_max3_f32 v250, v250, v153, v154
    v_max3_f32 v250, v250, v155, v156
    v_max3_f32 v250, v250, v157, v158
    v_max_f32 v250, v250, v159
    v_mov_b32 v251, v250
    v_mov_b32 v252, v250
    s_nop 1
    v_permlane32_swap_b32 v251, v252
    v_max_f32 v250, v251, v252
    v_sub_f32 v176, 0, v250
    v_sub_f32 v177, 0, v250
    v_sub_f32 v178, 0, v250
    v_sub_f32 v179, 0, v250
    v_sub_f32 v180, 0, v250
    v_sub_f32 v181, 0, v250
    v_sub_f32 v182, 0, v250
    v_sub_f32 v183, 0, v250
    v_sub_f32 v184, 0, v250
    v_sub_f32 v185, 0, v250
    v_sub_f32 v186, 0, v250
    v_sub_f32 v187, 0, v250
    v_sub_f32 v188, 0, v250
    v_sub_f32 v189, 0, v250
    v_sub_f32 v190, 0, v250
    v_sub_f32 v191, 0, v250
    v_sub_f32 v144, v144, v250
    v_sub_f32 v145, v145, v250
    v_sub_f32 v146, v146, v250
    v_sub_f32 v147, v147, v250
    v_sub_f32 v148, v148, v250
    v_sub_f32 v149, v149, v250
    v_sub_f32 v150, v150, v250
    v_sub_f32 v151, v151, v250
    v_sub_f32 v152, v152, v250
    v_sub_f32 v153, v153, v250
    v_sub_f32 v154, v154, v250
    v_sub_f32 v155, v155, v250
    v_sub_f32 v156, v156, v250
    v_sub_f32 v157, v157, v250
    v_sub_f32 v158, v158, v250
    v_sub_f32 v159, v159, v250
    s_mov_b32 s50, 14
    s_add_u32 s71, s71, 1
    s_mov_b32 s44, s42
    s_add_u32 s42, s42, 0x4000
    s_cmp_ge_u32 s42, 0x14000
    s_cselect_b32 s42, 0, s42
    s_sub_u32 s45, s42, s44
    s_mov_b32 s69, s47
    s_add_u32 s47, s47, 0x4000
    s_cmp_ge_u32 s47, 0x10000
    s_cselect_b32 s47, 0, s47
    s_sub_u32 s70, s47, s69
    v_add_u32 v238, s45, v238
    v_add_u32 v239, s45, v239
    v_add_u32 v240, s45, v240
    v_add_u32 v241, s45, v241
    v_add_u32 v242, s70, v242
    v_add_u32 v243, s70, v243
    v_add_u32 v246, s42, v244
    v_xor_b32 v247, 64, v246
    s_waitcnt lgkmcnt(0)
    s_barrier
    s_barrier
    ds_read_b128 v[204:207], v238 offset:0
    ds_read_b128 v[208:211], v239 offset:0
    ds_read_b128 v[212:215], v240 offset:0
    ds_read_b128 v[216:219], v241 offset:0
    ds_read_b128 v[220:223], v238 offset:512
    ds_read_b128 v[224:227], v239 offset:512
    s_waitcnt lgkmcnt(4)
    v_mfma_f32_32x32x16_bf16 v[160:175], v[204:207], v[96:99], v[176:191]
    ds_read_b128 v[228:231], v240 offset:512
    v_exp_f32 v144, v144
    v_exp_f32 v145, v145
    v_exp_f32 v146, v146
    v_add_f32 v236, v236, v144
    v_mfma_f32_32x32x16_bf16 v[160:175], v[208:211], v[100:103], v[160:175]
    ds_read_b128 v[232:235], v241 offset:512
    v_add_f32 v249, v249, v145
    v_cvt_pk_bf16_f32 v144, v144, v145
    v_exp_f32 v147, v147
    v_exp_f32 v148, v148
    v_add_f32 v236, v236, v146
    s_waitcnt lgkmcnt(4)
    v_mfma_f32_32x32x16_bf16 v[160:175], v[212:215], v[104:107], v[160:175]
    ds_read_b128 v[204:207], v246 offset:0
    v_add_f32 v249, v249, v147
    v_cvt_pk_bf16_f32 v145, v146, v147
    v_exp_f32 v149, v149
    v_exp_f32 v150, v150
    v_add_f32 v236, v236, v148
    v_mfma_f32_32x32x16_bf16 v[160:175], v[216:219], v[108:111], v[160:175]
    ds_read_b128 v[208:211], v246 offset:4096
    v_add_f32 v249, v249, v149
    v_cvt_pk_bf16_f32 v146, v148, v149
    v_exp_f32 v151, v151
    v_exp_f32 v152, v152
    v_add_f32 v236, v236, v150
    s_waitcnt lgkmcnt(4)
    v_mfma_f32_32x32x16_bf16 v[160:175], v[220:223], v[112:115], v[160:175]
    ds_read_b128 v[212:215], v247 offset:0
    v_add_f32 v249, v249, v151
    v_cvt_pk_bf16_f32 v147, v150, v151
    v_exp_f32 v153, v153
    v_exp_f32 v154, v154
    v_add_f32 v236, v236, v152
    v_mfma_f32_32x32x16_bf16 v[160:175], v[224:227], v[116:119], v[160:175]
    ds_read_b128 v[216:219], v247 offset:4096
    v_add_f32 v249, v249, v153
    v_cvt_pk_bf16_f32 v152, v152, v153
    v_exp_f32 v155, v155
    v_exp_f32 v156, v156
    v_add_f32 v236, v236, v154
    s_waitcnt lgkmcnt(4)
    v_mfma_f32_32x32x16_bf16 v[160:175], v[228:231], v[120:123], v[160:175]
    ds_read_b128 v[220:223], v246 offset:512
    v_add_f32 v249, v249, v155
    v_cvt_pk_bf16_f32 v153, v154, v155
    v_exp_f32 v157, v157
    v_exp_f32 v158, v158
    v_add_f32 v236, v236, v156
    v_mfma_f32_32x32x16_bf16 v[160:175], v[232:235], v[124:127], v[160:175]
    ds_read_b128 v[224:227], v246 offset:4608
    v_add_f32 v249, v249, v157
    v_cvt_pk_bf16_f32 v154, v156, v157
    v_exp_f32 v159, v159
    v_add_f32 v236, v236, v158
    v_add_f32 v249, v249, v159
    v_cvt_pk_bf16_f32 v155, v158, v159
    s_add_u32 s71, s71, 1
    s_waitcnt lgkmcnt(4)
    v_mfma_f32_16x16x32_bf16 v[192:195], v[204:207], v[128:131], 0
    ds_read_b128 v[228:231], v247 offset:512
    s_mov_b32 s44, s42
    s_add_u32 s42, s42, 0x4000
    s_cmp_ge_u32 s42, 0x14000
    s_cselect_b32 s42, 0, s42
    s_sub_u32 s45, s42, s44
    s_mov_b32 s69, s47
    v_mfma_f32_16x16x32_bf16 v[196:199], v[208:211], v[128:131], 0
    ds_read_b128 v[232:235], v247 offset:4608
    s_add_u32 s47, s47, 0x4000
    s_cmp_ge_u32 s47, 0x10000
    s_cselect_b32 s47, 0, s47
    s_sub_u32 s70, s47, s69
    v_max3_f32 v250, v160, v161, v162
    v_max3_f32 v250, v250, v163, v164
    v_max3_f32 v250, v250, v165, v166
    s_waitcnt lgkmcnt(4)
    v_mfma_f32_16x16x32_bf16 v[192:195], v[212:215], v[132:135], v[192:195]
    ds_read_b64_tr_b16 v[204:205], v242 offset:0
    ds_read_b64_tr_b16 v[206:207], v242 offset:2048
    v_max3_f32 v250, v250, v167, v168
    v_max3_f32 v250, v250, v169, v170
    v_max3_f32 v250, v250, v171, v172
    v_mfma_f32_16x16x32_bf16 v[196:199], v[216:219], v[132:135], v[196:199]
    ds_read_b64_tr_b16 v[208:209], v243 offset:0
    ds_read_b64_tr_b16 v[210:211], v243 offset:2048
    v_max3_f32 v250, v250, v173, v174
    v_max_f32 v250, v250, v175
    v_cmp_lt_f32 vcc, s58, v250
    s_cbranch_vccnz RARE_BY_first1
    s_waitcnt lgkmcnt(6)
    v_mfma_f32_16x16x32_bf16 v[192:195], v[220:223], v[136:139], v[192:195]
    ds_read_b64_tr_b16 v[212:213], v242 offset:512
    ds_read_b64_tr_b16 v[214:215], v242 offset:2560
    v_exp_f32 v160, v160
    v_exp_f32 v161, v161
    v_mfma_f32_16x16x32_bf16 v[196:199], v[224:227], v[136:139], v[196:199]
    ds_read_b64_tr_b16 v[216:217], v243 offset:512
    ds_read_b64_tr_b16 v[218:219], v243 offset:2560
    v_exp_f32 v162, v162
    v_add_f32 v236, v236, v160
    s_waitcnt lgkmcnt(8)
    v_mfma_f32_16x16x32_bf16 v[192:195], v[228:231], v[140:143], v[192:195]
    ds_read_b64_tr_b16 v[220:221], v242 offset:4096
    ds_read_b64_tr_b16 v[222:223], v242 offset:6144
    v_add_f32 v249, v249, v161
    v_cvt_pk_bf16_f32 v160, v160, v161
    v_mfma_f32_16x16x32_bf16 v[196:199], v[232:235], v[140:143], v[196:199]
    ds_read_b64_tr_b16 v[224:225], v243 offset:4096
    ds_read_b64_tr_b16 v[226:227], v243 offset:6144
    v_exp_f32 v163, v163
    s_waitcnt lgkmcnt(8)
    v_mfma_f32_32x32x16_bf16 v[0:15], v[204:207], v[144:147], 0
    ds_read_b64_tr_b16 v[228:229], v242 offset:4608
    ds_read_b64_tr_b16 v[230:231], v242 offset:6656
    v_exp_f32 v164, v164
    v_add_f32 v236, v236, v162
    v_add_f32 v249, v249, v163
    v_cvt_pk_bf16_f32 v161, v162, v163
    v_exp_f32 v165, v165
    v_mfma_f32_32x32x16_bf16 v[16:31], v[208:211], v[144:147], 0
    ds_read_b64_tr_b16 v[232:233], v243 offset:4608
    ds_read_b64_tr_b16 v[234:235], v243 offset:6656
    v_exp_f32 v166, v166
    v_add_f32 v236, v236, v164
    v_add_f32 v249, v249, v165
    v_cvt_pk_bf16_f32 v162, v164, v165
    v_exp_f32 v167, v167
    s_waitcnt lgkmcnt(8)
    v_mfma_f32_32x32x16_bf16 v[32:47], v[212:215], v[144:147], 0
    v_add_u32 v238, s45, v238
    v_add_u32 v239, s45, v239
    v_add_u32 v240, s45, v240
    v_add_u32 v241, s45, v241
    v_add_u32 v242, s70, v242
    v_add_u32 v243, s70, v243
    v_add_u32 v246, s47, v245
    v_xor_b32 v247, 64, v246
    s_waitcnt lgkmcnt(0)
    s_barrier
    v_exp_f32 v168, v168
    v_add_f32 v236, v236, v166
    v_add_f32 v249, v249, v167
    v_cvt_pk_bf16_f32 v163, v166, v167
    v_exp_f32 v169, v169
    v_mfma_f32_32x32x16_bf16 v[48:63], v[216:219], v[144:147], 0
    v_exp_f32 v170, v170
    v_add_f32 v236, v236, v168
    v_add_f32 v249, v249, v169
    v_cvt_pk_bf16_f32 v168, v168, v169
    v_exp_f32 v171, v171
    v_mfma_f32_32x32x16_bf16 v[0:15], v[220:223], v[152:155], v[0:15]
    s_barrier
    ds_read_b128 v[204:207], v238 offset:0
    ds_read_b128 v[208:211], v239 offset:0
    ds_read_b128 v[212:215], v240 offset:0
    v_exp_f32 v172, v172
    v_add_f32 v236, v236, v170
    v_add_f32 v249, v249, v171
    v_cvt_pk_bf16_f32 v169, v170, v171
    v_exp_f32 v173, v173
    v_mfma_f32_32x32x16_bf16 v[16:31], v[224:227], v[152:155], v[16:31]
    ds_read_b128 v[216:219], v241 offset:0
    v_exp_f32 v174, v174
    v_add_f32 v236, v236, v172
    v_add_f32 v249, v249, v173
    v_cvt_pk_bf16_f32 v170, v172, v173
    v_exp_f32 v175, v175
    v_mfma_f32_32x32x16_bf16 v[32:47], v[228:231], v[152:155], v[32:47]
    ds_read_b128 v[220:223], v238 offset:512
    v_add_f32 v236, v236, v174
    v_add_f32 v249, v249, v175
    v_cvt_pk_bf16_f32 v171, v174, v175
    v_mfma_f32_32x32x16_bf16 v[48:63], v[232:235], v[152:155], v[48:63]
REJ_BY_first1:
    ds_read_b128 v[224:227], v239 offset:512
    v_max3_f32 v253, v192, v193, v194
    v_max3_f32 v253, v253, v195, v196
    v_max3_f32 v253, v253, v197, v198
    v_max_f32 v253, v253, v199
    ds_swizzle_b32 v251, v253 offset:0x401F
    s_waitcnt lgkmcnt(0)
    v_mfma_f32_32x32x16_bf16 v[144:159], v[204:207], v[96:99], v[176:191]
    ds_read_b128 v[228:231], v240 offset:512
    v_max_f32 v253, v253, v251
    v_mov_b32 v251, v253
    v_mov_b32 v252, v253
    s_nop 1
    v_permlane32_swap_b32 v251, v252
    v_max_f32 v253, v251, v252
    v_sub_f32 v200, 0, v253
    v_mfma_f32_32x32x16_bf16 v[144:159], v[208:211], v[100:103], v[144:159]
    ds_read_b128 v[232:235], v241 offset:512
    v_sub_f32 v201, 0, v253
    v_sub_f32 v202, 0, v253
    v_sub_f32 v203, 0, v253
    v_sub_f32 v192, v192, v253
    v_sub_f32 v193, v193, v253
    v_sub_f32 v194, v194, v253
    v_mfma_f32_32x32x16_bf16 v[144:159], v[212:215], v[104:107], v[144:159]
    ds_read_b64_tr_b16 v[204:205], v246 offset:0
    ds_read_b64_tr_b16 v[206:207], v246 offset:4096
    v_sub_f32 v195, v195, v253
    v_sub_f32 v196, v196, v253
    v_sub_f32 v197, v197, v253
    v_sub_f32 v198, v198, v253
    v_sub_f32 v199, v199, v253
    v_exp_f32 v192, v192
    v_mfma_f32_32x32x16_bf16 v[144:159], v[216:219], v[108:111], v[144:159]
    ds_read_b64_tr_b16 v[208:209], v246 offset:32
    ds_read_b64_tr_b16 v[210:211], v246 offset:4128
    v_exp_f32 v193, v193
    v_exp_f32 v194, v194
    v_add_f32 v237, v237, v192
    v_add_f32 v237, v237, v193
    v_mfma_f32_32x32x16_bf16 v[144:159], v[220:223], v[112:115], v[144:159]
    ds_read_b64_tr_b16 v[212:213], v247 offset:0
    ds_read_b64_tr_b16 v[214:215], v247 offset:4096
    v_cvt_pk_bf16_f32 v192, v192, v193
    v_exp_f32 v195, v195
    v_exp_f32 v196, v196
    v_mfma_f32_32x32x16_bf16 v[144:159], v[224:227], v[116:119], v[144:159]
    ds_read_b64_tr_b16 v[216:217], v247 offset:32
    ds_read_b64_tr_b16 v[218:219], v247 offset:4128
    v_add_f32 v237, v237, v194
    v_add_f32 v237, v237, v195
    v_cvt_pk_bf16_f32 v193, v194, v195
    v_exp_f32 v197, v197
    s_waitcnt lgkmcnt(8)
    v_mfma_f32_32x32x16_bf16 v[144:159], v[228:231], v[120:123], v[144:159]
    ds_read_b64_tr_b16 v[220:221], v246 offset:512
    ds_read_b64_tr_b16 v[222:223], v246 offset:4608
    v_exp_f32 v198, v198
    v_add_f32 v237, v237, v196
    v_add_f32 v237, v237, v197
    v_cvt_pk_bf16_f32 v194, v196, v197
    v_mfma_f32_32x32x16_bf16 v[144:159], v[232:235], v[124:127], v[144:159]
    ds_read_b64_tr_b16 v[224:225], v246 offset:544
    ds_read_b64_tr_b16 v[226:227], v246 offset:4640
    v_exp_f32 v199, v199
    v_add_f32 v237, v237, v198
    v_add_f32 v237, v237, v199
    v_cvt_pk_bf16_f32 v195, v198, v199
LOOP_BY:
    s_add_u32 s71, s71, 1
    s_waitcnt lgkmcnt(8)
    v_mfma_f32_16x16x32_bf16 v[64:67], v[204:207], v[192:195], v[64:67]
    ds_read_b64_tr_b16 v[228:229], v247 offset:512
    ds_read_b64_tr_b16 v[230:231], v247 offset:4608
    s_mov_b32 s44, s42
    s_add_u32 s42, s42, 0x4000
    s_cmp_ge_u32 s42, 0x14000
    s_cselect_b32 s42, 0, s42
    s_sub_u32 s45, s42, s44
    s_mov_b32 s69, s47
    v_mfma_f32_16x16x32_bf16 v[68:71], v[208:211], v[192:195], v[68:71]
    ds_read_b64_tr_b16 v[232:233], v247 offset:544
    ds_read_b64_tr_b16 v[234:235], v247 offset:4640
    s_add_u32 s47, s47, 0x4000
    s_cmp_ge_u32 s47, 0x10000
    s_cselect_b32 s47, 0, s47
    s_sub_u32 s70, s47, s69
    v_max3_f32 v250, v144, v145, v146
    v_max3_f32 v250, v250, v147, v148
    s_waitcnt lgkmcnt(8)
    v_mfma_f32_16x16x32_bf16 v[72:75], v[212:215], v[192:195], v[72:75]
    ds_read_b64_tr_b16 v[204:205], v242 offset:0
    ds_read_b64_tr_b16 v[206:207], v242 offset:2048
    v_max3_f32 v250, v250, v149, v150
    v_max3_f32 v250, v250, v151, v152
    v_mfma_f32_16x16x32_bf16 v[76:79], v[216:219], v[192:195], v[76:79]
    ds_read_b64_tr_b16 v[208:209], v243 offset:0
    ds_read_b64_tr_b16 v[210:211], v243 offset:2048
    v_max3_f32 v250, v250, v153, v154
    v_max3_f32 v250, v250, v155, v156
    s_waitcnt lgkmcnt(8)
    v_mfma_f32_16x16x32_bf16 v[80:83], v[220:223], v[192:195], v[80:83]
    ds_read_b64_tr_b16 v[212:213], v242 offset:512
    ds_read_b64_tr_b16 v[214:215], v242 offset:2560
    v_max3_f32 v250, v250, v157, v158
    v_max_f32 v250, v250, v159
    v_mfma_f32_16x16x32_bf16 v[84:87], v[224:227], v[192:195], v[84:87]
    ds_read_b64_tr_b16 v[216:217], v243 offset:512
    ds_read_b64_tr_b16 v[218:219], v243 offset:2560
    v_cmp_lt_f32 vcc, s58, v250
    s_cbranch_vccnz RARE_BY_loop0
    v_exp_f32 v144, v144
    s_waitcnt lgkmcnt(8)
    v_mfma_f32_16x16x32_bf16 v[88:91], v[228:231], v[192:195], v[88:91]
    ds_read_b64_tr_b16 v[220:221], v242 offset:4096
    ds_read_b64_tr_b16 v[222:223], v242 offset:6144
    v_exp_f32 v145, v145
    v_mfma_f32_16x16x32_bf16 v[92:95], v[232:235], v[192:195], v[92:95]
    ds_read_b64_tr_b16 v[224:225], v243 offset:4096
    ds_read_b64_tr_b16 v[226:227], v243 offset:6144
    v_exp_f32 v146, v146
    s_waitcnt lgkmcnt(8)
    v_mfma_f32_32x32x16_bf16 v[0:15], v[204:207], v[160:163], v[0:15]
    ds_read_b64_tr_b16 v[228:229], v242 offset:4608
    ds_read_b64_tr_b16 v[230:231], v242 offset:6656
    v_add_f32 v236, v236, v144
    v_add_f32 v249, v249, v145
    v_cvt_pk_bf16_f32 v144, v144, v145
    v_exp_f32 v147, v147
    v_mfma_f32_32x32x16_bf16 v[16:31], v[208:211], v[160:163], v[16:31]
    ds_read_b64_tr_b16 v[232:233], v243 offset:4608
    ds_read_b64_tr_b16 v[234:235], v243 offset:6656
    v_exp_f32 v148, v148
    v_add_f32 v236, v236, v146
    s_waitcnt lgkmcnt(8)
    v_mfma_f32_32x32x16_bf16 v[32:47], v[212:215], v[160:163], v[32:47]
    v_add_u32 v238, s45, v238
    v_add_u32 v239, s45, v239
    v_add_u32 v240, s45, v240
    v_add_u32 v241, s45, v241
    v_add_u32 v242, s70, v242
    v_add_u32 v243, s70, v243
    v_add_u32 v246, s42, v244
    v_xor_b32 v247, 64, v246
    s_waitcnt lgkmcnt(0)
    s_barrier
    v_add_f32 v249, v249, v147
    v_cvt_pk_bf16_f32 v145, v146, v147
    v_exp_f32 v149, v149
    v_mfma_f32_32x32x16_bf16 v[48:63], v[216:219], v[160:163], v[48:63]
    v_exp_f32 v150, v150
    v_add_f32 v236, v236, v148
    v_mfma_f32_32x32x16_bf16 v[0:15], v[220:223], v[168:171], v[0:15]
    s_barrier
    ds_read_b128 v[204:207], v238 offset:0
    ds_read_b128 v[208:211], v239 offset:0
    ds_read_b128 v[212:215], v240 offset:0
    v_add_f32 v249, v249, v149
    v_cvt_pk_bf16_f32 v146, v148, v149
    v_exp_f32 v151, v151
    v_mfma_f32_32x32x16_bf16 v[16:31], v[224:227], v[168:171], v[16:31]
    ds_read_b128 v[216:219], v241 offset:0
    v_exp_f32 v152, v152
    v_add_f32 v236, v236, v150
    v_mfma_f32_32x32x16_bf16 v[32:47], v[228:231], v[168:171], v[32:47]
    ds_read_b128 v[220:223], v238 offset:512
    v_add_f32 v249, v249, v151
    v_cvt_pk_bf16_f32 v147, v150, v151
    v_exp_f32 v153, v153
    v_mfma_f32_32x32x16_bf16 v[48:63], v[232:235], v[168:171], v[48:63]
REJ_BY_loop0:
    ds_read_b128 v[224:227], v239 offset:512
    v_exp_f32 v154, v154
    v_add_f32 v236, v236, v152
    s_waitcnt lgkmcnt(4)
    v_mfma_f32_32x32x16_bf16 v[160:175], v[204:207], v[96:99], v[176:191]
    ds_read_b128 v[228:231], v240 offset:512
    v_add_f32 v249, v249, v153
    v_cvt_pk_bf16_f32 v152, v152, v153
    v_exp_f32 v155, v155
    v_mfma_f32_32x32x16_bf16 v[160:175], v[208:211], v[100:103], v[160:175]
    ds_read_b128 v[232:235], v241 offset:512
    v_exp_f32 v156, v156
    v_add_f32 v236, v236, v154
    s_waitcnt lgkmcnt(4)
    v_mfma_f32_32x32x16_bf16 v[160:175], v[212:215], v[104:107], v[160:175]
    ds_read_b128 v[204:207], v246 offset:0
    v_add_f32 v249, v249, v155
    v_cvt_pk_bf16_f32 v153, v154, v155
    v_exp_f32 v157, v157
    v_mfma_f32_32x32x16_bf16 v[160:175], v[216:219], v[108:111], v[160:175]
    ds_read_b128 v[208:211], v246 offset:4096
    v_exp_f32 v158, v158
    s_waitcnt lgkmcnt(4)
    v_mfma_f32_32x32x16_bf16 v[160:175], v[220:223], v[112:115], v[160:175]
    ds_read_b128 v[212:215], v247 offset:0
    v_add_f32 v236, v236, v156
    v_add_f32 v249, v249, v157
    v_mfma_f32_32x32x16_bf16 v[160:175], v[224:227], v[116:119], v[160:175]
    ds_read_b128 v[216:219], v247 offset:4096
    v_cvt_pk_bf16_f32 v154, v156, v157
    v_exp_f32 v159, v159
    s_waitcnt lgkmcnt(4)
    v_mfma_f32_32x32x16_bf16 v[160:175], v[228:231], v[120:123], v[160:175]
    ds_read_b128 v[220:223], v246 offset:512
    v_add_f32 v236, v236, v158
    v_add_f32 v249, v249, v159
    v_mfma_f32_32x32x16_bf16 v[160:175], v[232:235], v[124:127], v[160:175]
    ds_read_b128 v[224:227], v246 offset:4608
    v_cvt_pk_bf16_f32 v155, v158, v159
    s_add_u32 s71, s71, 1
    s_waitcnt lgkmcnt(4)
    v_mfma_f32_16x16x32_bf16 v[192:195], v[204:207], v[128:131], v[200:203]
    ds_read_b128 v[228:231], v247 offset:512
    s_mov_b32 s44, s42
    s_add_u32 s42, s42, 0x4000
    s_cmp_ge_u32 s42, 0x14000
    s_cselect_b32 s42, 0, s42
    s_sub_u32 s45, s42, s44
    s_mov_b32 s69, s47
    v_mfma_f32_16x16x32_bf16 v[196:199], v[208:211], v[128:131], v[200:203]
    ds_read_b128 v[232:235], v247 offset:4608
    s_add_u32 s47, s47, 0x4000
    s_cmp_ge_u32 s47, 0x10000
    s_cselect_b32 s47, 0, s47
    s_sub_u32 s70, s47, s69
    v_max3_f32 v250, v160, v161, v162
    v_max3_f32 v250, v250, v163, v164
    s_waitcnt lgkmcnt(4)
    v_mfma_f32_16x16x32_bf16 v[192:195], v[212:215], v[132:135], v[192:195]
    ds_read_b64_tr_b16 v[204:205], v242 offset:0
    ds_read_b64_tr_b16 v[206:207], v242 offset:2048
    v_max3_f32 v250, v250, v165, v166
    v_max3_f32 v250, v250, v167, v168
    v_mfma_f32_16x16x32_bf16 v[196:199], v[216:219], v[132:135], v[196:199]
    ds_read_b64_tr_b16 v[208:209], v243 offset:0
    ds_read_b64_tr_b16 v[210:211], v243 offset:2048
    v_max3_f32 v250, v250, v169, v170
    v_max3_f32 v250, v250, v171, v172
    s_waitcnt lgkmcnt(6)
    v_mfma_f32_16x16x32_bf16 v[192:195], v[220:223], v[136:139], v[192:195]
    ds_read_b64_tr_b16 v[212:213], v242 offset:512
    ds_read_b64_tr_b16 v[214:215], v242 offset:2560
    v_max3_f32 v250, v250, v173, v174
    v_max_f32 v250, v250, v175
    v_mfma_f32_16x16x32_bf16 v[196:199], v[224:227], v[136:139], v[196:199]
    ds_read_b64_tr_b16 v[216:217], v243 offset:512
    ds_read_b64_tr_b16 v[218:219], v243 offset:2560
    v_cmp_lt_f32 vcc, s58, v250
    s_cbranch_vccnz RARE_BY_loop1
    v_exp_f32 v160, v160
    s_waitcnt lgkmcnt(8)
    v_mfma_f32_16x16x32_bf16 v[192:195], v[228:231], v[140:143], v[192:195]
    ds_read_b64_tr_b16 v[220:221], v242 offset:4096
    ds_read_b64_tr_b16 v[222:223], v242 offset:6144
    v_exp_f32 v161, v161
    v_mfma_f32_16x16x32_bf16 v[196:199], v[232:235], v[140:143], v[196:199]
    ds_read_b64_tr_b16 v[224:225], v243 offset:4096
    ds_read_b64_tr_b16 v[226:227], v243 offset:6144
    v_exp_f32 v162, v162
    s_waitcnt lgkmcnt(8)
    v_mfma_f32_32x32x16_bf16 v[0:15], v[204:207], v[144:147], v[0:15]
    ds_read_b64_tr_b16 v[228:229], v242 offset:4608
    ds_read_b64_tr_b16 v[230:231], v242 offset:6656
    v_add_f32 v236, v236, v160
    v_add_f32 v249, v249, v161
    v_cvt_pk_bf16_f32 v160, v160, v161
    v_exp_f32 v163, v163
    v_exp_f32 v164, v164
    v_mfma_f32_32x32x16_bf16 v[16:31], v[208:211], v[144:147], v[16:31]
    ds_read_b64_tr_b16 v[232:233], v243 offset:4608
    ds_read_b64_tr_b16 v[234:235], v243 offset:6656
    v_add_f32 v236, v236, v162
    v_add_f32 v249, v249, v163
    v_cvt_pk_bf16_f32 v161, v162, v163
    v_exp_f32 v165, v165
    v_exp_f32 v166, v166
    s_waitcnt lgkmcnt(8)
    v_mfma_f32_32x32x16_bf16 v[32:47], v[212:215], v[144:147], v[32:47]
    v_add_u32 v238, s45, v238
    v_add_u32 v239, s45, v239
    v_add_u32 v240, s45, v240
    v_add_u32 v241, s45, v241
    v_add_u32 v242, s70, v242
    v_add_u32 v243, s70, v243
    v_add_u32 v246, s47, v245
    v_xor_b32 v247, 64, v246
    s_waitcnt lgkmcnt(0)
    s_barrier
    v_add_f32 v236, v236, v164
    v_add_f32 v249, v249, v165
    v_cvt_pk_bf16_f32 v162, v164, v165
    v_exp_f32 v167, v167
    v_mfma_f32_32x32x16_bf16 v[48:63], v[216:219], v[144:147], v[48:63]
    v_exp_f32 v168, v168
    v_add_f32 v236, v236, v166
    v_add_f32 v249, v249, v167
    v_cvt_pk_bf16_f32 v163, v166, v167
    v_mfma_f32_32x32x16_bf16 v[0:15], v[220:223], v[152:155], v[0:15]
    s_barrier
    ds_read_b128 v[204:207], v238 offset:0
    ds_read_b128 v[208:211], v239 offset:0
    ds_read_b128 v[212:215], v240 offset:0
    v_exp_f32 v169, v169
    v_exp_f32 v170, v170
    v_add_f32 v236, v236, v168
    v_mfma_f32_32x32x16_bf16 v[16:31], v[224:227], v[152:155], v[16:31]
    ds_read_b128 v[216:219], v241 offset:0
    v_add_f32 v249, v249, v169
    v_cvt_pk_bf16_f32 v168, v168, v169
    v_exp_f32 v171, v171
    v_exp_f32 v172, v172
    v_mfma_f32_32x32x16_bf16 v[32:47], v[228:231], v[152:155], v[32:47]
    ds_read_b128 v[220:223], v238 offset:512
    v_add_f32 v236, v236, v170
    v_add_f32 v249, v249, v171
    v_cvt_pk_bf16_f32 v169, v170, v171
    v_exp_f32 v173, v173
    v_mfma_f32_32x32x16_bf16 v[48:63], v[232:235], v[152:155], v[48:63]
REJ_BY_loop1:
    ds_read_b128 v[224:227], v239 offset:512
    v_max3_f32 v253, v192, v193, v194
    v_max3_f32 v253, v253, v195, v196
    v_max3_f32 v253, v253, v197, v198
    v_max_f32 v253, v253, v199
    v_cmp_lt_f32 vcc, s58, v253
    s_cbranch_vccnz RRARE_BY_loop
RREJ_BY_loop:
    s_waitcnt lgkmcnt(4)
    v_mfma_f32_32x32x16_bf16 v[144:159], v[204:207], v[96:99], v[176:191]
    ds_read_b128 v[228:231], v240 offset:512
    v_exp_f32 v192, v192
    v_exp_f32 v193, v193
    v_exp_f32 v194, v194
    v_mfma_f32_32x32x16_bf16 v[144:159], v[208:211], v[100:103], v[144:159]
    ds_read_b128 v[232:235], v241 offset:512
    v_add_f32 v237, v237, v192
    v_add_f32 v237, v237, v193
    v_cvt_pk_bf16_f32 v192, v192, v193
    v_exp_f32 v195, v195
    s_waitcnt lgkmcnt(4)
    v_mfma_f32_32x32x16_bf16 v[144:159], v[212:215], v[104:107], v[144:159]
    ds_read_b64_tr_b16 v[204:205], v246 offset:0
    ds_read_b64_tr_b16 v[206:207], v246 offset:4096
    v_exp_f32 v196, v196
    v_add_f32 v237, v237, v194
    v_add_f32 v237, v237, v195
    v_cvt_pk_bf16_f32 v193, v194, v195
    v_mfma_f32_32x32x16_bf16 v[144:159], v[216:219], v[108:111], v[144:159]
    ds_read_b64_tr_b16 v[208:209], v246 offset:32
    ds_read_b64_tr_b16 v[210:211], v246 offset:4128
    v_exp_f32 v197, v197
    v_exp_f32 v198, v198
    v_add_f32 v237, v237, v196
    s_waitcnt lgkmcnt(6)
    v_mfma_f32_32x32x16_bf16 v[144:159], v[220:223], v[112:115], v[144:159]
    ds_read_b64_tr_b16 v[212:213], v247 offset:0
    ds_read_b64_tr_b16 v[214:215], v247 offset:4096
    v_add_f32 v237, v237, v197
    v_cvt_pk_bf16_f32 v194, v196, v197
    v_exp_f32 v199, v199
    v_exp_f32 v174, v174
    v_mfma_f32_32x32x16_bf16 v[144:159], v[224:227], v[116:119], v[144:159]
    ds_read_b64_tr_b16 v[216:217], v247 offset:32
    ds_read_b64_tr_b16 v[218:219], v247 offset:4128
    v_add_f32 v237, v237, v198
    v_add_f32 v237, v237, v199
    v_cvt_pk_bf16_f32 v195, v198, v199
    v_add_f32 v236, v236, v172
    s_waitcnt lgkmcnt(8)
    v_mfma_f32_32x32x16_bf16 v[144:159], v[228:231], v[120:123], v[144:159]
    ds_read_b64_tr_b16 v[220:221], v246 offset:512
    ds_read_b64_tr_b16 v[222:223], v246 offset:4608
    v_add_f32 v249, v249, v173
    v_cvt_pk_bf16_f32 v170, v172, v173
    v_exp_f32 v175, v175
    v_mfma_f32_32x32x16_bf16 v[144:159], v[232:235], v[124:127], v[144:159]
    ds_read_b64_tr_b16 v[224:225], v246 offset:544
    ds_read_b64_tr_b16 v[226:227], v246 offset:4640
    v_add_f32 v236, v236, v174
    v_add_f32 v249, v249, v175
    v_cvt_pk_bf16_f32 v171, v174, v175
    s_cmp_lg_u32 s50, 3
    s_cbranch_scc1 NOT_BY
    v_and_b32 v251, 3, v254
    v_lshlrev_b32 v251, 7, v251
    v_min_u32 v251, 0x13c, v251
    v_lshrrev_b32 v252, 2, v254
    v_mul_u32_u24 v252, 0x480, v252
    v_add_u32 v251, v251, v252
    s_add_u32 s51, s36, 2
    s_and_b32 s51, s51, 3
    s_mul_i32 s51, s51, 36864
    s_mul_i32 s52, s39, 147456
    s_add_u32 s51, s51, s52
    buffer_load_dword v255, v251, s[20:23], s51 offen
    s_add_u32 s51, s51, 18432
    buffer_load_dword v255, v251, s[20:23], s51 offen
NOT_BY:
    s_sub_u32 s50, s50, 1
    s_cmp_lg_u32 s50, 0
    s_cbranch_scc1 LOOP_BY
    s_add_u32 s71, s71, 1
    s_waitcnt lgkmcnt(8)
    v_mfma_f32_16x16x32_bf16 v[64:67], v[204:207], v[192:195], v[64:67]
    ds_read_b64_tr_b16 v[228:229], v247 offset:512
    ds_read_b64_tr_b16 v[230:231], v247 offset:4608
    s_mov_b32 s44, s42
    s_add_u32 s42, s42, 0x4000
    s_cmp_ge_u32 s42, 0x14000
    s_cselect_b32 s42, 0, s42
    s_sub_u32 s45, s42, s44
    s_mov_b32 s69, s47
    v_mfma_f32_16x16x32_bf16 v[68:71], v[208:211], v[192:195], v[68:71]
    ds_read_b64_tr_b16 v[232:233], v247 offset:544
    ds_read_b64_tr_b16 v[234:235], v247 offset:4640
    s_add_u32 s47, s47, 0x4000
    s_cmp_ge_u32 s47, 0x10000
    s_cselect_b32 s47, 0, s47
    s_sub_u32 s70, s47, s69
    v_max3_f32 v250, v144, v145, v146
    v_max3_f32 v250, v250, v147, v148
    s_waitcnt lgkmcnt(8)
    v_mfma_f32_16x16x32_bf16 v[72:75], v[212:215], v[192:195], v[72:75]
    ds_read_b64_tr_b16 v[204:205], v242 offset:0
    ds_read_b64_tr_b16 v[206:207], v242 offset:2048
    v_max3_f32 v250, v250, v149, v150
    v_max3_f32 v250, v250, v151, v152
    v_mfma_f32_16x16x32_bf16 v[76:79], v[216:219], v[192:195], v[76:79]
    ds_read_b64_tr_b16 v[208:209], v243 offset:0
    ds_read_b64_tr_b16 v[210:211], v243 offset:2048
    v_max3_f32 v250, v250, v153, v154
    v_max3_f32 v250, v250, v155, v156
    s_waitcnt lgkmcnt(8)
    v_mfma_f32_16x16x32_bf16 v[80:83], v[220:223], v[192:195], v[80:83]
    ds_read_b64_tr_b16 v[212:213], v242 offset:512
    ds_read_b64_tr_b16 v[214:215], v242 offset:2560
    v_max3_f32 v250, v250, v157, v158
    v_max_f32 v250, v250, v159
    v_mfma_f32_16x16x32_bf16 v[84:87], v[224:227], v[192:195], v[84:87]
    ds_read_b64_tr_b16 v[216:217], v243 offset:512
    ds_read_b64_tr_b16 v[218:219], v243 offset:2560
    v_cmp_lt_f32 vcc, s58, v250
    s_cbranch_vccnz RARE_BY_last0
    v_exp_f32 v144, v144
    s_waitcnt lgkmcnt(8)
    v_mfma_f32_16x16x32_bf16 v[88:91], v[228:231], v[192:195], v[88:91]
    ds_read_b64_tr_b16 v[220:221], v242 offset:4096
    ds_read_b64_tr_b16 v[222:223], v242 offset:6144
    v_exp_f32 v145, v145
    v_mfma_f32_16x16x32_bf16 v[92:95], v[232:235], v[192:195], v[92:95]
    ds_read_b64_tr_b16 v[224:225], v243 offset:4096
    ds_read_b64_tr_b16 v[226:227], v243 offset:6144
    v_exp_f32 v146, v146
    s_waitcnt lgkmcnt(8)
    v_mfma_f32_32x32x16_bf16 v[0:15], v[204:207], v[160:163], v[0:15]
    ds_read_b64_tr_b16 v[228:229], v242 offset:4608
    ds_read_b64_tr_b16 v[230:231], v242 offset:6656
    v_add_f32 v236, v236, v144
    v_add_f32 v249, v249, v145
    v_cvt_pk_bf16_f32 v144, v144, v145
    v_exp_f32 v147, v147
    v_mfma_f32_32x32x16_bf16 v[16:31], v[208:211], v[160:163], v[16:31]
    ds_read_b64_tr_b16 v[232:233], v243 offset:4608
    ds_read_b64_tr_b16 v[234:235], v243 offset:6656
    v_exp_f32 v148, v148
    v_add_f32 v236, v236, v146
    s_waitcnt lgkmcnt(8)
    v_mfma_f32_32x32x16_bf16 v[32:47], v[212:215], v[160:163], v[32:47]
    v_add_u32 v238, s45, v238
    v_add_u32 v239, s45, v239
    v_add_u32 v240, s45, v240
    v_add_u32 v241, s45, v241
    v_add_u32 v242, s70, v242
    v_add_u32 v243, s70, v243
    v_add_u32 v246, s42, v244
    v_xor_b32 v247, 64, v246
    s_waitcnt lgkmcnt(0)
    s_barrier
    v_add_f32 v249, v249, v147
    v_cvt_pk_bf16_f32 v145, v146, v147
    v_exp_f32 v149, v149
    v_mfma_f32_32x32x16_bf16 v[48:63], v[216:219], v[160:163], v[48:63]
    v_exp_f32 v150, v150
    v_add_f32 v236, v236, v148
    v_mfma_f32_32x32x16_bf16 v[0:15], v[220:223], v[168:171], v[0:15]
    s_barrier
    ds_read_b128 v[204:207], v238 offset:0
    ds_read_b128 v[208:211], v239 offset:0
    ds_read_b128 v[212:215], v240 offset:0
    v_add_f32 v249, v249, v149
    v_cvt_pk_bf16_f32 v146, v148, v149
    v_exp_f32 v151, v151
    v_mfma_f32_32x32x16_bf16 v[16:31], v[224:227], v[168:171], v[16:31]
    ds_read_b128 v[216:219], v241 offset:0
    v_exp_f32 v152, v152
    v_add_f32 v236, v236, v150
    v_mfma_f32_32x32x16_bf16 v[32:47], v[228:231], v[168:171], v[32:47]
    ds_read_b128 v[220:223], v238 offset:512
    v_add_f32 v249, v249, v151
    v_cvt_pk_bf16_f32 v147, v150, v151
    v_exp_f32 v153, v153
    v_mfma_f32_32x32x16_bf16 v[48:63], v[232:235], v[168:171], v[48:63]
REJ_BY_last0:
    ds_read_b128 v[224:227], v239 offset:512
    v_exp_f32 v154, v154
    v_add_f32 v236, v236, v152
    s_waitcnt lgkmcnt(4)
    v_mfma_f32_32x32x16_bf16 v[160:175], v[204:207], v[96:99], v[176:191]
    ds_read_b128 v[228:231], v240 offset:512
    v_add_f32 v249, v249, v153
    v_cvt_pk_bf16_f32 v152, v152, v153
    v_exp_f32 v155, v155
    v_mfma_f32_32x32x16_bf16 v[160:175], v[208:211], v[100:103], v[160:175]
    ds_read_b128 v[232:235], v241 offset:512
    v_exp_f32 v156, v156
    v_add_f32 v236, v236, v154
    s_waitcnt lgkmcnt(4)
    v_mfma_f32_32x32x16_bf16 v[160:175], v[212:215], v[104:107], v[160:175]
    ds_read_b128 v[204:207], v246 offset:0
    v_add_f32 v249, v249, v155
    v_cvt_pk_bf16_f32 v153, v154, v155
    v_exp_f32 v157, v157
    v_mfma_f32_32x32x16_bf16 v[160:175], v[216:219], v[108:111], v[160:175]
    ds_read_b128 v[208:211], v246 offset:4096
    v_exp_f32 v158, v158
    s_waitcnt lgkmcnt(4)
    v_mfma_f32_32x32x16_bf16 v[160:175], v[220:223], v[112:115], v[160:175]
    ds_read_b128 v[212:215], v247 offset:0
    v_add_f32 v236, v236, v156
    v_add_f32 v249, v249, v157
    v_mfma_f32_32x32x16_bf16 v[160:175], v[224:227], v[116:119], v[160:175]
    ds_read_b128 v[216:219], v247 offset:4096
    v_cvt_pk_bf16_f32 v154, v156, v157
    v_exp_f32 v159, v159
    s_waitcnt lgkmcnt(4)
    v_mfma_f32_32x32x16_bf16 v[160:175], v[228:231], v[120:123], v[160:175]
    ds_read_b128 v[220:223], v246 offset:512
    v_add_f32 v236, v236, v158
    v_add_f32 v249, v249, v159
    v_mfma_f32_32x32x16_bf16 v[160:175], v[232:235], v[124:127], v[160:175]
    ds_read_b128 v[224:227], v246 offset:4608
    v_cvt_pk_bf16_f32 v155, v158, v159
    s_add_u32 s71, s71, 1
    s_waitcnt lgkmcnt(4)
    v_mfma_f32_16x16x32_bf16 v[192:195], v[204:207], v[128:131], v[200:203]
    ds_read_b128 v[228:231], v247 offset:512
    s_mov_b32 s44, s42
    s_add_u32 s42, s42, 0x4000
    s_cmp_ge_u32 s42, 0x14000
    s_cselect_b32 s42, 0, s42
    s_sub_u32 s45, s42, s44
    s_mov_b32 s69, s47
    v_mfma_f32_16x16x32_bf16 v[196:199], v[208:211], v[128:131], v[200:203]
    ds_read_b128 v[232:235], v247 offset:4608
    s_add_u32 s47, s47, 0x4000
    s_cmp_ge_u32 s47, 0x10000
    s_cselect_b32 s47, 0, s47
    s_sub_u32 s70, s47, s69
    v_max3_f32 v250, v160, v161, v162
    v_max3_f32 v250, v250, v163, v164
    v_max3_f32 v250, v250, v165, v166
    v_max3_f32 v250, v250, v167, v168
    s_waitcnt lgkmcnt(4)
    v_mfma_f32_16x16x32_bf16 v[192:195], v[212:215], v[132:135], v[192:195]
    ds_read_b64_tr_b16 v[204:205], v242 offset:0
    ds_read_b64_tr_b16 v[206:207], v242 offset:2048
    v_max3_f32 v250, v250, v169, v170
    v_max3_f32 v250, v250, v171, v172
    v_max3_f32 v250, v250, v173, v174
    v_max_f32 v250, v250, v175
    v_mfma_f32_16x16x32_bf16 v[196:199], v[216:219], v[132:135], v[196:199]
    ds_read_b64_tr_b16 v[208:209], v243 offset:0
    ds_read_b64_tr_b16 v[210:211], v243 offset:2048
    v_cmp_lt_f32 vcc, s58, v250
    s_cbranch_vccnz RARE_BY_last1
    v_exp_f32 v160, v160
    v_exp_f32 v161, v161
    s_waitcnt lgkmcnt(6)
    v_mfma_f32_16x16x32_bf16 v[192:195], v[220:223], v[136:139], v[192:195]
    ds_read_b64_tr_b16 v[212:213], v242 offset:512
    ds_read_b64_tr_b16 v[214:215], v242 offset:2560
    v_exp_f32 v162, v162
    v_add_f32 v236, v236, v160
    v_add_f32 v249, v249, v161
    v_mfma_f32_16x16x32_bf16 v[196:199], v[224:227], v[136:139], v[196:199]
    ds_read_b64_tr_b16 v[216:217], v243 offset:512
    ds_read_b64_tr_b16 v[218:219], v243 offset:2560
    v_cvt_pk_bf16_f32 v160, v160, v161
    v_exp_f32 v163, v163
    s_waitcnt lgkmcnt(8)
    v_mfma_f32_16x16x32_bf16 v[192:195], v[228:231], v[140:143], v[192:195]
    ds_read_b64_tr_b16 v[220:221], v242 offset:4096
    ds_read_b64_tr_b16 v[222:223], v242 offset:6144
    v_exp_f32 v164, v164
    v_add_f32 v236, v236, v162
    v_mfma_f32_16x16x32_bf16 v[196:199], v[232:235], v[140:143], v[196:199]
    ds_read_b64_tr_b16 v[224:225], v243 offset:4096
    ds_read_b64_tr_b16 v[226:227], v243 offset:6144
    v_add_f32 v249, v249, v163
    v_cvt_pk_bf16_f32 v161, v162, v163
    v_exp_f32 v165, v165
    s_waitcnt lgkmcnt(8)
    v_mfma_f32_32x32x16_bf16 v[0:15], v[204:207], v[144:147], v[0:15]
    ds_read_b64_tr_b16 v[228:229], v242 offset:4608
    ds_read_b64_tr_b16 v[230:231], v242 offset:6656
    v_exp_f32 v166, v166
    v_add_f32 v236, v236, v164
    v_add_f32 v249, v249, v165
    v_cvt_pk_bf16_f32 v162, v164, v165
    v_exp_f32 v167, v167
    v_exp_f32 v168, v168
    v_mfma_f32_32x32x16_bf16 v[16:31], v[208:211], v[144:147], v[16:31]
    ds_read_b64_tr_b16 v[232:233], v243 offset:4608
    ds_read_b64_tr_b16 v[234:235], v243 offset:6656
    v_add_f32 v236, v236, v166
    v_add_f32 v249, v249, v167
    v_cvt_pk_bf16_f32 v163, v166, v167
    v_exp_f32 v169, v169
    v_exp_f32 v170, v170
    v_add_f32 v236, v236, v168
    v_add_f32 v249, v249, v169
    s_waitcnt lgkmcnt(8)
    v_mfma_f32_32x32x16_bf16 v[32:47], v[212:215], v[144:147], v[32:47]
    v_add_u32 v238, s45, v238
    v_add_u32 v239, s45, v239
    v_add_u32 v240, s45, v240
    v_add_u32 v241, s45, v241
    v_add_u32 v242, s70, v242
    v_add_u32 v243, s70, v243
    v_add_u32 v246, s47, v245
    v_xor_b32 v247, 64, v246
    s_waitcnt lgkmcnt(0)
    s_barrier
    v_cvt_pk_bf16_f32 v168, v168, v169
    v_exp_f32 v171, v171
    v_exp_f32 v172, v172
    v_add_f32 v236, v236, v170
    v_add_f32 v249, v249, v171
    v_cvt_pk_bf16_f32 v169, v170, v171
    v_exp_f32 v173, v173
    v_mfma_f32_32x32x16_bf16 v[48:63], v[216:219], v[144:147], v[48:63]
    v_exp_f32 v174, v174
    v_add_f32 v236, v236, v172
    v_add_f32 v249, v249, v173
    v_cvt_pk_bf16_f32 v170, v172, v173
    v_exp_f32 v175, v175
    v_add_f32 v236, v236, v174
    v_add_f32 v249, v249, v175
    v_mfma_f32_32x32x16_bf16 v[0:15], v[220:223], v[152:155], v[0:15]
    s_barrier
    v_cvt_pk_bf16_f32 v171, v174, v175
    v_mfma_f32_32x32x16_bf16 v[16:31], v[224:227], v[152:155], v[16:31]
    v_mfma_f32_32x32x16_bf16 v[32:47], v[228:231], v[152:155], v[32:47]
    v_mfma_f32_32x32x16_bf16 v[48:63], v[232:235], v[152:155], v[48:63]
REJ_BY_last1:
    v_max3_f32 v253, v192, v193, v194
    v_max3_f32 v253, v253, v195, v196
    v_max3_f32 v253, v253, v197, v198
    v_max_f32 v253, v253, v199
    v_cmp_lt_f32 vcc, s58, v253
    s_cbranch_vccnz RRARE_BY_last
RREJ_BY_last:
    v_exp_f32 v192, v192
    v_exp_f32 v193, v193
    v_exp_f32 v194, v194
    v_add_f32 v237, v237, v192
    v_add_f32 v237, v237, v193
    v_cvt_pk_bf16_f32 v192, v192, v193
    v_exp_f32 v195, v195
    v_exp_f32 v196, v196
    v_add_f32 v237, v237, v194
    v_add_f32 v237, v237, v195
    v_cvt_pk_bf16_f32 v193, v194, v195
    v_exp_f32 v197, v197
    v_exp_f32 v198, v198
    v_add_f32 v237, v237, v196
    v_add_f32 v237, v237, v197
    v_cvt_pk_bf16_f32 v194, v196, v197
    v_exp_f32 v199, v199
    v_add_f32 v237, v237, v198
    v_add_f32 v237, v237, v199
    v_cvt_pk_bf16_f32 v195, v198, v199
    ds_read_b64_tr_b16 v[204:205], v246 offset:0
    ds_read_b64_tr_b16 v[206:207], v246 offset:4096
    ds_read_b64_tr_b16 v[208:209], v246 offset:32
    ds_read_b64_tr_b16 v[210:211], v246 offset:4128
    ds_read_b64_tr_b16 v[212:213], v247 offset:0
    ds_read_b64_tr_b16 v[214:215], v247 offset:4096
    ds_read_b64_tr_b16 v[216:217], v247 offset:32
    ds_read_b64_tr_b16 v[218:219], v247 offset:4128
    ds_read_b64_tr_b16 v[220:221], v246 offset:512
    ds_read_b64_tr_b16 v[222:223], v246 offset:4608
    ds_read_b64_tr_b16 v[224:225], v246 offset:544
    ds_read_b64_tr_b16 v[226:227], v246 offset:4640
    s_waitcnt lgkmcnt(10)
    v_mfma_f32_16x16x32_bf16 v[64:67], v[204:207], v[192:195], v[64:67]
    ds_read_b64_tr_b16 v[228:229], v247 offset:512
    ds_read_b64_tr_b16 v[230:231], v247 offset:4608
    s_waitcnt lgkmcnt(10)
    v_mfma_f32_16x16x32_bf16 v[68:71], v[208:211], v[192:195], v[68:71]
    ds_read_b64_tr_b16 v[232:233], v247 offset:544
    ds_read_b64_tr_b16 v[234:235], v247 offset:4640
    s_waitcnt lgkmcnt(10)
    v_mfma_f32_16x16x32_bf16 v[72:75], v[212:215], v[192:195], v[72:75]
    ds_read_b64_tr_b16 v[204:205], v242 offset:0
    ds_read_b64_tr_b16 v[206:207], v242 offset:2048
    s_waitcnt lgkmcnt(10)
    v_mfma_f32_16x16x32_bf16 v[76:79], v[216:219], v[192:195], v[76:79]
    ds_read_b64_tr_b16 v[208:209], v243 offset:0
    ds_read_b64_tr_b16 v[210:211], v243 offset:2048
    s_waitcnt lgkmcnt(10)
    v_mfma_f32_16x16x32_bf16 v[80:83], v[220:223], v[192:195], v[80:83]
    ds_read_b64_tr_b16 v[212:213], v242 offset:512
    ds_read_b64_tr_b16 v[214:215], v242 offset:2560
    s_waitcnt lgkmcnt(10)
    v_mfma_f32_16x16x32_bf16 v[84:87], v[224:227], v[192:195], v[84:87]
    ds_read_b64_tr_b16 v[216:217], v243 offset:512
    ds_read_b64_tr_b16 v[218:219], v243 offset:2560
    s_waitcnt lgkmcnt(10)
    v_mfma_f32_16x16x32_bf16 v[88:91], v[228:231], v[192:195], v[88:91]
    ds_read_b64_tr_b16 v[220:221], v242 offset:4096
    ds_read_b64_tr_b16 v[222:223], v242 offset:6144
    s_waitcnt lgkmcnt(10)
    v_mfma_f32_16x16x32_bf16 v[92:95], v[232:235], v[192:195], v[92:95]
    ds_read_b64_tr_b16 v[224:225], v243 offset:4096
    ds_read_b64_tr_b16 v[226:227], v243 offset:6144
    s_waitcnt lgkmcnt(10)
    v_mfma_f32_32x32x16_bf16 v[0:15], v[204:207], v[160:163], v[0:15]
    ds_read_b64_tr_b16 v[228:229], v242 offset:4608
    ds_read_b64_tr_b16 v[230:231], v242 offset:6656
    s_waitcnt lgkmcnt(10)
    v_mfma_f32_32x32x16_bf16 v[16:31], v[208:211], v[160:163], v[16:31]
    ds_read_b64_tr_b16 v[232:233], v243 offset:4608
    ds_read_b64_tr_b16 v[234:235], v243 offset:6656
    s_waitcnt lgkmcnt(10)
    v_mfma_f32_32x32x16_bf16 v[32:47], v[212:215], v[160:163], v[32:47]
    s_waitcnt lgkmcnt(8)
    v_mfma_f32_32x32x16_bf16 v[48:63], v[216:219], v[160:163], v[48:63]
    s_waitcnt lgkmcnt(6)
    v_mfma_f32_32x32x16_bf16 v[0:15], v[220:223], v[168:171], v[0:15]
    s_waitcnt lgkmcnt(4)
    v_mfma_f32_32x32x16_bf16 v[16:31], v[224:227], v[168:171], v[16:31]
    s_waitcnt lgkmcnt(2)
    v_mfma_f32_32x32x16_bf16 v[32:47], v[228:231], v[168:171], v[32:47]
    s_waitcnt lgkmcnt(0)
    v_mfma_f32_32x32x16_bf16 v[48:63], v[232:235], v[168:171], v[48:63]
    v_add_f32 v236, v236, v249
    s_branch TAIL_Y
RARE_BY_first1:
    s_waitcnt lgkmcnt(6)
    v_mfma_f32_16x16x32_bf16 v[192:195], v[220:223], v[136:139], v[192:195]
    ds_read_b64_tr_b16 v[212:213], v242 offset:512
    ds_read_b64_tr_b16 v[214:215], v242 offset:2560
    v_mfma_f32_16x16x32_bf16 v[196:199], v[224:227], v[136:139], v[196:199]
    ds_read_b64_tr_b16 v[216:217], v243 offset:512
    ds_read_b64_tr_b16 v[218:219], v243 offset:2560
    s_waitcnt lgkmcnt(8)
    v_mfma_f32_16x16x32_bf16 v[192:195], v[228:231], v[140:143], v[192:195]
    ds_read_b64_tr_b16 v[220:221], v242 offset:4096
    ds_read_b64_tr_b16 v[222:223], v242 offset:6144
    v_mfma_f32_16x16x32_bf16 v[196:199], v[232:235], v[140:143], v[196:199]
    ds_read_b64_tr_b16 v[224:225], v243 offset:4096
    ds_read_b64_tr_b16 v[226:227], v243 offset:6144
    s_waitcnt lgkmcnt(8)
    v_mfma_f32_32x32x16_bf16 v[0:15], v[204:207], v[144:147], 0
    ds_read_b64_tr_b16 v[228:229], v242 offset:4608
    ds_read_b64_tr_b16 v[230:231], v242 offset:6656
    v_mfma_f32_32x32x16_bf16 v[16:31], v[208:211], v[144:147], 0
    ds_read_b64_tr_b16 v[232:233], v243 offset:4608
    ds_read_b64_tr_b16 v[234:235], v243 offset:6656
    s_waitcnt lgkmcnt(8)
    v_mfma_f32_32x32x16_bf16 v[32:47], v[212:215], v[144:147], 0
    v_add_u32 v238, s45, v238
    v_add_u32 v239, s45, v239
    v_add_u32 v240, s45, v240
    v_add_u32 v241, s45, v241
    v_add_u32 v242, s70, v242
    v_add_u32 v243, s70, v243
    v_add_u32 v246, s47, v245
    v_xor_b32 v247, 64, v246
    s_waitcnt lgkmcnt(0)
    s_barrier
    v_mfma_f32_32x32x16_bf16 v[48:63], v[216:219], v[144:147], 0
    v_mfma_f32_32x32x16_bf16 v[0:15], v[220:223], v[152:155], v[0:15]
    s_barrier
    ds_read_b128 v[204:207], v238 offset:0
    ds_read_b128 v[208:211], v239 offset:0
    ds_read_b128 v[212:215], v240 offset:0
    v_mfma_f32_32x32x16_bf16 v[16:31], v[224:227], v[152:155], v[16:31]
    ds_read_b128 v[216:219], v241 offset:0
    v_mfma_f32_32x32x16_bf16 v[32:47], v[228:231], v[152:155], v[32:47]
    ds_read_b128 v[220:223], v238 offset:512
    v_mfma_f32_32x32x16_bf16 v[48:63], v[232:235], v[152:155], v[48:63]
    v_mov_b32 v251, v250
    v_mov_b32 v252, v250
    s_nop 1
    v_permlane32_swap_b32 v251, v252
    v_max_f32 v250, v251, v252
    v_max_f32 v250, 0, v250
    v_exp_f32 v251, -v250
    v_sub_f32 v160, v160, v250
    v_sub_f32 v161, v161, v250
    v_sub_f32 v162, v162, v250
    v_sub_f32 v163, v163, v250
    v_sub_f32 v164, v164, v250
    v_sub_f32 v165, v165, v250
    v_sub_f32 v166, v166, v250
    v_sub_f32 v167, v167, v250
    v_sub_f32 v168, v168, v250
    v_sub_f32 v169, v169, v250
    v_sub_f32 v170, v170, v250
    v_sub_f32 v171, v171, v250
    v_sub_f32 v172, v172, v250
    v_sub_f32 v173, v173, v250
    v_sub_f32 v174, v174, v250
    v_sub_f32 v175, v175, v250
    v_sub_f32 v176, v176, v250
    v_sub_f32 v177, v177, v250
    v_sub_f32 v178, v178, v250
    v_sub_f32 v179, v179, v250
    v_sub_f32 v180, v180, v250
    v_sub_f32 v181, v181, v250
    v_sub_f32 v182, v182, v250
    v_sub_f32 v183, v183, v250
    v_sub_f32 v184, v184, v250
    v_sub_f32 v185, v185, v250
    v_sub_f32 v186, v186, v250
    v_sub_f32 v187, v187, v250
    v_sub_f32 v188, v188, v250
    v_sub_f32 v189, v189, v250
    v_sub_f32 v190, v190, v250
    v_sub_f32 v191, v191, v250
    v_mul_f32 v236, v236, v251
    v_mul_f32 v249, v249, v251
    v_mul_f32 v0, v0, v251
    v_mul_f32 v1, v1, v251
    v_mul_f32 v2, v2, v251
    v_mul_f32 v3, v3, v251
    v_mul_f32 v4, v4, v251
    v_mul_f32 v5, v5, v251
    v_mul_f32 v6, v6, v251
    v_mul_f32 v7, v7, v251
    v_mul_f32 v8, v8, v251
    v_mul_f32 v9, v9, v251
    v_mul_f32 v10, v10, v251
    v_mul_f32 v11, v11, v251
    v_mul_f32 v12, v12, v251
    v_mul_f32 v13, v13, v251
    v_mul_f32 v14, v14, v251
    v_mul_f32 v15, v15, v251
    v_mul_f32 v16, v16, v251
    v_mul_f32 v17, v17, v251
    v_mul_f32 v18, v18, v251
    v_mul_f32 v19, v19, v251
    v_mul_f32 v20, v20, v251
    v_mul_f32 v21, v21, v251
    v_mul_f32 v22, v22, v251
    v_mul_f32 v23, v23, v251
    v_mul_f32 v24, v24, v251
    v_mul_f32 v25, v25, v251
    v_mul_f32 v26, v26, v251
    v_mul_f32 v27, v27, v251
    v_mul_f32 v28, v28, v251
    v_mul_f32 v29, v29, v251
    v_mul_f32 v30, v30, v251
    v_mul_f32 v31, v31, v251
    v_mul_f32 v32, v32, v251
    v_mul_f32 v33, v33, v251
    v_mul_f32 v34, v34, v251
    v_mul_f32 v35, v35, v251
    v_mul_f32 v36, v36, v251
    v_mul_f32 v37, v37, v251
    v_mul_f32 v38, v38, v251
    v_mul_f32 v39, v39, v251
    v_mul_f32 v40, v40, v251
    v_mul_f32 v41, v41, v251
    v_mul_f32 v42, v42, v251
    v_mul_f32 v43, v43, v251
    v_mul_f32 v44, v44, v251
    v_mul_f32 v45, v45, v251
    v_mul_f32 v46, v46, v251
    v_mul_f32 v47, v47, v251
    v_mul_f32 v48, v48, v251
    v_mul_f32 v49, v49, v251
    v_mul_f32 v50, v50, v251
    v_mul_f32 v51, v51, v251
    v_mul_f32 v52, v52, v251
    v_mul_f32 v53, v53, v251
    v_mul_f32 v54, v54, v251
    v_mul_f32 v55, v55, v251
    v_mul_f32 v56, v56, v251
    v_mul_f32 v57, v57, v251
    v_mul_f32 v58, v58, v251
    v_mul_f32 v59, v59, v251
    v_mul_f32 v60, v60, v251
    v_mul_f32 v61, v61, v251
    v_mul_f32 v62, v62, v251
    v_mul_f32 v63, v63, v251
    v_exp_f32 v160, v160
    v_exp_f32 v161, v161
    v_exp_f32 v162, v162
    v_add_f32 v236, v236, v160
    v_add_f32 v249, v249, v161
    v_cvt_pk_bf16_f32 v160, v160, v161
    v_exp_f32 v163, v163
    v_exp_f32 v164, v164
    v_add_f32 v236, v236, v162
    v_add_f32 v249, v249, v163
    v_cvt_pk_bf16_f32 v161, v162, v163
    v_exp_f32 v165, v165
    v_exp_f32 v166, v166
    v_add_f32 v236, v236, v164
    v_add_f32 v249, v249, v165
    v_cvt_pk_bf16_f32 v162, v164, v165
    v_exp_f32 v167, v167
    v_exp_f32 v168, v168
    v_add_f32 v236, v236, v166
    v_add_f32 v249, v249, v167
    v_cvt_pk_bf16_f32 v163, v166, v167
    v_exp_f32 v169, v169
    v_exp_f32 v170, v170
    v_add_f32 v236, v236, v168
    v_add_f32 v249, v249, v169
    v_cvt_pk_bf16_f32 v168, v168, v169
    v_exp_f32 v171, v171
    v_exp_f32 v172, v172
    v_add_f32 v236, v236, v170
    v_add_f32 v249, v249, v171
    v_cvt_pk_bf16_f32 v169, v170, v171
    v_exp_f32 v173, v173
    v_exp_f32 v174, v174
    v_add_f32 v236, v236, v172
    v_add_f32 v249, v249, v173
    v_cvt_pk_bf16_f32 v170, v172, v173
    v_exp_f32 v175, v175
    v_add_f32 v236, v236, v174
    v_add_f32 v249, v249, v175
    v_cvt_pk_bf16_f32 v171, v174, v175
    s_branch REJ_BY_first1
RARE_BY_loop0:
    s_waitcnt lgkmcnt(8)
    v_mfma_f32_16x16x32_bf16 v[88:91], v[228:231], v[192:195], v[88:91]
    ds_read_b64_tr_b16 v[220:221], v242 offset:4096
    ds_read_b64_tr_b16 v[222:223], v242 offset:6144
    v_mfma_f32_16x16x32_bf16 v[92:95], v[232:235], v[192:195], v[92:95]
    ds_read_b64_tr_b16 v[224:225], v243 offset:4096
    ds_read_b64_tr_b16 v[226:227], v243 offset:6144
    s_waitcnt lgkmcnt(8)
    v_mfma_f32_32x32x16_bf16 v[0:15], v[204:207], v[160:163], v[0:15]
    ds_read_b64_tr_b16 v[228:229], v242 offset:4608
    ds_read_b64_tr_b16 v[230:231], v242 offset:6656
    v_mfma_f32_32x32x16_bf16 v[16:31], v[208:211], v[160:163], v[16:31]
    ds_read_b64_tr_b16 v[232:233], v243 offset:4608
    ds_read_b64_tr_b16 v[234:235], v243 offset:6656
    s_waitcnt lgkmcnt(8)
    v_mfma_f32_32x32x16_bf16 v[32:47], v[212:215], v[160:163], v[32:47]
    v_add_u32 v238, s45, v238
    v_add_u32 v239, s45, v239
    v_add_u32 v240, s45, v240
    v_add_u32 v241, s45, v241
    v_add_u32 v242, s70, v242
    v_add_u32 v243, s70, v243
    v_add_u32 v246, s42, v244
    v_xor_b32 v247, 64, v246
    s_waitcnt lgkmcnt(0)
    s_barrier
    v_mfma_f32_32x32x16_bf16 v[48:63], v[216:219], v[160:163], v[48:63]
    v_mfma_f32_32x32x16_bf16 v[0:15], v[220:223], v[168:171], v[0:15]
    s_barrier
    ds_read_b128 v[204:207], v238 offset:0
    ds_read_b128 v[208:211], v239 offset:0
    ds_read_b128 v[212:215], v240 offset:0
    v_mfma_f32_32x32x16_bf16 v[16:31], v[224:227], v[168:171], v[16:31]
    ds_read_b128 v[216:219], v241 offset:0
    v_mfma_f32_32x32x16_bf16 v[32:47], v[228:231], v[168:171], v[32:47]
    ds_read_b128 v[220:223], v238 offset:512
    v_mfma_f32_32x32x16_bf16 v[48:63], v[232:235], v[168:171], v[48:63]
    v_mov_b32 v251, v250
    v_mov_b32 v252, v250
    s_nop 1
    v_permlane32_swap_b32 v251, v252
    v_max_f32 v250, v251, v252
    v_max_f32 v250, 0, v250
    v_exp_f32 v251, -v250
    v_sub_f32 v144, v144, v250
    v_sub_f32 v145, v145, v250
    v_sub_f32 v146, v146, v250
    v_sub_f32 v147, v147, v250
    v_sub_f32 v148, v148, v250
    v_sub_f32 v149, v149, v250
    v_sub_f32 v150, v150, v250
    v_sub_f32 v151, v151, v250
    v_sub_f32 v152, v152, v250
    v_sub_f32 v153, v153, v250
    v_sub_f32 v154, v154, v250
    v_sub_f32 v155, v155, v250
    v_sub_f32 v156, v156, v250
    v_sub_f32 v157, v157, v250
    v_sub_f32 v158, v158, v250
    v_sub_f32 v159, v159, v250
    v_sub_f32 v176, v176, v250
    v_sub_f32 v177, v177, v250
    v_sub_f32 v178, v178, v250
    v_sub_f32 v179, v179, v250
    v_sub_f32 v180, v180, v250
    v_sub_f32 v181, v181, v250
    v_sub_f32 v182, v182, v250
    v_sub_f32 v183, v183, v250
    v_sub_f32 v184, v184, v250
    v_sub_f32 v185, v185, v250
    v_sub_f32 v186, v186, v250
    v_sub_f32 v187, v187, v250
    v_sub_f32 v188, v188, v250
    v_sub_f32 v189, v189, v250
    v_sub_f32 v190, v190, v250
    v_sub_f32 v191, v191, v250
    v_mul_f32 v236, v236, v251
    v_mul_f32 v249, v249, v251
    v_mul_f32 v0, v0, v251
    v_mul_f32 v1, v1, v251
    v_mul_f32 v2, v2, v251
    v_mul_f32 v3, v3, v251
    v_mul_f32 v4, v4, v251
    v_mul_f32 v5, v5, v251
    v_mul_f32 v6, v6, v251
    v_mul_f32 v7, v7, v251
    v_mul_f32 v8, v8, v251
    v_mul_f32 v9, v9, v251
    v_mul_f32 v10, v10, v251
    v_mul_f32 v11, v11, v251
    v_mul_f32 v12, v12, v251
    v_mul_f32 v13, v13, v251
    v_mul_f32 v14, v14, v251
    v_mul_f32 v15, v15, v251
    v_mul_f32 v16, v16, v251
    v_mul_f32 v17, v17, v251
    v_mul_f32 v18, v18, v251
    v_mul_f32 v19, v19, v251
    v_mul_f32 v20, v20, v251
    v_mul_f32 v21, v21, v251
    v_mul_f32 v22, v22, v251
    v_mul_f32 v23, v23, v251
    v_mul_f32 v24, v24, v251
    v_mul_f32 v25, v25, v251
    v_mul_f32 v26, v26, v251
    v_mul_f32 v27, v27, v251
    v_mul_f32 v28, v28, v251
    v_mul_f32 v29, v29, v251
    v_mul_f32 v30, v30, v251
    v_mul_f32 v31, v31, v251
    v_mul_f32 v32, v32, v251
    v_mul_f32 v33, v33, v251
    v_mul_f32 v34, v34, v251
    v_mul_f32 v35, v35, v251
    v_mul_f32 v36, v36, v251
    v_mul_f32 v37, v37, v251
    v_mul_f32 v38, v38, v251
    v_mul_f32 v39, v39, v251
    v_mul_f32 v40, v40, v251
    v_mul_f32 v41, v41, v251
    v_mul_f32 v42, v42, v251
    v_mul_f32 v43, v43, v251
    v_mul_f32 v44, v44, v251
    v_mul_f32 v45, v45, v251
    v_mul_f32 v46, v46, v251
    v_mul_f32 v47, v47, v251
    v_mul_f32 v48, v48, v251
    v_mul_f32 v49, v49, v251
    v_mul_f32 v50, v50, v251
    v_mul_f32 v51, v51, v251
    v_mul_f32 v52, v52, v251
    v_mul_f32 v53, v53, v251
    v_mul_f32 v54, v54, v251
    v_mul_f32 v55, v55, v251
    v_mul_f32 v56, v56, v251
    v_mul_f32 v57, v57, v251
    v_mul_f32 v58, v58, v251
    v_mul_f32 v59, v59, v251
    v_mul_f32 v60, v60, v251
    v_mul_f32 v61, v61, v251
    v_mul_f32 v62, v62, v251
    v_mul_f32 v63, v63, v251
    v_exp_f32 v144, v144
    v_exp_f32 v145, v145
    v_exp_f32 v146, v146
    v_add_f32 v236, v236, v144
    v_add_f32 v249, v249, v145
    v_cvt_pk_bf16_f32 v144, v144, v145
    v_exp_f32 v147, v147
    v_exp_f32 v148, v148
    v_add_f32 v236, v236, v146
    v_add_f32 v249, v249, v147
    v_cvt_pk_bf16_f32 v145, v146, v147
    v_exp_f32 v149, v149
    v_exp_f32 v150, v150
    v_add_f32 v236, v236, v148
    v_add_f32 v249, v249, v149
    v_cvt_pk_bf16_f32 v146, v148, v149
    v_exp_f32 v151, v151
    v_exp_f32 v152, v152
    v_add_f32 v236, v236, v150
    v_add_f32 v249, v249, v151
    v_cvt_pk_bf16_f32 v147, v150, v151
    v_exp_f32 v153, v153
    s_branch REJ_BY_loop0
RARE_BY_loop1:
    s_waitcnt lgkmcnt(8)
    v_mfma_f32_16x16x32_bf16 v[192:195], v[228:231], v[140:143], v[192:195]
    ds_read_b64_tr_b16 v[220:221], v242 offset:4096
    ds_read_b64_tr_b16 v[222:223], v242 offset:6144
    v_mfma_f32_16x16x32_bf16 v[196:199], v[232:235], v[140:143], v[196:199]
    ds_read_b64_tr_b16 v[224:225], v243 offset:4096
    ds_read_b64_tr_b16 v[226:227], v243 offset:6144
    s_waitcnt lgkmcnt(8)
    v_mfma_f32_32x32x16_bf16 v[0:15], v[204:207], v[144:147], v[0:15]
    ds_read_b64_tr_b16 v[228:229], v242 offset:4608
    ds_read_b64_tr_b16 v[230:231], v242 offset:6656
    v_mfma_f32_32x32x16_bf16 v[16:31], v[208:211], v[144:147], v[16:31]
    ds_read_b64_tr_b16 v[232:233], v243 offset:4608
    ds_read_b64_tr_b16 v[234:235], v243 offset:6656
    s_waitcnt lgkmcnt(8)
    v_mfma_f32_32x32x16_bf16 v[32:47], v[212:215], v[144:147], v[32:47]
    v_add_u32 v238, s45, v238
    v_add_u32 v239, s45, v239
    v_add_u32 v240, s45, v240
    v_add_u32 v241, s45, v241
    v_add_u32 v242, s70, v242
    v_add_u32 v243, s70, v243
    v_add_u32 v246, s47, v245
    v_xor_b32 v247, 64, v246
    s_waitcnt lgkmcnt(0)
    s_barrier
    v_mfma_f32_32x32x16_bf16 v[48:63], v[216:219], v[144:147], v[48:63]
    v_mfma_f32_32x32x16_bf16 v[0:15], v[220:223], v[152:155], v[0:15]
    s_barrier
    ds_read_b128 v[204:207], v238 offset:0
    ds_read_b128 v[208:211], v239 offset:0
    ds_read_b128 v[212:215], v240 offset:0
    v_mfma_f32_32x32x16_bf16 v[16:31], v[224:227], v[152:155], v[16:31]
    ds_read_b128 v[216:219], v241 offset:0
    v_mfma_f32_32x32x16_bf16 v[32:47], v[228:231], v[152:155], v[32:47]
    ds_read_b128 v[220:223], v238 offset:512
    v_mfma_f32_32x32x16_bf16 v[48:63], v[232:235], v[152:155], v[48:63]
    v_mov_b32 v251, v250
    v_mov_b32 v252, v250
    s_nop 1
    v_permlane32_swap_b32 v251, v252
    v_max_f32 v250, v251, v252
    v_max_f32 v250, 0, v250
    v_exp_f32 v251, -v250
    v_sub_f32 v160, v160, v250
    v_sub_f32 v161, v161, v250
    v_sub_f32 v162, v162, v250
    v_sub_f32 v163, v163, v250
    v_sub_f32 v164, v164, v250
    v_sub_f32 v165, v165, v250
    v_sub_f32 v166, v166, v250
    v_sub_f32 v167, v167, v250
    v_sub_f32 v168, v168, v250
    v_sub_f32 v169, v169, v250
    v_sub_f32 v170, v170, v250
    v_sub_f32 v171, v171, v250
    v_sub_f32 v172, v172, v250
    v_sub_f32 v173, v173, v250
    v_sub_f32 v174, v174, v250
    v_sub_f32 v175, v175, v250
    v_sub_f32 v176, v176, v250
    v_sub_f32 v177, v177, v250
    v_sub_f32 v178, v178, v250
    v_sub_f32 v179, v179, v250
    v_sub_f32 v180, v180, v250
    v_sub_f32 v181, v181, v250
    v_sub_f32 v182, v182, v250
    v_sub_f32 v183, v183, v250
    v_sub_f32 v184, v184, v250
    v_sub_f32 v185, v185, v250
    v_sub_f32 v186, v186, v250
    v_sub_f32 v187, v187, v250
    v_sub_f32 v188, v188, v250
    v_sub_f32 v189, v189, v250
    v_sub_f32 v190, v190, v250
    v_sub_f32 v191, v191, v250
    v_mul_f32 v236, v236, v251
    v_mul_f32 v249, v249, v251
    v_mul_f32 v0, v0, v251
    v_mul_f32 v1, v1, v251
    v_mul_f32 v2, v2, v251
    v_mul_f32 v3, v3, v251
    v_mul_f32 v4, v4, v251
    v_mul_f32 v5, v5, v251
    v_mul_f32 v6, v6, v251
    v_mul_f32 v7, v7, v251
    v_mul_f32 v8, v8, v251
    v_mul_f32 v9, v9, v251
    v_mul_f32 v10, v10, v251
    v_mul_f32 v11, v11, v251
    v_mul_f32 v12, v12, v251
    v_mul_f32 v13, v13, v251
    v_mul_f32 v14, v14, v251
    v_mul_f32 v15, v15, v251
    v_mul_f32 v16, v16, v251
    v_mul_f32 v17, v17, v251
    v_mul_f32 v18, v18, v251
    v_mul_f32 v19, v19, v251
    v_mul_f32 v20, v20, v251
    v_mul_f32 v21, v21, v251
    v_mul_f32 v22, v22, v251
    v_mul_f32 v23, v23, v251
    v_mul_f32 v24, v24, v251
    v_mul_f32 v25, v25, v251
    v_mul_f32 v26, v26, v251
    v_mul_f32 v27, v27, v251
    v_mul_f32 v28, v28, v251
    v_mul_f32 v29, v29, v251
    v_mul_f32 v30, v30, v251
    v_mul_f32 v31, v31, v251
    v_mul_f32 v32, v32, v251
    v_mul_f32 v33, v33, v251
    v_mul_f32 v34, v34, v251
    v_mul_f32 v35, v35, v251
    v_mul_f32 v36, v36, v251
    v_mul_f32 v37, v37, v251
    v_mul_f32 v38, v38, v251
    v_mul_f32 v39, v39, v251
    v_mul_f32 v40, v40, v251
    v_mul_f32 v41, v41, v251
    v_mul_f32 v42, v42, v251
    v_mul_f32 v43, v43, v251
    v_mul_f32 v44, v44, v251
    v_mul_f32 v45, v45, v251
    v_mul_f32 v46, v46, v251
    v_mul_f32 v47, v47, v251
    v_mul_f32 v48, v48, v251
    v_mul_f32 v49, v49, v251
    v_mul_f32 v50, v50, v251
    v_mul_f32 v51, v51, v251
    v_mul_f32 v52, v52, v251
    v_mul_f32 v53, v53, v251
    v_mul_f32 v54, v54, v251
    v_mul_f32 v55, v55, v251
    v_mul_f32 v56, v56, v251
    v_mul_f32 v57, v57, v251
    v_mul_f32 v58, v58, v251
    v_mul_f32 v59, v59, v251
    v_mul_f32 v60, v60, v251
    v_mul_f32 v61, v61, v251
    v_mul_f32 v62, v62, v251
    v_mul_f32 v63, v63, v251
    v_exp_f32 v160, v160
    v_exp_f32 v161, v161
    v_exp_f32 v162, v162
    v_add_f32 v236, v236, v160
    v_add_f32 v249, v249, v161
    v_cvt_pk_bf16_f32 v160, v160, v161
    v_exp_f32 v163, v163
    v_exp_f32 v164, v164
    v_add_f32 v236, v236, v162
    v_add_f32 v249, v249, v163
    v_cvt_pk_bf16_f32 v161, v162, v163
    v_exp_f32 v165, v165
    v_exp_f32 v166, v166
    v_add_f32 v236, v236, v164
    v_add_f32 v249, v249, v165
    v_cvt_pk_bf16_f32 v162, v164, v165
    v_exp_f32 v167, v167
    v_exp_f32 v168, v168
    v_add_f32 v236, v236, v166
    v_add_f32 v249, v249, v167
    v_cvt_pk_bf16_f32 v163, v166, v167
    v_exp_f32 v169, v169
    v_exp_f32 v170, v170
    v_add_f32 v236, v236, v168
    v_add_f32 v249, v249, v169
    v_cvt_pk_bf16_f32 v168, v168, v169
    v_exp_f32 v171, v171
    v_exp_f32 v172, v172
    v_add_f32 v236, v236, v170
    v_add_f32 v249, v249, v171
    v_cvt_pk_bf16_f32 v169, v170, v171
    v_exp_f32 v173, v173
    s_branch REJ_BY_loop1
RRARE_BY_loop:
    ds_swizzle_b32 v251, v253 offset:0x401F
    s_waitcnt lgkmcnt(0)
    v_max_f32 v253, v253, v251
    v_mov_b32 v251, v253
    v_mov_b32 v252, v253
    s_nop 1
    v_permlane32_swap_b32 v251, v252
    v_max_f32 v253, v251, v252
    v_max_f32 v253, 0, v253
    v_exp_f32 v251, -v253
    v_sub_f32 v192, v192, v253
    v_sub_f32 v193, v193, v253
    v_sub_f32 v194, v194, v253
    v_sub_f32 v195, v195, v253
    v_sub_f32 v196, v196, v253
    v_sub_f32 v197, v197, v253
    v_sub_f32 v198, v198, v253
    v_sub_f32 v199, v199, v253
    v_sub_f32 v200, v200, v253
    v_sub_f32 v201, v201, v253
    v_sub_f32 v202, v202, v253
    v_sub_f32 v203, v203, v253
    v_mul_f32 v237, v237, v251
    v_mul_f32 v64, v64, v251
    v_mul_f32 v65, v65, v251
    v_mul_f32 v66, v66, v251
    v_mul_f32 v67, v67, v251
    v_mul_f32 v68, v68, v251
    v_mul_f32 v69, v69, v251
    v_mul_f32 v70, v70, v251
    v_mul_f32 v71, v71, v251
    v_mul_f32 v72, v72, v251
    v_mul_f32 v73, v73, v251
    v_mul_f32 v74, v74, v251
    v_mul_f32 v75, v75, v251
    v_mul_f32 v76, v76, v251
    v_mul_f32 v77, v77, v251
    v_mul_f32 v78, v78, v251
    v_mul_f32 v79, v79, v251
    v_mul_f32 v80, v80, v251
    v_mul_f32 v81, v81, v251
    v_mul_f32 v82, v82, v251
    v_mul_f32 v83, v83, v251
    v_mul_f32 v84, v84, v251
    v_mul_f32 v85, v85, v251
    v_mul_f32 v86, v86, v251
    v_mul_f32 v87, v87, v251
    v_mul_f32 v88, v88, v251
    v_mul_f32 v89, v89, v251
    v_mul_f32 v90, v90, v251
    v_mul_f32 v91, v91, v251
    v_mul_f32 v92, v92, v251
    v_mul_f32 v93, v93, v251
    v_mul_f32 v94, v94, v251
    v_mul_f32 v95, v95, v251
    s_branch RREJ_BY_loop
RARE_BY_last0:
    s_waitcnt lgkmcnt(8)
    v_mfma_f32_16x16x32_bf16 v[88:91], v[228:231], v[192:195], v[88:91]
    ds_read_b64_tr_b16 v[220:221], v242 offset:4096
    ds_read_b64_tr_b16 v[222:223], v242 offset:6144
    v_mfma_f32_16x16x32_bf16 v[92:95], v[232:235], v[192:195], v[92:95]
    ds_read_b64_tr_b16 v[224:225], v243 offset:4096
    ds_read_b64_tr_b16 v[226:227], v243 offset:6144
    s_waitcnt lgkmcnt(8)
    v_mfma_f32_32x32x16_bf16 v[0:15], v[204:207], v[160:163], v[0:15]
    ds_read_b64_tr_b16 v[228:229], v242 offset:4608
    ds_read_b64_tr_b16 v[230:231], v242 offset:6656
    v_mfma_f32_32x32x16_bf16 v[16:31], v[208:211], v[160:163], v[16:31]
    ds_read_b64_tr_b16 v[232:233], v243 offset:4608
    ds_read_b64_tr_b16 v[234:235], v243 offset:6656
    s_waitcnt lgkmcnt(8)
    v_mfma_f32_32x32x16_bf16 v[32:47], v[212:215], v[160:163], v[32:47]
    v_add_u32 v238, s45, v238
    v_add_u32 v239, s45, v239
    v_add_u32 v240, s45, v240
    v_add_u32 v241, s45, v241
    v_add_u32 v242, s70, v242
    v_add_u32 v243, s70, v243
    v_add_u32 v246, s42, v244
    v_xor_b32 v247, 64, v246
    s_waitcnt lgkmcnt(0)
    s_barrier
    v_mfma_f32_32x32x16_bf16 v[48:63], v[216:219], v[160:163], v[48:63]
    v_mfma_f32_32x32x16_bf16 v[0:15], v[220:223], v[168:171], v[0:15]
    s_barrier
    ds_read_b128 v[204:207], v238 offset:0
    ds_read_b128 v[208:211], v239 offset:0
    ds_read_b128 v[212:215], v240 offset:0
    v_mfma_f32_32x32x16_bf16 v[16:31], v[224:227], v[168:171], v[16:31]
    ds_read_b128 v[216:219], v241 offset:0
    v_mfma_f32_32x32x16_bf16 v[32:47], v[228:231], v[168:171], v[32:47]
    ds_read_b128 v[220:223], v238 offset:512
    v_mfma_f32_32x32x16_bf16 v[48:63], v[232:235], v[168:171], v[48:63]
    v_mov_b32 v251, v250
    v_mov_b32 v252, v250
    s_nop 1
    v_permlane32_swap_b32 v251, v252
    v_max_f32 v250, v251, v252
    v_max_f32 v250, 0, v250
    v_exp_f32 v251, -v250
    v_sub_f32 v144, v144, v250
    v_sub_f32 v145, v145, v250
    v_sub_f32 v146, v146, v250
    v_sub_f32 v147, v147, v250
    v_sub_f32 v148, v148, v250
    v_sub_f32 v149, v149, v250
    v_sub_f32 v150, v150, v250
    v_sub_f32 v151, v151, v250
    v_sub_f32 v152, v152, v250
    v_sub_f32 v153, v153, v250
    v_sub_f32 v154, v154, v250
    v_sub_f32 v155, v155, v250
    v_sub_f32 v156, v156, v250
    v_sub_f32 v157, v157, v250
    v_sub_f32 v158, v158, v250
    v_sub_f32 v159, v159, v250
    v_sub_f32 v176, v176, v250
    v_sub_f32 v177, v177, v250
    v_sub_f32 v178, v178, v250
    v_sub_f32 v179, v179, v250
    v_sub_f32 v180, v180, v250
    v_sub_f32 v181, v181, v250
    v_sub_f32 v182, v182, v250
    v_sub_f32 v183, v183, v250
    v_sub_f32 v184, v184, v250
    v_sub_f32 v185, v185, v250
    v_sub_f32 v186, v186, v250
    v_sub_f32 v187, v187, v250
    v_sub_f32 v188, v188, v250
    v_sub_f32 v189, v189, v250
    v_sub_f32 v190, v190, v250
    v_sub_f32 v191, v191, v250
    v_mul_f32 v236, v236, v251
    v_mul_f32 v249, v249, v251
    v_mul_f32 v0, v0, v251
    v_mul_f32 v1, v1, v251
    v_mul_f32 v2, v2, v251
    v_mul_f32 v3, v3, v251
    v_mul_f32 v4, v4, v251
    v_mul_f32 v5, v5, v251
    v_mul_f32 v6, v6, v251
    v_mul_f32 v7, v7, v251
    v_mul_f32 v8, v8, v251
    v_mul_f32 v9, v9, v251
    v_mul_f32 v10, v10, v251
    v_mul_f32 v11, v11, v251
    v_mul_f32 v12, v12, v251
    v_mul_f32 v13, v13, v251
    v_mul_f32 v14, v14, v251
    v_mul_f32 v15, v15, v251
    v_mul_f32 v16, v16, v251
    v_mul_f32 v17, v17, v251
    v_mul_f32 v18, v18, v251
    v_mul_f32 v19, v19, v251
    v_mul_f32 v20, v20, v251
    v_mul_f32 v21, v21, v251
    v_mul_f32 v22, v22, v251
    v_mul_f32 v23, v23, v251
    v_mul_f32 v24, v24, v251
    v_mul_f32 v25, v25, v251
    v_mul_f32 v26, v26, v251
    v_mul_f32 v27, v27, v251
    v_mul_f32 v28, v28, v251
    v_mul_f32 v29, v29, v251
    v_mul_f32 v30, v30, v251
    v_mul_f32 v31, v31, v251
    v_mul_f32 v32, v32, v251
    v_mul_f32 v33, v33, v251
    v_mul_f32 v34, v34, v251
    v_mul_f32 v35, v35, v251
    v_mul_f32 v36, v36, v251
    v_mul_f32 v37, v37, v251
    v_mul_f32 v38, v38, v251
    v_mul_f32 v39, v39, v251
    v_mul_f32 v40, v40, v251
    v_mul_f32 v41, v41, v251
    v_mul_f32 v42, v42, v251
    v_mul_f32 v43, v43, v251
    v_mul_f32 v44, v44, v251
    v_mul_f32 v45, v45, v251
    v_mul_f32 v46, v46, v251
    v_mul_f32 v47, v47, v251
    v_mul_f32 v48, v48, v251
    v_mul_f32 v49, v49, v251
    v_mul_f32 v50, v50, v251
    v_mul_f32 v51, v51, v251
    v_mul_f32 v52, v52, v251
    v_mul_f32 v53, v53, v251
    v_mul_f32 v54, v54, v251
    v_mul_f32 v55, v55, v251
    v_mul_f32 v56, v56, v251
    v_mul_f32 v57, v57, v251
    v_mul_f32 v58, v58, v251
    v_mul_f32 v59, v59, v251
    v_mul_f32 v60, v60, v251
    v_mul_f32 v61, v61, v251
    v_mul_f32 v62, v62, v251
    v_mul_f32 v63, v63, v251
    v_exp_f32 v144, v144
    v_exp_f32 v145, v145
    v_exp_f32 v146, v146
    v_add_f32 v236, v236, v144
    v_add_f32 v249, v249, v145
    v_cvt_pk_bf16_f32 v144, v144, v145
    v_exp_f32 v147, v147
    v_exp_f32 v148, v148
    v_add_f32 v236, v236, v146
    v_add_f32 v249, v249, v147
    v_cvt_pk_bf16_f32 v145, v146, v147
    v_exp_f32 v149, v149
    v_exp_f32 v150, v150
    v_add_f32 v236, v236, v148
    v_add_f32 v249, v249, v149
    v_cvt_pk_bf16_f32 v146, v148, v149
    v_exp_f32 v151, v151
    v_exp_f32 v152, v152
    v_add_f32 v236, v236, v150
    v_add_f32 v249, v249, v151
    v_cvt_pk_bf16_f32 v147, v150, v151
    v_exp_f32 v153, v153
    s_branch REJ_BY_last0
RARE_BY_last1:
    s_waitcnt lgkmcnt(6)
    v_mfma_f32_16x16x32_bf16 v[192:195], v[220:223], v[136:139], v[192:195]
    ds_read_b64_tr_b16 v[212:213], v242 offset:512
    ds_read_b64_tr_b16 v[214:215], v242 offset:2560
    v_mfma_f32_16x16x32_bf16 v[196:199], v[224:227], v[136:139], v[196:199]
    ds_read_b64_tr_b16 v[216:217], v243 offset:512
    ds_read_b64_tr_b16 v[218:219], v243 offset:2560
    s_waitcnt lgkmcnt(8)
    v_mfma_f32_16x16x32_bf16 v[192:195], v[228:231], v[140:143], v[192:195]
    ds_read_b64_tr_b16 v[220:221], v242 offset:4096
    ds_read_b64_tr_b16 v[222:223], v242 offset:6144
    v_mfma_f32_16x16x32_bf16 v[196:199], v[232:235], v[140:143], v[196:199]
    ds_read_b64_tr_b16 v[224:225], v243 offset:4096
    ds_read_b64_tr_b16 v[226:227], v243 offset:6144
    s_waitcnt lgkmcnt(8)
    v_mfma_f32_32x32x16_bf16 v[0:15], v[204:207], v[144:147], v[0:15]
    ds_read_b64_tr_b16 v[228:229], v242 offset:4608
    ds_read_b64_tr_b16 v[230:231], v242 offset:6656
    v_mfma_f32_32x32x16_bf16 v[16:31], v[208:211], v[144:147], v[16:31]
    ds_read_b64_tr_b16 v[232:233], v243 offset:4608
    ds_read_b64_tr_b16 v[234:235], v243 offset:6656
    s_waitcnt lgkmcnt(8)
    v_mfma_f32_32x32x16_bf16 v[32:47], v[212:215], v[144:147], v[32:47]
    v_add_u32 v238, s45, v238
    v_add_u32 v239, s45, v239
    v_add_u32 v240, s45, v240
    v_add_u32 v241, s45, v241
    v_add_u32 v242, s70, v242
    v_add_u32 v243, s70, v243
    v_add_u32 v246, s47, v245
    v_xor_b32 v247, 64, v246
    s_waitcnt lgkmcnt(0)
    s_barrier
    v_mfma_f32_32x32x16_bf16 v[48:63], v[216:219], v[144:147], v[48:63]
    v_mfma_f32_32x32x16_bf16 v[0:15], v[220:223], v[152:155], v[0:15]
    s_barrier
    v_mfma_f32_32x32x16_bf16 v[16:31], v[224:227], v[152:155], v[16:31]
    v_mfma_f32_32x32x16_bf16 v[32:47], v[228:231], v[152:155], v[32:47]
    v_mfma_f32_32x32x16_bf16 v[48:63], v[232:235], v[152:155], v[48:63]
    v_mov_b32 v251, v250
    v_mov_b32 v252, v250
    s_nop 1
    v_permlane32_swap_b32 v251, v252
    v_max_f32 v250, v251, v252
    v_max_f32 v250, 0, v250
    v_exp_f32 v251, -v250
    v_sub_f32 v160, v160, v250
    v_sub_f32 v161, v161, v250
    v_sub_f32 v162, v162, v250
    v_sub_f32 v163, v163, v250
    v_sub_f32 v164, v164, v250
    v_sub_f32 v165, v165, v250
    v_sub_f32 v166, v166, v250
    v_sub_f32 v167, v167, v250
    v_sub_f32 v168, v168, v250
    v_sub_f32 v169, v169, v250
    v_sub_f32 v170, v170, v250
    v_sub_f32 v171, v171, v250
    v_sub_f32 v172, v172, v250
    v_sub_f32 v173, v173, v250
    v_sub_f32 v174, v174, v250
    v_sub_f32 v175, v175, v250
    v_sub_f32 v176, v176, v250
    v_sub_f32 v177, v177, v250
    v_sub_f32 v178, v178, v250
    v_sub_f32 v179, v179, v250
    v_sub_f32 v180, v180, v250
    v_sub_f32 v181, v181, v250
    v_sub_f32 v182, v182, v250
    v_sub_f32 v183, v183, v250
    v_sub_f32 v184, v184, v250
    v_sub_f32 v185, v185, v250
    v_sub_f32 v186, v186, v250
    v_sub_f32 v187, v187, v250
    v_sub_f32 v188, v188, v250
    v_sub_f32 v189, v189, v250
    v_sub_f32 v190, v190, v250
    v_sub_f32 v191, v191, v250
    v_mul_f32 v236, v236, v251
    v_mul_f32 v249, v249, v251
    v_mul_f32 v0, v0, v251
    v_mul_f32 v1, v1, v251
    v_mul_f32 v2, v2, v251
    v_mul_f32 v3, v3, v251
    v_mul_f32 v4, v4, v251
    v_mul_f32 v5, v5, v251
    v_mul_f32 v6, v6, v251
    v_mul_f32 v7, v7, v251
    v_mul_f32 v8, v8, v251
    v_mul_f32 v9, v9, v251
    v_mul_f32 v10, v10, v251
    v_mul_f32 v11, v11, v251
    v_mul_f32 v12, v12, v251
    v_mul_f32 v13, v13, v251
    v_mul_f32 v14, v14, v251
    v_mul_f32 v15, v15, v251
    v_mul_f32 v16, v16, v251
    v_mul_f32 v17, v17, v251
    v_mul_f32 v18, v18, v251
    v_mul_f32 v19, v19, v251
    v_mul_f32 v20, v20, v251
    v_mul_f32 v21, v21, v251
    v_mul_f32 v22, v22, v251
    v_mul_f32 v23, v23, v251
    v_mul_f32 v24, v24, v251
    v_mul_f32 v25, v25, v251
    v_mul_f32 v26, v26, v251
    v_mul_f32 v27, v27, v251
    v_mul_f32 v28, v28, v251
    v_mul_f32 v29, v29, v251
    v_mul_f32 v30, v30, v251
    v_mul_f32 v31, v31, v251
    v_mul_f32 v32, v32, v251
    v_mul_f32 v33, v33, v251
    v_mul_f32 v34, v34, v251
    v_mul_f32 v35, v35, v251
    v_mul_f32 v36, v36, v251
    v_mul_f32 v37, v37, v251
    v_mul_f32 v38, v38, v251
    v_mul_f32 v39, v39, v251
    v_mul_f32 v40, v40, v251
    v_mul_f32 v41, v41, v251
    v_mul_f32 v42, v42, v251
    v_mul_f32 v43, v43, v251
    v_mul_f32 v44, v44, v251
    v_mul_f32 v45, v45, v251
    v_mul_f32 v46, v46, v251
    v_mul_f32 v47, v47, v251
    v_mul_f32 v48, v48, v251
    v_mul_f32 v49, v49, v251
    v_mul_f32 v50, v50, v251
    v_mul_f32 v51, v51, v251
    v_mul_f32 v52, v52, v251
    v_mul_f32 v53, v53, v251
    v_mul_f32 v54, v54, v251
    v_mul_f32 v55, v55, v251
    v_mul_f32 v56, v56, v251
    v_mul_f32 v57, v57, v251
    v_mul_f32 v58, v58, v251
    v_mul_f32 v59, v59, v251
    v_mul_f32 v60, v60, v251
    v_mul_f32 v61, v61, v251
    v_mul_f32 v62, v62, v251
    v_mul_f32 v63, v63, v251
    v_exp_f32 v160, v160
    v_exp_f32 v161, v161
    v_exp_f32 v162, v162
    v_add_f32 v236, v236, v160
    v_add_f32 v249, v249, v161
    v_cvt_pk_bf16_f32 v160, v160, v161
    v_exp_f32 v163, v163
    v_exp_f32 v164, v164
    v_add_f32 v236, v236, v162
    v_add_f32 v249, v249, v163
    v_cvt_pk_bf16_f32 v161, v162, v163
    v_exp_f32 v165, v165
    v_exp_f32 v166, v166
    v_add_f32 v236, v236, v164
    v_add_f32 v249, v249, v165
    v_cvt_pk_bf16_f32 v162, v164, v165
    v_exp_f32 v167, v167
    v_exp_f32 v168, v168
    v_add_f32 v236, v236, v166
    v_add_f32 v249, v249, v167
    v_cvt_pk_bf16_f32 v163, v166, v167
    v_exp_f32 v169, v169
    v_exp_f32 v170, v170
    v_add_f32 v236, v236, v168
    v_add_f32 v249, v249, v169
    v_cvt_pk_bf16_f32 v168, v168, v169
    v_exp_f32 v171, v171
    v_exp_f32 v172, v172
    v_add_f32 v236, v236, v170
    v_add_f32 v249, v249, v171
    v_cvt_pk_bf16_f32 v169, v170, v171
    v_exp_f32 v173, v173
    v_exp_f32 v174, v174
    v_add_f32 v236, v236, v172
    v_add_f32 v249, v249, v173
    v_cvt_pk_bf16_f32 v170, v172, v173
    v_exp_f32 v175, v175
    v_add_f32 v236, v236, v174
    v_add_f32 v249, v249, v175
    v_cvt_pk_bf16_f32 v171, v174, v175
    s_branch REJ_BY_last1
RRARE_BY_last:
    ds_swizzle_b32 v251, v253 offset:0x401F
    s_waitcnt lgkmcnt(0)
    v_max_f32 v253, v253, v251
    v_mov_b32 v251, v253
    v_mov_b32 v252, v253
    s_nop 1
    v_permlane32_swap_b32 v251, v252
    v_max_f32 v253, v251, v252
    v_max_f32 v253, 0, v253
    v_exp_f32 v251, -v253
    v_sub_f32 v192, v192, v253
    v_sub_f32 v193, v193, v253
    v_sub_f32 v194, v194, v253
    v_sub_f32 v195, v195, v253
    v_sub_f32 v196, v196, v253
    v_sub_f32 v197, v197, v253
    v_sub_f32 v198, v198, v253
    v_sub_f32 v199, v199, v253
    v_sub_f32 v200, v200, v253
    v_sub_f32 v201, v201, v253
    v_sub_f32 v202, v202, v253
    v_sub_f32 v203, v203, v253
    v_mul_f32 v237, v237, v251
    v_mul_f32 v64, v64, v251
    v_mul_f32 v65, v65, v251
    v_mul_f32 v66, v66, v251
    v_mul_f32 v67, v67, v251
    v_mul_f32 v68, v68, v251
    v_mul_f32 v69, v69, v251
    v_mul_f32 v70, v70, v251
    v_mul_f32 v71, v71, v251
    v_mul_f32 v72, v72, v251
    v_mul_f32 v73, v73, v251
    v_mul_f32 v74, v74, v251
    v_mul_f32 v75, v75, v251
    v_mul_f32 v76, v76, v251
    v_mul_f32 v77, v77, v251
    v_mul_f32 v78, v78, v251
    v_mul_f32 v79, v79, v251
    v_mul_f32 v80, v80, v251
    v_mul_f32 v81, v81, v251
    v_mul_f32 v82, v82, v251
    v_mul_f32 v83, v83, v251
    v_mul_f32 v84, v84, v251
    v_mul_f32 v85, v85, v251
    v_mul_f32 v86, v86, v251
    v_mul_f32 v87, v87, v251
    v_mul_f32 v88, v88, v251
    v_mul_f32 v89, v89, v251
    v_mul_f32 v90, v90, v251
    v_mul_f32 v91, v91, v251
    v_mul_f32 v92, v92, v251
    v_mul_f32 v93, v93, v251
    v_mul_f32 v94, v94, v251
    v_mul_f32 v95, v95, v251
    s_branch RREJ_BY_last
TAIL_L:
    s_setprio 0
    v_mov_b32 v251, v236
    v_mov_b32 v252, v236
    s_nop 1
    v_permlane32_swap_b32 v251, v252
    v_add_f32 v236, v251, v252
    v_rcp_f32 v236, v236
    v_lshlrev_b32 v253, 4, v254
    s_lshl_b32 s51, s41, 3
    s_add_u32 s51, s51, s39
    s_lshl_b32 s51, s51, 4
    s_add_u32 s51, s51, s40
    s_mul_i32 s51, s51, 73728
    s_add_u32 s24, s74, s51
    s_addc_u32 s25, s75, 0
    s_mov_b32 s26, 73728
    s_mov_b32 s27, 0x20000
    s_mul_i32 s51, s37, 36864
    s_lshl_b32 s52, s38, 10
    s_add_u32 s53, s51, s52
    v_add_u32 v250, s53, v253
    v_mul_f32 v0, v0, v236
    v_mul_f32 v1, v1, v236
    v_mul_f32 v2, v2, v236
    v_mul_f32 v3, v3, v236
    v_mul_f32 v4, v4, v236
    v_mul_f32 v5, v5, v236
    v_mul_f32 v6, v6, v236
    v_mul_f32 v7, v7, v236
    v_mul_f32 v8, v8, v236
    v_mul_f32 v9, v9, v236
    v_mul_f32 v10, v10, v236
    v_mul_f32 v11, v11, v236
    v_mul_f32 v12, v12, v236
    v_mul_f32 v13, v13, v236
    v_mul_f32 v14, v14, v236
    v_mul_f32 v15, v15, v236
    v_cvt_pk_bf16_f32 v144, v0, v1
    v_cvt_pk_bf16_f32 v145, v2, v3
    v_cvt_pk_bf16_f32 v146, v4, v5
    v_cvt_pk_bf16_f32 v147, v6, v7
    v_cvt_pk_bf16_f32 v148, v8, v9
    v_cvt_pk_bf16_f32 v149, v10, v11
    v_cvt_pk_bf16_f32 v150, v12, v13
    v_cvt_pk_bf16_f32 v151, v14, v15
    s_mov_b32 s53, 0
    buffer_store_dwordx4 v[144:147], v250, s[24:27], s53 offen sc1
    s_mov_b32 s53, 4096
    buffer_store_dwordx4 v[148:151], v250, s[24:27], s53 offen sc1
    v_mul_f32 v16, v16, v236
    v_mul_f32 v17, v17, v236
    v_mul_f32 v18, v18, v236
    v_mul_f32 v19, v19, v236
    v_mul_f32 v20, v20, v236
    v_mul_f32 v21, v21, v236
    v_mul_f32 v22, v22, v236
    v_mul_f32 v23, v23, v236
    v_mul_f32 v24, v24, v236
    v_mul_f32 v25, v25, v236
    v_mul_f32 v26, v26, v236
    v_mul_f32 v27, v27, v236
    v_mul_f32 v28, v28, v236
    v_mul_f32 v29, v29, v236
    v_mul_f32 v30, v30, v236
    v_mul_f32 v31, v31, v236
    v_cvt_pk_bf16_f32 v152, v16, v17
    v_cvt_pk_bf16_f32 v153, v18, v19
    v_cvt_pk_bf16_f32 v154, v20, v21
    v_cvt_pk_bf16_f32 v155, v22, v23
    v_cvt_pk_bf16_f32 v156, v24, v25
    v_cvt_pk_bf16_f32 v157, v26, v27
    v_cvt_pk_bf16_f32 v158, v28, v29
    v_cvt_pk_bf16_f32 v159, v30, v31
    s_mov_b32 s53, 9216
    buffer_store_dwordx4 v[152:155], v250, s[24:27], s53 offen sc1
    s_mov_b32 s53, 13312
    buffer_store_dwordx4 v[156:159], v250, s[24:27], s53 offen sc1
    v_mul_f32 v32, v32, v236
    v_mul_f32 v33, v33, v236
    v_mul_f32 v34, v34, v236
    v_mul_f32 v35, v35, v236
    v_mul_f32 v36, v36, v236
    v_mul_f32 v37, v37, v236
    v_mul_f32 v38, v38, v236
    v_mul_f32 v39, v39, v236
    v_mul_f32 v40, v40, v236
    v_mul_f32 v41, v41, v236
    v_mul_f32 v42, v42, v236
    v_mul_f32 v43, v43, v236
    v_mul_f32 v44, v44, v236
    v_mul_f32 v45, v45, v236
    v_mul_f32 v46, v46, v236
    v_mul_f32 v47, v47, v236
    v_cvt_pk_bf16_f32 v160, v32, v33
    v_cvt_pk_bf16_f32 v161, v34, v35
    v_cvt_pk_bf16_f32 v162, v36, v37
    v_cvt_pk_bf16_f32 v163, v38, v39
    v_cvt_pk_bf16_f32 v164, v40, v41
    v_cvt_pk_bf16_f32 v165, v42, v43
    v_cvt_pk_bf16_f32 v166, v44, v45
    v_cvt_pk_bf16_f32 v167, v46, v47
    s_mov_b32 s53, 18432
    buffer_store_dwordx4 v[160:163], v250, s[24:27], s53 offen sc1
    s_mov_b32 s53, 22528
    buffer_store_dwordx4 v[164:167], v250, s[24:27], s53 offen sc1
    v_mul_f32 v48, v48, v236
    v_mul_f32 v49, v49, v236
    v_mul_f32 v50, v50, v236
    v_mul_f32 v51, v51, v236
    v_mul_f32 v52, v52, v236
    v_mul_f32 v53, v53, v236
    v_mul_f32 v54, v54, v236
    v_mul_f32 v55, v55, v236
    v_mul_f32 v56, v56, v236
    v_mul_f32 v57, v57, v236
    v_mul_f32 v58, v58, v236
    v_mul_f32 v59, v59, v236
    v_mul_f32 v60, v60, v236
    v_mul_f32 v61, v61, v236
    v_mul_f32 v62, v62, v236
    v_mul_f32 v63, v63, v236
    v_cvt_pk_bf16_f32 v168, v48, v49
    v_cvt_pk_bf16_f32 v169, v50, v51
    v_cvt_pk_bf16_f32 v170, v52, v53
    v_cvt_pk_bf16_f32 v171, v54, v55
    v_cvt_pk_bf16_f32 v172, v56, v57
    v_cvt_pk_bf16_f32 v173, v58, v59
    v_cvt_pk_bf16_f32 v174, v60, v61
    v_cvt_pk_bf16_f32 v175, v62, v63
    s_mov_b32 s53, 27648
    buffer_store_dwordx4 v[168:171], v250, s[24:27], s53 offen sc1
    s_mov_b32 s53, 31744
    buffer_store_dwordx4 v[172:175], v250, s[24:27], s53 offen sc1
    s_cmp_eq_u32 s37, 0
    s_cselect_b32 s42, s64, s66
    s_cselect_b32 s44, s65, s67
    v_add_u32 v251, s52, v253
    v_add_u32 v252, s44, v251
    v_add_u32 v251, s42, v251
    s_waitcnt lgkmcnt(0)
    s_barrier
    ds_write_b128 v251, v[144:147] offset:0
    ds_write_b128 v251, v[148:151] offset:4096
    ds_write_b128 v251, v[152:155] offset:9216
    ds_write_b128 v251, v[156:159] offset:13312
    ds_write_b128 v252, v[160:163] offset:0
    ds_write_b128 v252, v[164:167] offset:4096
    ds_write_b128 v252, v[168:171] offset:9216
    ds_write_b128 v252, v[172:175] offset:13312
    s_waitcnt vmcnt(8)
    s_branch TAILC
TAIL_X:
    s_setprio 0
    v_mov_b32 v251, v236
    v_mov_b32 v252, v236
    s_nop 1
    v_permlane32_swap_b32 v251, v252
    v_add_f32 v236, v251, v252
    v_rcp_f32 v236, v236
    v_lshlrev_b32 v253, 4, v254
    s_lshl_b32 s51, s41, 3
    s_add_u32 s51, s51, s39
    s_lshl_b32 s51, s51, 4
    s_add_u32 s51, s51, s40
    s_mul_i32 s51, s51, 73728
    s_add_u32 s24, s74, s51
    s_addc_u32 s25, s75, 0
    s_mov_b32 s26, 73728
    s_mov_b32 s27, 0x20000
    ds_swizzle_b32 v251, v237 offset:0x401F
    s_waitcnt lgkmcnt(0)
    v_add_f32 v237, v237, v251
    v_mov_b32 v251, v237
    v_mov_b32 v252, v237
    s_nop 1
    v_permlane32_swap_b32 v251, v252
    v_add_f32 v237, v251, v252
    s_lshl_b32 s51, s37, 13
    s_add_u32 s51, s51, s66
    s_add_u32 s51, s51, 18432
    v_add_u32 v246, s51, v253
    s_lshl_b32 s52, s37, 10
    s_add_u32 s52, s52, s66
    s_add_u32 s52, s52, 34816
    v_add_u32 v247, s52, v253
    s_mul_i32 s51, s37, 36864
    s_lshl_b32 s52, s38, 10
    s_add_u32 s53, s51, s52
    v_add_u32 v250, s53, v253
    v_mul_f32 v0, v0, v236
    v_mul_f32 v1, v1, v236
    v_mul_f32 v2, v2, v236
    v_mul_f32 v3, v3, v236
    v_mul_f32 v4, v4, v236
    v_mul_f32 v5, v5, v236
    v_mul_f32 v6, v6, v236
    v_mul_f32 v7, v7, v236
    v_mul_f32 v8, v8, v236
    v_mul_f32 v9, v9, v236
    v_mul_f32 v10, v10, v236
    v_mul_f32 v11, v11, v236
    v_mul_f32 v12, v12, v236
    v_mul_f32 v13, v13, v236
    v_mul_f32 v14, v14, v236
    v_mul_f32 v15, v15, v236
    v_cvt_pk_bf16_f32 v144, v0, v1
    v_cvt_pk_bf16_f32 v145, v2, v3
    v_cvt_pk_bf16_f32 v146, v4, v5
    v_cvt_pk_bf16_f32 v147, v6, v7
    v_cvt_pk_bf16_f32 v148, v8, v9
    v_cvt_pk_bf16_f32 v149, v10, v11
    v_cvt_pk_bf16_f32 v150, v12, v13
    v_cvt_pk_bf16_f32 v151, v14, v15
    s_mov_b32 s53, 0
    buffer_store_dwordx4 v[144:147], v250, s[24:27], s53 offen sc1
    s_mov_b32 s53, 4096
    buffer_store_dwordx4 v[148:151], v250, s[24:27], s53 offen sc1
    v_mul_f32 v16, v16, v236
    v_mul_f32 v17, v17, v236
    v_mul_f32 v18, v18, v236
    v_mul_f32 v19, v19, v236
    v_mul_f32 v20, v20, v236
    v_mul_f32 v21, v21, v236
    v_mul_f32 v22, v22, v236
    v_mul_f32 v23, v23, v236
    v_mul_f32 v24, v24, v236
    v_mul_f32 v25, v25, v236
    v_mul_f32 v26, v26, v236
    v_mul_f32 v27, v27, v236
    v_mul_f32 v28, v28, v236
    v_mul_f32 v29, v29, v236
    v_mul_f32 v30, v30, v236
    v_mul_f32 v31, v31, v236
    v_cvt_pk_bf16_f32 v152, v16, v17
    v_cvt_pk_bf16_f32 v153, v18, v19
    v_cvt_pk_bf16_f32 v154, v20, v21
    v_cvt_pk_bf16_f32 v155, v22, v23
    v_cvt_pk_bf16_f32 v156, v24, v25
    v_cvt_pk_bf16_f32 v157, v26, v27
    v_cvt_pk_bf16_f32 v158, v28, v29
    v_cvt_pk_bf16_f32 v159, v30, v31
    s_mov_b32 s53, 9216
    buffer_store_dwordx4 v[152:155], v250, s[24:27], s53 offen sc1
    s_mov_b32 s53, 13312
    buffer_store_dwordx4 v[156:159], v250, s[24:27], s53 offen sc1
    v_mul_f32 v32, v32, v236
    v_mul_f32 v33, v33, v236
    v_mul_f32 v34, v34, v236
    v_mul_f32 v35, v35, v236
    v_mul_f32 v36, v36, v236
    v_mul_f32 v37, v37, v236
    v_mul_f32 v38, v38, v236
    v_mul_f32 v39, v39, v236
    v_mul_f32 v40, v40, v236
    v_mul_f32 v41, v41, v236
    v_mul_f32 v42, v42, v236
    v_mul_f32 v43, v43, v236
    v_mul_f32 v44, v44, v236
    v_mul_f32 v45, v45, v236
    v_mul_f32 v46, v46, v236
    v_mul_f32 v47, v47, v236
    v_cvt_pk_bf16_f32 v160, v32, v33
    v_cvt_pk_bf16_f32 v161, v34, v35
    v_cvt_pk_bf16_f32 v162, v36, v37
    v_cvt_pk_bf16_f32 v163, v38, v39
    v_cvt_pk_bf16_f32 v164, v40, v41
    v_cvt_pk_bf16_f32 v165, v42, v43
    v_cvt_pk_bf16_f32 v166, v44, v45
    v_cvt_pk_bf16_f32 v167, v46, v47
    s_mov_b32 s53, 18432
    buffer_store_dwordx4 v[160:163], v250, s[24:27], s53 offen sc1
    s_mov_b32 s53, 22528
    buffer_store_dwordx4 v[164:167], v250, s[24:27], s53 offen sc1
    v_mul_f32 v48, v48, v236
    v_mul_f32 v49, v49, v236
    v_mul_f32 v50, v50, v236
    v_mul_f32 v51, v51, v236
    v_mul_f32 v52, v52, v236
    v_mul_f32 v53, v53, v236
    v_mul_f32 v54, v54, v236
    v_mul_f32 v55, v55, v236
    v_mul_f32 v56, v56, v236
    v_mul_f32 v57, v57, v236
    v_mul_f32 v58, v58, v236
    v_mul_f32 v59, v59, v236
    v_mul_f32 v60, v60, v236
    v_mul_f32 v61, v61, v236
    v_mul_f32 v62, v62, v236
    v_mul_f32 v63, v63, v236
    v_cvt_pk_bf16_f32 v168, v48, v49
    v_cvt_pk_bf16_f32 v169, v50, v51
    v_cvt_pk_bf16_f32 v170, v52, v53
    v_cvt_pk_bf16_f32 v171, v54, v55
    v_cvt_pk_bf16_f32 v172, v56, v57
    v_cvt_pk_bf16_f32 v173, v58, v59
    v_cvt_pk_bf16_f32 v174, v60, v61
    v_cvt_pk_bf16_f32 v175, v62, v63
    s_mov_b32 s53, 27648
    buffer_store_dwordx4 v[168:171], v250, s[24:27], s53 offen sc1
    s_mov_b32 s53, 31744
    buffer_store_dwordx4 v[172:175], v250, s[24:27], s53 offen sc1
    s_cmp_eq_u32 s37, 0
    s_cselect_b32 s42, s64, s66
    s_cselect_b32 s44, s65, s67
    v_add_u32 v251, s52, v253
    v_add_u32 v252, s44, v251
    v_add_u32 v251, s42, v251
    s_waitcnt lgkmcnt(0)
    s_barrier
    ds_write_b128 v251, v[144:147] offset:0
    ds_write_b128 v251, v[148:151] offset:4096
    ds_write_b128 v251, v[152:155] offset:9216
    ds_write_b128 v251, v[156:159] offset:13312
    ds_write_b128 v252, v[160:163] offset:0
    ds_write_b128 v252, v[164:167] offset:4096
    ds_write_b128 v252, v[168:171] offset:9216
    ds_write_b128 v252, v[172:175] offset:13312
    ds_read_b128 v[0:3], v246 offset:0
    ds_read_b128 v[4:7], v246 offset:1024
    ds_read_b128 v[8:11], v246 offset:2048
    ds_read_b128 v[12:15], v246 offset:3072
    ds_read_b128 v[16:19], v246 offset:4096
    ds_read_b128 v[20:23], v246 offset:5120
    ds_read_b128 v[24:27], v246 offset:6144
    ds_read_b128 v[28:31], v246 offset:7168
    ds_read_b128 v[32:35], v247
    s_waitcnt lgkmcnt(0)
    v_min_f32 v250, v200, v32
    v_sub_f32 v251, v250, v200
    v_sub_f32 v252, v250, v32
    v_exp_f32 v251, v251
    v_exp_f32 v252, v252
    s_nop 0
    v_mul_f32 v237, v237, v251
    v_fmac_f32 v237, v33, v252
    v_rcp_f32 v237, v237
    s_nop 0
    v_mul_f32 v251, v251, v237
    v_mul_f32 v252, v252, v237
    v_mul_f32 v64, v64, v251
    v_fmac_f32 v64, v0, v252
    v_mul_f32 v65, v65, v251
    v_fmac_f32 v65, v1, v252
    v_mul_f32 v66, v66, v251
    v_fmac_f32 v66, v2, v252
    v_mul_f32 v67, v67, v251
    v_fmac_f32 v67, v3, v252
    v_mul_f32 v68, v68, v251
    v_fmac_f32 v68, v4, v252
    v_mul_f32 v69, v69, v251
    v_fmac_f32 v69, v5, v252
    v_mul_f32 v70, v70, v251
    v_fmac_f32 v70, v6, v252
    v_mul_f32 v71, v71, v251
    v_fmac_f32 v71, v7, v252
    v_mul_f32 v72, v72, v251
    v_fmac_f32 v72, v8, v252
    v_mul_f32 v73, v73, v251
    v_fmac_f32 v73, v9, v252
    v_mul_f32 v74, v74, v251
    v_fmac_f32 v74, v10, v252
    v_mul_f32 v75, v75, v251
    v_fmac_f32 v75, v11, v252
    v_mul_f32 v76, v76, v251
    v_fmac_f32 v76, v12, v252
    v_mul_f32 v77, v77, v251
    v_fmac_f32 v77, v13, v252
    v_mul_f32 v78, v78, v251
    v_fmac_f32 v78, v14, v252
    v_mul_f32 v79, v79, v251
    v_fmac_f32 v79, v15, v252
    v_mul_f32 v80, v80, v251
    v_fmac_f32 v80, v16, v252
    v_mul_f32 v81, v81, v251
    v_fmac_f32 v81, v17, v252
    v_mul_f32 v82, v82, v251
    v_fmac_f32 v82, v18, v252
    v_mul_f32 v83, v83, v251
    v_fmac_f32 v83, v19, v252
    v_mul_f32 v84, v84, v251
    v_fmac_f32 v84, v20, v252
    v_mul_f32 v85, v85, v251
    v_fmac_f32 v85, v21, v252
    v_mul_f32 v86, v86, v251
    v_fmac_f32 v86, v22, v252
    v_mul_f32 v87, v87, v251
    v_fmac_f32 v87, v23, v252
    v_mul_f32 v88, v88, v251
    v_fmac_f32 v88, v24, v252
    v_mul_f32 v89, v89, v251
    v_fmac_f32 v89, v25, v252
    v_mul_f32 v90, v90, v251
    v_fmac_f32 v90, v26, v252
    v_mul_f32 v91, v91, v251
    v_fmac_f32 v91, v27, v252
    v_mul_f32 v92, v92, v251
    v_fmac_f32 v92, v28, v252
    v_mul_f32 v93, v93, v251
    v_fmac_f32 v93, v29, v252
    v_mul_f32 v94, v94, v251
    v_fmac_f32 v94, v30, v252
    v_mul_f32 v95, v95, v251
    v_fmac_f32 v95, v31, v252
    v_cvt_pk_bf16_f32 v40, v64, v65
    v_cvt_pk_bf16_f32 v41, v66, v67
    v_cvt_pk_bf16_f32 v42, v68, v69
    v_cvt_pk_bf16_f32 v43, v70, v71
    v_cvt_pk_bf16_f32 v44, v72, v73
    v_cvt_pk_bf16_f32 v45, v74, v75
    v_cvt_pk_bf16_f32 v46, v76, v77
    v_cvt_pk_bf16_f32 v47, v78, v79
    v_cvt_pk_bf16_f32 v48, v80, v81
    v_cvt_pk_bf16_f32 v49, v82, v83
    v_cvt_pk_bf16_f32 v50, v84, v85
    v_cvt_pk_bf16_f32 v51, v86, v87
    v_cvt_pk_bf16_f32 v52, v88, v89
    v_cvt_pk_bf16_f32 v53, v90, v91
    v_cvt_pk_bf16_f32 v54, v92, v93
    v_cvt_pk_bf16_f32 v55, v94, v95
    v_add_u32 v251, s42, v253
    v_add_u32 v252, s44, v253
    v_add_u32 v250, s51, v253
    ds_write_b128 v251, v[40:43] offset:8192
    s_mov_b32 s53, 8192
    buffer_store_dwordx4 v[40:43], v250, s[24:27], s53 offen sc1
    ds_write_b128 v251, v[44:47] offset:17408
    s_mov_b32 s53, 17408
    buffer_store_dwordx4 v[44:47], v250, s[24:27], s53 offen sc1
    ds_write_b128 v252, v[48:51] offset:8192
    s_mov_b32 s53, 26624
    buffer_store_dwordx4 v[48:51], v250, s[24:27], s53 offen sc1
    ds_write_b128 v252, v[52:55] offset:17408
    s_mov_b32 s53, 35840
    buffer_store_dwordx4 v[52:55], v250, s[24:27], s53 offen sc1
    s_branch TAILC
TAIL_Y:
    s_setprio 0
    v_mov_b32 v251, v236
    v_mov_b32 v252, v236
    s_nop 1
    v_permlane32_swap_b32 v251, v252
    v_add_f32 v236, v251, v252
    v_rcp_f32 v236, v236
    v_lshlrev_b32 v253, 4, v254
    s_lshl_b32 s51, s41, 3
    s_add_u32 s51, s51, s39
    s_lshl_b32 s51, s51, 4
    s_add_u32 s51, s51, s40
    s_mul_i32 s51, s51, 73728
    s_add_u32 s24, s74, s51
    s_addc_u32 s25, s75, 0
    s_mov_b32 s26, 73728
    s_mov_b32 s27, 0x20000
    ds_swizzle_b32 v251, v237 offset:0x401F
    s_waitcnt lgkmcnt(0)
    v_add_f32 v237, v237, v251
    v_mov_b32 v251, v237
    v_mov_b32 v252, v237
    s_nop 1
    v_permlane32_swap_b32 v251, v252
    v_add_f32 v237, v251, v252
    s_lshl_b32 s51, s37, 13
    s_add_u32 s51, s51, s66
    s_add_u32 s51, s51, 18432
    v_add_u32 v246, s51, v253
    s_lshl_b32 s52, s37, 10
    s_add_u32 s52, s52, s66
    s_add_u32 s52, s52, 34816
    v_add_u32 v247, s52, v253
    ds_write_b128 v246, v[64:67] offset:0
    ds_write_b128 v246, v[68:71] offset:1024
    ds_write_b128 v246, v[72:75] offset:2048
    ds_write_b128 v246, v[76:79] offset:3072
    ds_write_b128 v246, v[80:83] offset:4096
    ds_write_b128 v246, v[84:87] offset:5120
    ds_write_b128 v246, v[88:91] offset:6144
    ds_write_b128 v246, v[92:95] offset:7168
    v_mov_b32 v201, v237
    ds_write_b128 v247, v[200:203]
    s_mul_i32 s51, s37, 36864
    s_lshl_b32 s52, s38, 10
    s_add_u32 s53, s51, s52
    v_add_u32 v250, s53, v253
    v_mul_f32 v0, v0, v236
    v_mul_f32 v1, v1, v236
    v_mul_f32 v2, v2, v236
    v_mul_f32 v3, v3, v236
    v_mul_f32 v4, v4, v236
    v_mul_f32 v5, v5, v236
    v_mul_f32 v6, v6, v236
    v_mul_f32 v7, v7, v236
    v_mul_f32 v8, v8, v236
    v_mul_f32 v9, v9, v236
    v_mul_f32 v10, v10, v236
    v_mul_f32 v11, v11, v236
    v_mul_f32 v12, v12, v236
    v_mul_f32 v13, v13, v236
    v_mul_f32 v14, v14, v236
    v_mul_f32 v15, v15, v236
    v_cvt_pk_bf16_f32 v144, v0, v1
    v_cvt_pk_bf16_f32 v145, v2, v3
    v_cvt_pk_bf16_f32 v146, v4, v5
    v_cvt_pk_bf16_f32 v147, v6, v7
    v_cvt_pk_bf16_f32 v148, v8, v9
    v_cvt_pk_bf16_f32 v149, v10, v11
    v_cvt_pk_bf16_f32 v150, v12, v13
    v_cvt_pk_bf16_f32 v151, v14, v15
    s_mov_b32 s53, 0
    buffer_store_dwordx4 v[144:147], v250, s[24:27], s53 offen sc1
    s_mov_b32 s53, 4096
    buffer_store_dwordx4 v[148:151], v250, s[24:27], s53 offen sc1
    v_mul_f32 v16, v16, v236
    v_mul_f32 v17, v17, v236
    v_mul_f32 v18, v18, v236
    v_mul_f32 v19, v19, v236
    v_mul_f32 v20, v20, v236
    v_mul_f32 v21, v21, v236
    v_mul_f32 v22, v22, v236
    v_mul_f32 v23, v23, v236
    v_mul_f32 v24, v24, v236
    v_mul_f32 v25, v25, v236
    v_mul_f32 v26, v26, v236
    v_mul_f32 v27, v27, v236
    v_mul_f32 v28, v28, v236
    v_mul_f32 v29, v29, v236
    v_mul_f32 v30, v30, v236
    v_mul_f32 v31, v31, v236
    v_cvt_pk_bf16_f32 v152, v16, v17
    v_cvt_pk_bf16_f32 v153, v18, v19
    v_cvt_pk_bf16_f32 v154, v20, v21
    v_cvt_pk_bf16_f32 v155, v22, v23
    v_cvt_pk_bf16_f32 v156, v24, v25
    v_cvt_pk_bf16_f32 v157, v26, v27
    v_cvt_pk_bf16_f32 v158, v28, v29
    v_cvt_pk_bf16_f32 v159, v30, v31
    s_mov_b32 s53, 9216
    buffer_store_dwordx4 v[152:155], v250, s[24:27], s53 offen sc1
    s_mov_b32 s53, 13312
    buffer_store_dwordx4 v[156:159], v250, s[24:27], s53 offen sc1
    v_mul_f32 v32, v32, v236
    v_mul_f32 v33, v33, v236
    v_mul_f32 v34, v34, v236
    v_mul_f32 v35, v35, v236
    v_mul_f32 v36, v36, v236
    v_mul_f32 v37, v37, v236
    v_mul_f32 v38, v38, v236
    v_mul_f32 v39, v39, v236
    v_mul_f32 v40, v40, v236
    v_mul_f32 v41, v41, v236
    v_mul_f32 v42, v42, v236
    v_mul_f32 v43, v43, v236
    v_mul_f32 v44, v44, v236
    v_mul_f32 v45, v45, v236
    v_mul_f32 v46, v46, v236
    v_mul_f32 v47, v47, v236
    v_cvt_pk_bf16_f32 v160, v32, v33
    v_cvt_pk_bf16_f32 v161, v34, v35
    v_cvt_pk_bf16_f32 v162, v36, v37
    v_cvt_pk_bf16_f32 v163, v38, v39
    v_cvt_pk_bf16_f32 v164, v40, v41
    v_cvt_pk_bf16_f32 v165, v42, v43
    v_cvt_pk_bf16_f32 v166, v44, v45
    v_cvt_pk_bf16_f32 v167, v46, v47
    s_mov_b32 s53, 18432
    buffer_store_dwordx4 v[160:163], v250, s[24:27], s53 offen sc1
    s_mov_b32 s53, 22528
    buffer_store_dwordx4 v[164:167], v250, s[24:27], s53 offen sc1
    v_mul_f32 v48, v48, v236
    v_mul_f32 v49, v49, v236
    v_mul_f32 v50, v50, v236
    v_mul_f32 v51, v51, v236
    v_mul_f32 v52, v52, v236
    v_mul_f32 v53, v53, v236
    v_mul_f32 v54, v54, v236
    v_mul_f32 v55, v55, v236
    v_mul_f32 v56, v56, v236
    v_mul_f32 v57, v57, v236
    v_mul_f32 v58, v58, v236
    v_mul_f32 v59, v59, v236
    v_mul_f32 v60, v60, v236
    v_mul_f32 v61, v61, v236
    v_mul_f32 v62, v62, v236
    v_mul_f32 v63, v63, v236
    v_cvt_pk_bf16_f32 v168, v48, v49
    v_cvt_pk_bf16_f32 v169, v50, v51
    v_cvt_pk_bf16_f32 v170, v52, v53
    v_cvt_pk_bf16_f32 v171, v54, v55
    v_cvt_pk_bf16_f32 v172, v56, v57
    v_cvt_pk_bf16_f32 v173, v58, v59
    v_cvt_pk_bf16_f32 v174, v60, v61
    v_cvt_pk_bf16_f32 v175, v62, v63
    s_mov_b32 s53, 27648
    buffer_store_dwordx4 v[168:171], v250, s[24:27], s53 offen sc1
    s_mov_b32 s53, 31744
    buffer_store_dwordx4 v[172:175], v250, s[24:27], s53 offen sc1
    s_cmp_eq_u32 s37, 0
    s_cselect_b32 s42, s64, s66
    s_cselect_b32 s44, s65, s67
    v_add_u32 v251, s52, v253
    v_add_u32 v252, s44, v251
    v_add_u32 v251, s42, v251
    s_waitcnt lgkmcnt(0)
    s_barrier
    ds_write_b128 v251, v[144:147] offset:0
    ds_write_b128 v251, v[148:151] offset:4096
    ds_write_b128 v251, v[152:155] offset:9216
    ds_write_b128 v251, v[156:159] offset:13312
    ds_write_b128 v252, v[160:163] offset:0
    ds_write_b128 v252, v[164:167] offset:4096
    ds_write_b128 v252, v[168:171] offset:9216
    ds_write_b128 v252, v[172:175] offset:13312
TAILC:
    s_lshr_b32 s72, s40, 2
    s_and_b32 s73, s40, 3
    v_bfe_u32 v200, v254, 2, 2
    v_lshrrev_b32 v201, 5, v254
    v_lshl_add_u32 v201, v201, 2, v200
    v_mul_u32_u24 v201, 0x140, v201
    v_and_b32 v202, 3, v254
    v_lshl_add_u32 v201, v202, 3, v201
    v_bfe_u32 v200, v254, 4, 1
    v_lshl_add_u32 v201, v200, 5, v201
    s_mul_i32 s51, s37, 192
    s_add_u32 s51, s51, 18432
    v_add_u32 v136, s51, v201
    s_lshl_b32 s51, s38, 10
    v_add_u32 v137, s51, v253
    v_add_u32 v139, 0x2000, v253
    v_lshrrev_b32 v201, 2, v254
    v_mul_u32_u24 v201, 0x140, v201
    v_lshl_add_u32 v201, v202, 3, v201
    s_mul_i32 s62, s38, 3
    s_min_u32 s62, s62, 7
    s_lshl_b32 s51, s62, 5
    s_add_u32 s51, s51, 18432
    v_add_u32 v138, s51, v201
    s_mul_i32 s51, s37, 24576
    s_lshl_b32 s52, s38, 11
    s_add_u32 s51, s51, s52
    v_add_u32 v177, s51, v253
    v_add_u32 v178, 0xa000, v253
    v_and_b32 v200, 3, v254
    s_lshl_b32 s51, s72, 2
    v_add_u32 v201, s51, v200
    v_lshl_add_u32 v202, v200, 2, s73
    s_lshl_b32 s51, s40, 8
    v_lshl_add_u32 v181, v201, 2, s51
    v_lshl_add_u32 v182, v202, 2, s51
    s_lshl_b32 s51, s40, 2
    v_lshl_add_u32 v179, v201, 8, s51
    v_lshl_add_u32 v180, v202, 8, s51
    v_mov_b32 v200, 0x7f000000
    v_cmp_gt_u32 vcc, 4, v254
    s_nop 1
    v_cndmask_b32 v179, v200, v179, vcc
    v_cndmask_b32 v180, v200, v180, vcc
    s_lshl_b32 s51, s41, 3
    s_add_u32 s51, s51, s39
    s_lshl_b32 s52, s51, 2
    s_add_u32 s53, s52, s72
    s_lshl_b32 s53, s53, 2
    v_mov_b32 v185, s53
    s_add_u32 s53, s52, s73
    s_lshl_b32 s53, s53, 2
    v_mov_b32 v186, s53
    s_mov_b32 s8, s78
    s_mov_b32 s9, s79
    s_mov_b32 s10, 256
    s_mov_b32 s11, 0x20000
    s_lshl_b32 s51, s51, 4
    s_lshl_b32 s52, s72, 2
    s_add_u32 s52, s52, s51
    s_mul_i32 s52, s52, 73728
    s_add_u32 s12, s74, s52
    s_addc_u32 s13, s75, 0
    s_mov_b32 s14, 294912
    s_mov_b32 s15, 0x20000
    s_add_u32 s52, s51, s40
    s_mul_i32 s52, s52, 46080
    s_add_u32 s52, s52, 0x1800000
    s_add_u32 s16, s74, s52
    s_addc_u32 s17, s75, 0
    s_mov_b32 s18, 46080
    s_mov_b32 s19, 0x20000
    s_add_u32 s52, s51, s73
    s_mul_i32 s52, s52, 46080
    s_add_u32 s52, s52, 0x1800000
    s_add_u32 s32, s74, s52
    s_addc_u32 s33, s75, 0
    s_mov_b32 s34, 599040
    s_mov_b32 s35, 0x20000
    s_cmp_eq_u32 s37, 0
    s_cbranch_scc1 OUTP_0
    s_sub_u32 s51, s36, 4
    s_mul_i32 s61, s51, 5120
    s_add_u32 s61, s61, 18432
    s_mul_i32 s51, s51, 18432
    v_add_u32 v251, 0, v254
    v_mul_u32_u24 v252, 0xccd, v251
    v_lshrrev_b32 v252, 16, v252
    v_mul_u32_u24 v128, 20, v252
    v_sub_u32 v251, v251, v128
    v_mul_u32_u24 v252, 0x480, v252
    v_lshl_add_u32 v251, v251, 4, v252
    v_add_u32 v128, s51, v251
    v_add_u32 v251, 64, v254
    v_mul_u32_u24 v252, 0xccd, v251
    v_lshrrev_b32 v252, 16, v252
    v_mul_u32_u24 v129, 20, v252
    v_sub_u32 v251, v251, v129
    v_mul_u32_u24 v252, 0x480, v252
    v_lshl_add_u32 v251, v251, 4, v252
    v_add_u32 v129, s51, v251
    v_add_u32 v251, 128, v254
    v_mul_u32_u24 v252, 0xccd, v251
    v_lshrrev_b32 v252, 16, v252
    v_mul_u32_u24 v130, 20, v252
    v_sub_u32 v251, v251, v130
    v_mul_u32_u24 v252, 0x480, v252
    v_lshl_add_u32 v251, v251, 4, v252
    v_add_u32 v130, s51, v251
    v_add_u32 v251, 192, v254
    v_mul_u32_u24 v252, 0xccd, v251
    v_lshrrev_b32 v252, 16, v252
    v_mul_u32_u24 v131, 20, v252
    v_sub_u32 v251, v251, v131
    v_mul_u32_u24 v252, 0x480, v252
    v_lshl_add_u32 v251, v251, 4, v252
    v_add_u32 v131, s51, v251
    v_add_u32 v251, 256, v254
    v_mul_u32_u24 v252, 0xccd, v251
    v_lshrrev_b32 v252, 16, v252
    v_mul_u32_u24 v132, 20, v252
    v_sub_u32 v251, v251, v132
    v_mul_u32_u24 v252, 0x480, v252
    v_lshl_add_u32 v251, v251, 4, v252
    v_add_u32 v132, s51, v251
    s_lshl_b32 s59, s38, 10
    s_cmp_lt_u32 s38, 2
    s_cselect_b32 s60, 0, 0x30000
    s_setprio 1
    v_add_u32 v140, s64, v136
    v_add_u32 v141, s64, v137
    v_add_u32 v142, s64, v138
    v_add_u32 v143, s64, v139
    s_waitcnt lgkmcnt(0)
    s_barrier
    ds_read_b64_tr_b16 v[96:97], v140 offset:0
    ds_read_b64_tr_b16 v[98:99], v140 offset:2560
    ds_read_b128 v[64:67], v141 offset:0
    ds_read_b64_tr_b16 v[100:101], v140 offset:64
    ds_read_b64_tr_b16 v[102:103], v140 offset:2624
    ds_read_b64_tr_b16 v[104:105], v140 offset:5120
    ds_read_b64_tr_b16 v[106:107], v140 offset:7680
    ds_read_b128 v[68:71], v141 offset:4096
    ds_read_b64_tr_b16 v[108:109], v140 offset:5184
    ds_read_b64_tr_b16 v[110:111], v140 offset:7744
    ds_read_b64_tr_b16 v[112:113], v142 offset:0
    ds_read_b64_tr_b16 v[114:115], v142 offset:5120
    ds_read_b128 v[80:83], v143 offset:0
    s_waitcnt lgkmcnt(10)
    v_mfma_f32_32x32x16_bf16 v[0:15], v[96:99], v[64:67], 0
    ds_read_b64_tr_b16 v[116:117], v142 offset:32
    ds_read_b64_tr_b16 v[118:119], v142 offset:5152
    s_add_u32 s53, s40, 0
    s_and_b32 s53, s53, 3
    s_mul_i32 s53, s53, 294912
    s_add_u32 s53, s53, 147456
    s_add_u32 m0, s66, s61
    s_nop 0
    buffer_load_dwordx4 v128, s[20:23], s53 offen lds
    s_add_u32 m0, m0, 0x400
    s_nop 0
    buffer_load_dwordx4 v129, s[20:23], s53 offen lds
    s_waitcnt lgkmcnt(10)
    v_mfma_f32_32x32x16_bf16 v[16:31], v[100:103], v[64:67], 0
    ds_read_b64_tr_b16 v[120:121], v142 offset:64
    ds_read_b64_tr_b16 v[122:123], v142 offset:5184
    s_add_u32 m0, m0, 0x400
    s_nop 0
    buffer_load_dwordx4 v130, s[20:23], s53 offen lds
    s_waitcnt lgkmcnt(9)
    v_mfma_f32_32x32x16_bf16 v[0:15], v[104:107], v[68:71], v[0:15]
    ds_read_b64_tr_b16 v[124:125], v140 offset:10240
    ds_read_b64_tr_b16 v[126:127], v140 offset:12800
    ds_read_b128 v[72:75], v141 offset:9216
    s_add_u32 m0, m0, 0x400
    s_nop 0
    buffer_load_dwordx4 v131, s[20:23], s53 offen lds
    s_waitcnt lgkmcnt(10)
    v_mfma_f32_32x32x16_bf16 v[16:31], v[108:111], v[68:71], v[16:31]
    ds_read_b64_tr_b16 v[96:97], v140 offset:10304
    ds_read_b64_tr_b16 v[98:99], v140 offset:12864
    s_add_u32 m0, m0, 0x400
    s_nop 0
    buffer_load_dwordx4 v132, s[20:23], s53 offen lds
    s_waitcnt lgkmcnt(9)
    v_mfma_f32_16x16x32_bf16 v[48:51], v[112:115], v[80:83], 0
    ds_read_b64_tr_b16 v[100:101], v140 offset:15360
    ds_read_b64_tr_b16 v[102:103], v140 offset:17920
    ds_read_b128 v[76:79], v141 offset:13312
    s_add_u32 s53, s40, 0
    s_and_b32 s53, s53, 3
    s_mul_i32 s53, s53, 294912
    s_add_u32 s53, s53, 221184
    s_add_u32 m0, s67, s61
    s_nop 0
    buffer_load_dwordx4 v128, s[20:23], s53 offen lds
    s_waitcnt lgkmcnt(10)
    v_mfma_f32_16x16x32_bf16 v[52:55], v[116:119], v[80:83], 0
    ds_read_b64_tr_b16 v[104:105], v140 offset:15424
    ds_read_b64_tr_b16 v[106:107], v140 offset:17984
    s_add_u32 m0, m0, 0x400
    s_nop 0
    buffer_load_dwordx4 v129, s[20:23], s53 offen lds
    s_waitcnt lgkmcnt(10)
    v_mfma_f32_16x16x32_bf16 v[56:59], v[120:123], v[80:83], 0
    ds_read_b64_tr_b16 v[108:109], v142 offset:10240
    ds_read_b64_tr_b16 v[110:111], v142 offset:15360
    ds_read_b128 v[84:87], v143 offset:9216
    s_add_u32 m0, m0, 0x400
    s_nop 0
    buffer_load_dwordx4 v130, s[20:23], s53 offen lds
    s_waitcnt lgkmcnt(10)
    v_mfma_f32_32x32x16_bf16 v[0:15], v[124:127], v[72:75], v[0:15]
    ds_read_b64_tr_b16 v[112:113], v142 offset:10272
    ds_read_b64_tr_b16 v[114:115], v142 offset:15392
    s_add_u32 m0, m0, 0x400
    s_nop 0
    buffer_load_dwordx4 v131, s[20:23], s53 offen lds
    s_waitcnt lgkmcnt(10)
    v_mfma_f32_32x32x16_bf16 v[16:31], v[96:99], v[72:75], v[16:31]
    ds_read_b64_tr_b16 v[116:117], v142 offset:10304
    ds_read_b64_tr_b16 v[118:119], v142 offset:15424
    s_add_u32 m0, m0, 0x400
    s_nop 0
    buffer_load_dwordx4 v132, s[20:23], s53 offen lds
    s_waitcnt lgkmcnt(9)
    v_mfma_f32_32x32x16_bf16 v[0:15], v[100:103], v[76:79], v[0:15]
    s_waitcnt lgkmcnt(7)
    v_mfma_f32_32x32x16_bf16 v[16:31], v[104:107], v[76:79], v[16:31]
    v_add_u32 v140, s65, v136
    v_add_u32 v141, s65, v137
    v_add_u32 v142, s65, v138
    v_add_u32 v143, s65, v139
    s_waitcnt lgkmcnt(0)
    s_barrier
    ds_read_b64_tr_b16 v[120:121], v140 offset:0
    ds_read_b64_tr_b16 v[122:123], v140 offset:2560
    ds_read_b128 v[64:67], v141 offset:0
    ds_read_b64_tr_b16 v[124:125], v140 offset:64
    ds_read_b64_tr_b16 v[126:127], v140 offset:2624
    v_mfma_f32_16x16x32_bf16 v[48:51], v[108:111], v[84:87], v[48:51]
    ds_read_b64_tr_b16 v[96:97], v140 offset:5120
    ds_read_b64_tr_b16 v[98:99], v140 offset:7680
    ds_read_b128 v[68:71], v141 offset:4096
    s_add_u32 s53, s40, 1
    s_and_b32 s53, s53, 3
    s_mul_i32 s53, s53, 294912
    s_add_u32 s53, s53, 0
    s_add_u32 m0, s64, s61
    s_nop 0
    buffer_load_dwordx4 v128, s[20:23], s53 offen lds
    v_mfma_f32_16x16x32_bf16 v[52:55], v[112:115], v[84:87], v[52:55]
    ds_read_b64_tr_b16 v[100:101], v140 offset:5184
    ds_read_b64_tr_b16 v[102:103], v140 offset:7744
    s_add_u32 m0, m0, 0x400
    s_nop 0
    buffer_load_dwordx4 v129, s[20:23], s53 offen lds
    v_mfma_f32_16x16x32_bf16 v[56:59], v[116:119], v[84:87], v[56:59]
    ds_read_b64_tr_b16 v[104:105], v142 offset:0
    ds_read_b64_tr_b16 v[106:107], v142 offset:5120
    ds_read_b128 v[80:83], v143 offset:0
    s_add_u32 m0, m0, 0x400
    s_nop 0
    buffer_load_dwordx4 v130, s[20:23], s53 offen lds
    s_waitcnt lgkmcnt(10)
    v_mfma_f32_32x32x16_bf16 v[0:15], v[120:123], v[64:67], v[0:15]
    ds_read_b64_tr_b16 v[108:109], v142 offset:32
    ds_read_b64_tr_b16 v[110:111], v142 offset:5152
    s_add_u32 m0, m0, 0x400
    s_nop 0
    buffer_load_dwordx4 v131, s[20:23], s53 offen lds
    s_waitcnt lgkmcnt(10)
    v_mfma_f32_32x32x16_bf16 v[16:31], v[124:127], v[64:67], v[16:31]
    ds_read_b64_tr_b16 v[112:113], v142 offset:64
    ds_read_b64_tr_b16 v[114:115], v142 offset:5184
    s_add_u32 m0, m0, 0x400
    s_nop 0
    buffer_load_dwordx4 v132, s[20:23], s53 offen lds
    s_waitcnt lgkmcnt(9)
    v_mfma_f32_32x32x16_bf16 v[0:15], v[96:99], v[68:71], v[0:15]
    ds_read_b64_tr_b16 v[116:117], v140 offset:10240
    ds_read_b64_tr_b16 v[118:119], v140 offset:12800
    ds_read_b128 v[72:75], v141 offset:9216
    s_waitcnt lgkmcnt(10)
    v_mfma_f32_32x32x16_bf16 v[16:31], v[100:103], v[68:71], v[16:31]
    ds_read_b64_tr_b16 v[120:121], v140 offset:10304
    ds_read_b64_tr_b16 v[122:123], v140 offset:12864
    s_waitcnt lgkmcnt(9)
    v_mfma_f32_16x16x32_bf16 v[48:51], v[104:107], v[80:83], v[48:51]
    ds_read_b64_tr_b16 v[124:125], v140 offset:15360
    ds_read_b64_tr_b16 v[126:127], v140 offset:17920
    ds_read_b128 v[76:79], v141 offset:13312
    s_waitcnt lgkmcnt(10)
    v_mfma_f32_16x16x32_bf16 v[52:55], v[108:111], v[80:83], v[52:55]
    ds_read_b64_tr_b16 v[96:97], v140 offset:15424
    ds_read_b64_tr_b16 v[98:99], v140 offset:17984
    s_waitcnt lgkmcnt(10)
    v_mfma_f32_16x16x32_bf16 v[56:59], v[112:115], v[80:83], v[56:59]
    ds_read_b64_tr_b16 v[100:101], v142 offset:10240
    ds_read_b64_tr_b16 v[102:103], v142 offset:15360
    ds_read_b128 v[84:87], v143 offset:9216
    s_waitcnt lgkmcnt(10)
    v_mfma_f32_32x32x16_bf16 v[0:15], v[116:119], v[72:75], v[0:15]
    ds_read_b64_tr_b16 v[104:105], v142 offset:10272
    ds_read_b64_tr_b16 v[106:107], v142 offset:15392
    s_waitcnt lgkmcnt(10)
    v_mfma_f32_32x32x16_bf16 v[16:31], v[120:123], v[72:75], v[16:31]
    ds_read_b64_tr_b16 v[108:109], v142 offset:10304
    ds_read_b64_tr_b16 v[110:111], v142 offset:15424
    s_waitcnt lgkmcnt(9)
    v_mfma_f32_32x32x16_bf16 v[0:15], v[124:127], v[76:79], v[0:15]
    s_waitcnt lgkmcnt(7)
    v_mfma_f32_32x32x16_bf16 v[16:31], v[96:99], v[76:79], v[16:31]
    v_add_u32 v140, s66, v136
    v_add_u32 v141, s66, v137
    v_add_u32 v142, s66, v138
    v_add_u32 v143, s66, v139
    s_waitcnt vmcnt(10) lgkmcnt(0)
    s_barrier
    ds_read_b64_tr_b16 v[112:113], v140 offset:0
    ds_read_b64_tr_b16 v[114:115], v140 offset:2560
    ds_read_b128 v[64:67], v141 offset:0
    ds_read_b64_tr_b16 v[116:117], v140 offset:64
    ds_read_b64_tr_b16 v[118:119], v140 offset:2624
    s_cmp_lg_u32 s36, 4
    s_cbranch_scc1 NOPUB1
    v_mov_b32 v183, 1
    buffer_store_dword v183, v179, s[96:99], 0 offen sc1
    v_mov_b32 v184, 0x1
    s_mov_b64 exec, 1
    buffer_atomic_add v184, v185, s[8:11], 0 offen sc1
    s_mov_b64 exec, -1
NOPUB1:
    v_mfma_f32_16x16x32_bf16 v[48:51], v[100:103], v[84:87], v[48:51]
    ds_read_b64_tr_b16 v[120:121], v140 offset:5120
    ds_read_b64_tr_b16 v[122:123], v140 offset:7680
    ds_read_b128 v[68:71], v141 offset:4096
    s_add_u32 s53, s40, 1
    s_and_b32 s53, s53, 3
    s_mul_i32 s53, s53, 294912
    s_add_u32 s53, s53, 73728
    s_add_u32 m0, s65, s61
    s_nop 0
    buffer_load_dwordx4 v128, s[20:23], s53 offen lds
    s_add_u32 m0, m0, 0x400
    s_nop 0
    buffer_load_dwordx4 v129, s[20:23], s53 offen lds
    v_mfma_f32_16x16x32_bf16 v[52:55], v[104:107], v[84:87], v[52:55]
    ds_read_b64_tr_b16 v[124:125], v140 offset:5184
    ds_read_b64_tr_b16 v[126:127], v140 offset:7744
    s_add_u32 m0, m0, 0x400
    s_nop 0
    buffer_load_dwordx4 v130, s[20:23], s53 offen lds
    s_add_u32 m0, m0, 0x400
    s_nop 0
    buffer_load_dwordx4 v131, s[20:23], s53 offen lds
    v_mfma_f32_16x16x32_bf16 v[56:59], v[108:111], v[84:87], v[56:59]
    ds_read_b64_tr_b16 v[96:97], v142 offset:0
    ds_read_b64_tr_b16 v[98:99], v142 offset:5120
    ds_read_b128 v[80:83], v143 offset:0
    s_add_u32 m0, m0, 0x400
    s_nop 0
    buffer_load_dwordx4 v132, s[20:23], s53 offen lds
    s_mov_b32 s50, 3000
RTP1:
    buffer_load_dword v184, v181, s[96:99], 0 offen sc1
    s_waitcnt vmcnt(0)
    v_cmp_gt_u32 vcc, 1, v184
    s_cbranch_vccz OKP1
    s_sleep 2
    s_sub_u32 s50, s50, 1
    s_cmp_lg_u32 s50, 0
    s_cbranch_scc1 RTP1
    s_mov_b32 s50, 100000
RTQ1:
    buffer_load_dword v184, v185, s[8:11], 0 offen sc1
    s_waitcnt vmcnt(0)
    v_bfe_u32 v184, v184, 0, 8
    v_cmp_gt_u32 vcc, 4, v184
    s_cbranch_vccz OKP1
    s_sleep 8
    s_sub_u32 s50, s50, 1
    s_cmp_lg_u32 s50, 0
    s_cbranch_scc1 RTQ1
OKP1:
    s_waitcnt lgkmcnt(10)
    v_mfma_f32_32x32x16_bf16 v[0:15], v[112:115], v[64:67], v[0:15]
    ds_read_b64_tr_b16 v[100:101], v142 offset:32
    ds_read_b64_tr_b16 v[102:103], v142 offset:5152
    s_add_u32 s52, s73, 1
    s_and_b32 s52, s52, 3
    s_mul_i32 s52, s52, 73728
    s_add_u32 s52, s52, 0
    s_add_u32 m0, s64, s59
    s_nop 0
    buffer_load_dwordx4 v137, s[12:15], s52 offen sc1 lds
    s_add_u32 m0, m0, 0x1000
    s_add_u32 s52, s52, 0x1000
    buffer_load_dwordx4 v137, s[12:15], s52 offen sc1 lds
    s_waitcnt lgkmcnt(10)
    v_mfma_f32_32x32x16_bf16 v[16:31], v[116:119], v[64:67], v[16:31]
    ds_read_b64_tr_b16 v[104:105], v142 offset:64
    ds_read_b64_tr_b16 v[106:107], v142 offset:5184
    s_add_u32 m0, m0, 0x1000
    s_add_u32 s52, s52, 0x1000
    buffer_load_dwordx4 v137, s[12:15], s52 offen sc1 lds
    s_waitcnt lgkmcnt(9)
    v_mfma_f32_32x32x16_bf16 v[0:15], v[120:123], v[68:71], v[0:15]
    ds_read_b64_tr_b16 v[108:109], v140 offset:10240
    ds_read_b64_tr_b16 v[110:111], v140 offset:12800
    ds_read_b128 v[72:75], v141 offset:9216
    s_add_u32 m0, m0, 0x1000
    s_add_u32 s52, s52, 0x1000
    buffer_load_dwordx4 v137, s[12:15], s52 offen sc1 lds
    s_waitcnt lgkmcnt(10)
    v_mfma_f32_32x32x16_bf16 v[16:31], v[124:127], v[68:71], v[16:31]
    ds_read_b64_tr_b16 v[112:113], v140 offset:10304
    ds_read_b64_tr_b16 v[114:115], v140 offset:12864
    s_add_u32 m0, m0, 0x1000
    s_add_u32 s52, s52, 0x1000
    s_max_u32 m0, m0, s60
    s_nop 0
    buffer_load_dwordx4 v137, s[12:15], s52 offen sc1 lds
    s_waitcnt lgkmcnt(9)
    v_mfma_f32_16x16x32_bf16 v[48:51], v[96:99], v[80:83], v[48:51]
    ds_read_b64_tr_b16 v[116:117], v140 offset:15360
    ds_read_b64_tr_b16 v[118:119], v140 offset:17920
    ds_read_b128 v[76:79], v141 offset:13312
    s_add_u32 s52, s73, 1
    s_and_b32 s52, s52, 3
    s_mul_i32 s52, s52, 73728
    s_add_u32 s52, s52, 18432
    s_add_u32 m0, s65, s59
    s_nop 0
    buffer_load_dwordx4 v137, s[12:15], s52 offen sc1 lds
    s_waitcnt lgkmcnt(10)
    v_mfma_f32_16x16x32_bf16 v[52:55], v[100:103], v[80:83], v[52:55]
    ds_read_b64_tr_b16 v[120:121], v140 offset:15424
    ds_read_b64_tr_b16 v[122:123], v140 offset:17984
    s_add_u32 m0, m0, 0x1000
    s_add_u32 s52, s52, 0x1000
    buffer_load_dwordx4 v137, s[12:15], s52 offen sc1 lds
    s_waitcnt lgkmcnt(10)
    v_mfma_f32_16x16x32_bf16 v[56:59], v[104:107], v[80:83], v[56:59]
    ds_read_b64_tr_b16 v[124:125], v142 offset:10240
    ds_read_b64_tr_b16 v[126:127], v142 offset:15360
    ds_read_b128 v[84:87], v143 offset:9216
    s_add_u32 m0, m0, 0x1000
    s_add_u32 s52, s52, 0x1000
    buffer_load_dwordx4 v137, s[12:15], s52 offen sc1 lds
    s_waitcnt lgkmcnt(10)
    v_mfma_f32_32x32x16_bf16 v[0:15], v[108:111], v[72:75], v[0:15]
    ds_read_b64_tr_b16 v[96:97], v142 offset:10272
    ds_read_b64_tr_b16 v[98:99], v142 offset:15392
    s_add_u32 m0, m0, 0x1000
    s_add_u32 s52, s52, 0x1000
    buffer_load_dwordx4 v137, s[12:15], s52 offen sc1 lds
    s_waitcnt lgkmcnt(10)
    v_mfma_f32_32x32x16_bf16 v[16:31], v[112:115], v[72:75], v[16:31]
    ds_read_b64_tr_b16 v[100:101], v142 offset:10304
    ds_read_b64_tr_b16 v[102:103], v142 offset:15424
    s_add_u32 m0, m0, 0x1000
    s_add_u32 s52, s52, 0x1000
    s_max_u32 m0, m0, s60
    s_nop 0
    buffer_load_dwordx4 v137, s[12:15], s52 offen sc1 lds
    s_waitcnt lgkmcnt(9)
    v_mfma_f32_32x32x16_bf16 v[0:15], v[116:119], v[76:79], v[0:15]
    s_waitcnt lgkmcnt(7)
    v_mfma_f32_32x32x16_bf16 v[16:31], v[120:123], v[76:79], v[16:31]
    v_add_u32 v140, s67, v136
    v_add_u32 v141, s67, v137
    v_add_u32 v142, s67, v138
    v_add_u32 v143, s67, v139
    s_waitcnt vmcnt(20) lgkmcnt(0)
    s_barrier
    ds_read_b64_tr_b16 v[104:105], v140 offset:0
    ds_read_b64_tr_b16 v[106:107], v140 offset:2560
    ds_read_b128 v[64:67], v141 offset:0
    ds_read_b64_tr_b16 v[108:109], v140 offset:64
    ds_read_b64_tr_b16 v[110:111], v140 offset:2624
    v_mfma_f32_16x16x32_bf16 v[48:51], v[124:127], v[84:87], v[48:51]
    ds_read_b64_tr_b16 v[112:113], v140 offset:5120
    ds_read_b64_tr_b16 v[114:115], v140 offset:7680
    ds_read_b128 v[68:71], v141 offset:4096
    s_add_u32 s53, s40, 1
    s_and_b32 s53, s53, 3
    s_mul_i32 s53, s53, 294912
    s_add_u32 s53, s53, 147456
    s_add_u32 m0, s66, s61
    s_nop 0
    buffer_load_dwordx4 v128, s[20:23], s53 offen lds
    s_add_u32 m0, m0, 0x400
    s_nop 0
    buffer_load_dwordx4 v129, s[20:23], s53 offen lds
    v_mfma_f32_16x16x32_bf16 v[52:55], v[96:99], v[84:87], v[52:55]
    ds_read_b64_tr_b16 v[116:117], v140 offset:5184
    ds_read_b64_tr_b16 v[118:119], v140 offset:7744
    s_add_u32 m0, m0, 0x400
    s_nop 0
    buffer_load_dwordx4 v130, s[20:23], s53 offen lds
    v_mfma_f32_16x16x32_bf16 v[56:59], v[100:103], v[84:87], v[56:59]
    ds_read_b64_tr_b16 v[120:121], v142 offset:0
    ds_read_b64_tr_b16 v[122:123], v142 offset:5120
    ds_read_b128 v[80:83], v143 offset:0
    s_add_u32 m0, m0, 0x400
    s_nop 0
    buffer_load_dwordx4 v131, s[20:23], s53 offen lds
    s_waitcnt lgkmcnt(10)
    v_mfma_f32_32x32x16_bf16 v[0:15], v[104:107], v[64:67], v[0:15]
    ds_read_b64_tr_b16 v[124:125], v142 offset:32
    ds_read_b64_tr_b16 v[126:127], v142 offset:5152
    s_add_u32 m0, m0, 0x400
    s_nop 0
    buffer_load_dwordx4 v132, s[20:23], s53 offen lds
    s_waitcnt lgkmcnt(10)
    v_mfma_f32_32x32x16_bf16 v[16:31], v[108:111], v[64:67], v[16:31]
    ds_read_b64_tr_b16 v[96:97], v142 offset:64
    ds_read_b64_tr_b16 v[98:99], v142 offset:5184
    s_add_u32 s52, s73, 1
    s_and_b32 s52, s52, 3
    s_mul_i32 s52, s52, 73728
    s_add_u32 s52, s52, 36864
    s_add_u32 m0, s66, s59
    s_nop 0
    buffer_load_dwordx4 v137, s[12:15], s52 offen sc1 lds
    s_waitcnt lgkmcnt(9)
    v_mfma_f32_32x32x16_bf16 v[0:15], v[112:115], v[68:71], v[0:15]
    ds_read_b64_tr_b16 v[100:101], v140 offset:10240
    ds_read_b64_tr_b16 v[102:103], v140 offset:12800
    ds_read_b128 v[72:75], v141 offset:9216
    s_add_u32 m0, m0, 0x1000
    s_add_u32 s52, s52, 0x1000
    buffer_load_dwordx4 v137, s[12:15], s52 offen sc1 lds
    s_waitcnt lgkmcnt(10)
    v_mfma_f32_32x32x16_bf16 v[16:31], v[116:119], v[68:71], v[16:31]
    ds_read_b64_tr_b16 v[104:105], v140 offset:10304
    ds_read_b64_tr_b16 v[106:107], v140 offset:12864
    s_add_u32 m0, m0, 0x1000
    s_add_u32 s52, s52, 0x1000
    buffer_load_dwordx4 v137, s[12:15], s52 offen sc1 lds
    s_waitcnt lgkmcnt(9)
    v_mfma_f32_16x16x32_bf16 v[48:51], v[120:123], v[80:83], v[48:51]
    ds_read_b64_tr_b16 v[108:109], v140 offset:15360
    ds_read_b64_tr_b16 v[110:111], v140 offset:17920
    ds_read_b128 v[76:79], v141 offset:13312
    s_add_u32 m0, m0, 0x1000
    s_add_u32 s52, s52, 0x1000
    buffer_load_dwordx4 v137, s[12:15], s52 offen sc1 lds
    s_waitcnt lgkmcnt(10)
    v_mfma_f32_16x16x32_bf16 v[52:55], v[124:127], v[80:83], v[52:55]
    ds_read_b64_tr_b16 v[112:113], v140 offset:15424
    ds_read_b64_tr_b16 v[114:115], v140 offset:17984
    s_add_u32 m0, m0, 0x1000
    s_add_u32 s52, s52, 0x1000
    s_max_u32 m0, m0, s60
    s_nop 0
    buffer_load_dwordx4 v137, s[12:15], s52 offen sc1 lds
    s_waitcnt lgkmcnt(10)
    v_mfma_f32_16x16x32_bf16 v[56:59], v[96:99], v[80:83], v[56:59]
    ds_read_b64_tr_b16 v[116:117], v142 offset:10240
    ds_read_b64_tr_b16 v[118:119], v142 offset:15360
    ds_read_b128 v[84:87], v143 offset:9216
    s_waitcnt lgkmcnt(10)
    v_mfma_f32_32x32x16_bf16 v[0:15], v[100:103], v[72:75], v[0:15]
    ds_read_b64_tr_b16 v[120:121], v142 offset:10272
    ds_read_b64_tr_b16 v[122:123], v142 offset:15392
    s_waitcnt lgkmcnt(10)
    v_mfma_f32_32x32x16_bf16 v[16:31], v[104:107], v[72:75], v[16:31]
    ds_read_b64_tr_b16 v[124:125], v142 offset:10304
    ds_read_b64_tr_b16 v[126:127], v142 offset:15424
    s_waitcnt lgkmcnt(9)
    v_mfma_f32_32x32x16_bf16 v[0:15], v[108:111], v[76:79], v[0:15]
    s_waitcnt lgkmcnt(7)
    v_mfma_f32_32x32x16_bf16 v[16:31], v[112:115], v[76:79], v[16:31]
    v_add_u32 v140, s64, v136
    v_add_u32 v141, s64, v137
    v_add_u32 v142, s64, v138
    v_add_u32 v143, s64, v139
    s_waitcnt vmcnt(15) lgkmcnt(0)
    s_barrier
    ds_read_b64_tr_b16 v[96:97], v140 offset:0
    ds_read_b64_tr_b16 v[98:99], v140 offset:2560
    ds_read_b128 v[64:67], v141 offset:0
    ds_read_b64_tr_b16 v[100:101], v140 offset:64
    ds_read_b64_tr_b16 v[102:103], v140 offset:2624
    v_mfma_f32_16x16x32_bf16 v[48:51], v[116:119], v[84:87], v[48:51]
    ds_read_b64_tr_b16 v[104:105], v140 offset:5120
    ds_read_b64_tr_b16 v[106:107], v140 offset:7680
    ds_read_b128 v[68:71], v141 offset:4096
    s_add_u32 s53, s40, 1
    s_and_b32 s53, s53, 3
    s_mul_i32 s53, s53, 294912
    s_add_u32 s53, s53, 221184
    s_add_u32 m0, s67, s61
    s_nop 0
    buffer_load_dwordx4 v128, s[20:23], s53 offen lds
    s_add_u32 m0, m0, 0x400
    s_nop 0
    buffer_load_dwordx4 v129, s[20:23], s53 offen lds
    v_mfma_f32_16x16x32_bf16 v[52:55], v[120:123], v[84:87], v[52:55]
    ds_read_b64_tr_b16 v[108:109], v140 offset:5184
    ds_read_b64_tr_b16 v[110:111], v140 offset:7744
    s_add_u32 m0, m0, 0x400
    s_nop 0
    buffer_load_dwordx4 v130, s[20:23], s53 offen lds
    v_mfma_f32_16x16x32_bf16 v[56:59], v[124:127], v[84:87], v[56:59]
    ds_read_b64_tr_b16 v[112:113], v142 offset:0
    ds_read_b64_tr_b16 v[114:115], v142 offset:5120
    ds_read_b128 v[80:83], v143 offset:0
    s_add_u32 m0, m0, 0x400
    s_nop 0
    buffer_load_dwordx4 v131, s[20:23], s53 offen lds
    s_waitcnt lgkmcnt(10)
    v_mfma_f32_32x32x16_bf16 v[0:15], v[96:99], v[64:67], v[0:15]
    ds_read_b64_tr_b16 v[116:117], v142 offset:32
    ds_read_b64_tr_b16 v[118:119], v142 offset:5152
    s_add_u32 m0, m0, 0x400
    s_nop 0
    buffer_load_dwordx4 v132, s[20:23], s53 offen lds
    s_waitcnt lgkmcnt(10)
    v_mfma_f32_32x32x16_bf16 v[16:31], v[100:103], v[64:67], v[16:31]
    ds_read_b64_tr_b16 v[120:121], v142 offset:64
    ds_read_b64_tr_b16 v[122:123], v142 offset:5184
    s_add_u32 s52, s73, 1
    s_and_b32 s52, s52, 3
    s_mul_i32 s52, s52, 73728
    s_add_u32 s52, s52, 55296
    s_add_u32 m0, s67, s59
    s_nop 0
    buffer_load_dwordx4 v137, s[12:15], s52 offen sc1 lds
    s_waitcnt lgkmcnt(9)
    v_mfma_f32_32x32x16_bf16 v[0:15], v[104:107], v[68:71], v[0:15]
    ds_read_b64_tr_b16 v[124:125], v140 offset:10240
    ds_read_b64_tr_b16 v[126:127], v140 offset:12800
    ds_read_b128 v[72:75], v141 offset:9216
    s_add_u32 m0, m0, 0x1000
    s_add_u32 s52, s52, 0x1000
    buffer_load_dwordx4 v137, s[12:15], s52 offen sc1 lds
    s_waitcnt lgkmcnt(10)
    v_mfma_f32_32x32x16_bf16 v[16:31], v[108:111], v[68:71], v[16:31]
    ds_read_b64_tr_b16 v[96:97], v140 offset:10304
    ds_read_b64_tr_b16 v[98:99], v140 offset:12864
    s_add_u32 m0, m0, 0x1000
    s_add_u32 s52, s52, 0x1000
    buffer_load_dwordx4 v137, s[12:15], s52 offen sc1 lds
    s_waitcnt lgkmcnt(9)
    v_mfma_f32_16x16x32_bf16 v[48:51], v[112:115], v[80:83], v[48:51]
    ds_read_b64_tr_b16 v[100:101], v140 offset:15360
    ds_read_b64_tr_b16 v[102:103], v140 offset:17920
    ds_read_b128 v[76:79], v141 offset:13312
    s_add_u32 m0, m0, 0x1000
    s_add_u32 s52, s52, 0x1000
    buffer_load_dwordx4 v137, s[12:15], s52 offen sc1 lds
    s_waitcnt lgkmcnt(10)
    v_mfma_f32_16x16x32_bf16 v[52:55], v[116:119], v[80:83], v[52:55]
    ds_read_b64_tr_b16 v[104:105], v140 offset:15424
    ds_read_b64_tr_b16 v[106:107], v140 offset:17984
    s_add_u32 m0, m0, 0x1000
    s_add_u32 s52, s52, 0x1000
    s_max_u32 m0, m0, s60
    s_nop 0
    buffer_load_dwordx4 v137, s[12:15], s52 offen sc1 lds
    s_waitcnt lgkmcnt(10)
    v_mfma_f32_16x16x32_bf16 v[56:59], v[120:123], v[80:83], v[56:59]
    ds_read_b64_tr_b16 v[108:109], v142 offset:10240
    ds_read_b64_tr_b16 v[110:111], v142 offset:15360
    ds_read_b128 v[84:87], v143 offset:9216
    s_waitcnt lgkmcnt(10)
    v_mfma_f32_32x32x16_bf16 v[0:15], v[124:127], v[72:75], v[0:15]
    ds_read_b64_tr_b16 v[112:113], v142 offset:10272
    ds_read_b64_tr_b16 v[114:115], v142 offset:15392
    s_waitcnt lgkmcnt(10)
    v_mfma_f32_32x32x16_bf16 v[16:31], v[96:99], v[72:75], v[16:31]
    ds_read_b64_tr_b16 v[116:117], v142 offset:10304
    ds_read_b64_tr_b16 v[118:119], v142 offset:15424
    s_waitcnt lgkmcnt(9)
    v_mfma_f32_32x32x16_bf16 v[0:15], v[100:103], v[76:79], v[0:15]
    s_waitcnt lgkmcnt(7)
    v_mfma_f32_32x32x16_bf16 v[16:31], v[104:107], v[76:79], v[16:31]
    v_add_u32 v140, s65, v136
    v_add_u32 v141, s65, v137
    v_add_u32 v142, s65, v138
    v_add_u32 v143, s65, v139
    s_waitcnt vmcnt(20) lgkmcnt(0)
    s_barrier
    ds_read_b64_tr_b16 v[120:121], v140 offset:0
    ds_read_b64_tr_b16 v[122:123], v140 offset:2560
    ds_read_b128 v[64:67], v141 offset:0
    ds_read_b64_tr_b16 v[124:125], v140 offset:64
    ds_read_b64_tr_b16 v[126:127], v140 offset:2624
    v_mfma_f32_16x16x32_bf16 v[48:51], v[108:111], v[84:87], v[48:51]
    ds_read_b64_tr_b16 v[96:97], v140 offset:5120
    ds_read_b64_tr_b16 v[98:99], v140 offset:7680
    ds_read_b128 v[68:71], v141 offset:4096
    s_add_u32 s53, s40, 2
    s_and_b32 s53, s53, 3
    s_mul_i32 s53, s53, 294912
    s_add_u32 s53, s53, 0
    s_add_u32 m0, s64, s61
    s_nop 0
    buffer_load_dwordx4 v128, s[20:23], s53 offen lds
    s_add_u32 m0, m0, 0x400
    s_nop 0
    buffer_load_dwordx4 v129, s[20:23], s53 offen lds
    v_mfma_f32_16x16x32_bf16 v[52:55], v[112:115], v[84:87], v[52:55]
    ds_read_b64_tr_b16 v[100:101], v140 offset:5184
    ds_read_b64_tr_b16 v[102:103], v140 offset:7744
    s_add_u32 m0, m0, 0x400
    s_nop 0
    buffer_load_dwordx4 v130, s[20:23], s53 offen lds
    v_mfma_f32_16x16x32_bf16 v[56:59], v[116:119], v[84:87], v[56:59]
    ds_read_b64_tr_b16 v[104:105], v142 offset:0
    ds_read_b64_tr_b16 v[106:107], v142 offset:5120
    ds_read_b128 v[80:83], v143 offset:0
    s_add_u32 m0, m0, 0x400
    s_nop 0
    buffer_load_dwordx4 v131, s[20:23], s53 offen lds
    s_waitcnt lgkmcnt(10)
    v_mfma_f32_32x32x16_bf16 v[0:15], v[120:123], v[64:67], v[0:15]
    ds_read_b64_tr_b16 v[108:109], v142 offset:32
    ds_read_b64_tr_b16 v[110:111], v142 offset:5152
    s_add_u32 m0, m0, 0x400
    s_nop 0
    buffer_load_dwordx4 v132, s[20:23], s53 offen lds
    s_waitcnt lgkmcnt(10)
    v_mfma_f32_32x32x16_bf16 v[16:31], v[124:127], v[64:67], v[16:31]
    ds_read_b64_tr_b16 v[112:113], v142 offset:64
    ds_read_b64_tr_b16 v[114:115], v142 offset:5184
    s_add_u32 s52, s73, 2
    s_and_b32 s52, s52, 3
    s_mul_i32 s52, s52, 73728
    s_add_u32 s52, s52, 0
    s_add_u32 m0, s64, s59
    s_nop 0
    buffer_load_dwordx4 v137, s[12:15], s52 offen sc1 lds
    s_waitcnt lgkmcnt(9)
    v_mfma_f32_32x32x16_bf16 v[0:15], v[96:99], v[68:71], v[0:15]
    ds_read_b64_tr_b16 v[116:117], v140 offset:10240
    ds_read_b64_tr_b16 v[118:119], v140 offset:12800
    ds_read_b128 v[72:75], v141 offset:9216
    s_add_u32 m0, m0, 0x1000
    s_add_u32 s52, s52, 0x1000
    buffer_load_dwordx4 v137, s[12:15], s52 offen sc1 lds
    s_waitcnt lgkmcnt(10)
    v_mfma_f32_32x32x16_bf16 v[16:31], v[100:103], v[68:71], v[16:31]
    ds_read_b64_tr_b16 v[120:121], v140 offset:10304
    ds_read_b64_tr_b16 v[122:123], v140 offset:12864
    s_add_u32 m0, m0, 0x1000
    s_add_u32 s52, s52, 0x1000
    buffer_load_dwordx4 v137, s[12:15], s52 offen sc1 lds
    s_waitcnt lgkmcnt(9)
    v_mfma_f32_16x16x32_bf16 v[48:51], v[104:107], v[80:83], v[48:51]
    ds_read_b64_tr_b16 v[124:125], v140 offset:15360
    ds_read_b64_tr_b16 v[126:127], v140 offset:17920
    ds_read_b128 v[76:79], v141 offset:13312
    s_add_u32 m0, m0, 0x1000
    s_add_u32 s52, s52, 0x1000
    buffer_load_dwordx4 v137, s[12:15], s52 offen sc1 lds
    s_waitcnt lgkmcnt(10)
    v_mfma_f32_16x16x32_bf16 v[52:55], v[108:111], v[80:83], v[52:55]
    ds_read_b64_tr_b16 v[96:97], v140 offset:15424
    ds_read_b64_tr_b16 v[98:99], v140 offset:17984
    s_add_u32 m0, m0, 0x1000
    s_add_u32 s52, s52, 0x1000
    s_max_u32 m0, m0, s60
    s_nop 0
    buffer_load_dwordx4 v137, s[12:15], s52 offen sc1 lds
    s_waitcnt lgkmcnt(10)
    v_mfma_f32_16x16x32_bf16 v[56:59], v[112:115], v[80:83], v[56:59]
    ds_read_b64_tr_b16 v[100:101], v142 offset:10240
    ds_read_b64_tr_b16 v[102:103], v142 offset:15360
    ds_read_b128 v[84:87], v143 offset:9216
    s_waitcnt lgkmcnt(10)
    v_mfma_f32_32x32x16_bf16 v[0:15], v[116:119], v[72:75], v[0:15]
    ds_read_b64_tr_b16 v[104:105], v142 offset:10272
    ds_read_b64_tr_b16 v[106:107], v142 offset:15392
    s_waitcnt lgkmcnt(10)
    v_mfma_f32_32x32x16_bf16 v[16:31], v[120:123], v[72:75], v[16:31]
    ds_read_b64_tr_b16 v[108:109], v142 offset:10304
    ds_read_b64_tr_b16 v[110:111], v142 offset:15424
    s_waitcnt lgkmcnt(9)
    v_mfma_f32_32x32x16_bf16 v[0:15], v[124:127], v[76:79], v[0:15]
    s_waitcnt lgkmcnt(7)
    v_mfma_f32_32x32x16_bf16 v[16:31], v[96:99], v[76:79], v[16:31]
    v_add_u32 v140, s66, v136
    v_add_u32 v141, s66, v137
    v_add_u32 v142, s66, v138
    v_add_u32 v143, s66, v139
    s_waitcnt vmcnt(20) lgkmcnt(0)
    s_barrier
    ds_read_b64_tr_b16 v[112:113], v140 offset:0
    ds_read_b64_tr_b16 v[114:115], v140 offset:2560
    ds_read_b128 v[64:67], v141 offset:0
    ds_read_b64_tr_b16 v[116:117], v140 offset:64
    ds_read_b64_tr_b16 v[118:119], v140 offset:2624
    v_mfma_f32_16x16x32_bf16 v[48:51], v[100:103], v[84:87], v[48:51]
    ds_read_b64_tr_b16 v[120:121], v140 offset:5120
    ds_read_b64_tr_b16 v[122:123], v140 offset:7680
    ds_read_b128 v[68:71], v141 offset:4096
    s_add_u32 s53, s40, 2
    s_and_b32 s53, s53, 3
    s_mul_i32 s53, s53, 294912
    s_add_u32 s53, s53, 73728
    s_add_u32 m0, s65, s61
    s_nop 0
    buffer_load_dwordx4 v128, s[20:23], s53 offen lds
    s_add_u32 m0, m0, 0x400
    s_nop 0
    buffer_load_dwordx4 v129, s[20:23], s53 offen lds
    v_mfma_f32_16x16x32_bf16 v[52:55], v[104:107], v[84:87], v[52:55]
    ds_read_b64_tr_b16 v[124:125], v140 offset:5184
    ds_read_b64_tr_b16 v[126:127], v140 offset:7744
    s_add_u32 m0, m0, 0x400
    s_nop 0
    buffer_load_dwordx4 v130, s[20:23], s53 offen lds
    v_mfma_f32_16x16x32_bf16 v[56:59], v[108:111], v[84:87], v[56:59]
    ds_read_b64_tr_b16 v[96:97], v142 offset:0
    ds_read_b64_tr_b16 v[98:99], v142 offset:5120
    ds_read_b128 v[80:83], v143 offset:0
    s_add_u32 m0, m0, 0x400
    s_nop 0
    buffer_load_dwordx4 v131, s[20:23], s53 offen lds
    s_waitcnt lgkmcnt(10)
    v_mfma_f32_32x32x16_bf16 v[0:15], v[112:115], v[64:67], v[0:15]
    ds_read_b64_tr_b16 v[100:101], v142 offset:32
    ds_read_b64_tr_b16 v[102:103], v142 offset:5152
    s_add_u32 m0, m0, 0x400
    s_nop 0
    buffer_load_dwordx4 v132, s[20:23], s53 offen lds
    s_waitcnt lgkmcnt(10)
    v_mfma_f32_32x32x16_bf16 v[16:31], v[116:119], v[64:67], v[16:31]
    ds_read_b64_tr_b16 v[104:105], v142 offset:64
    ds_read_b64_tr_b16 v[106:107], v142 offset:5184
    s_add_u32 s52, s73, 2
    s_and_b32 s52, s52, 3
    s_mul_i32 s52, s52, 73728
    s_add_u32 s52, s52, 18432
    s_add_u32 m0, s65, s59
    s_nop 0
    buffer_load_dwordx4 v137, s[12:15], s52 offen sc1 lds
    s_waitcnt lgkmcnt(9)
    v_mfma_f32_32x32x16_bf16 v[0:15], v[120:123], v[68:71], v[0:15]
    ds_read_b64_tr_b16 v[108:109], v140 offset:10240
    ds_read_b64_tr_b16 v[110:111], v140 offset:12800
    ds_read_b128 v[72:75], v141 offset:9216
    s_add_u32 m0, m0, 0x1000
    s_add_u32 s52, s52, 0x1000
    buffer_load_dwordx4 v137, s[12:15], s52 offen sc1 lds
    s_waitcnt lgkmcnt(10)
    v_mfma_f32_32x32x16_bf16 v[16:31], v[124:127], v[68:71], v[16:31]
    ds_read_b64_tr_b16 v[112:113], v140 offset:10304
    ds_read_b64_tr_b16 v[114:115], v140 offset:12864
    s_add_u32 m0, m0, 0x1000
    s_add_u32 s52, s52, 0x1000
    buffer_load_dwordx4 v137, s[12:15], s52 offen sc1 lds
    s_waitcnt lgkmcnt(9)
    v_mfma_f32_16x16x32_bf16 v[48:51], v[96:99], v[80:83], v[48:51]
    ds_read_b64_tr_b16 v[116:117], v140 offset:15360
    ds_read_b64_tr_b16 v[118:119], v140 offset:17920
    ds_read_b128 v[76:79], v141 offset:13312
    s_add_u32 m0, m0, 0x1000
    s_add_u32 s52, s52, 0x1000
    buffer_load_dwordx4 v137, s[12:15], s52 offen sc1 lds
    s_waitcnt lgkmcnt(10)
    v_mfma_f32_16x16x32_bf16 v[52:55], v[100:103], v[80:83], v[52:55]
    ds_read_b64_tr_b16 v[120:121], v140 offset:15424
    ds_read_b64_tr_b16 v[122:123], v140 offset:17984
    s_add_u32 m0, m0, 0x1000
    s_add_u32 s52, s52, 0x1000
    s_max_u32 m0, m0, s60
    s_nop 0
    buffer_load_dwordx4 v137, s[12:15], s52 offen sc1 lds
    s_waitcnt lgkmcnt(10)
    v_mfma_f32_16x16x32_bf16 v[56:59], v[104:107], v[80:83], v[56:59]
    ds_read_b64_tr_b16 v[124:125], v142 offset:10240
    ds_read_b64_tr_b16 v[126:127], v142 offset:15360
    ds_read_b128 v[84:87], v143 offset:9216
    s_waitcnt lgkmcnt(10)
    v_mfma_f32_32x32x16_bf16 v[0:15], v[108:111], v[72:75], v[0:15]
    ds_read_b64_tr_b16 v[96:97], v142 offset:10272
    ds_read_b64_tr_b16 v[98:99], v142 offset:15392
    s_waitcnt lgkmcnt(10)
    v_mfma_f32_32x32x16_bf16 v[16:31], v[112:115], v[72:75], v[16:31]
    ds_read_b64_tr_b16 v[100:101], v142 offset:10304
    ds_read_b64_tr_b16 v[102:103], v142 offset:15424
    s_waitcnt lgkmcnt(9)
    v_mfma_f32_32x32x16_bf16 v[0:15], v[116:119], v[76:79], v[0:15]
    s_waitcnt lgkmcnt(7)
    v_mfma_f32_32x32x16_bf16 v[16:31], v[120:123], v[76:79], v[16:31]
    v_add_u32 v140, s67, v136
    v_add_u32 v141, s67, v137
    v_add_u32 v142, s67, v138
    v_add_u32 v143, s67, v139
    s_waitcnt vmcnt(20) lgkmcnt(0)
    s_barrier
    ds_read_b64_tr_b16 v[104:105], v140 offset:0
    ds_read_b64_tr_b16 v[106:107], v140 offset:2560
    ds_read_b128 v[64:67], v141 offset:0
    ds_read_b64_tr_b16 v[108:109], v140 offset:64
    ds_read_b64_tr_b16 v[110:111], v140 offset:2624
    v_mfma_f32_16x16x32_bf16 v[48:51], v[124:127], v[84:87], v[48:51]
    ds_read_b64_tr_b16 v[112:113], v140 offset:5120
    ds_read_b64_tr_b16 v[114:115], v140 offset:7680
    ds_read_b128 v[68:71], v141 offset:4096
    s_add_u32 s53, s40, 2
    s_and_b32 s53, s53, 3
    s_mul_i32 s53, s53, 294912
    s_add_u32 s53, s53, 147456
    s_add_u32 m0, s66, s61
    s_nop 0
    buffer_load_dwordx4 v128, s[20:23], s53 offen lds
    s_add_u32 m0, m0, 0x400
    s_nop 0
    buffer_load_dwordx4 v129, s[20:23], s53 offen lds
    v_mfma_f32_16x16x32_bf16 v[52:55], v[96:99], v[84:87], v[52:55]
    ds_read_b64_tr_b16 v[116:117], v140 offset:5184
    ds_read_b64_tr_b16 v[118:119], v140 offset:7744
    s_add_u32 m0, m0, 0x400
    s_nop 0
    buffer_load_dwordx4 v130, s[20:23], s53 offen lds
    v_mfma_f32_16x16x32_bf16 v[56:59], v[100:103], v[84:87], v[56:59]
    ds_read_b64_tr_b16 v[120:121], v142 offset:0
    ds_read_b64_tr_b16 v[122:123], v142 offset:5120
    ds_read_b128 v[80:83], v143 offset:0
    s_add_u32 m0, m0, 0x400
    s_nop 0
    buffer_load_dwordx4 v131, s[20:23], s53 offen lds
    s_waitcnt lgkmcnt(10)
    v_mfma_f32_32x32x16_bf16 v[0:15], v[104:107], v[64:67], v[0:15]
    ds_read_b64_tr_b16 v[124:125], v142 offset:32
    ds_read_b64_tr_b16 v[126:127], v142 offset:5152
    s_add_u32 m0, m0, 0x400
    s_nop 0
    buffer_load_dwordx4 v132, s[20:23], s53 offen lds
    s_waitcnt lgkmcnt(10)
    v_mfma_f32_32x32x16_bf16 v[16:31], v[108:111], v[64:67], v[16:31]
    ds_read_b64_tr_b16 v[96:97], v142 offset:64
    ds_read_b64_tr_b16 v[98:99], v142 offset:5184
    s_add_u32 s52, s73, 2
    s_and_b32 s52, s52, 3
    s_mul_i32 s52, s52, 73728
    s_add_u32 s52, s52, 36864
    s_add_u32 m0, s66, s59
    s_nop 0
    buffer_load_dwordx4 v137, s[12:15], s52 offen sc1 lds
    s_waitcnt lgkmcnt(9)
    v_mfma_f32_32x32x16_bf16 v[0:15], v[112:115], v[68:71], v[0:15]
    ds_read_b64_tr_b16 v[100:101], v140 offset:10240
    ds_read_b64_tr_b16 v[102:103], v140 offset:12800
    ds_read_b128 v[72:75], v141 offset:9216
    s_add_u32 m0, m0, 0x1000
    s_add_u32 s52, s52, 0x1000
    buffer_load_dwordx4 v137, s[12:15], s52 offen sc1 lds
    s_waitcnt lgkmcnt(10)
    v_mfma_f32_32x32x16_bf16 v[16:31], v[116:119], v[68:71], v[16:31]
    ds_read_b64_tr_b16 v[104:105], v140 offset:10304
    ds_read_b64_tr_b16 v[106:107], v140 offset:12864
    s_add_u32 m0, m0, 0x1000
    s_add_u32 s52, s52, 0x1000
    buffer_load_dwordx4 v137, s[12:15], s52 offen sc1 lds
    s_waitcnt lgkmcnt(9)
    v_mfma_f32_16x16x32_bf16 v[48:51], v[120:123], v[80:83], v[48:51]
    ds_read_b64_tr_b16 v[108:109], v140 offset:15360
    ds_read_b64_tr_b16 v[110:111], v140 offset:17920
    ds_read_b128 v[76:79], v141 offset:13312
    s_add_u32 m0, m0, 0x1000
    s_add_u32 s52, s52, 0x1000
    buffer_load_dwordx4 v137, s[12:15], s52 offen sc1 lds
    s_waitcnt lgkmcnt(10)
    v_mfma_f32_16x16x32_bf16 v[52:55], v[124:127], v[80:83], v[52:55]
    ds_read_b64_tr_b16 v[112:113], v140 offset:15424
    ds_read_b64_tr_b16 v[114:115], v140 offset:17984
    s_add_u32 m0, m0, 0x1000
    s_add_u32 s52, s52, 0x1000
    s_max_u32 m0, m0, s60
    s_nop 0
    buffer_load_dwordx4 v137, s[12:15], s52 offen sc1 lds
    s_waitcnt lgkmcnt(10)
    v_mfma_f32_16x16x32_bf16 v[56:59], v[96:99], v[80:83], v[56:59]
    ds_read_b64_tr_b16 v[116:117], v142 offset:10240
    ds_read_b64_tr_b16 v[118:119], v142 offset:15360
    ds_read_b128 v[84:87], v143 offset:9216
    s_waitcnt lgkmcnt(10)
    v_mfma_f32_32x32x16_bf16 v[0:15], v[100:103], v[72:75], v[0:15]
    ds_read_b64_tr_b16 v[120:121], v142 offset:10272
    ds_read_b64_tr_b16 v[122:123], v142 offset:15392
    s_waitcnt lgkmcnt(10)
    v_mfma_f32_32x32x16_bf16 v[16:31], v[104:107], v[72:75], v[16:31]
    ds_read_b64_tr_b16 v[124:125], v142 offset:10304
    ds_read_b64_tr_b16 v[126:127], v142 offset:15424
    s_waitcnt lgkmcnt(9)
    v_mfma_f32_32x32x16_bf16 v[0:15], v[108:111], v[76:79], v[0:15]
    s_waitcnt lgkmcnt(7)
    v_mfma_f32_32x32x16_bf16 v[16:31], v[112:115], v[76:79], v[16:31]
    v_add_u32 v140, s64, v136
    v_add_u32 v141, s64, v137
    v_add_u32 v142, s64, v138
    v_add_u32 v143, s64, v139
    s_waitcnt vmcnt(20) lgkmcnt(0)
    s_barrier
    ds_read_b64_tr_b16 v[96:97], v140 offset:0
    ds_read_b64_tr_b16 v[98:99], v140 offset:2560
    ds_read_b128 v[64:67], v141 offset:0
    ds_read_b64_tr_b16 v[100:101], v140 offset:64
    ds_read_b64_tr_b16 v[102:103], v140 offset:2624
    v_mfma_f32_16x16x32_bf16 v[48:51], v[116:119], v[84:87], v[48:51]
    ds_read_b64_tr_b16 v[104:105], v140 offset:5120
    ds_read_b64_tr_b16 v[106:107], v140 offset:7680
    ds_read_b128 v[68:71], v141 offset:4096
    s_add_u32 s53, s40, 2
    s_and_b32 s53, s53, 3
    s_mul_i32 s53, s53, 294912
    s_add_u32 s53, s53, 221184
    s_add_u32 m0, s67, s61
    s_nop 0
    buffer_load_dwordx4 v128, s[20:23], s53 offen lds
    s_add_u32 m0, m0, 0x400
    s_nop 0
    buffer_load_dwordx4 v129, s[20:23], s53 offen lds
    v_mfma_f32_16x16x32_bf16 v[52:55], v[120:123], v[84:87], v[52:55]
    ds_read_b64_tr_b16 v[108:109], v140 offset:5184
    ds_read_b64_tr_b16 v[110:111], v140 offset:7744
    s_add_u32 m0, m0, 0x400
    s_nop 0
    buffer_load_dwordx4 v130, s[20:23], s53 offen lds
    v_mfma_f32_16x16x32_bf16 v[56:59], v[124:127], v[84:87], v[56:59]
    ds_read_b64_tr_b16 v[112:113], v142 offset:0
    ds_read_b64_tr_b16 v[114:115], v142 offset:5120
    ds_read_b128 v[80:83], v143 offset:0
    s_add_u32 m0, m0, 0x400
    s_nop 0
    buffer_load_dwordx4 v131, s[20:23], s53 offen lds
    s_waitcnt lgkmcnt(10)
    v_mfma_f32_32x32x16_bf16 v[0:15], v[96:99], v[64:67], v[0:15]
    ds_read_b64_tr_b16 v[116:117], v142 offset:32
    ds_read_b64_tr_b16 v[118:119], v142 offset:5152
    s_add_u32 m0, m0, 0x400
    s_nop 0
    buffer_load_dwordx4 v132, s[20:23], s53 offen lds
    s_waitcnt lgkmcnt(10)
    v_mfma_f32_32x32x16_bf16 v[16:31], v[100:103], v[64:67], v[16:31]
    ds_read_b64_tr_b16 v[120:121], v142 offset:64
    ds_read_b64_tr_b16 v[122:123], v142 offset:5184
    s_add_u32 s52, s73, 2
    s_and_b32 s52, s52, 3
    s_mul_i32 s52, s52, 73728
    s_add_u32 s52, s52, 55296
    s_add_u32 m0, s67, s59
    s_nop 0
    buffer_load_dwordx4 v137, s[12:15], s52 offen sc1 lds
    s_waitcnt lgkmcnt(9)
    v_mfma_f32_32x32x16_bf16 v[0:15], v[104:107], v[68:71], v[0:15]
    ds_read_b64_tr_b16 v[124:125], v140 offset:10240
    ds_read_b64_tr_b16 v[126:127], v140 offset:12800
    ds_read_b128 v[72:75], v141 offset:9216
    s_add_u32 m0, m0, 0x1000
    s_add_u32 s52, s52, 0x1000
    buffer_load_dwordx4 v137, s[12:15], s52 offen sc1 lds
    s_waitcnt lgkmcnt(10)
    v_mfma_f32_32x32x16_bf16 v[16:31], v[108:111], v[68:71], v[16:31]
    ds_read_b64_tr_b16 v[96:97], v140 offset:10304
    ds_read_b64_tr_b16 v[98:99], v140 offset:12864
    s_add_u32 m0, m0, 0x1000
    s_add_u32 s52, s52, 0x1000
    buffer_load_dwordx4 v137, s[12:15], s52 offen sc1 lds
    s_waitcnt lgkmcnt(9)
    v_mfma_f32_16x16x32_bf16 v[48:51], v[112:115], v[80:83], v[48:51]
    ds_read_b64_tr_b16 v[100:101], v140 offset:15360
    ds_read_b64_tr_b16 v[102:103], v140 offset:17920
    ds_read_b128 v[76:79], v141 offset:13312
    s_add_u32 m0, m0, 0x1000
    s_add_u32 s52, s52, 0x1000
    buffer_load_dwordx4 v137, s[12:15], s52 offen sc1 lds
    s_waitcnt lgkmcnt(10)
    v_mfma_f32_16x16x32_bf16 v[52:55], v[116:119], v[80:83], v[52:55]
    ds_read_b64_tr_b16 v[104:105], v140 offset:15424
    ds_read_b64_tr_b16 v[106:107], v140 offset:17984
    s_add_u32 m0, m0, 0x1000
    s_add_u32 s52, s52, 0x1000
    s_max_u32 m0, m0, s60
    s_nop 0
    buffer_load_dwordx4 v137, s[12:15], s52 offen sc1 lds
    s_waitcnt lgkmcnt(10)
    v_mfma_f32_16x16x32_bf16 v[56:59], v[120:123], v[80:83], v[56:59]
    ds_read_b64_tr_b16 v[108:109], v142 offset:10240
    ds_read_b64_tr_b16 v[110:111], v142 offset:15360
    ds_read_b128 v[84:87], v143 offset:9216
    s_waitcnt lgkmcnt(10)
    v_mfma_f32_32x32x16_bf16 v[0:15], v[124:127], v[72:75], v[0:15]
    ds_read_b64_tr_b16 v[112:113], v142 offset:10272
    ds_read_b64_tr_b16 v[114:115], v142 offset:15392
    s_waitcnt lgkmcnt(10)
    v_mfma_f32_32x32x16_bf16 v[16:31], v[96:99], v[72:75], v[16:31]
    ds_read_b64_tr_b16 v[116:117], v142 offset:10304
    ds_read_b64_tr_b16 v[118:119], v142 offset:15424
    s_waitcnt lgkmcnt(9)
    v_mfma_f32_32x32x16_bf16 v[0:15], v[100:103], v[76:79], v[0:15]
    s_waitcnt lgkmcnt(7)
    v_mfma_f32_32x32x16_bf16 v[16:31], v[104:107], v[76:79], v[16:31]
    v_add_u32 v140, s65, v136
    v_add_u32 v141, s65, v137
    v_add_u32 v142, s65, v138
    v_add_u32 v143, s65, v139
    s_waitcnt vmcnt(20) lgkmcnt(0)
    s_barrier
    ds_read_b64_tr_b16 v[120:121], v140 offset:0
    ds_read_b64_tr_b16 v[122:123], v140 offset:2560
    ds_read_b128 v[64:67], v141 offset:0
    ds_read_b64_tr_b16 v[124:125], v140 offset:64
    ds_read_b64_tr_b16 v[126:127], v140 offset:2624
    v_mfma_f32_16x16x32_bf16 v[48:51], v[108:111], v[84:87], v[48:51]
    ds_read_b64_tr_b16 v[96:97], v140 offset:5120
    ds_read_b64_tr_b16 v[98:99], v140 offset:7680
    ds_read_b128 v[68:71], v141 offset:4096
    s_add_u32 s53, s40, 3
    s_and_b32 s53, s53, 3
    s_mul_i32 s53, s53, 294912
    s_add_u32 s53, s53, 0
    s_add_u32 m0, s64, s61
    s_nop 0
    buffer_load_dwordx4 v128, s[20:23], s53 offen lds
    s_add_u32 m0, m0, 0x400
    s_nop 0
    buffer_load_dwordx4 v129, s[20:23], s53 offen lds
    v_mfma_f32_16x16x32_bf16 v[52:55], v[112:115], v[84:87], v[52:55]
    ds_read_b64_tr_b16 v[100:101], v140 offset:5184
    ds_read_b64_tr_b16 v[102:103], v140 offset:7744
    s_add_u32 m0, m0, 0x400
    s_nop 0
    buffer_load_dwordx4 v130, s[20:23], s53 offen lds
    v_mfma_f32_16x16x32_bf16 v[56:59], v[116:119], v[84:87], v[56:59]
    ds_read_b64_tr_b16 v[104:105], v142 offset:0
    ds_read_b64_tr_b16 v[106:107], v142 offset:5120
    ds_read_b128 v[80:83], v143 offset:0
    s_add_u32 m0, m0, 0x400
    s_nop 0
    buffer_load_dwordx4 v131, s[20:23], s53 offen lds
    s_waitcnt lgkmcnt(10)
    v_mfma_f32_32x32x16_bf16 v[0:15], v[120:123], v[64:67], v[0:15]
    ds_read_b64_tr_b16 v[108:109], v142 offset:32
    ds_read_b64_tr_b16 v[110:111], v142 offset:5152
    s_add_u32 m0, m0, 0x400
    s_nop 0
    buffer_load_dwordx4 v132, s[20:23], s53 offen lds
    s_waitcnt lgkmcnt(10)
    v_mfma_f32_32x32x16_bf16 v[16:31], v[124:127], v[64:67], v[16:31]
    ds_read_b64_tr_b16 v[112:113], v142 offset:64
    ds_read_b64_tr_b16 v[114:115], v142 offset:5184
    s_add_u32 s52, s73, 3
    s_and_b32 s52, s52, 3
    s_mul_i32 s52, s52, 73728
    s_add_u32 s52, s52, 0
    s_add_u32 m0, s64, s59
    s_nop 0
    buffer_load_dwordx4 v137, s[12:15], s52 offen sc1 lds
    s_waitcnt lgkmcnt(9)
    v_mfma_f32_32x32x16_bf16 v[0:15], v[96:99], v[68:71], v[0:15]
    ds_read_b64_tr_b16 v[116:117], v140 offset:10240
    ds_read_b64_tr_b16 v[118:119], v140 offset:12800
    ds_read_b128 v[72:75], v141 offset:9216
    s_add_u32 m0, m0, 0x1000
    s_add_u32 s52, s52, 0x1000
    buffer_load_dwordx4 v137, s[12:15], s52 offen sc1 lds
    s_waitcnt lgkmcnt(10)
    v_mfma_f32_32x32x16_bf16 v[16:31], v[100:103], v[68:71], v[16:31]
    ds_read_b64_tr_b16 v[120:121], v140 offset:10304
    ds_read_b64_tr_b16 v[122:123], v140 offset:12864
    s_add_u32 m0, m0, 0x1000
    s_add_u32 s52, s52, 0x1000
    buffer_load_dwordx4 v137, s[12:15], s52 offen sc1 lds
    s_waitcnt lgkmcnt(9)
    v_mfma_f32_16x16x32_bf16 v[48:51], v[104:107], v[80:83], v[48:51]
    ds_read_b64_tr_b16 v[124:125], v140 offset:15360
    ds_read_b64_tr_b16 v[126:127], v140 offset:17920
    ds_read_b128 v[76:79], v141 offset:13312
    s_add_u32 m0, m0, 0x1000
    s_add_u32 s52, s52, 0x1000
    buffer_load_dwordx4 v137, s[12:15], s52 offen sc1 lds
    s_waitcnt lgkmcnt(10)
    v_mfma_f32_16x16x32_bf16 v[52:55], v[108:111], v[80:83], v[52:55]
    ds_read_b64_tr_b16 v[96:97], v140 offset:15424
    ds_read_b64_tr_b16 v[98:99], v140 offset:17984
    s_add_u32 m0, m0, 0x1000
    s_add_u32 s52, s52, 0x1000
    s_max_u32 m0, m0, s60
    s_nop 0
    buffer_load_dwordx4 v137, s[12:15], s52 offen sc1 lds
    s_waitcnt lgkmcnt(10)
    v_mfma_f32_16x16x32_bf16 v[56:59], v[112:115], v[80:83], v[56:59]
    ds_read_b64_tr_b16 v[100:101], v142 offset:10240
    ds_read_b64_tr_b16 v[102:103], v142 offset:15360
    ds_read_b128 v[84:87], v143 offset:9216
    s_waitcnt lgkmcnt(10)
    v_mfma_f32_32x32x16_bf16 v[0:15], v[116:119], v[72:75], v[0:15]
    ds_read_b64_tr_b16 v[104:105], v142 offset:10272
    ds_read_b64_tr_b16 v[106:107], v142 offset:15392
    s_waitcnt lgkmcnt(10)
    v_mfma_f32_32x32x16_bf16 v[16:31], v[120:123], v[72:75], v[16:31]
    ds_read_b64_tr_b16 v[108:109], v142 offset:10304
    ds_read_b64_tr_b16 v[110:111], v142 offset:15424
    s_waitcnt lgkmcnt(9)
    v_mfma_f32_32x32x16_bf16 v[0:15], v[124:127], v[76:79], v[0:15]
    s_waitcnt lgkmcnt(7)
    v_mfma_f32_32x32x16_bf16 v[16:31], v[96:99], v[76:79], v[16:31]
    v_add_u32 v140, s66, v136
    v_add_u32 v141, s66, v137
    v_add_u32 v142, s66, v138
    v_add_u32 v143, s66, v139
    s_waitcnt vmcnt(20) lgkmcnt(0)
    s_barrier
    ds_read_b64_tr_b16 v[112:113], v140 offset:0
    ds_read_b64_tr_b16 v[114:115], v140 offset:2560
    ds_read_b128 v[64:67], v141 offset:0
    ds_read_b64_tr_b16 v[116:117], v140 offset:64
    ds_read_b64_tr_b16 v[118:119], v140 offset:2624
    v_mfma_f32_16x16x32_bf16 v[48:51], v[100:103], v[84:87], v[48:51]
    ds_read_b64_tr_b16 v[120:121], v140 offset:5120
    ds_read_b64_tr_b16 v[122:123], v140 offset:7680
    ds_read_b128 v[68:71], v141 offset:4096
    s_add_u32 s53, s40, 3
    s_and_b32 s53, s53, 3
    s_mul_i32 s53, s53, 294912
    s_add_u32 s53, s53, 73728
    s_add_u32 m0, s65, s61
    s_nop 0
    buffer_load_dwordx4 v128, s[20:23], s53 offen lds
    s_add_u32 m0, m0, 0x400
    s_nop 0
    buffer_load_dwordx4 v129, s[20:23], s53 offen lds
    v_mfma_f32_16x16x32_bf16 v[52:55], v[104:107], v[84:87], v[52:55]
    ds_read_b64_tr_b16 v[124:125], v140 offset:5184
    ds_read_b64_tr_b16 v[126:127], v140 offset:7744
    s_add_u32 m0, m0, 0x400
    s_nop 0
    buffer_load_dwordx4 v130, s[20:23], s53 offen lds
    v_mfma_f32_16x16x32_bf16 v[56:59], v[108:111], v[84:87], v[56:59]
    ds_read_b64_tr_b16 v[96:97], v142 offset:0
    ds_read_b64_tr_b16 v[98:99], v142 offset:5120
    ds_read_b128 v[80:83], v143 offset:0
    s_add_u32 m0, m0, 0x400
    s_nop 0
    buffer_load_dwordx4 v131, s[20:23], s53 offen lds
    s_waitcnt lgkmcnt(10)
    v_mfma_f32_32x32x16_bf16 v[0:15], v[112:115], v[64:67], v[0:15]
    ds_read_b64_tr_b16 v[100:101], v142 offset:32
    ds_read_b64_tr_b16 v[102:103], v142 offset:5152
    s_add_u32 m0, m0, 0x400
    s_nop 0
    buffer_load_dwordx4 v132, s[20:23], s53 offen lds
    s_waitcnt lgkmcnt(10)
    v_mfma_f32_32x32x16_bf16 v[16:31], v[116:119], v[64:67], v[16:31]
    ds_read_b64_tr_b16 v[104:105], v142 offset:64
    ds_read_b64_tr_b16 v[106:107], v142 offset:5184
    s_add_u32 s52, s73, 3
    s_and_b32 s52, s52, 3
    s_mul_i32 s52, s52, 73728
    s_add_u32 s52, s52, 18432
    s_add_u32 m0, s65, s59
    s_nop 0
    buffer_load_dwordx4 v137, s[12:15], s52 offen sc1 lds
    s_waitcnt lgkmcnt(9)
    v_mfma_f32_32x32x16_bf16 v[0:15], v[120:123], v[68:71], v[0:15]
    ds_read_b64_tr_b16 v[108:109], v140 offset:10240
    ds_read_b64_tr_b16 v[110:111], v140 offset:12800
    ds_read_b128 v[72:75], v141 offset:9216
    s_add_u32 m0, m0, 0x1000
    s_add_u32 s52, s52, 0x1000
    buffer_load_dwordx4 v137, s[12:15], s52 offen sc1 lds
    s_waitcnt lgkmcnt(10)
    v_mfma_f32_32x32x16_bf16 v[16:31], v[124:127], v[68:71], v[16:31]
    ds_read_b64_tr_b16 v[112:113], v140 offset:10304
    ds_read_b64_tr_b16 v[114:115], v140 offset:12864
    s_add_u32 m0, m0, 0x1000
    s_add_u32 s52, s52, 0x1000
    buffer_load_dwordx4 v137, s[12:15], s52 offen sc1 lds
    s_waitcnt lgkmcnt(9)
    v_mfma_f32_16x16x32_bf16 v[48:51], v[96:99], v[80:83], v[48:51]
    ds_read_b64_tr_b16 v[116:117], v140 offset:15360
    ds_read_b64_tr_b16 v[118:119], v140 offset:17920
    ds_read_b128 v[76:79], v141 offset:13312
    s_add_u32 m0, m0, 0x1000
    s_add_u32 s52, s52, 0x1000
    buffer_load_dwordx4 v137, s[12:15], s52 offen sc1 lds
    s_waitcnt lgkmcnt(10)
    v_mfma_f32_16x16x32_bf16 v[52:55], v[100:103], v[80:83], v[52:55]
    ds_read_b64_tr_b16 v[120:121], v140 offset:15424
    ds_read_b64_tr_b16 v[122:123], v140 offset:17984
    s_add_u32 m0, m0, 0x1000
    s_add_u32 s52, s52, 0x1000
    s_max_u32 m0, m0, s60
    s_nop 0
    buffer_load_dwordx4 v137, s[12:15], s52 offen sc1 lds
    s_waitcnt lgkmcnt(10)
    v_mfma_f32_16x16x32_bf16 v[56:59], v[104:107], v[80:83], v[56:59]
    ds_read_b64_tr_b16 v[124:125], v142 offset:10240
    ds_read_b64_tr_b16 v[126:127], v142 offset:15360
    ds_read_b128 v[84:87], v143 offset:9216
    s_waitcnt lgkmcnt(10)
    v_mfma_f32_32x32x16_bf16 v[0:15], v[108:111], v[72:75], v[0:15]
    ds_read_b64_tr_b16 v[96:97], v142 offset:10272
    ds_read_b64_tr_b16 v[98:99], v142 offset:15392
    s_waitcnt lgkmcnt(10)
    v_mfma_f32_32x32x16_bf16 v[16:31], v[112:115], v[72:75], v[16:31]
    ds_read_b64_tr_b16 v[100:101], v142 offset:10304
    ds_read_b64_tr_b16 v[102:103], v142 offset:15424
    s_waitcnt lgkmcnt(9)
    v_mfma_f32_32x32x16_bf16 v[0:15], v[116:119], v[76:79], v[0:15]
    s_waitcnt lgkmcnt(7)
    v_mfma_f32_32x32x16_bf16 v[16:31], v[120:123], v[76:79], v[16:31]
    v_add_u32 v140, s67, v136
    v_add_u32 v141, s67, v137
    v_add_u32 v142, s67, v138
    v_add_u32 v143, s67, v139
    s_waitcnt vmcnt(20) lgkmcnt(0)
    s_barrier
    ds_read_b64_tr_b16 v[104:105], v140 offset:0
    ds_read_b64_tr_b16 v[106:107], v140 offset:2560
    ds_read_b128 v[64:67], v141 offset:0
    ds_read_b64_tr_b16 v[108:109], v140 offset:64
    ds_read_b64_tr_b16 v[110:111], v140 offset:2624
    v_mfma_f32_16x16x32_bf16 v[48:51], v[124:127], v[84:87], v[48:51]
    ds_read_b64_tr_b16 v[112:113], v140 offset:5120
    ds_read_b64_tr_b16 v[114:115], v140 offset:7680
    ds_read_b128 v[68:71], v141 offset:4096
    s_add_u32 s53, s40, 3
    s_and_b32 s53, s53, 3
    s_mul_i32 s53, s53, 294912
    s_add_u32 s53, s53, 147456
    s_add_u32 m0, s66, s61
    s_nop 0
    buffer_load_dwordx4 v128, s[20:23], s53 offen lds
    s_add_u32 m0, m0, 0x400
    s_nop 0
    buffer_load_dwordx4 v129, s[20:23], s53 offen lds
    v_mfma_f32_16x16x32_bf16 v[52:55], v[96:99], v[84:87], v[52:55]
    ds_read_b64_tr_b16 v[116:117], v140 offset:5184
    ds_read_b64_tr_b16 v[118:119], v140 offset:7744
    s_add_u32 m0, m0, 0x400
    s_nop 0
    buffer_load_dwordx4 v130, s[20:23], s53 offen lds
    v_mfma_f32_16x16x32_bf16 v[56:59], v[100:103], v[84:87], v[56:59]
    ds_read_b64_tr_b16 v[120:121], v142 offset:0
    ds_read_b64_tr_b16 v[122:123], v142 offset:5120
    ds_read_b128 v[80:83], v143 offset:0
    s_add_u32 m0, m0, 0x400
    s_nop 0
    buffer_load_dwordx4 v131, s[20:23], s53 offen lds
    s_waitcnt lgkmcnt(10)
    v_mfma_f32_32x32x16_bf16 v[0:15], v[104:107], v[64:67], v[0:15]
    ds_read_b64_tr_b16 v[124:125], v142 offset:32
    ds_read_b64_tr_b16 v[126:127], v142 offset:5152
    s_add_u32 m0, m0, 0x400
    s_nop 0
    buffer_load_dwordx4 v132, s[20:23], s53 offen lds
    s_waitcnt lgkmcnt(10)
    v_mfma_f32_32x32x16_bf16 v[16:31], v[108:111], v[64:67], v[16:31]
    ds_read_b64_tr_b16 v[96:97], v142 offset:64
    ds_read_b64_tr_b16 v[98:99], v142 offset:5184
    s_add_u32 s52, s73, 3
    s_and_b32 s52, s52, 3
    s_mul_i32 s52, s52, 73728
    s_add_u32 s52, s52, 36864
    s_add_u32 m0, s66, s59
    s_nop 0
    buffer_load_dwordx4 v137, s[12:15], s52 offen sc1 lds
    s_waitcnt lgkmcnt(9)
    v_mfma_f32_32x32x16_bf16 v[0:15], v[112:115], v[68:71], v[0:15]
    ds_read_b64_tr_b16 v[100:101], v140 offset:10240
    ds_read_b64_tr_b16 v[102:103], v140 offset:12800
    ds_read_b128 v[72:75], v141 offset:9216
    s_add_u32 m0, m0, 0x1000
    s_add_u32 s52, s52, 0x1000
    buffer_load_dwordx4 v137, s[12:15], s52 offen sc1 lds
    s_waitcnt lgkmcnt(10)
    v_mfma_f32_32x32x16_bf16 v[16:31], v[116:119], v[68:71], v[16:31]
    ds_read_b64_tr_b16 v[104:105], v140 offset:10304
    ds_read_b64_tr_b16 v[106:107], v140 offset:12864
    s_add_u32 m0, m0, 0x1000
    s_add_u32 s52, s52, 0x1000
    buffer_load_dwordx4 v137, s[12:15], s52 offen sc1 lds
    s_waitcnt lgkmcnt(9)
    v_mfma_f32_16x16x32_bf16 v[48:51], v[120:123], v[80:83], v[48:51]
    ds_read_b64_tr_b16 v[108:109], v140 offset:15360
    ds_read_b64_tr_b16 v[110:111], v140 offset:17920
    ds_read_b128 v[76:79], v141 offset:13312
    s_add_u32 m0, m0, 0x1000
    s_add_u32 s52, s52, 0x1000
    buffer_load_dwordx4 v137, s[12:15], s52 offen sc1 lds
    s_waitcnt lgkmcnt(10)
    v_mfma_f32_16x16x32_bf16 v[52:55], v[124:127], v[80:83], v[52:55]
    ds_read_b64_tr_b16 v[112:113], v140 offset:15424
    ds_read_b64_tr_b16 v[114:115], v140 offset:17984
    s_add_u32 m0, m0, 0x1000
    s_add_u32 s52, s52, 0x1000
    s_max_u32 m0, m0, s60
    s_nop 0
    buffer_load_dwordx4 v137, s[12:15], s52 offen sc1 lds
    s_waitcnt lgkmcnt(10)
    v_mfma_f32_16x16x32_bf16 v[56:59], v[96:99], v[80:83], v[56:59]
    ds_read_b64_tr_b16 v[116:117], v142 offset:10240
    ds_read_b64_tr_b16 v[118:119], v142 offset:15360
    ds_read_b128 v[84:87], v143 offset:9216
    s_waitcnt lgkmcnt(10)
    v_mfma_f32_32x32x16_bf16 v[0:15], v[100:103], v[72:75], v[0:15]
    ds_read_b64_tr_b16 v[120:121], v142 offset:10272
    ds_read_b64_tr_b16 v[122:123], v142 offset:15392
    s_waitcnt lgkmcnt(10)
    v_mfma_f32_32x32x16_bf16 v[16:31], v[104:107], v[72:75], v[16:31]
    ds_read_b64_tr_b16 v[124:125], v142 offset:10304
    ds_read_b64_tr_b16 v[126:127], v142 offset:15424
    s_waitcnt lgkmcnt(9)
    v_mfma_f32_32x32x16_bf16 v[0:15], v[108:111], v[76:79], v[0:15]
    s_waitcnt lgkmcnt(7)
    v_mfma_f32_32x32x16_bf16 v[16:31], v[112:115], v[76:79], v[16:31]
    v_add_u32 v140, s64, v136
    v_add_u32 v141, s64, v137
    v_add_u32 v142, s64, v138
    v_add_u32 v143, s64, v139
    s_waitcnt vmcnt(20) lgkmcnt(0)
    s_barrier
    ds_read_b64_tr_b16 v[96:97], v140 offset:0
    ds_read_b64_tr_b16 v[98:99], v140 offset:2560
    ds_read_b128 v[64:67], v141 offset:0
    ds_read_b64_tr_b16 v[100:101], v140 offset:64
    ds_read_b64_tr_b16 v[102:103], v140 offset:2624
    v_mfma_f32_16x16x32_bf16 v[48:51], v[116:119], v[84:87], v[48:51]
    ds_read_b64_tr_b16 v[104:105], v140 offset:5120
    ds_read_b64_tr_b16 v[106:107], v140 offset:7680
    ds_read_b128 v[68:71], v141 offset:4096
    s_add_u32 s53, s40, 3
    s_and_b32 s53, s53, 3
    s_mul_i32 s53, s53, 294912
    s_add_u32 s53, s53, 221184
    s_add_u32 m0, s67, s61
    s_nop 0
    buffer_load_dwordx4 v128, s[20:23], s53 offen lds
    s_add_u32 m0, m0, 0x400
    s_nop 0
    buffer_load_dwordx4 v129, s[20:23], s53 offen lds
    v_mfma_f32_16x16x32_bf16 v[52:55], v[120:123], v[84:87], v[52:55]
    ds_read_b64_tr_b16 v[108:109], v140 offset:5184
    ds_read_b64_tr_b16 v[110:111], v140 offset:7744
    s_add_u32 m0, m0, 0x400
    s_nop 0
    buffer_load_dwordx4 v130, s[20:23], s53 offen lds
    v_mfma_f32_16x16x32_bf16 v[56:59], v[124:127], v[84:87], v[56:59]
    ds_read_b64_tr_b16 v[112:113], v142 offset:0
    ds_read_b64_tr_b16 v[114:115], v142 offset:5120
    ds_read_b128 v[80:83], v143 offset:0
    s_add_u32 m0, m0, 0x400
    s_nop 0
    buffer_load_dwordx4 v131, s[20:23], s53 offen lds
    s_waitcnt lgkmcnt(10)
    v_mfma_f32_32x32x16_bf16 v[0:15], v[96:99], v[64:67], v[0:15]
    ds_read_b64_tr_b16 v[116:117], v142 offset:32
    ds_read_b64_tr_b16 v[118:119], v142 offset:5152
    s_add_u32 m0, m0, 0x400
    s_nop 0
    buffer_load_dwordx4 v132, s[20:23], s53 offen lds
    s_waitcnt lgkmcnt(10)
    v_mfma_f32_32x32x16_bf16 v[16:31], v[100:103], v[64:67], v[16:31]
    ds_read_b64_tr_b16 v[120:121], v142 offset:64
    ds_read_b64_tr_b16 v[122:123], v142 offset:5184
    s_add_u32 s52, s73, 3
    s_and_b32 s52, s52, 3
    s_mul_i32 s52, s52, 73728
    s_add_u32 s52, s52, 55296
    s_add_u32 m0, s67, s59
    s_nop 0
    buffer_load_dwordx4 v137, s[12:15], s52 offen sc1 lds
    s_waitcnt lgkmcnt(9)
    v_mfma_f32_32x32x16_bf16 v[0:15], v[104:107], v[68:71], v[0:15]
    ds_read_b64_tr_b16 v[124:125], v140 offset:10240
    ds_read_b64_tr_b16 v[126:127], v140 offset:12800
    ds_read_b128 v[72:75], v141 offset:9216
    s_add_u32 m0, m0, 0x1000
    s_add_u32 s52, s52, 0x1000
    buffer_load_dwordx4 v137, s[12:15], s52 offen sc1 lds
    s_waitcnt lgkmcnt(10)
    v_mfma_f32_32x32x16_bf16 v[16:31], v[108:111], v[68:71], v[16:31]
    ds_read_b64_tr_b16 v[96:97], v140 offset:10304
    ds_read_b64_tr_b16 v[98:99], v140 offset:12864
    s_add_u32 m0, m0, 0x1000
    s_add_u32 s52, s52, 0x1000
    buffer_load_dwordx4 v137, s[12:15], s52 offen sc1 lds
    s_waitcnt lgkmcnt(9)
    v_mfma_f32_16x16x32_bf16 v[48:51], v[112:115], v[80:83], v[48:51]
    ds_read_b64_tr_b16 v[100:101], v140 offset:15360
    ds_read_b64_tr_b16 v[102:103], v140 offset:17920
    ds_read_b128 v[76:79], v141 offset:13312
    s_add_u32 m0, m0, 0x1000
    s_add_u32 s52, s52, 0x1000
    buffer_load_dwordx4 v137, s[12:15], s52 offen sc1 lds
    s_waitcnt lgkmcnt(10)
    v_mfma_f32_16x16x32_bf16 v[52:55], v[116:119], v[80:83], v[52:55]
    ds_read_b64_tr_b16 v[104:105], v140 offset:15424
    ds_read_b64_tr_b16 v[106:107], v140 offset:17984
    s_add_u32 m0, m0, 0x1000
    s_add_u32 s52, s52, 0x1000
    s_max_u32 m0, m0, s60
    s_nop 0
    buffer_load_dwordx4 v137, s[12:15], s52 offen sc1 lds
    s_waitcnt lgkmcnt(10)
    v_mfma_f32_16x16x32_bf16 v[56:59], v[120:123], v[80:83], v[56:59]
    ds_read_b64_tr_b16 v[108:109], v142 offset:10240
    ds_read_b64_tr_b16 v[110:111], v142 offset:15360
    ds_read_b128 v[84:87], v143 offset:9216
    s_waitcnt lgkmcnt(10)
    v_mfma_f32_32x32x16_bf16 v[0:15], v[124:127], v[72:75], v[0:15]
    ds_read_b64_tr_b16 v[112:113], v142 offset:10272
    ds_read_b64_tr_b16 v[114:115], v142 offset:15392
    s_waitcnt lgkmcnt(10)
    v_mfma_f32_32x32x16_bf16 v[16:31], v[96:99], v[72:75], v[16:31]
    ds_read_b64_tr_b16 v[116:117], v142 offset:10304
    ds_read_b64_tr_b16 v[118:119], v142 offset:15424
    s_waitcnt lgkmcnt(9)
    v_mfma_f32_32x32x16_bf16 v[0:15], v[100:103], v[76:79], v[0:15]
    s_waitcnt lgkmcnt(7)
    v_mfma_f32_32x32x16_bf16 v[16:31], v[104:107], v[76:79], v[16:31]
    v_add_u32 v140, s65, v136
    v_add_u32 v141, s65, v137
    v_add_u32 v142, s65, v138
    v_add_u32 v143, s65, v139
    s_waitcnt vmcnt(20) lgkmcnt(0)
    s_barrier
    ds_read_b64_tr_b16 v[120:121], v140 offset:0
    ds_read_b64_tr_b16 v[122:123], v140 offset:2560
    ds_read_b128 v[64:67], v141 offset:0
    ds_read_b64_tr_b16 v[124:125], v140 offset:64
    ds_read_b64_tr_b16 v[126:127], v140 offset:2624
    v_mfma_f32_16x16x32_bf16 v[48:51], v[108:111], v[84:87], v[48:51]
    ds_read_b64_tr_b16 v[96:97], v140 offset:5120
    ds_read_b64_tr_b16 v[98:99], v140 offset:7680
    ds_read_b128 v[68:71], v141 offset:4096
    v_mfma_f32_16x16x32_bf16 v[52:55], v[112:115], v[84:87], v[52:55]
    ds_read_b64_tr_b16 v[100:101], v140 offset:5184
    ds_read_b64_tr_b16 v[102:103], v140 offset:7744
    v_mfma_f32_16x16x32_bf16 v[56:59], v[116:119], v[84:87], v[56:59]
    ds_read_b64_tr_b16 v[104:105], v142 offset:0
    ds_read_b64_tr_b16 v[106:107], v142 offset:5120
    ds_read_b128 v[80:83], v143 offset:0
    s_waitcnt lgkmcnt(10)
    v_mfma_f32_32x32x16_bf16 v[0:15], v[120:123], v[64:67], v[0:15]
    ds_read_b64_tr_b16 v[108:109], v142 offset:32
    ds_read_b64_tr_b16 v[110:111], v142 offset:5152
    s_waitcnt lgkmcnt(10)
    v_mfma_f32_32x32x16_bf16 v[16:31], v[124:127], v[64:67], v[16:31]
    ds_read_b64_tr_b16 v[112:113], v142 offset:64
    ds_read_b64_tr_b16 v[114:115], v142 offset:5184
    s_waitcnt lgkmcnt(9)
    v_mfma_f32_32x32x16_bf16 v[0:15], v[96:99], v[68:71], v[0:15]
    ds_read_b64_tr_b16 v[116:117], v140 offset:10240
    ds_read_b64_tr_b16 v[118:119], v140 offset:12800
    ds_read_b128 v[72:75], v141 offset:9216
    s_waitcnt lgkmcnt(10)
    v_mfma_f32_32x32x16_bf16 v[16:31], v[100:103], v[68:71], v[16:31]
    ds_read_b64_tr_b16 v[120:121], v140 offset:10304
    ds_read_b64_tr_b16 v[122:123], v140 offset:12864
    s_waitcnt lgkmcnt(9)
    v_mfma_f32_16x16x32_bf16 v[48:51], v[104:107], v[80:83], v[48:51]
    ds_read_b64_tr_b16 v[124:125], v140 offset:15360
    ds_read_b64_tr_b16 v[126:127], v140 offset:17920
    ds_read_b128 v[76:79], v141 offset:13312
    s_waitcnt lgkmcnt(10)
    v_mfma_f32_16x16x32_bf16 v[52:55], v[108:111], v[80:83], v[52:55]
    ds_read_b64_tr_b16 v[96:97], v140 offset:15424
    ds_read_b64_tr_b16 v[98:99], v140 offset:17984
    s_waitcnt lgkmcnt(10)
    v_mfma_f32_16x16x32_bf16 v[56:59], v[112:115], v[80:83], v[56:59]
    ds_read_b64_tr_b16 v[100:101], v142 offset:10240
    ds_read_b64_tr_b16 v[102:103], v142 offset:15360
    ds_read_b128 v[84:87], v143 offset:9216
    s_waitcnt lgkmcnt(10)
    v_mfma_f32_32x32x16_bf16 v[0:15], v[116:119], v[72:75], v[0:15]
    ds_read_b64_tr_b16 v[104:105], v142 offset:10272
    ds_read_b64_tr_b16 v[106:107], v142 offset:15392
    s_waitcnt lgkmcnt(10)
    v_mfma_f32_32x32x16_bf16 v[16:31], v[120:123], v[72:75], v[16:31]
    ds_read_b64_tr_b16 v[108:109], v142 offset:10304
    ds_read_b64_tr_b16 v[110:111], v142 offset:15424
    s_waitcnt lgkmcnt(9)
    v_mfma_f32_32x32x16_bf16 v[0:15], v[124:127], v[76:79], v[0:15]
    s_waitcnt lgkmcnt(7)
    v_mfma_f32_32x32x16_bf16 v[16:31], v[96:99], v[76:79], v[16:31]
    v_add_u32 v140, s66, v136
    v_add_u32 v141, s66, v137
    v_add_u32 v142, s66, v138
    v_add_u32 v143, s66, v139
    s_waitcnt vmcnt(10) lgkmcnt(0)
    s_barrier
    ds_read_b64_tr_b16 v[112:113], v140 offset:0
    ds_read_b64_tr_b16 v[114:115], v140 offset:2560
    ds_read_b128 v[64:67], v141 offset:0
    ds_read_b64_tr_b16 v[116:117], v140 offset:64
    ds_read_b64_tr_b16 v[118:119], v140 offset:2624
    v_mfma_f32_16x16x32_bf16 v[48:51], v[100:103], v[84:87], v[48:51]
    ds_read_b64_tr_b16 v[120:121], v140 offset:5120
    ds_read_b64_tr_b16 v[122:123], v140 offset:7680
    ds_read_b128 v[68:71], v141 offset:4096
    v_mfma_f32_16x16x32_bf16 v[52:55], v[104:107], v[84:87], v[52:55]
    ds_read_b64_tr_b16 v[124:125], v140 offset:5184
    ds_read_b64_tr_b16 v[126:127], v140 offset:7744
    v_mfma_f32_16x16x32_bf16 v[56:59], v[108:111], v[84:87], v[56:59]
    ds_read_b64_tr_b16 v[96:97], v142 offset:0
    ds_read_b64_tr_b16 v[98:99], v142 offset:5120
    ds_read_b128 v[80:83], v143 offset:0
    s_waitcnt lgkmcnt(10)
    v_mfma_f32_32x32x16_bf16 v[0:15], v[112:115], v[64:67], v[0:15]
    ds_read_b64_tr_b16 v[100:101], v142 offset:32
    ds_read_b64_tr_b16 v[102:103], v142 offset:5152
    s_waitcnt lgkmcnt(10)
    v_mfma_f32_32x32x16_bf16 v[16:31], v[116:119], v[64:67], v[16:31]
    ds_read_b64_tr_b16 v[104:105], v142 offset:64
    ds_read_b64_tr_b16 v[106:107], v142 offset:5184
    s_waitcnt lgkmcnt(9)
    v_mfma_f32_32x32x16_bf16 v[0:15], v[120:123], v[68:71], v[0:15]
    ds_read_b64_tr_b16 v[108:109], v140 offset:10240
    ds_read_b64_tr_b16 v[110:111], v140 offset:12800
    ds_read_b128 v[72:75], v141 offset:9216
    s_waitcnt lgkmcnt(10)
    v_mfma_f32_32x32x16_bf16 v[16:31], v[124:127], v[68:71], v[16:31]
    ds_read_b64_tr_b16 v[112:113], v140 offset:10304
    ds_read_b64_tr_b16 v[114:115], v140 offset:12864
    s_waitcnt lgkmcnt(9)
    v_mfma_f32_16x16x32_bf16 v[48:51], v[96:99], v[80:83], v[48:51]
    ds_read_b64_tr_b16 v[116:117], v140 offset:15360
    ds_read_b64_tr_b16 v[118:119], v140 offset:17920
    ds_read_b128 v[76:79], v141 offset:13312
    s_waitcnt lgkmcnt(10)
    v_mfma_f32_16x16x32_bf16 v[52:55], v[100:103], v[80:83], v[52:55]
    ds_read_b64_tr_b16 v[120:121], v140 offset:15424
    ds_read_b64_tr_b16 v[122:123], v140 offset:17984
    s_waitcnt lgkmcnt(10)
    v_mfma_f32_16x16x32_bf16 v[56:59], v[104:107], v[80:83], v[56:59]
    ds_read_b64_tr_b16 v[124:125], v142 offset:10240
    ds_read_b64_tr_b16 v[126:127], v142 offset:15360
    ds_read_b128 v[84:87], v143 offset:9216
    s_waitcnt lgkmcnt(10)
    v_mfma_f32_32x32x16_bf16 v[0:15], v[108:111], v[72:75], v[0:15]
    ds_read_b64_tr_b16 v[96:97], v142 offset:10272
    ds_read_b64_tr_b16 v[98:99], v142 offset:15392
    s_waitcnt lgkmcnt(10)
    v_mfma_f32_32x32x16_bf16 v[16:31], v[112:115], v[72:75], v[16:31]
    ds_read_b64_tr_b16 v[100:101], v142 offset:10304
    ds_read_b64_tr_b16 v[102:103], v142 offset:15424
    s_waitcnt lgkmcnt(9)
    v_mfma_f32_32x32x16_bf16 v[0:15], v[116:119], v[76:79], v[0:15]
    s_waitcnt lgkmcnt(7)
    v_mfma_f32_32x32x16_bf16 v[16:31], v[120:123], v[76:79], v[16:31]
    v_add_u32 v140, s67, v136
    v_add_u32 v141, s67, v137
    v_add_u32 v142, s67, v138
    v_add_u32 v143, s67, v139
    s_waitcnt vmcnt(0) lgkmcnt(0)
    s_barrier
    ds_read_b64_tr_b16 v[104:105], v140 offset:0
    ds_read_b64_tr_b16 v[106:107], v140 offset:2560
    ds_read_b128 v[64:67], v141 offset:0
    ds_read_b64_tr_b16 v[108:109], v140 offset:64
    ds_read_b64_tr_b16 v[110:111], v140 offset:2624
    v_mfma_f32_16x16x32_bf16 v[48:51], v[124:127], v[84:87], v[48:51]
    ds_read_b64_tr_b16 v[112:113], v140 offset:5120
    ds_read_b64_tr_b16 v[114:115], v140 offset:7680
    ds_read_b128 v[68:71], v141 offset:4096
    v_mfma_f32_16x16x32_bf16 v[52:55], v[96:99], v[84:87], v[52:55]
    ds_read_b64_tr_b16 v[116:117], v140 offset:5184
    ds_read_b64_tr_b16 v[118:119], v140 offset:7744
    v_mfma_f32_16x16x32_bf16 v[56:59], v[100:103], v[84:87], v[56:59]
    ds_read_b64_tr_b16 v[120:121], v142 offset:0
    ds_read_b64_tr_b16 v[122:123], v142 offset:5120
    ds_read_b128 v[80:83], v143 offset:0
    s_waitcnt lgkmcnt(10)
    v_mfma_f32_32x32x16_bf16 v[0:15], v[104:107], v[64:67], v[0:15]
    ds_read_b64_tr_b16 v[124:125], v142 offset:32
    ds_read_b64_tr_b16 v[126:127], v142 offset:5152
    s_waitcnt lgkmcnt(10)
    v_mfma_f32_32x32x16_bf16 v[16:31], v[108:111], v[64:67], v[16:31]
    ds_read_b64_tr_b16 v[96:97], v142 offset:64
    ds_read_b64_tr_b16 v[98:99], v142 offset:5184
    s_waitcnt lgkmcnt(9)
    v_mfma_f32_32x32x16_bf16 v[0:15], v[112:115], v[68:71], v[0:15]
    ds_read_b64_tr_b16 v[100:101], v140 offset:10240
    ds_read_b64_tr_b16 v[102:103], v140 offset:12800
    ds_read_b128 v[72:75], v141 offset:9216
    s_waitcnt lgkmcnt(10)
    v_mfma_f32_32x32x16_bf16 v[16:31], v[116:119], v[68:71], v[16:31]
    ds_read_b64_tr_b16 v[104:105], v140 offset:10304
    ds_read_b64_tr_b16 v[106:107], v140 offset:12864
    s_waitcnt lgkmcnt(9)
    v_mfma_f32_16x16x32_bf16 v[48:51], v[120:123], v[80:83], v[48:51]
    ds_read_b64_tr_b16 v[108:109], v140 offset:15360
    ds_read_b64_tr_b16 v[110:111], v140 offset:17920
    ds_read_b128 v[76:79], v141 offset:13312
    s_waitcnt lgkmcnt(10)
    v_mfma_f32_16x16x32_bf16 v[52:55], v[124:127], v[80:83], v[52:55]
    ds_read_b64_tr_b16 v[112:113], v140 offset:15424
    ds_read_b64_tr_b16 v[114:115], v140 offset:17984
    s_waitcnt lgkmcnt(10)
    v_mfma_f32_16x16x32_bf16 v[56:59], v[96:99], v[80:83], v[56:59]
    ds_read_b64_tr_b16 v[116:117], v142 offset:10240
    ds_read_b64_tr_b16 v[118:119], v142 offset:15360
    ds_read_b128 v[84:87], v143 offset:9216
    s_waitcnt lgkmcnt(10)
    v_mfma_f32_32x32x16_bf16 v[0:15], v[100:103], v[72:75], v[0:15]
    ds_read_b64_tr_b16 v[120:121], v142 offset:10272
    ds_read_b64_tr_b16 v[122:123], v142 offset:15392
    s_waitcnt lgkmcnt(10)
    v_mfma_f32_32x32x16_bf16 v[16:31], v[104:107], v[72:75], v[16:31]
    ds_read_b64_tr_b16 v[124:125], v142 offset:10304
    ds_read_b64_tr_b16 v[126:127], v142 offset:15424
    s_waitcnt lgkmcnt(9)
    v_mfma_f32_32x32x16_bf16 v[0:15], v[108:111], v[76:79], v[0:15]
    s_waitcnt lgkmcnt(7)
    v_mfma_f32_32x32x16_bf16 v[16:31], v[112:115], v[76:79], v[16:31]
    s_waitcnt lgkmcnt(4)
    v_mfma_f32_16x16x32_bf16 v[48:51], v[116:119], v[84:87], v[48:51]
    s_waitcnt lgkmcnt(2)
    v_mfma_f32_16x16x32_bf16 v[52:55], v[120:123], v[84:87], v[52:55]
    s_waitcnt lgkmcnt(0)
    v_mfma_f32_16x16x32_bf16 v[56:59], v[124:127], v[84:87], v[56:59]
    s_nop 3
    v_cvt_pk_bf16_f32 v0, v0, v1
    v_cvt_pk_bf16_f32 v1, v2, v3
    v_cvt_pk_bf16_f32 v2, v4, v5
    v_cvt_pk_bf16_f32 v3, v6, v7
    s_mov_b32 s52, 0x0
    buffer_store_dwordx4 v[0:3], v177, s[16:19], s52 offen offset:0 sc1
    v_cvt_pk_bf16_f32 v8, v8, v9
    v_cvt_pk_bf16_f32 v9, v10, v11
    v_cvt_pk_bf16_f32 v10, v12, v13
    v_cvt_pk_bf16_f32 v11, v14, v15
    s_mov_b32 s52, 0x0
    buffer_store_dwordx4 v[8:11], v177, s[16:19], s52 offen offset:1024 sc1
    v_cvt_pk_bf16_f32 v16, v16, v17
    v_cvt_pk_bf16_f32 v17, v18, v19
    v_cvt_pk_bf16_f32 v18, v20, v21
    v_cvt_pk_bf16_f32 v19, v22, v23
    s_mov_b32 s52, 0x2000
    buffer_store_dwordx4 v[16:19], v177, s[16:19], s52 offen offset:0 sc1
    v_cvt_pk_bf16_f32 v24, v24, v25
    v_cvt_pk_bf16_f32 v25, v26, v27
    v_cvt_pk_bf16_f32 v26, v28, v29
    v_cvt_pk_bf16_f32 v27, v30, v31
    s_mov_b32 s52, 0x2000
    buffer_store_dwordx4 v[24:27], v177, s[16:19], s52 offen offset:1024 sc1
    v_cvt_pk_bf16_f32 v48, v48, v49
    v_cvt_pk_bf16_f32 v49, v50, v51
    s_add_u32 s51, s62, 0
    s_lshr_b32 s52, s51, 1
    s_lshl_b32 s52, s52, 10
    s_and_b32 s51, s51, 1
    s_lshl_b32 s51, s51, 3
    s_add_u32 s52, s52, s51
    buffer_store_dwordx2 v[48:49], v178, s[16:19], s52 offen sc1
    v_cvt_pk_bf16_f32 v52, v52, v53
    v_cvt_pk_bf16_f32 v53, v54, v55
    s_add_u32 s51, s62, 1
    s_lshr_b32 s52, s51, 1
    s_lshl_b32 s52, s52, 10
    s_and_b32 s51, s51, 1
    s_lshl_b32 s51, s51, 3
    s_add_u32 s52, s52, s51
    buffer_store_dwordx2 v[52:53], v178, s[16:19], s52 offen sc1
    v_cvt_pk_bf16_f32 v56, v56, v57
    v_cvt_pk_bf16_f32 v57, v58, v59
    s_add_u32 s51, s62, 2
    s_lshr_b32 s52, s51, 1
    s_lshl_b32 s52, s52, 10
    s_and_b32 s51, s51, 1
    s_lshl_b32 s51, s51, 3
    s_add_u32 s52, s52, s51
    buffer_store_dwordx2 v[56:57], v178, s[16:19], s52 offen sc1
    s_branch SYNC
OUTP_0:
    v_and_b32 v187, 3, v254
    v_lshlrev_b32 v187, 7, v187
    v_min_u32 v187, 0x13c, v187
    v_bfe_u32 v188, v254, 2, 3
    v_mul_u32_u24 v188, 0x480, v188
    v_add_u32 v187, v187, v188
    v_lshrrev_b32 v188, 5, v254
    v_mul_u32_u24 v188, 0x12000, v188
    s_mul_i32 s51, s39, 9216
    v_add3_u32 v187, v187, v188, s51
    v_add_u32 v140, s64, v136
    v_add_u32 v141, s64, v137
    s_waitcnt lgkmcnt(0)
    s_barrier
    ds_read_b64_tr_b16 v[96:97], v140 offset:0
    ds_read_b64_tr_b16 v[98:99], v140 offset:2560
    ds_read_b128 v[64:67], v141 offset:0
    ds_read_b64_tr_b16 v[100:101], v140 offset:64
    ds_read_b64_tr_b16 v[102:103], v140 offset:2624
    ds_read_b64_tr_b16 v[104:105], v140 offset:128
    ds_read_b64_tr_b16 v[106:107], v140 offset:2688
    ds_read_b64_tr_b16 v[108:109], v140 offset:5120
    ds_read_b64_tr_b16 v[110:111], v140 offset:7680
    ds_read_b128 v[68:71], v141 offset:4096
    ds_read_b64_tr_b16 v[112:113], v140 offset:5184
    ds_read_b64_tr_b16 v[114:115], v140 offset:7744
    s_waitcnt lgkmcnt(9)
    v_mfma_f32_32x32x16_bf16 v[0:15], v[96:99], v[64:67], 0
    ds_read_b64_tr_b16 v[116:117], v140 offset:5248
    ds_read_b64_tr_b16 v[118:119], v140 offset:7808
    s_waitcnt lgkmcnt(9)
    v_mfma_f32_32x32x16_bf16 v[16:31], v[100:103], v[64:67], 0
    ds_read_b64_tr_b16 v[120:121], v140 offset:10240
    ds_read_b64_tr_b16 v[122:123], v140 offset:12800
    ds_read_b128 v[72:75], v141 offset:9216
    s_waitcnt lgkmcnt(10)
    v_mfma_f32_32x32x16_bf16 v[32:47], v[104:107], v[64:67], 0
    ds_read_b64_tr_b16 v[124:125], v140 offset:10304
    ds_read_b64_tr_b16 v[126:127], v140 offset:12864
    s_waitcnt lgkmcnt(9)
    v_mfma_f32_32x32x16_bf16 v[0:15], v[108:111], v[68:71], v[0:15]
    ds_read_b64_tr_b16 v[96:97], v140 offset:10368
    ds_read_b64_tr_b16 v[98:99], v140 offset:12928
    s_waitcnt lgkmcnt(9)
    v_mfma_f32_32x32x16_bf16 v[16:31], v[112:115], v[68:71], v[16:31]
    ds_read_b64_tr_b16 v[100:101], v140 offset:15360
    ds_read_b64_tr_b16 v[102:103], v140 offset:17920
    ds_read_b128 v[76:79], v141 offset:13312
    s_waitcnt lgkmcnt(10)
    v_mfma_f32_32x32x16_bf16 v[32:47], v[116:119], v[68:71], v[32:47]
    ds_read_b64_tr_b16 v[104:105], v140 offset:15424
    ds_read_b64_tr_b16 v[106:107], v140 offset:17984
    s_waitcnt lgkmcnt(9)
    v_mfma_f32_32x32x16_bf16 v[0:15], v[120:123], v[72:75], v[0:15]
    ds_read_b64_tr_b16 v[108:109], v140 offset:15488
    ds_read_b64_tr_b16 v[110:111], v140 offset:18048
    s_waitcnt lgkmcnt(9)
    v_mfma_f32_32x32x16_bf16 v[16:31], v[124:127], v[72:75], v[16:31]
    s_waitcnt lgkmcnt(7)
    v_mfma_f32_32x32x16_bf16 v[32:47], v[96:99], v[72:75], v[32:47]
    v_add_u32 v140, s65, v136
    v_add_u32 v141, s65, v137
    s_waitcnt lgkmcnt(0)
    s_barrier
    ds_read_b64_tr_b16 v[112:113], v140 offset:0
    ds_read_b64_tr_b16 v[114:115], v140 offset:2560
    ds_read_b128 v[64:67], v141 offset:0
    ds_read_b64_tr_b16 v[116:117], v140 offset:64
    ds_read_b64_tr_b16 v[118:119], v140 offset:2624
    v_mfma_f32_32x32x16_bf16 v[0:15], v[100:103], v[76:79], v[0:15]
    ds_read_b64_tr_b16 v[120:121], v140 offset:128
    ds_read_b64_tr_b16 v[122:123], v140 offset:2688
    v_mfma_f32_32x32x16_bf16 v[16:31], v[104:107], v[76:79], v[16:31]
    ds_read_b64_tr_b16 v[124:125], v140 offset:5120
    ds_read_b64_tr_b16 v[126:127], v140 offset:7680
    ds_read_b128 v[68:71], v141 offset:4096
    v_mfma_f32_32x32x16_bf16 v[32:47], v[108:111], v[76:79], v[32:47]
    ds_read_b64_tr_b16 v[96:97], v140 offset:5184
    ds_read_b64_tr_b16 v[98:99], v140 offset:7744
    s_waitcnt lgkmcnt(9)
    v_mfma_f32_32x32x16_bf16 v[0:15], v[112:115], v[64:67], v[0:15]
    ds_read_b64_tr_b16 v[100:101], v140 offset:5248
    ds_read_b64_tr_b16 v[102:103], v140 offset:7808
    s_waitcnt lgkmcnt(9)
    v_mfma_f32_32x32x16_bf16 v[16:31], v[116:119], v[64:67], v[16:31]
    ds_read_b64_tr_b16 v[104:105], v140 offset:10240
    ds_read_b64_tr_b16 v[106:107], v140 offset:12800
    ds_read_b128 v[72:75], v141 offset:9216
    s_waitcnt lgkmcnt(10)
    v_mfma_f32_32x32x16_bf16 v[32:47], v[120:123], v[64:67], v[32:47]
    ds_read_b64_tr_b16 v[108:109], v140 offset:10304
    ds_read_b64_tr_b16 v[110:111], v140 offset:12864
    s_waitcnt lgkmcnt(9)
    v_mfma_f32_32x32x16_bf16 v[0:15], v[124:127], v[68:71], v[0:15]
    ds_read_b64_tr_b16 v[112:113], v140 offset:10368
    ds_read_b64_tr_b16 v[114:115], v140 offset:12928
    s_waitcnt lgkmcnt(9)
    v_mfma_f32_32x32x16_bf16 v[16:31], v[96:99], v[68:71], v[16:31]
    ds_read_b64_tr_b16 v[116:117], v140 offset:15360
    ds_read_b64_tr_b16 v[118:119], v140 offset:17920
    ds_read_b128 v[76:79], v141 offset:13312
    s_waitcnt lgkmcnt(10)
    v_mfma_f32_32x32x16_bf16 v[32:47], v[100:103], v[68:71], v[32:47]
    ds_read_b64_tr_b16 v[120:121], v140 offset:15424
    ds_read_b64_tr_b16 v[122:123], v140 offset:17984
    s_waitcnt lgkmcnt(9)
    v_mfma_f32_32x32x16_bf16 v[0:15], v[104:107], v[72:75], v[0:15]
    ds_read_b64_tr_b16 v[124:125], v140 offset:15488
    ds_read_b64_tr_b16 v[126:127], v140 offset:18048
    s_waitcnt lgkmcnt(9)
    v_mfma_f32_32x32x16_bf16 v[16:31], v[108:111], v[72:75], v[16:31]
    s_waitcnt lgkmcnt(7)
    v_mfma_f32_32x32x16_bf16 v[32:47], v[112:115], v[72:75], v[32:47]
    v_add_u32 v140, s66, v136
    v_add_u32 v141, s66, v137
    s_waitcnt vmcnt(0) lgkmcnt(0)
    s_barrier
    ds_read_b64_tr_b16 v[96:97], v140 offset:0
    ds_read_b64_tr_b16 v[98:99], v140 offset:2560
    ds_read_b128 v[64:67], v141 offset:0
    ds_read_b64_tr_b16 v[100:101], v140 offset:64
    ds_read_b64_tr_b16 v[102:103], v140 offset:2624
    v_mfma_f32_32x32x16_bf16 v[0:15], v[116:119], v[76:79], v[0:15]
    ds_read_b64_tr_b16 v[104:105], v140 offset:128
    ds_read_b64_tr_b16 v[106:107], v140 offset:2688
    v_mfma_f32_32x32x16_bf16 v[16:31], v[120:123], v[76:79], v[16:31]
    ds_read_b64_tr_b16 v[108:109], v140 offset:5120
    ds_read_b64_tr_b16 v[110:111], v140 offset:7680
    ds_read_b128 v[68:71], v141 offset:4096
    v_mfma_f32_32x32x16_bf16 v[32:47], v[124:127], v[76:79], v[32:47]
    ds_read_b64_tr_b16 v[112:113], v140 offset:5184
    ds_read_b64_tr_b16 v[114:115], v140 offset:7744
    s_waitcnt lgkmcnt(9)
    v_mfma_f32_32x32x16_bf16 v[0:15], v[96:99], v[64:67], v[0:15]
    ds_read_b64_tr_b16 v[116:117], v140 offset:5248
    ds_read_b64_tr_b16 v[118:119], v140 offset:7808
    s_waitcnt lgkmcnt(9)
    v_mfma_f32_32x32x16_bf16 v[16:31], v[100:103], v[64:67], v[16:31]
    ds_read_b64_tr_b16 v[120:121], v140 offset:10240
    ds_read_b64_tr_b16 v[122:123], v140 offset:12800
    ds_read_b128 v[72:75], v141 offset:9216
    s_waitcnt lgkmcnt(10)
    v_mfma_f32_32x32x16_bf16 v[32:47], v[104:107], v[64:67], v[32:47]
    ds_read_b64_tr_b16 v[124:125], v140 offset:10304
    ds_read_b64_tr_b16 v[126:127], v140 offset:12864
    s_waitcnt lgkmcnt(9)
    v_mfma_f32_32x32x16_bf16 v[0:15], v[108:111], v[68:71], v[0:15]
    ds_read_b64_tr_b16 v[96:97], v140 offset:10368
    ds_read_b64_tr_b16 v[98:99], v140 offset:12928
    s_waitcnt lgkmcnt(9)
    v_mfma_f32_32x32x16_bf16 v[16:31], v[112:115], v[68:71], v[16:31]
    ds_read_b64_tr_b16 v[100:101], v140 offset:15360
    ds_read_b64_tr_b16 v[102:103], v140 offset:17920
    ds_read_b128 v[76:79], v141 offset:13312
    s_waitcnt lgkmcnt(10)
    v_mfma_f32_32x32x16_bf16 v[32:47], v[116:119], v[68:71], v[32:47]
    ds_read_b64_tr_b16 v[104:105], v140 offset:15424
    ds_read_b64_tr_b16 v[106:107], v140 offset:17984
    s_waitcnt lgkmcnt(9)
    v_mfma_f32_32x32x16_bf16 v[0:15], v[120:123], v[72:75], v[0:15]
    ds_read_b64_tr_b16 v[108:109], v140 offset:15488
    ds_read_b64_tr_b16 v[110:111], v140 offset:18048
    s_waitcnt lgkmcnt(9)
    v_mfma_f32_32x32x16_bf16 v[16:31], v[124:127], v[72:75], v[16:31]
    s_waitcnt lgkmcnt(7)
    v_mfma_f32_32x32x16_bf16 v[32:47], v[96:99], v[72:75], v[32:47]
    v_add_u32 v140, s67, v136
    v_add_u32 v141, s67, v137
    s_waitcnt lgkmcnt(0)
    s_barrier
    ds_read_b64_tr_b16 v[112:113], v140 offset:0
    ds_read_b64_tr_b16 v[114:115], v140 offset:2560
    ds_read_b128 v[64:67], v141 offset:0
    ds_read_b64_tr_b16 v[116:117], v140 offset:64
    ds_read_b64_tr_b16 v[118:119], v140 offset:2624
    v_mfma_f32_32x32x16_bf16 v[0:15], v[100:103], v[76:79], v[0:15]
    ds_read_b64_tr_b16 v[120:121], v140 offset:128
    ds_read_b64_tr_b16 v[122:123], v140 offset:2688
    v_mfma_f32_32x32x16_bf16 v[16:31], v[104:107], v[76:79], v[16:31]
    ds_read_b64_tr_b16 v[124:125], v140 offset:5120
    ds_read_b64_tr_b16 v[126:127], v140 offset:7680
    ds_read_b128 v[68:71], v141 offset:4096
    v_mfma_f32_32x32x16_bf16 v[32:47], v[108:111], v[76:79], v[32:47]
    ds_read_b64_tr_b16 v[96:97], v140 offset:5184
    ds_read_b64_tr_b16 v[98:99], v140 offset:7744
    s_waitcnt lgkmcnt(9)
    v_mfma_f32_32x32x16_bf16 v[0:15], v[112:115], v[64:67], v[0:15]
    ds_read_b64_tr_b16 v[100:101], v140 offset:5248
    ds_read_b64_tr_b16 v[102:103], v140 offset:7808
    s_waitcnt lgkmcnt(9)
    v_mfma_f32_32x32x16_bf16 v[16:31], v[116:119], v[64:67], v[16:31]
    ds_read_b64_tr_b16 v[104:105], v140 offset:10240
    ds_read_b64_tr_b16 v[106:107], v140 offset:12800
    ds_read_b128 v[72:75], v141 offset:9216
    s_waitcnt lgkmcnt(10)
    v_mfma_f32_32x32x16_bf16 v[32:47], v[120:123], v[64:67], v[32:47]
    ds_read_b64_tr_b16 v[108:109], v140 offset:10304
    ds_read_b64_tr_b16 v[110:111], v140 offset:12864
    s_waitcnt lgkmcnt(9)
    v_mfma_f32_32x32x16_bf16 v[0:15], v[124:127], v[68:71], v[0:15]
    ds_read_b64_tr_b16 v[112:113], v140 offset:10368
    ds_read_b64_tr_b16 v[114:115], v140 offset:12928
    s_waitcnt lgkmcnt(9)
    v_mfma_f32_32x32x16_bf16 v[16:31], v[96:99], v[68:71], v[16:31]
    ds_read_b64_tr_b16 v[116:117], v140 offset:15360
    ds_read_b64_tr_b16 v[118:119], v140 offset:17920
    ds_read_b128 v[76:79], v141 offset:13312
    s_waitcnt lgkmcnt(10)
    v_mfma_f32_32x32x16_bf16 v[32:47], v[100:103], v[68:71], v[32:47]
    ds_read_b64_tr_b16 v[120:121], v140 offset:15424
    ds_read_b64_tr_b16 v[122:123], v140 offset:17984
    s_waitcnt lgkmcnt(9)
    v_mfma_f32_32x32x16_bf16 v[0:15], v[104:107], v[72:75], v[0:15]
    ds_read_b64_tr_b16 v[124:125], v140 offset:15488
    ds_read_b64_tr_b16 v[126:127], v140 offset:18048
    s_waitcnt lgkmcnt(9)
    v_mfma_f32_32x32x16_bf16 v[16:31], v[108:111], v[72:75], v[16:31]
    s_waitcnt lgkmcnt(7)
    v_mfma_f32_32x32x16_bf16 v[32:47], v[112:115], v[72:75], v[32:47]
    v_add_u32 v140, s64, v136
    v_add_u32 v141, s64, v137
    s_waitcnt lgkmcnt(0)
    s_barrier
    ds_read_b64_tr_b16 v[96:97], v140 offset:0
    ds_read_b64_tr_b16 v[98:99], v140 offset:2560
    ds_read_b128 v[64:67], v141 offset:0
    ds_read_b64_tr_b16 v[100:101], v140 offset:64
    ds_read_b64_tr_b16 v[102:103], v140 offset:2624
    v_mfma_f32_32x32x16_bf16 v[0:15], v[116:119], v[76:79], v[0:15]
    ds_read_b64_tr_b16 v[104:105], v140 offset:128
    ds_read_b64_tr_b16 v[106:107], v140 offset:2688
    v_mfma_f32_32x32x16_bf16 v[16:31], v[120:123], v[76:79], v[16:31]
    ds_read_b64_tr_b16 v[108:109], v140 offset:5120
    ds_read_b64_tr_b16 v[110:111], v140 offset:7680
    ds_read_b128 v[68:71], v141 offset:4096
    v_mfma_f32_32x32x16_bf16 v[32:47], v[124:127], v[76:79], v[32:47]
    ds_read_b64_tr_b16 v[112:113], v140 offset:5184
    ds_read_b64_tr_b16 v[114:115], v140 offset:7744
    s_waitcnt lgkmcnt(9)
    v_mfma_f32_32x32x16_bf16 v[0:15], v[96:99], v[64:67], v[0:15]
    ds_read_b64_tr_b16 v[116:117], v140 offset:5248
    ds_read_b64_tr_b16 v[118:119], v140 offset:7808
    s_waitcnt lgkmcnt(9)
    v_mfma_f32_32x32x16_bf16 v[16:31], v[100:103], v[64:67], v[16:31]
    ds_read_b64_tr_b16 v[120:121], v140 offset:10240
    ds_read_b64_tr_b16 v[122:123], v140 offset:12800
    ds_read_b128 v[72:75], v141 offset:9216
    s_waitcnt lgkmcnt(10)
    v_mfma_f32_32x32x16_bf16 v[32:47], v[104:107], v[64:67], v[32:47]
    ds_read_b64_tr_b16 v[124:125], v140 offset:10304
    ds_read_b64_tr_b16 v[126:127], v140 offset:12864
    s_waitcnt lgkmcnt(9)
    v_mfma_f32_32x32x16_bf16 v[0:15], v[108:111], v[68:71], v[0:15]
    ds_read_b64_tr_b16 v[96:97], v140 offset:10368
    ds_read_b64_tr_b16 v[98:99], v140 offset:12928
    s_waitcnt lgkmcnt(9)
    v_mfma_f32_32x32x16_bf16 v[16:31], v[112:115], v[68:71], v[16:31]
    ds_read_b64_tr_b16 v[100:101], v140 offset:15360
    ds_read_b64_tr_b16 v[102:103], v140 offset:17920
    ds_read_b128 v[76:79], v141 offset:13312
    s_waitcnt lgkmcnt(10)
    v_mfma_f32_32x32x16_bf16 v[32:47], v[116:119], v[68:71], v[32:47]
    ds_read_b64_tr_b16 v[104:105], v140 offset:15424
    ds_read_b64_tr_b16 v[106:107], v140 offset:17984
    s_waitcnt lgkmcnt(9)
    v_mfma_f32_32x32x16_bf16 v[0:15], v[120:123], v[72:75], v[0:15]
    ds_read_b64_tr_b16 v[108:109], v140 offset:15488
    ds_read_b64_tr_b16 v[110:111], v140 offset:18048
    s_waitcnt lgkmcnt(9)
    v_mfma_f32_32x32x16_bf16 v[16:31], v[124:127], v[72:75], v[16:31]
    s_waitcnt lgkmcnt(7)
    v_mfma_f32_32x32x16_bf16 v[32:47], v[96:99], v[72:75], v[32:47]
    v_add_u32 v140, s65, v136
    v_add_u32 v141, s65, v137
    s_waitcnt lgkmcnt(0)
    s_barrier
    ds_read_b64_tr_b16 v[112:113], v140 offset:0
    ds_read_b64_tr_b16 v[114:115], v140 offset:2560
    ds_read_b128 v[64:67], v141 offset:0
    ds_read_b64_tr_b16 v[116:117], v140 offset:64
    ds_read_b64_tr_b16 v[118:119], v140 offset:2624
    v_mfma_f32_32x32x16_bf16 v[0:15], v[100:103], v[76:79], v[0:15]
    ds_read_b64_tr_b16 v[120:121], v140 offset:128
    ds_read_b64_tr_b16 v[122:123], v140 offset:2688
    v_mfma_f32_32x32x16_bf16 v[16:31], v[104:107], v[76:79], v[16:31]
    ds_read_b64_tr_b16 v[124:125], v140 offset:5120
    ds_read_b64_tr_b16 v[126:127], v140 offset:7680
    ds_read_b128 v[68:71], v141 offset:4096
    v_mfma_f32_32x32x16_bf16 v[32:47], v[108:111], v[76:79], v[32:47]
    ds_read_b64_tr_b16 v[96:97], v140 offset:5184
    ds_read_b64_tr_b16 v[98:99], v140 offset:7744
    s_waitcnt lgkmcnt(9)
    v_mfma_f32_32x32x16_bf16 v[0:15], v[112:115], v[64:67], v[0:15]
    ds_read_b64_tr_b16 v[100:101], v140 offset:5248
    ds_read_b64_tr_b16 v[102:103], v140 offset:7808
    s_waitcnt lgkmcnt(9)
    v_mfma_f32_32x32x16_bf16 v[16:31], v[116:119], v[64:67], v[16:31]
    ds_read_b64_tr_b16 v[104:105], v140 offset:10240
    ds_read_b64_tr_b16 v[106:107], v140 offset:12800
    ds_read_b128 v[72:75], v141 offset:9216
    s_waitcnt lgkmcnt(10)
    v_mfma_f32_32x32x16_bf16 v[32:47], v[120:123], v[64:67], v[32:47]
    ds_read_b64_tr_b16 v[108:109], v140 offset:10304
    ds_read_b64_tr_b16 v[110:111], v140 offset:12864
    s_waitcnt lgkmcnt(9)
    v_mfma_f32_32x32x16_bf16 v[0:15], v[124:127], v[68:71], v[0:15]
    ds_read_b64_tr_b16 v[112:113], v140 offset:10368
    ds_read_b64_tr_b16 v[114:115], v140 offset:12928
    s_waitcnt lgkmcnt(9)
    v_mfma_f32_32x32x16_bf16 v[16:31], v[96:99], v[68:71], v[16:31]
    ds_read_b64_tr_b16 v[116:117], v140 offset:15360
    ds_read_b64_tr_b16 v[118:119], v140 offset:17920
    ds_read_b128 v[76:79], v141 offset:13312
    s_waitcnt lgkmcnt(10)
    v_mfma_f32_32x32x16_bf16 v[32:47], v[100:103], v[68:71], v[32:47]
    ds_read_b64_tr_b16 v[120:121], v140 offset:15424
    ds_read_b64_tr_b16 v[122:123], v140 offset:17984
    s_waitcnt lgkmcnt(9)
    v_mfma_f32_32x32x16_bf16 v[0:15], v[104:107], v[72:75], v[0:15]
    ds_read_b64_tr_b16 v[124:125], v140 offset:15488
    ds_read_b64_tr_b16 v[126:127], v140 offset:18048
    s_waitcnt lgkmcnt(9)
    v_mfma_f32_32x32x16_bf16 v[16:31], v[108:111], v[72:75], v[16:31]
    s_waitcnt lgkmcnt(7)
    v_mfma_f32_32x32x16_bf16 v[32:47], v[112:115], v[72:75], v[32:47]
    v_add_u32 v140, s66, v136
    v_add_u32 v141, s66, v137
    s_waitcnt lgkmcnt(0)
    s_barrier
    ds_read_b64_tr_b16 v[96:97], v140 offset:0
    ds_read_b64_tr_b16 v[98:99], v140 offset:2560
    ds_read_b128 v[64:67], v141 offset:0
    ds_read_b64_tr_b16 v[100:101], v140 offset:64
    ds_read_b64_tr_b16 v[102:103], v140 offset:2624
    v_mfma_f32_32x32x16_bf16 v[0:15], v[116:119], v[76:79], v[0:15]
    ds_read_b64_tr_b16 v[104:105], v140 offset:128
    ds_read_b64_tr_b16 v[106:107], v140 offset:2688
    v_mfma_f32_32x32x16_bf16 v[16:31], v[120:123], v[76:79], v[16:31]
    ds_read_b64_tr_b16 v[108:109], v140 offset:5120
    ds_read_b64_tr_b16 v[110:111], v140 offset:7680
    ds_read_b128 v[68:71], v141 offset:4096
    v_mfma_f32_32x32x16_bf16 v[32:47], v[124:127], v[76:79], v[32:47]
    ds_read_b64_tr_b16 v[112:113], v140 offset:5184
    ds_read_b64_tr_b16 v[114:115], v140 offset:7744
    s_waitcnt lgkmcnt(9)
    v_mfma_f32_32x32x16_bf16 v[0:15], v[96:99], v[64:67], v[0:15]
    ds_read_b64_tr_b16 v[116:117], v140 offset:5248
    ds_read_b64_tr_b16 v[118:119], v140 offset:7808
    s_waitcnt lgkmcnt(9)
    v_mfma_f32_32x32x16_bf16 v[16:31], v[100:103], v[64:67], v[16:31]
    ds_read_b64_tr_b16 v[120:121], v140 offset:10240
    ds_read_b64_tr_b16 v[122:123], v140 offset:12800
    ds_read_b128 v[72:75], v141 offset:9216
    s_waitcnt lgkmcnt(10)
    v_mfma_f32_32x32x16_bf16 v[32:47], v[104:107], v[64:67], v[32:47]
    ds_read_b64_tr_b16 v[124:125], v140 offset:10304
    ds_read_b64_tr_b16 v[126:127], v140 offset:12864
    s_waitcnt lgkmcnt(9)
    v_mfma_f32_32x32x16_bf16 v[0:15], v[108:111], v[68:71], v[0:15]
    ds_read_b64_tr_b16 v[96:97], v140 offset:10368
    ds_read_b64_tr_b16 v[98:99], v140 offset:12928
    s_waitcnt lgkmcnt(9)
    v_mfma_f32_32x32x16_bf16 v[16:31], v[112:115], v[68:71], v[16:31]
    ds_read_b64_tr_b16 v[100:101], v140 offset:15360
    ds_read_b64_tr_b16 v[102:103], v140 offset:17920
    ds_read_b128 v[76:79], v141 offset:13312
    s_waitcnt lgkmcnt(10)
    v_mfma_f32_32x32x16_bf16 v[32:47], v[116:119], v[68:71], v[32:47]
    ds_read_b64_tr_b16 v[104:105], v140 offset:15424
    ds_read_b64_tr_b16 v[106:107], v140 offset:17984
    s_waitcnt lgkmcnt(9)
    v_mfma_f32_32x32x16_bf16 v[0:15], v[120:123], v[72:75], v[0:15]
    ds_read_b64_tr_b16 v[108:109], v140 offset:15488
    ds_read_b64_tr_b16 v[110:111], v140 offset:18048
    s_waitcnt lgkmcnt(9)
    v_mfma_f32_32x32x16_bf16 v[16:31], v[124:127], v[72:75], v[16:31]
    s_waitcnt lgkmcnt(7)
    v_mfma_f32_32x32x16_bf16 v[32:47], v[96:99], v[72:75], v[32:47]
    v_add_u32 v140, s67, v136
    v_add_u32 v141, s67, v137
    s_waitcnt lgkmcnt(0)
    s_barrier
    ds_read_b64_tr_b16 v[112:113], v140 offset:0
    ds_read_b64_tr_b16 v[114:115], v140 offset:2560
    ds_read_b128 v[64:67], v141 offset:0
    ds_read_b64_tr_b16 v[116:117], v140 offset:64
    ds_read_b64_tr_b16 v[118:119], v140 offset:2624
    v_mfma_f32_32x32x16_bf16 v[0:15], v[100:103], v[76:79], v[0:15]
    ds_read_b64_tr_b16 v[120:121], v140 offset:128
    ds_read_b64_tr_b16 v[122:123], v140 offset:2688
    v_mfma_f32_32x32x16_bf16 v[16:31], v[104:107], v[76:79], v[16:31]
    ds_read_b64_tr_b16 v[124:125], v140 offset:5120
    ds_read_b64_tr_b16 v[126:127], v140 offset:7680
    ds_read_b128 v[68:71], v141 offset:4096
    v_mfma_f32_32x32x16_bf16 v[32:47], v[108:111], v[76:79], v[32:47]
    ds_read_b64_tr_b16 v[96:97], v140 offset:5184
    ds_read_b64_tr_b16 v[98:99], v140 offset:7744
    s_waitcnt lgkmcnt(9)
    v_mfma_f32_32x32x16_bf16 v[0:15], v[112:115], v[64:67], v[0:15]
    ds_read_b64_tr_b16 v[100:101], v140 offset:5248
    ds_read_b64_tr_b16 v[102:103], v140 offset:7808
    s_waitcnt lgkmcnt(9)
    v_mfma_f32_32x32x16_bf16 v[16:31], v[116:119], v[64:67], v[16:31]
    ds_read_b64_tr_b16 v[104:105], v140 offset:10240
    ds_read_b64_tr_b16 v[106:107], v140 offset:12800
    ds_read_b128 v[72:75], v141 offset:9216
    s_waitcnt lgkmcnt(10)
    v_mfma_f32_32x32x16_bf16 v[32:47], v[120:123], v[64:67], v[32:47]
    ds_read_b64_tr_b16 v[108:109], v140 offset:10304
    ds_read_b64_tr_b16 v[110:111], v140 offset:12864
    s_waitcnt lgkmcnt(9)
    v_mfma_f32_32x32x16_bf16 v[0:15], v[124:127], v[68:71], v[0:15]
    ds_read_b64_tr_b16 v[112:113], v140 offset:10368
    ds_read_b64_tr_b16 v[114:115], v140 offset:12928
    s_waitcnt lgkmcnt(9)
    v_mfma_f32_32x32x16_bf16 v[16:31], v[96:99], v[68:71], v[16:31]
    ds_read_b64_tr_b16 v[116:117], v140 offset:15360
    ds_read_b64_tr_b16 v[118:119], v140 offset:17920
    ds_read_b128 v[76:79], v141 offset:13312
    s_waitcnt lgkmcnt(10)
    v_mfma_f32_32x32x16_bf16 v[32:47], v[100:103], v[68:71], v[32:47]
    ds_read_b64_tr_b16 v[120:121], v140 offset:15424
    ds_read_b64_tr_b16 v[122:123], v140 offset:17984
    s_waitcnt lgkmcnt(9)
    v_mfma_f32_32x32x16_bf16 v[0:15], v[104:107], v[72:75], v[0:15]
    ds_read_b64_tr_b16 v[124:125], v140 offset:15488
    ds_read_b64_tr_b16 v[126:127], v140 offset:18048
    s_waitcnt lgkmcnt(9)
    v_mfma_f32_32x32x16_bf16 v[16:31], v[108:111], v[72:75], v[16:31]
    s_waitcnt lgkmcnt(7)
    v_mfma_f32_32x32x16_bf16 v[32:47], v[112:115], v[72:75], v[32:47]
    v_add_u32 v140, s64, v136
    v_add_u32 v141, s64, v137
    s_waitcnt lgkmcnt(0)
    s_barrier
    ds_read_b64_tr_b16 v[96:97], v140 offset:0
    ds_read_b64_tr_b16 v[98:99], v140 offset:2560
    ds_read_b128 v[64:67], v141 offset:0
    ds_read_b64_tr_b16 v[100:101], v140 offset:64
    ds_read_b64_tr_b16 v[102:103], v140 offset:2624
    v_mfma_f32_32x32x16_bf16 v[0:15], v[116:119], v[76:79], v[0:15]
    ds_read_b64_tr_b16 v[104:105], v140 offset:128
    ds_read_b64_tr_b16 v[106:107], v140 offset:2688
    v_mfma_f32_32x32x16_bf16 v[16:31], v[120:123], v[76:79], v[16:31]
    ds_read_b64_tr_b16 v[108:109], v140 offset:5120
    ds_read_b64_tr_b16 v[110:111], v140 offset:7680
    ds_read_b128 v[68:71], v141 offset:4096
    v_mfma_f32_32x32x16_bf16 v[32:47], v[124:127], v[76:79], v[32:47]
    ds_read_b64_tr_b16 v[112:113], v140 offset:5184
    ds_read_b64_tr_b16 v[114:115], v140 offset:7744
    s_waitcnt lgkmcnt(9)
    v_mfma_f32_32x32x16_bf16 v[0:15], v[96:99], v[64:67], v[0:15]
    ds_read_b64_tr_b16 v[116:117], v140 offset:5248
    ds_read_b64_tr_b16 v[118:119], v140 offset:7808
    s_waitcnt lgkmcnt(9)
    v_mfma_f32_32x32x16_bf16 v[16:31], v[100:103], v[64:67], v[16:31]
    ds_read_b64_tr_b16 v[120:121], v140 offset:10240
    ds_read_b64_tr_b16 v[122:123], v140 offset:12800
    ds_read_b128 v[72:75], v141 offset:9216
    s_waitcnt lgkmcnt(10)
    v_mfma_f32_32x32x16_bf16 v[32:47], v[104:107], v[64:67], v[32:47]
    ds_read_b64_tr_b16 v[124:125], v140 offset:10304
    ds_read_b64_tr_b16 v[126:127], v140 offset:12864
    s_waitcnt lgkmcnt(9)
    v_mfma_f32_32x32x16_bf16 v[0:15], v[108:111], v[68:71], v[0:15]
    ds_read_b64_tr_b16 v[96:97], v140 offset:10368
    ds_read_b64_tr_b16 v[98:99], v140 offset:12928
    s_waitcnt lgkmcnt(9)
    v_mfma_f32_32x32x16_bf16 v[16:31], v[112:115], v[68:71], v[16:31]
    ds_read_b64_tr_b16 v[100:101], v140 offset:15360
    ds_read_b64_tr_b16 v[102:103], v140 offset:17920
    ds_read_b128 v[76:79], v141 offset:13312
    s_waitcnt lgkmcnt(10)
    v_mfma_f32_32x32x16_bf16 v[32:47], v[116:119], v[68:71], v[32:47]
    ds_read_b64_tr_b16 v[104:105], v140 offset:15424
    ds_read_b64_tr_b16 v[106:107], v140 offset:17984
    s_waitcnt lgkmcnt(9)
    v_mfma_f32_32x32x16_bf16 v[0:15], v[120:123], v[72:75], v[0:15]
    ds_read_b64_tr_b16 v[108:109], v140 offset:15488
    ds_read_b64_tr_b16 v[110:111], v140 offset:18048
    s_waitcnt lgkmcnt(9)
    v_mfma_f32_32x32x16_bf16 v[16:31], v[124:127], v[72:75], v[16:31]
    s_waitcnt lgkmcnt(7)
    v_mfma_f32_32x32x16_bf16 v[32:47], v[96:99], v[72:75], v[32:47]
    v_add_u32 v140, s65, v136
    v_add_u32 v141, s65, v137
    s_waitcnt lgkmcnt(0)
    s_barrier
    ds_read_b64_tr_b16 v[112:113], v140 offset:0
    ds_read_b64_tr_b16 v[114:115], v140 offset:2560
    ds_read_b128 v[64:67], v141 offset:0
    ds_read_b64_tr_b16 v[116:117], v140 offset:64
    ds_read_b64_tr_b16 v[118:119], v140 offset:2624
    v_mfma_f32_32x32x16_bf16 v[0:15], v[100:103], v[76:79], v[0:15]
    ds_read_b64_tr_b16 v[120:121], v140 offset:128
    ds_read_b64_tr_b16 v[122:123], v140 offset:2688
    v_mfma_f32_32x32x16_bf16 v[16:31], v[104:107], v[76:79], v[16:31]
    ds_read_b64_tr_b16 v[124:125], v140 offset:5120
    ds_read_b64_tr_b16 v[126:127], v140 offset:7680
    ds_read_b128 v[68:71], v141 offset:4096
    v_mfma_f32_32x32x16_bf16 v[32:47], v[108:111], v[76:79], v[32:47]
    ds_read_b64_tr_b16 v[96:97], v140 offset:5184
    ds_read_b64_tr_b16 v[98:99], v140 offset:7744
    s_waitcnt lgkmcnt(9)
    v_mfma_f32_32x32x16_bf16 v[0:15], v[112:115], v[64:67], v[0:15]
    ds_read_b64_tr_b16 v[100:101], v140 offset:5248
    ds_read_b64_tr_b16 v[102:103], v140 offset:7808
    s_waitcnt lgkmcnt(9)
    v_mfma_f32_32x32x16_bf16 v[16:31], v[116:119], v[64:67], v[16:31]
    ds_read_b64_tr_b16 v[104:105], v140 offset:10240
    ds_read_b64_tr_b16 v[106:107], v140 offset:12800
    ds_read_b128 v[72:75], v141 offset:9216
    s_waitcnt lgkmcnt(10)
    v_mfma_f32_32x32x16_bf16 v[32:47], v[120:123], v[64:67], v[32:47]
    ds_read_b64_tr_b16 v[108:109], v140 offset:10304
    ds_read_b64_tr_b16 v[110:111], v140 offset:12864
    s_waitcnt lgkmcnt(9)
    v_mfma_f32_32x32x16_bf16 v[0:15], v[124:127], v[68:71], v[0:15]
    ds_read_b64_tr_b16 v[112:113], v140 offset:10368
    ds_read_b64_tr_b16 v[114:115], v140 offset:12928
    s_waitcnt lgkmcnt(9)
    v_mfma_f32_32x32x16_bf16 v[16:31], v[96:99], v[68:71], v[16:31]
    ds_read_b64_tr_b16 v[116:117], v140 offset:15360
    ds_read_b64_tr_b16 v[118:119], v140 offset:17920
    ds_read_b128 v[76:79], v141 offset:13312
    s_waitcnt lgkmcnt(10)
    v_mfma_f32_32x32x16_bf16 v[32:47], v[100:103], v[68:71], v[32:47]
    ds_read_b64_tr_b16 v[120:121], v140 offset:15424
    ds_read_b64_tr_b16 v[122:123], v140 offset:17984
    s_waitcnt lgkmcnt(9)
    v_mfma_f32_32x32x16_bf16 v[0:15], v[104:107], v[72:75], v[0:15]
    ds_read_b64_tr_b16 v[124:125], v140 offset:15488
    ds_read_b64_tr_b16 v[126:127], v140 offset:18048
    s_waitcnt lgkmcnt(9)
    v_mfma_f32_32x32x16_bf16 v[16:31], v[108:111], v[72:75], v[16:31]
    s_waitcnt lgkmcnt(7)
    v_mfma_f32_32x32x16_bf16 v[32:47], v[112:115], v[72:75], v[32:47]
    v_add_u32 v140, s66, v136
    v_add_u32 v141, s66, v137
    s_waitcnt lgkmcnt(0)
    s_barrier
    ds_read_b64_tr_b16 v[96:97], v140 offset:0
    ds_read_b64_tr_b16 v[98:99], v140 offset:2560
    ds_read_b128 v[64:67], v141 offset:0
    ds_read_b64_tr_b16 v[100:101], v140 offset:64
    ds_read_b64_tr_b16 v[102:103], v140 offset:2624
    v_mfma_f32_32x32x16_bf16 v[0:15], v[116:119], v[76:79], v[0:15]
    ds_read_b64_tr_b16 v[104:105], v140 offset:128
    ds_read_b64_tr_b16 v[106:107], v140 offset:2688
    v_mfma_f32_32x32x16_bf16 v[16:31], v[120:123], v[76:79], v[16:31]
    ds_read_b64_tr_b16 v[108:109], v140 offset:5120
    ds_read_b64_tr_b16 v[110:111], v140 offset:7680
    ds_read_b128 v[68:71], v141 offset:4096
    v_mfma_f32_32x32x16_bf16 v[32:47], v[124:127], v[76:79], v[32:47]
    ds_read_b64_tr_b16 v[112:113], v140 offset:5184
    ds_read_b64_tr_b16 v[114:115], v140 offset:7744
    s_waitcnt lgkmcnt(9)
    v_mfma_f32_32x32x16_bf16 v[0:15], v[96:99], v[64:67], v[0:15]
    ds_read_b64_tr_b16 v[116:117], v140 offset:5248
    ds_read_b64_tr_b16 v[118:119], v140 offset:7808
    s_waitcnt lgkmcnt(9)
    v_mfma_f32_32x32x16_bf16 v[16:31], v[100:103], v[64:67], v[16:31]
    ds_read_b64_tr_b16 v[120:121], v140 offset:10240
    ds_read_b64_tr_b16 v[122:123], v140 offset:12800
    ds_read_b128 v[72:75], v141 offset:9216
    s_waitcnt lgkmcnt(10)
    v_mfma_f32_32x32x16_bf16 v[32:47], v[104:107], v[64:67], v[32:47]
    ds_read_b64_tr_b16 v[124:125], v140 offset:10304
    ds_read_b64_tr_b16 v[126:127], v140 offset:12864
    s_waitcnt lgkmcnt(9)
    v_mfma_f32_32x32x16_bf16 v[0:15], v[108:111], v[68:71], v[0:15]
    ds_read_b64_tr_b16 v[96:97], v140 offset:10368
    ds_read_b64_tr_b16 v[98:99], v140 offset:12928
    s_waitcnt lgkmcnt(9)
    v_mfma_f32_32x32x16_bf16 v[16:31], v[112:115], v[68:71], v[16:31]
    ds_read_b64_tr_b16 v[100:101], v140 offset:15360
    ds_read_b64_tr_b16 v[102:103], v140 offset:17920
    ds_read_b128 v[76:79], v141 offset:13312
    s_waitcnt lgkmcnt(10)
    v_mfma_f32_32x32x16_bf16 v[32:47], v[116:119], v[68:71], v[32:47]
    ds_read_b64_tr_b16 v[104:105], v140 offset:15424
    ds_read_b64_tr_b16 v[106:107], v140 offset:17984
    s_waitcnt lgkmcnt(9)
    v_mfma_f32_32x32x16_bf16 v[0:15], v[120:123], v[72:75], v[0:15]
    ds_read_b64_tr_b16 v[108:109], v140 offset:15488
    ds_read_b64_tr_b16 v[110:111], v140 offset:18048
    s_waitcnt lgkmcnt(9)
    v_mfma_f32_32x32x16_bf16 v[16:31], v[124:127], v[72:75], v[16:31]
    s_waitcnt lgkmcnt(7)
    v_mfma_f32_32x32x16_bf16 v[32:47], v[96:99], v[72:75], v[32:47]
    v_add_u32 v140, s67, v136
    v_add_u32 v141, s67, v137
    s_waitcnt lgkmcnt(0)
    s_barrier
    ds_read_b64_tr_b16 v[112:113], v140 offset:0
    ds_read_b64_tr_b16 v[114:115], v140 offset:2560
    ds_read_b128 v[64:67], v141 offset:0
    ds_read_b64_tr_b16 v[116:117], v140 offset:64
    ds_read_b64_tr_b16 v[118:119], v140 offset:2624
    v_mfma_f32_32x32x16_bf16 v[0:15], v[100:103], v[76:79], v[0:15]
    ds_read_b64_tr_b16 v[120:121], v140 offset:128
    ds_read_b64_tr_b16 v[122:123], v140 offset:2688
    v_mfma_f32_32x32x16_bf16 v[16:31], v[104:107], v[76:79], v[16:31]
    ds_read_b64_tr_b16 v[124:125], v140 offset:5120
    ds_read_b64_tr_b16 v[126:127], v140 offset:7680
    ds_read_b128 v[68:71], v141 offset:4096
    v_mfma_f32_32x32x16_bf16 v[32:47], v[108:111], v[76:79], v[32:47]
    ds_read_b64_tr_b16 v[96:97], v140 offset:5184
    ds_read_b64_tr_b16 v[98:99], v140 offset:7744
    s_waitcnt lgkmcnt(9)
    v_mfma_f32_32x32x16_bf16 v[0:15], v[112:115], v[64:67], v[0:15]
    ds_read_b64_tr_b16 v[100:101], v140 offset:5248
    ds_read_b64_tr_b16 v[102:103], v140 offset:7808
    s_waitcnt lgkmcnt(9)
    v_mfma_f32_32x32x16_bf16 v[16:31], v[116:119], v[64:67], v[16:31]
    ds_read_b64_tr_b16 v[104:105], v140 offset:10240
    ds_read_b64_tr_b16 v[106:107], v140 offset:12800
    ds_read_b128 v[72:75], v141 offset:9216
    s_waitcnt lgkmcnt(10)
    v_mfma_f32_32x32x16_bf16 v[32:47], v[120:123], v[64:67], v[32:47]
    ds_read_b64_tr_b16 v[108:109], v140 offset:10304
    ds_read_b64_tr_b16 v[110:111], v140 offset:12864
    s_waitcnt lgkmcnt(9)
    v_mfma_f32_32x32x16_bf16 v[0:15], v[124:127], v[68:71], v[0:15]
    ds_read_b64_tr_b16 v[112:113], v140 offset:10368
    ds_read_b64_tr_b16 v[114:115], v140 offset:12928
    s_waitcnt lgkmcnt(9)
    v_mfma_f32_32x32x16_bf16 v[16:31], v[96:99], v[68:71], v[16:31]
    ds_read_b64_tr_b16 v[116:117], v140 offset:15360
    ds_read_b64_tr_b16 v[118:119], v140 offset:17920
    ds_read_b128 v[76:79], v141 offset:13312
    s_waitcnt lgkmcnt(10)
    v_mfma_f32_32x32x16_bf16 v[32:47], v[100:103], v[68:71], v[32:47]
    ds_read_b64_tr_b16 v[120:121], v140 offset:15424
    ds_read_b64_tr_b16 v[122:123], v140 offset:17984
    s_waitcnt lgkmcnt(9)
    v_mfma_f32_32x32x16_bf16 v[0:15], v[104:107], v[72:75], v[0:15]
    ds_read_b64_tr_b16 v[124:125], v140 offset:15488
    ds_read_b64_tr_b16 v[126:127], v140 offset:18048
    s_waitcnt lgkmcnt(9)
    v_mfma_f32_32x32x16_bf16 v[16:31], v[108:111], v[72:75], v[16:31]
    s_waitcnt lgkmcnt(7)
    v_mfma_f32_32x32x16_bf16 v[32:47], v[112:115], v[72:75], v[32:47]
    v_add_u32 v140, s64, v136
    v_add_u32 v141, s64, v137
    s_waitcnt lgkmcnt(0)
    s_barrier
    ds_read_b64_tr_b16 v[96:97], v140 offset:0
    ds_read_b64_tr_b16 v[98:99], v140 offset:2560
    ds_read_b128 v[64:67], v141 offset:0
    ds_read_b64_tr_b16 v[100:101], v140 offset:64
    ds_read_b64_tr_b16 v[102:103], v140 offset:2624
    v_mfma_f32_32x32x16_bf16 v[0:15], v[116:119], v[76:79], v[0:15]
    ds_read_b64_tr_b16 v[104:105], v140 offset:128
    ds_read_b64_tr_b16 v[106:107], v140 offset:2688
    v_mfma_f32_32x32x16_bf16 v[16:31], v[120:123], v[76:79], v[16:31]
    ds_read_b64_tr_b16 v[108:109], v140 offset:5120
    ds_read_b64_tr_b16 v[110:111], v140 offset:7680
    ds_read_b128 v[68:71], v141 offset:4096
    v_mfma_f32_32x32x16_bf16 v[32:47], v[124:127], v[76:79], v[32:47]
    ds_read_b64_tr_b16 v[112:113], v140 offset:5184
    ds_read_b64_tr_b16 v[114:115], v140 offset:7744
    s_waitcnt lgkmcnt(9)
    v_mfma_f32_32x32x16_bf16 v[0:15], v[96:99], v[64:67], v[0:15]
    ds_read_b64_tr_b16 v[116:117], v140 offset:5248
    ds_read_b64_tr_b16 v[118:119], v140 offset:7808
    s_waitcnt lgkmcnt(9)
    v_mfma_f32_32x32x16_bf16 v[16:31], v[100:103], v[64:67], v[16:31]
    ds_read_b64_tr_b16 v[120:121], v140 offset:10240
    ds_read_b64_tr_b16 v[122:123], v140 offset:12800
    ds_read_b128 v[72:75], v141 offset:9216
    s_waitcnt lgkmcnt(10)
    v_mfma_f32_32x32x16_bf16 v[32:47], v[104:107], v[64:67], v[32:47]
    ds_read_b64_tr_b16 v[124:125], v140 offset:10304
    ds_read_b64_tr_b16 v[126:127], v140 offset:12864
    s_waitcnt lgkmcnt(9)
    v_mfma_f32_32x32x16_bf16 v[0:15], v[108:111], v[68:71], v[0:15]
    ds_read_b64_tr_b16 v[96:97], v140 offset:10368
    ds_read_b64_tr_b16 v[98:99], v140 offset:12928
    s_waitcnt lgkmcnt(9)
    v_mfma_f32_32x32x16_bf16 v[16:31], v[112:115], v[68:71], v[16:31]
    ds_read_b64_tr_b16 v[100:101], v140 offset:15360
    ds_read_b64_tr_b16 v[102:103], v140 offset:17920
    ds_read_b128 v[76:79], v141 offset:13312
    s_waitcnt lgkmcnt(10)
    v_mfma_f32_32x32x16_bf16 v[32:47], v[116:119], v[68:71], v[32:47]
    ds_read_b64_tr_b16 v[104:105], v140 offset:15424
    ds_read_b64_tr_b16 v[106:107], v140 offset:17984
    s_waitcnt lgkmcnt(9)
    v_mfma_f32_32x32x16_bf16 v[0:15], v[120:123], v[72:75], v[0:15]
    ds_read_b64_tr_b16 v[108:109], v140 offset:15488
    ds_read_b64_tr_b16 v[110:111], v140 offset:18048
    s_waitcnt lgkmcnt(9)
    v_mfma_f32_32x32x16_bf16 v[16:31], v[124:127], v[72:75], v[16:31]
    s_waitcnt lgkmcnt(7)
    v_mfma_f32_32x32x16_bf16 v[32:47], v[96:99], v[72:75], v[32:47]
    v_add_u32 v140, s65, v136
    v_add_u32 v141, s65, v137
    s_waitcnt lgkmcnt(0)
    s_barrier
    ds_read_b64_tr_b16 v[112:113], v140 offset:0
    ds_read_b64_tr_b16 v[114:115], v140 offset:2560
    ds_read_b128 v[64:67], v141 offset:0
    ds_read_b64_tr_b16 v[116:117], v140 offset:64
    ds_read_b64_tr_b16 v[118:119], v140 offset:2624
    v_mfma_f32_32x32x16_bf16 v[0:15], v[100:103], v[76:79], v[0:15]
    ds_read_b64_tr_b16 v[120:121], v140 offset:128
    ds_read_b64_tr_b16 v[122:123], v140 offset:2688
    v_mfma_f32_32x32x16_bf16 v[16:31], v[104:107], v[76:79], v[16:31]
    ds_read_b64_tr_b16 v[124:125], v140 offset:5120
    ds_read_b64_tr_b16 v[126:127], v140 offset:7680
    ds_read_b128 v[68:71], v141 offset:4096
    v_mfma_f32_32x32x16_bf16 v[32:47], v[108:111], v[76:79], v[32:47]
    ds_read_b64_tr_b16 v[96:97], v140 offset:5184
    ds_read_b64_tr_b16 v[98:99], v140 offset:7744
    s_waitcnt lgkmcnt(9)
    v_mfma_f32_32x32x16_bf16 v[0:15], v[112:115], v[64:67], v[0:15]
    ds_read_b64_tr_b16 v[100:101], v140 offset:5248
    ds_read_b64_tr_b16 v[102:103], v140 offset:7808
    s_waitcnt lgkmcnt(9)
    v_mfma_f32_32x32x16_bf16 v[16:31], v[116:119], v[64:67], v[16:31]
    ds_read_b64_tr_b16 v[104:105], v140 offset:10240
    ds_read_b64_tr_b16 v[106:107], v140 offset:12800
    ds_read_b128 v[72:75], v141 offset:9216
    s_waitcnt lgkmcnt(10)
    v_mfma_f32_32x32x16_bf16 v[32:47], v[120:123], v[64:67], v[32:47]
    ds_read_b64_tr_b16 v[108:109], v140 offset:10304
    ds_read_b64_tr_b16 v[110:111], v140 offset:12864
    s_waitcnt lgkmcnt(9)
    v_mfma_f32_32x32x16_bf16 v[0:15], v[124:127], v[68:71], v[0:15]
    ds_read_b64_tr_b16 v[112:113], v140 offset:10368
    ds_read_b64_tr_b16 v[114:115], v140 offset:12928
    s_waitcnt lgkmcnt(9)
    v_mfma_f32_32x32x16_bf16 v[16:31], v[96:99], v[68:71], v[16:31]
    ds_read_b64_tr_b16 v[116:117], v140 offset:15360
    ds_read_b64_tr_b16 v[118:119], v140 offset:17920
    ds_read_b128 v[76:79], v141 offset:13312
    s_waitcnt lgkmcnt(10)
    v_mfma_f32_32x32x16_bf16 v[32:47], v[100:103], v[68:71], v[32:47]
    ds_read_b64_tr_b16 v[120:121], v140 offset:15424
    ds_read_b64_tr_b16 v[122:123], v140 offset:17984
    s_waitcnt lgkmcnt(9)
    v_mfma_f32_32x32x16_bf16 v[0:15], v[104:107], v[72:75], v[0:15]
    ds_read_b64_tr_b16 v[124:125], v140 offset:15488
    ds_read_b64_tr_b16 v[126:127], v140 offset:18048
    s_waitcnt lgkmcnt(9)
    v_mfma_f32_32x32x16_bf16 v[16:31], v[108:111], v[72:75], v[16:31]
    s_waitcnt lgkmcnt(7)
    v_mfma_f32_32x32x16_bf16 v[32:47], v[112:115], v[72:75], v[32:47]
    v_add_u32 v140, s66, v136
    v_add_u32 v141, s66, v137
    s_waitcnt lgkmcnt(0)
    s_barrier
    ds_read_b64_tr_b16 v[96:97], v140 offset:0
    ds_read_b64_tr_b16 v[98:99], v140 offset:2560
    ds_read_b128 v[64:67], v141 offset:0
    ds_read_b64_tr_b16 v[100:101], v140 offset:64
    ds_read_b64_tr_b16 v[102:103], v140 offset:2624
    v_mfma_f32_32x32x16_bf16 v[0:15], v[116:119], v[76:79], v[0:15]
    ds_read_b64_tr_b16 v[104:105], v140 offset:128
    ds_read_b64_tr_b16 v[106:107], v140 offset:2688
    v_mfma_f32_32x32x16_bf16 v[16:31], v[120:123], v[76:79], v[16:31]
    ds_read_b64_tr_b16 v[108:109], v140 offset:5120
    ds_read_b64_tr_b16 v[110:111], v140 offset:7680
    ds_read_b128 v[68:71], v141 offset:4096
    v_mfma_f32_32x32x16_bf16 v[32:47], v[124:127], v[76:79], v[32:47]
    ds_read_b64_tr_b16 v[112:113], v140 offset:5184
    ds_read_b64_tr_b16 v[114:115], v140 offset:7744
    s_waitcnt lgkmcnt(9)
    v_mfma_f32_32x32x16_bf16 v[0:15], v[96:99], v[64:67], v[0:15]
    ds_read_b64_tr_b16 v[116:117], v140 offset:5248
    ds_read_b64_tr_b16 v[118:119], v140 offset:7808
    s_waitcnt lgkmcnt(9)
    v_mfma_f32_32x32x16_bf16 v[16:31], v[100:103], v[64:67], v[16:31]
    ds_read_b64_tr_b16 v[120:121], v140 offset:10240
    ds_read_b64_tr_b16 v[122:123], v140 offset:12800
    ds_read_b128 v[72:75], v141 offset:9216
    s_waitcnt lgkmcnt(10)
    v_mfma_f32_32x32x16_bf16 v[32:47], v[104:107], v[64:67], v[32:47]
    ds_read_b64_tr_b16 v[124:125], v140 offset:10304
    ds_read_b64_tr_b16 v[126:127], v140 offset:12864
    s_waitcnt lgkmcnt(9)
    v_mfma_f32_32x32x16_bf16 v[0:15], v[108:111], v[68:71], v[0:15]
    ds_read_b64_tr_b16 v[96:97], v140 offset:10368
    ds_read_b64_tr_b16 v[98:99], v140 offset:12928
    s_waitcnt lgkmcnt(9)
    v_mfma_f32_32x32x16_bf16 v[16:31], v[112:115], v[68:71], v[16:31]
    ds_read_b64_tr_b16 v[100:101], v140 offset:15360
    ds_read_b64_tr_b16 v[102:103], v140 offset:17920
    ds_read_b128 v[76:79], v141 offset:13312
    s_waitcnt lgkmcnt(10)
    v_mfma_f32_32x32x16_bf16 v[32:47], v[116:119], v[68:71], v[32:47]
    ds_read_b64_tr_b16 v[104:105], v140 offset:15424
    ds_read_b64_tr_b16 v[106:107], v140 offset:17984
    s_waitcnt lgkmcnt(9)
    v_mfma_f32_32x32x16_bf16 v[0:15], v[120:123], v[72:75], v[0:15]
    ds_read_b64_tr_b16 v[108:109], v140 offset:15488
    ds_read_b64_tr_b16 v[110:111], v140 offset:18048
    s_waitcnt lgkmcnt(9)
    v_mfma_f32_32x32x16_bf16 v[16:31], v[124:127], v[72:75], v[16:31]
    s_waitcnt lgkmcnt(7)
    v_mfma_f32_32x32x16_bf16 v[32:47], v[96:99], v[72:75], v[32:47]
    v_add_u32 v140, s67, v136
    v_add_u32 v141, s67, v137
    s_waitcnt lgkmcnt(0)
    s_barrier
    ds_read_b64_tr_b16 v[112:113], v140 offset:0
    ds_read_b64_tr_b16 v[114:115], v140 offset:2560
    ds_read_b128 v[64:67], v141 offset:0
    ds_read_b64_tr_b16 v[116:117], v140 offset:64
    ds_read_b64_tr_b16 v[118:119], v140 offset:2624
    v_mfma_f32_32x32x16_bf16 v[0:15], v[100:103], v[76:79], v[0:15]
    ds_read_b64_tr_b16 v[120:121], v140 offset:128
    ds_read_b64_tr_b16 v[122:123], v140 offset:2688
    v_mfma_f32_32x32x16_bf16 v[16:31], v[104:107], v[76:79], v[16:31]
    ds_read_b64_tr_b16 v[124:125], v140 offset:5120
    ds_read_b64_tr_b16 v[126:127], v140 offset:7680
    ds_read_b128 v[68:71], v141 offset:4096
    v_mfma_f32_32x32x16_bf16 v[32:47], v[108:111], v[76:79], v[32:47]
    ds_read_b64_tr_b16 v[96:97], v140 offset:5184
    ds_read_b64_tr_b16 v[98:99], v140 offset:7744
    s_waitcnt lgkmcnt(9)
    v_mfma_f32_32x32x16_bf16 v[0:15], v[112:115], v[64:67], v[0:15]
    ds_read_b64_tr_b16 v[100:101], v140 offset:5248
    ds_read_b64_tr_b16 v[102:103], v140 offset:7808
    s_waitcnt lgkmcnt(9)
    v_mfma_f32_32x32x16_bf16 v[16:31], v[116:119], v[64:67], v[16:31]
    ds_read_b64_tr_b16 v[104:105], v140 offset:10240
    ds_read_b64_tr_b16 v[106:107], v140 offset:12800
    ds_read_b128 v[72:75], v141 offset:9216
    s_waitcnt lgkmcnt(10)
    v_mfma_f32_32x32x16_bf16 v[32:47], v[120:123], v[64:67], v[32:47]
    ds_read_b64_tr_b16 v[108:109], v140 offset:10304
    ds_read_b64_tr_b16 v[110:111], v140 offset:12864
    s_waitcnt lgkmcnt(9)
    v_mfma_f32_32x32x16_bf16 v[0:15], v[124:127], v[68:71], v[0:15]
    ds_read_b64_tr_b16 v[112:113], v140 offset:10368
    ds_read_b64_tr_b16 v[114:115], v140 offset:12928
    s_waitcnt lgkmcnt(9)
    v_mfma_f32_32x32x16_bf16 v[16:31], v[96:99], v[68:71], v[16:31]
    ds_read_b64_tr_b16 v[116:117], v140 offset:15360
    ds_read_b64_tr_b16 v[118:119], v140 offset:17920
    ds_read_b128 v[76:79], v141 offset:13312
    s_waitcnt lgkmcnt(10)
    v_mfma_f32_32x32x16_bf16 v[32:47], v[100:103], v[68:71], v[32:47]
    ds_read_b64_tr_b16 v[120:121], v140 offset:15424
    ds_read_b64_tr_b16 v[122:123], v140 offset:17984
    s_waitcnt lgkmcnt(9)
    v_mfma_f32_32x32x16_bf16 v[0:15], v[104:107], v[72:75], v[0:15]
    ds_read_b64_tr_b16 v[124:125], v140 offset:15488
    ds_read_b64_tr_b16 v[126:127], v140 offset:18048
    s_waitcnt lgkmcnt(9)
    v_mfma_f32_32x32x16_bf16 v[16:31], v[108:111], v[72:75], v[16:31]
    s_waitcnt lgkmcnt(7)
    v_mfma_f32_32x32x16_bf16 v[32:47], v[112:115], v[72:75], v[32:47]
    s_waitcnt lgkmcnt(4)
    v_mfma_f32_32x32x16_bf16 v[0:15], v[116:119], v[76:79], v[0:15]
    s_waitcnt lgkmcnt(2)
    v_mfma_f32_32x32x16_bf16 v[16:31], v[120:123], v[76:79], v[16:31]
    s_waitcnt lgkmcnt(0)
    v_mfma_f32_32x32x16_bf16 v[32:47], v[124:127], v[76:79], v[32:47]
    s_nop 7
    v_cvt_pk_bf16_f32 v0, v0, v1
    v_cvt_pk_bf16_f32 v1, v2, v3
    v_cvt_pk_bf16_f32 v2, v4, v5
    v_cvt_pk_bf16_f32 v3, v6, v7
    s_mov_b32 s52, 0x0
    buffer_store_dwordx4 v[0:3], v177, s[16:19], s52 offen offset:0 sc1
    v_cvt_pk_bf16_f32 v8, v8, v9
    v_cvt_pk_bf16_f32 v9, v10, v11
    v_cvt_pk_bf16_f32 v10, v12, v13
    v_cvt_pk_bf16_f32 v11, v14, v15
    s_mov_b32 s52, 0x0
    buffer_store_dwordx4 v[8:11], v177, s[16:19], s52 offen offset:1024 sc1
    v_cvt_pk_bf16_f32 v16, v16, v17
    v_cvt_pk_bf16_f32 v17, v18, v19
    v_cvt_pk_bf16_f32 v18, v20, v21
    v_cvt_pk_bf16_f32 v19, v22, v23
    s_mov_b32 s52, 0x2000
    buffer_store_dwordx4 v[16:19], v177, s[16:19], s52 offen offset:0 sc1
    v_cvt_pk_bf16_f32 v24, v24, v25
    v_cvt_pk_bf16_f32 v25, v26, v27
    v_cvt_pk_bf16_f32 v26, v28, v29
    v_cvt_pk_bf16_f32 v27, v30, v31
    s_mov_b32 s52, 0x2000
    buffer_store_dwordx4 v[24:27], v177, s[16:19], s52 offen offset:1024 sc1
    v_cvt_pk_bf16_f32 v32, v32, v33
    v_cvt_pk_bf16_f32 v33, v34, v35
    v_cvt_pk_bf16_f32 v34, v36, v37
    v_cvt_pk_bf16_f32 v35, v38, v39
    s_mov_b32 s52, 0x4000
    buffer_store_dwordx4 v[32:35], v177, s[16:19], s52 offen offset:0 sc1
    v_cvt_pk_bf16_f32 v40, v40, v41
    v_cvt_pk_bf16_f32 v41, v42, v43
    v_cvt_pk_bf16_f32 v42, v44, v45
    v_cvt_pk_bf16_f32 v43, v46, v47
    s_mov_b32 s52, 0x4000
    buffer_store_dwordx4 v[40:43], v177, s[16:19], s52 offen offset:1024 sc1
SYNC:
    s_lshr_b32 s53, s73, 1
    s_lshl_b32 s52, s73, 2
    s_add_u32 s53, s53, s52
    s_lshl_b32 s53, s53, 6
    s_mul_i32 s51, s39, 331776
    s_mul_i32 s52, s41, 1152
    s_add_u32 s52, s52, s53
    s_add_u32 s51, s51, s52
    s_add_u32 s4, s76, s51
    s_addc_u32 s5, s77, 0
    s_sub_u32 s6, 331776, s52
    s_mov_b32 s7, 0x20000
    s_and_b32 s42, s73, 1
    s_lshl_b32 s51, s36, 6
    s_add_u32 s51, s51, 0
    v_add_u32 v165, s51, v254
    v_mov_b32 v162, 0x2d0
    v_cmp_gt_u32 s[54:55], v162, v165
    s_mul_i32 s51, s72, 720
    v_add_u32 v128, s51, v165
    v_lshlrev_b32 v130, 4, v128
    v_lshrrev_b32 v160, 6, v128
    v_and_b32 v161, 63, v128
    v_cmp_gt_u32 vcc, 40, v160
    v_bfe_u32 v162, v160, 1, 2
    v_and_b32 v165, 31, v161
    v_lshl_add_u32 v162, v162, 5, v165
    v_lshrrev_b32 v164, 3, v160
    v_lshlrev_b32 v163, 5, v164
    v_and_b32 v165, 1, v160
    v_lshl_add_u32 v163, v165, 4, v163
    v_lshrrev_b32 v165, 5, v161
    v_lshl_add_u32 v163, v165, 2, v163
    v_mul_u32_u24 v162, 0x900, v162
    v_lshl_add_u32 v132, v163, 1, v162
    v_and_b32 v162, 15, v161
    v_add_u32 v162, 0x80, v162
    v_mul_u32_u24 v162, 0x900, v162
    v_subrev_u32 v160, 40, v160
    v_lshlrev_b32 v163, 5, v160
    v_lshrrev_b32 v165, 4, v161
    v_lshl_add_u32 v163, v165, 2, v163
    v_lshl_add_u32 v162, v163, 1, v162
    v_cndmask_b32 v132, v162, v132, vcc
    v_cndmask_b32 v160, v160, v164, vcc
    v_mov_b32 v165, 32
    v_mov_b32 v164, 16
    v_cndmask_b32 v164, v165, v164, vcc
    v_cmp_le_u32 vcc, s42, v160
    s_nop 0
    s_and_b64 s[54:55], s[54:55], vcc
    v_mov_b32 v165, 0x7f000000
    v_cndmask_b32 v132, v165, v132, s[54:55]
    v_cndmask_b32 v130, v165, v130, s[54:55]
    v_add_u32 v133, v132, v164
    s_lshl_b32 s51, s36, 6
    s_add_u32 s51, s51, 512
    v_add_u32 v165, s51, v254
    v_mov_b32 v162, 0x2d0
    v_cmp_gt_u32 s[54:55], v162, v165
    s_mul_i32 s51, s72, 720
    v_add_u32 v128, s51, v165
    v_lshlrev_b32 v131, 4, v128
    v_lshrrev_b32 v160, 6, v128
    v_and_b32 v161, 63, v128
    v_cmp_gt_u32 vcc, 40, v160
    v_bfe_u32 v162, v160, 1, 2
    v_and_b32 v165, 31, v161
    v_lshl_add_u32 v162, v162, 5, v165
    v_lshrrev_b32 v164, 3, v160
    v_lshlrev_b32 v163, 5, v164
    v_and_b32 v165, 1, v160
    v_lshl_add_u32 v163, v165, 4, v163
    v_lshrrev_b32 v165, 5, v161
    v_lshl_add_u32 v163, v165, 2, v163
    v_mul_u32_u24 v162, 0x900, v162
    v_lshl_add_u32 v134, v163, 1, v162
    v_and_b32 v162, 15, v161
    v_add_u32 v162, 0x80, v162
    v_mul_u32_u24 v162, 0x900, v162
    v_subrev_u32 v160, 40, v160
    v_lshlrev_b32 v163, 5, v160
    v_lshrrev_b32 v165, 4, v161
    v_lshl_add_u32 v163, v165, 2, v163
    v_lshl_add_u32 v162, v163, 1, v162
    v_cndmask_b32 v134, v162, v134, vcc
    v_cndmask_b32 v160, v160, v164, vcc
    v_mov_b32 v165, 32
    v_mov_b32 v164, 16
    v_cndmask_b32 v164, v165, v164, vcc
    v_cmp_le_u32 vcc, s42, v160
    s_nop 0
    s_and_b64 s[54:55], s[54:55], vcc
    v_mov_b32 v165, 0x7f000000
    v_cndmask_b32 v134, v165, v134, s[54:55]
    v_cndmask_b32 v131, v165, v131, s[54:55]
    v_add_u32 v135, v134, v164
    s_waitcnt vmcnt(0)
    s_barrier
    s_cmp_lg_u32 s36, 0
    s_cbranch_scc1 NOPUB2
    v_mov_b32 v183, 2
    buffer_store_dword v183, v180, s[96:99], 0 offen sc1
    v_mov_b32 v184, 0x100
    s_mov_b64 exec, 1
    buffer_atomic_add v184, v186, s[8:11], 0 offen sc1
    s_mov_b64 exec, -1
NOPUB2:
    s_mov_b32 s50, 3000
RTP2:
    buffer_load_dword v184, v182, s[96:99], 0 offen sc1
    s_waitcnt vmcnt(0)
    v_cmp_gt_u32 vcc, 2, v184
    s_cbranch_vccz OKP2
    s_sleep 2
    s_sub_u32 s50, s50, 1
    s_cmp_lg_u32 s50, 0
    s_cbranch_scc1 RTP2
    s_mov_b32 s50, 100000
RTQ2:
    buffer_load_dword v184, v186, s[8:11], 0 offen sc1
    s_waitcnt vmcnt(0)
    v_bfe_u32 v184, v184, 8, 8
    v_cmp_gt_u32 vcc, 4, v184
    s_cbranch_vccz OKP2
    s_sleep 8
    s_sub_u32 s50, s50, 1
    s_cmp_lg_u32 s50, 0
    s_cbranch_scc1 RTQ2
OKP2:
    s_mov_b32 s52, 0
    buffer_load_dwordx4 v[0:3], v130, s[32:35], s52 offen sc1
    s_mov_b32 s52, 184320
    buffer_load_dwordx4 v[4:7], v130, s[32:35], s52 offen sc1
    s_mov_b32 s52, 368640
    buffer_load_dwordx4 v[8:11], v130, s[32:35], s52 offen sc1
    s_mov_b32 s52, 552960
    buffer_load_dwordx4 v[12:15], v130, s[32:35], s52 offen sc1
    s_mov_b32 s52, 0
    buffer_load_dwordx4 v[16:19], v131, s[32:35], s52 offen sc1
    s_mov_b32 s52, 184320
    buffer_load_dwordx4 v[20:23], v131, s[32:35], s52 offen sc1
    s_mov_b32 s52, 368640
    buffer_load_dwordx4 v[24:27], v131, s[32:35], s52 offen sc1
    s_mov_b32 s52, 552960
    buffer_load_dwordx4 v[28:31], v131, s[32:35], s52 offen sc1
    s_mov_b32 s52, 0x3f80
    s_mov_b32 s53, 0x3f800000
    s_waitcnt vmcnt(7)
    v_dot2_f32_bf16 v136, v0, s52, 0
    v_dot2_f32_bf16 v137, v0, s53, 0
    v_dot2_f32_bf16 v138, v1, s52, 0
    v_dot2_f32_bf16 v139, v1, s53, 0
    v_dot2_f32_bf16 v140, v2, s52, 0
    v_dot2_f32_bf16 v141, v2, s53, 0
    v_dot2_f32_bf16 v142, v3, s52, 0
    v_dot2_f32_bf16 v143, v3, s53, 0
    s_waitcnt vmcnt(6)
    v_dot2_f32_bf16 v136, v4, s52, v136
    v_dot2_f32_bf16 v137, v4, s53, v137
    v_dot2_f32_bf16 v138, v5, s52, v138
    v_dot2_f32_bf16 v139, v5, s53, v139
    v_dot2_f32_bf16 v140, v6, s52, v140
    v_dot2_f32_bf16 v141, v6, s53, v141
    v_dot2_f32_bf16 v142, v7, s52, v142
    v_dot2_f32_bf16 v143, v7, s53, v143
    s_waitcnt vmcnt(5)
    v_dot2_f32_bf16 v136, v8, s52, v136
    v_dot2_f32_bf16 v137, v8, s53, v137
    v_dot2_f32_bf16 v138, v9, s52, v138
    v_dot2_f32_bf16 v139, v9, s53, v139
    v_dot2_f32_bf16 v140, v10, s52, v140
    v_dot2_f32_bf16 v141, v10, s53, v141
    v_dot2_f32_bf16 v142, v11, s52, v142
    v_dot2_f32_bf16 v143, v11, s53, v143
    s_waitcnt vmcnt(4)
    v_dot2_f32_bf16 v136, v12, s52, v136
    v_dot2_f32_bf16 v137, v12, s53, v137
    v_dot2_f32_bf16 v138, v13, s52, v138
    v_dot2_f32_bf16 v139, v13, s53, v139
    v_dot2_f32_bf16 v140, v14, s52, v140
    v_dot2_f32_bf16 v141, v14, s53, v141
    v_dot2_f32_bf16 v142, v15, s52, v142
    v_dot2_f32_bf16 v143, v15, s53, v143
    v_cvt_pk_bf16_f32 v144, v136, v137
    v_cvt_pk_bf16_f32 v145, v138, v139
    v_cvt_pk_bf16_f32 v146, v140, v141
    v_cvt_pk_bf16_f32 v147, v142, v143
    buffer_store_dwordx2 v[144:145], v132, s[4:7], 0 offen
    buffer_store_dwordx2 v[146:147], v133, s[4:7], 0 offen
    s_waitcnt vmcnt(5)
    v_dot2_f32_bf16 v148, v16, s52, 0
    v_dot2_f32_bf16 v149, v16, s53, 0
    v_dot2_f32_bf16 v150, v17, s52, 0
    v_dot2_f32_bf16 v151, v17, s53, 0
    v_dot2_f32_bf16 v152, v18, s52, 0
    v_dot2_f32_bf16 v153, v18, s53, 0
    v_dot2_f32_bf16 v154, v19, s52, 0
    v_dot2_f32_bf16 v155, v19, s53, 0
    s_waitcnt vmcnt(4)
    v_dot2_f32_bf16 v148, v20, s52, v148
    v_dot2_f32_bf16 v149, v20, s53, v149
    v_dot2_f32_bf16 v150, v21, s52, v150
    v_dot2_f32_bf16 v151, v21, s53, v151
    v_dot2_f32_bf16 v152, v22, s52, v152
    v_dot2_f32_bf16 v153, v22, s53, v153
    v_dot2_f32_bf16 v154, v23, s52, v154
    v_dot2_f32_bf16 v155, v23, s53, v155
    s_waitcnt vmcnt(3)
    v_dot2_f32_bf16 v148, v24, s52, v148
    v_dot2_f32_bf16 v149, v24, s53, v149
    v_dot2_f32_bf16 v150, v25, s52, v150
    v_dot2_f32_bf16 v151, v25, s53, v151
    v_dot2_f32_bf16 v152, v26, s52, v152
    v_dot2_f32_bf16 v153, v26, s53, v153
    v_dot2_f32_bf16 v154, v27, s52, v154
    v_dot2_f32_bf16 v155, v27, s53, v155
    s_waitcnt vmcnt(2)
    v_dot2_f32_bf16 v148, v28, s52, v148
    v_dot2_f32_bf16 v149, v28, s53, v149
    v_dot2_f32_bf16 v150, v29, s52, v150
    v_dot2_f32_bf16 v151, v29, s53, v151
    v_dot2_f32_bf16 v152, v30, s52, v152
    v_dot2_f32_bf16 v153, v30, s53, v153
    v_dot2_f32_bf16 v154, v31, s52, v154
    v_dot2_f32_bf16 v155, v31, s53, v155
    v_cvt_pk_bf16_f32 v156, v148, v149
    v_cvt_pk_bf16_f32 v157, v150, v151
    v_cvt_pk_bf16_f32 v158, v152, v153
    v_cvt_pk_bf16_f32 v159, v154, v155
    buffer_store_dwordx2 v[156:157], v134, s[4:7], 0 offen
    buffer_store_dwordx2 v[158:159], v135, s[4:7], 0 offen
K_END:
    s_endpgm
.section .rodata,"a"
.p2align 6
.amdhsa_kernel concat_heads__gqa_block_cached__mha_block_cached__near_ridge_kernel
  .amdhsa_next_free_vgpr 256
  .amdhsa_next_free_sgpr 102
  .amdhsa_accum_offset 256
  .amdhsa_group_segment_fixed_size 0
  .amdhsa_kernarg_size 104
  .amdhsa_user_sgpr_count 2
  .amdhsa_user_sgpr_kernarg_segment_ptr 1
  .amdhsa_system_sgpr_workgroup_id_x 1
.end_amdhsa_kernel
```
